```python
import torch

def _softmax(x, axis=-1):
    return torch.softmax(x, dim=axis)
def _gelu(x):
    return torch.nn.functional.gelu(x, approximate="tanh")
def _silu(x):
    return torch.nn.functional.silu(x)
def _sigmoid(x):
    return torch.sigmoid(x)
def _layernorm(x, axis=-1, eps=1e-5):
    m = x.mean(dim=axis, keepdim=True)
    v = x.var(dim=axis, keepdim=True, unbiased=False)
    return (x - m) / torch.sqrt(v + eps)
def _scatter_add(tgt, idx, src, axis=0):
    return tgt.clone().index_add_(axis, idx, src)
def _segment_sum(src, seg, n):
    out = torch.zeros((n,) + src.shape[1:], dtype=src.dtype)
    return out.index_add_(0, seg, src)
def _pad(x, pw):
    flat = tuple(v for pair in reversed(pw) for v in pair)
    return torch.nn.functional.pad(x, flat)

kernel_name = 'standalone__mha_softmax__near_ridge'

def setup_inputs():

    _w = (lambda a: (lambda t: t.to(torch.bfloat16) if t.is_floating_point() else t)(torch.as_tensor(a)))
    B, H, Sq, Sk, D = 8, 32, 432, 2048, 128
    return {
        "q": _w((lambda *s: torch.randn(*s, dtype=torch.bfloat16) * 0.8)(B, H, Sq, D)),
        "k": _w((lambda *s: torch.randn(*s, dtype=torch.bfloat16) * 0.8)(B, H, Sk, D)),
        "v": _w((lambda *s: torch.randn(*s, dtype=torch.bfloat16) * 0.05)(B, H, Sk, D)),
    }

def reference(q, k, v):
    scale = q.shape[-1] ** -0.5
    scores = torch.einsum("bhqd,bhkd->bhqk", q, k) * scale
    p = _softmax(scores, axis=-1)
    return torch.einsum("bhqk,bhkd->bhqd", p, v)
```

```asm
; @launch grid=(256,1,1) block=(256,1,1) lds=163840
.amdgcn_target "amdgcn-amd-amdhsa--gfx950"
.text
.globl standalone__mha_softmax__near_ridge_kernel
.p2align 8
.type standalone__mha_softmax__near_ridge_kernel,@function
standalone__mha_softmax__near_ridge_kernel:
 s_cmp_ge_u32 s2, 256
 s_cbranch_scc1 L_exit
 s_load_dwordx8 s[80:87], s[0:1], 0
 v_lshrrev_b32 v4, 6, v0
 v_and_b32 v5, 63, v0
 v_readfirstlane_b32 s24, v4
 s_getpc_b64 s[90:91]
L_pc:
 s_lshr_b32 s92, s2, 3
 s_mul_i32 s92, s92, (((L_exit-L_pc+4095)>>12)<<7)
 v_and_b32 v6, 31, v0
 v_lshlrev_b32 v6, 7, v6
 v_min_u32 v6, (((L_exit-L_pc+4095)>>12)<<7)-128, v6
 v_add_u32 v6, s92, v6
 v_min_u32 v6, L_exit-L_pc-4, v6
 global_load_dword v20, v6, s[90:91]
 v_bfe_u32 v6, v5, 2, 3
 v_lshlrev_b32 v3, 8, v6
 v_lshrrev_b32 v6, 5, v5
 v_lshl_add_u32 v3, v6, 6, v3
 v_lshrrev_b32 v6, 3, v5
 v_and_b32 v6, 2, v6
 v_and_b32 v7, 3, v5
 v_xor_b32 v6, v6, v7
 v_lshl_add_u32 v3, v6, 4, v3
 s_lshl_b32 s28, s24, 11
 s_getreg_b32 s3, hwreg(HW_REG_XCC_ID, 0, 4)
 s_and_b32 s29, s2, 7
 s_lshl_b32 s29, s29, 5
 s_lshr_b32 s30, s2, 3
 s_or_b32 s29, s29, s30
 s_mul_i32 s30, s29, 110592
 s_lshl_b32 s31, s29, 19
 s_mov_b32 s6, 110592
 s_mov_b32 s18, 110592
 s_mov_b32 s10, 0x80000
 s_mov_b32 s14, 0x80000
 s_mov_b32 s7, 0x20000
 s_mov_b32 s11, 0x20000
 s_mov_b32 s15, 0x20000
 s_mov_b32 s19, 0x20000
 s_lshl_b32 s34, s24, 14
 s_add_u32 s34, s34, 98304
 s_mul_i32 s35, s24, 28672
 s_add_u32 m0, s28, 0
 s_add_u32 s36, s28, 0
 s_waitcnt lgkmcnt(0)
 s_add_u32 s8, s82, s31
 s_addc_u32 s9, s83, 0
 buffer_load_dwordx4 v3, s[8:11], s36 offen offset:0 nt lds
 v_lshlrev_b32 v6, 4, v5
 s_add_u32 s12, s84, s31
 s_addc_u32 s13, s85, 0
 buffer_load_dwordx4 v[232:235], v6, s[12:15], 0 offen
 s_add_u32 m0, s28, 896
 s_nop 0
 buffer_load_dwordx4 v3, s[8:11], s36 offen offset:128 nt lds
 s_add_u32 m0, s34, 0
 s_add_u32 s36, s35, 0
 s_add_u32 s4, s80, s30
 s_addc_u32 s5, s81, 0
 buffer_load_dwordx4 v3, s[4:7], s36 offen offset:0 nt lds
 buffer_load_dwordx4 v3, s[4:7], s36 offen offset:2048 nt lds
 s_add_u32 m0, s34, 896
 s_nop 0
 buffer_load_dwordx4 v3, s[4:7], s36 offen offset:128 nt lds
 buffer_load_dwordx4 v3, s[4:7], s36 offen offset:2176 nt lds
 s_add_u32 s16, s86, s30
 s_addc_u32 s17, s87, 0
 s_bitcmp0_b32 s3, 0
 s_cbranch_scc1 L_even
 s_add_u32 m0, s28, 8192
 s_add_u32 s36, s28, 8192
 buffer_load_dwordx4 v3, s[8:11], s36 offen offset:0 nt lds
 s_add_u32 m0, s28, 9088
 s_nop 0
 buffer_load_dwordx4 v3, s[8:11], s36 offen offset:128 nt lds
 s_add_u32 m0, s28, 16384
 s_add_u32 s36, s28, 16384
 buffer_load_dwordx4 v3, s[8:11], s36 offen offset:0 nt lds
 s_add_u32 m0, s28, 17280
 s_nop 0
 buffer_load_dwordx4 v3, s[8:11], s36 offen offset:128 nt lds
 s_add_u32 m0, s34, 4096
 s_add_u32 s36, s35, 4096
 buffer_load_dwordx4 v3, s[4:7], s36 offen offset:0 nt lds
 buffer_load_dwordx4 v3, s[4:7], s36 offen offset:2048 nt lds
 s_add_u32 m0, s34, 4992
 s_nop 0
 buffer_load_dwordx4 v3, s[4:7], s36 offen offset:128 nt lds
 buffer_load_dwordx4 v3, s[4:7], s36 offen offset:2176 nt lds
 v_bfe_u32 v6, v5, 3, 1
 v_lshlrev_b32 v0, 11, v6
 v_lshrrev_b32 v8, 5, v5
 v_lshlrev_b32 v1, 11, v8
 v_bfe_u32 v7, v5, 4, 1
 v_lshl_add_u32 v0, v7, 4, v0
 v_and_b32 v6, 7, v5
 v_lshl_add_u32 v0, v6, 6, v0
 v_bfe_u32 v6, v5, 2, 1
 v_xor_b32 v6, v6, v8
 v_lshl_add_u32 v0, v6, 5, v0
 v_bfe_u32 v6, v5, 2, 3
 v_lshl_add_u32 v1, v6, 6, v1
 v_lshl_add_u32 v1, v7, 5, v1
 v_and_b32 v6, 3, v5
 v_lshl_add_u32 v1, v6, 3, v1
 v_add_u32 v1, 65536, v1
 v_xor_b32 v2, 32, v1
 v_add_u32 v11, s34, v0
 v_mov_b32 v240, 0x3e803e80
 v_mov_b32 v241, 0x3e803e80
 v_mov_b32 v242, 0x3e803e80
 v_mov_b32 v243, 0x3e803e80
 v_bfe_u32 v6, v5, 2, 2
 v_lshrrev_b32 v7, 4, v5
 v_and_b32 v8, 1, v5
 v_lshlrev_b32 v8, 4, v8
 v_xor_b32 v6, v6, v7
 v_bfe_u32 v7, v5, 1, 1
 v_lshl_add_u32 v6, v6, 1, v7
 v_mov_b32 v9, 0x3e03
 v_mov_b32 v10, 0xb9d8
 v_lshlrev_b32 v9, v8, v9
 v_lshlrev_b32 v10, v8, v10
 v_accvgpr_write_b32 a112, 0
 v_accvgpr_write_b32 a113, 0
 v_accvgpr_write_b32 a116, 0
 v_accvgpr_write_b32 a117, 0
 v_accvgpr_write_b32 a120, 0
 v_accvgpr_write_b32 a121, 0
 v_cmp_eq_u32 vcc, 0, v6
 s_nop 1
 v_cndmask_b32 v7, 0, v9, vcc
 v_cndmask_b32 v8, 0, v10, vcc
 v_accvgpr_write_b32 a114, v7
 v_accvgpr_write_b32 a118, v8
 v_cmp_eq_u32 vcc, 1, v6
 s_nop 1
 v_cndmask_b32 v7, 0, v9, vcc
 v_cndmask_b32 v8, 0, v10, vcc
 v_accvgpr_write_b32 a115, v7
 v_accvgpr_write_b32 a119, v8
 s_mov_b32 s38, 0x3e0293ee
 s_mov_b32 s39, 0x3e0293ee
 s_mov_b32 s88, 0x3f800000
 s_mov_b32 s89, 0x7d800000
 s_waitcnt vmcnt(13)
 v_and_b32 v232, 0x7fff7fff, v232
 v_and_b32 v233, 0x7fff7fff, v233
 v_and_b32 v234, 0x7fff7fff, v234
 v_and_b32 v235, 0x7fff7fff, v235
 v_mov_b32 v236, v232
 v_mov_b32 v237, v233
 v_mov_b32 v238, v234
 v_mov_b32 v239, v235
 v_permlane32_swap_b32 v232, v236
 v_permlane32_swap_b32 v233, v237
 v_permlane32_swap_b32 v234, v238
 v_permlane32_swap_b32 v235, v239
 v_pk_max_u16 v232, v232, v236
 v_pk_max_u16 v233, v233, v237
 v_pk_max_u16 v234, v234, v238
 v_pk_max_u16 v235, v235, v239
 v_mov_b32 v236, v232
 v_mov_b32 v237, v233
 v_mov_b32 v238, v234
 v_mov_b32 v239, v235
 v_permlane16_swap_b32 v232, v236
 v_permlane16_swap_b32 v233, v237
 v_permlane16_swap_b32 v234, v238
 v_permlane16_swap_b32 v235, v239
 v_pk_max_u16 v232, v232, v236
 v_pk_max_u16 v233, v233, v237
 v_pk_max_u16 v234, v234, v238
 v_pk_max_u16 v235, v235, v239
 v_pk_min_u16 v232, v232, v233
 v_pk_min_u16 v234, v234, v235
 v_pk_min_u16 v232, v232, v234
 v_lshlrev_b32 v198, 16, v232
 v_min_u32 v198, v198, v232
 s_nop 1
 v_min_u32_dpp v198, v198, v198 row_ror:8 row_mask:0xf bank_mask:0xf
 s_nop 1
 v_min_u32_dpp v198, v198, v198 row_ror:4 row_mask:0xf bank_mask:0xf
 s_nop 1
 v_min_u32_dpp v198, v198, v198 row_ror:2 row_mask:0xf bank_mask:0xf
 s_nop 1
 v_min_u32_dpp v198, v198, v198 row_ror:1 row_mask:0xf bank_mask:0xf
 v_mul_f32 v198, 0x41800000, v198
 s_waitcnt vmcnt(8)
 ds_read_b128 v[136:139], v11 offset:0
 ds_read_b128 v[140:143], v11 offset:512
 ds_read_b128 v[144:147], v11 offset:1024
 ds_read_b128 v[148:151], v11 offset:1536
 s_add_u32 m0, s34, 8192
 s_add_u32 s36, s35, 8192
 buffer_load_dwordx4 v3, s[4:7], s36 offen offset:0 nt lds
 buffer_load_dwordx4 v3, s[4:7], s36 offen offset:2048 nt lds
 s_add_u32 m0, s34, 9088
 s_nop 0
 buffer_load_dwordx4 v3, s[4:7], s36 offen offset:128 nt lds
 buffer_load_dwordx4 v3, s[4:7], s36 offen offset:2176 nt lds
 s_waitcnt lgkmcnt(3)
 v_mfma_f32_16x16x32_bf16 v[248:251], a[114:117], v[136:139], 0
 s_nop 0
 v_mfma_f32_16x16x32_bf16 v[248:251], a[118:121], v[136:139], v[248:251]
 s_nop 0
 v_mfma_f32_16x16x32_bf16 v[252:255], a[112:115], v[136:139], 0
 s_nop 0
 v_mfma_f32_16x16x32_bf16 v[252:255], a[116:119], v[136:139], v[252:255]
 s_waitcnt lgkmcnt(2)
 s_nop 0
 v_mfma_f32_16x16x32_bf16 v[16:19], a[114:117], v[140:143], 0
 s_nop 0
 v_mfma_f32_16x16x32_bf16 v[16:19], a[118:121], v[140:143], v[16:19]
 v_cvt_pk_bf16_f32 v192, v248, v249
 v_cvt_pk_bf16_f32 v193, v250, v251
 v_mfma_f32_16x16x32_bf16 v[20:23], a[112:115], v[140:143], 0
 v_accvgpr_write_b32 a0, v192
 v_accvgpr_write_b32 a1, v193
 v_mfma_f32_16x16x32_bf16 v[20:23], a[116:119], v[140:143], v[20:23]
 s_waitcnt lgkmcnt(0)
 v_cvt_pk_bf16_f32 v194, v252, v253
 v_cvt_pk_bf16_f32 v195, v254, v255
 s_barrier
 ds_read_b128 a[152:155], v0 offset:0
 ds_read_b128 a[156:159], v0 offset:512
 ds_read_b128 a[160:163], v0 offset:1024
 ds_read_b128 a[164:167], v0 offset:1536
 ds_read_b128 a[168:171], v0 offset:4096
 ds_read_b128 a[172:175], v0 offset:4608
 ds_read_b128 a[176:179], v0 offset:5120
 ds_read_b128 a[180:183], v0 offset:5632
 v_mfma_f32_16x16x32_bf16 v[248:251], a[114:117], v[144:147], 0
 v_accvgpr_write_b32 a2, v194
 v_accvgpr_write_b32 a3, v195
 v_mfma_f32_16x16x32_bf16 v[248:251], a[118:121], v[144:147], v[248:251]
 v_cvt_pk_bf16_f32 v192, v16, v17
 v_cvt_pk_bf16_f32 v193, v18, v19
 v_mfma_f32_16x16x32_bf16 v[252:255], a[112:115], v[144:147], 0
 v_accvgpr_write_b32 a4, v192
 v_accvgpr_write_b32 a5, v193
 v_mfma_f32_16x16x32_bf16 v[252:255], a[116:119], v[144:147], v[252:255]
 v_cvt_pk_bf16_f32 v194, v20, v21
 v_cvt_pk_bf16_f32 v195, v22, v23
 v_mfma_f32_16x16x32_bf16 v[16:19], a[114:117], v[148:151], 0
 v_accvgpr_write_b32 a6, v194
 v_accvgpr_write_b32 a7, v195
 v_mfma_f32_16x16x32_bf16 v[16:19], a[118:121], v[148:151], v[16:19]
 v_cvt_pk_bf16_f32 v192, v248, v249
 v_cvt_pk_bf16_f32 v193, v250, v251
 v_mfma_f32_16x16x32_bf16 v[20:23], a[112:115], v[148:151], 0
 v_accvgpr_write_b32 a8, v192
 v_accvgpr_write_b32 a9, v193
 v_mfma_f32_16x16x32_bf16 v[20:23], a[116:119], v[148:151], v[20:23]
 s_waitcnt lgkmcnt(0)
 v_cvt_pk_bf16_f32 v194, v252, v253
 v_cvt_pk_bf16_f32 v195, v254, v255
 v_mfma_f32_16x16x32_bf16 v[168:171], a[152:155], a[0:3], 0
 v_accvgpr_write_b32 a10, v194
 v_accvgpr_write_b32 a11, v195
 v_mfma_f32_16x16x32_bf16 v[168:171], a[156:159], a[4:7], v[168:171]
 v_cvt_pk_bf16_f32 v192, v16, v17
 v_cvt_pk_bf16_f32 v193, v18, v19
 v_mfma_f32_16x16x32_bf16 v[172:175], a[168:171], a[0:3], 0
 v_accvgpr_write_b32 a12, v192
 v_accvgpr_write_b32 a13, v193
 v_mfma_f32_16x16x32_bf16 v[172:175], a[172:175], a[4:7], v[172:175]
 v_cvt_pk_bf16_f32 v194, v20, v21
 v_cvt_pk_bf16_f32 v195, v22, v23
 v_mfma_f32_16x16x32_bf16 v[168:171], a[160:163], a[8:11], v[168:171]
 v_accvgpr_write_b32 a14, v194
 v_accvgpr_write_b32 a15, v195
 v_mfma_f32_16x16x32_bf16 v[172:175], a[176:179], a[8:11], v[172:175]
 s_nop 0
 v_mfma_f32_16x16x32_bf16 v[168:171], a[164:167], a[12:15], v[168:171]
 v_mfma_f32_16x16x32_bf16 v[172:175], a[180:183], a[12:15], v[172:175]
 s_nop 6
 v_max3_f32 v196, v168, v169, v170
 v_max_f32 v196, v196, v171
 v_mov_b32 v197, v196
 s_nop 1
 v_permlane32_swap_b32 v196, v197
 s_nop 0
 v_max_f32 v196, v196, v197
 v_mov_b32 v197, v196
 s_nop 1
 v_permlane16_swap_b32 v196, v197
 s_nop 0
 v_max_f32 v196, v196, v197
 s_nop 1
 v_max_f32_dpp v196, v196, v196 row_ror:8 row_mask:0xf bank_mask:0xf
 s_nop 1
 v_max_f32_dpp v196, v196, v196 row_ror:4 row_mask:0xf bank_mask:0xf
 s_nop 1
 v_max_f32_dpp v196, v196, v196 row_ror:2 row_mask:0xf bank_mask:0xf
 s_nop 1
 v_max_f32_dpp v196, v196, v196 row_ror:1 row_mask:0xf bank_mask:0xf
 v_sub_f32 v12, 0x428b8000, v196
 v_sub_f32 v13, 0x428b8000, v196
 v_sub_f32 v14, 0x428b8000, v196
 v_sub_f32 v15, 0x428b8000, v196
 v_add_f32 v168, v12, v168
 v_add_f32 v169, v12, v169
 v_add_f32 v170, v12, v170
 v_add_f32 v171, v12, v171
 v_exp_f32 v168, v168
 v_exp_f32 v169, v169
 v_exp_f32 v170, v170
 v_exp_f32 v171, v171
 v_cvt_pk_bf16_f32 v24, v168, v169
 v_cvt_pk_bf16_f32 v25, v170, v171
 s_waitcnt vmcnt(8)
 s_barrier
 ds_read_b128 a[184:187], v0 offset:8192
 ds_read_b128 a[188:191], v0 offset:8704
 ds_read_b128 a[192:195], v0 offset:9216
 ds_read_b128 a[196:199], v0 offset:9728
 ds_read_b128 a[200:203], v0 offset:12288
 ds_read_b128 a[204:207], v0 offset:12800
 ds_read_b128 a[208:211], v0 offset:13312
 ds_read_b128 a[212:215], v0 offset:13824
 ds_read_b128 a[216:219], v0 offset:16384
 ds_read_b128 a[224:227], v0 offset:16896
 ds_read_b128 a[228:231], v0 offset:17408
 ds_read_b128 a[232:235], v0 offset:17920
 s_add_u32 m0, s34, 12288
 s_add_u32 s36, s35, 12288
 buffer_load_dwordx4 v3, s[4:7], s36 offen offset:0 nt lds
 buffer_load_dwordx4 v3, s[4:7], s36 offen offset:2048 nt lds
 s_add_u32 m0, s34, 13184
 s_nop 0
 buffer_load_dwordx4 v3, s[4:7], s36 offen offset:128 nt lds
 buffer_load_dwordx4 v3, s[4:7], s36 offen offset:2176 nt lds
 v_add_f32 v172, v12, v172
 v_add_f32 v173, v12, v173
 v_add_f32 v174, v12, v174
 v_add_f32 v175, v12, v175
 v_exp_f32 v172, v172
 v_exp_f32 v173, v173
 v_exp_f32 v174, v174
 v_exp_f32 v175, v175
 ds_read_b128 a[236:239], v0 offset:20480
 ds_read_b128 a[240:243], v0 offset:20992
 ds_read_b128 a[244:247], v0 offset:21504
 ds_read_b128 a[248:251], v0 offset:22016
 s_waitcnt lgkmcnt(14)
 v_mfma_f32_16x16x32_bf16 v[176:179], a[184:187], a[0:3], v[12:15]
 s_waitcnt lgkmcnt(14)
 v_cvt_pk_bf16_f32 v26, v172, v173
 v_cvt_pk_bf16_f32 v27, v174, v175
 v_mfma_f32_16x16x32_bf16 v[176:179], a[188:191], a[4:7], v[176:179]
 s_waitcnt lgkmcnt(13)
 v_mfma_f32_16x16x32_bf16 v[176:179], a[192:195], a[8:11], v[176:179]
 s_waitcnt lgkmcnt(12)
 v_mfma_f32_16x16x32_bf16 v[176:179], a[196:199], a[12:15], v[176:179]
 s_waitcnt lgkmcnt(11)
 v_mfma_f32_16x16x32_bf16 v[180:183], a[200:203], a[0:3], v[12:15]
 s_waitcnt lgkmcnt(10)
 v_mfma_f32_16x16x32_bf16 v[180:183], a[204:207], a[4:7], v[180:183]
 s_waitcnt lgkmcnt(9)
 v_mfma_f32_16x16x32_bf16 v[180:183], a[208:211], a[8:11], v[180:183]
 s_waitcnt lgkmcnt(0)
 v_mfma_f32_16x16x32_bf16 v[180:183], a[212:215], a[12:15], v[180:183]
 v_mfma_f32_16x16x32_bf16 v[184:187], a[216:219], a[0:3], v[12:15]
 v_mfma_f32_16x16x32_bf16 v[184:187], a[224:227], a[4:7], v[184:187]
 v_mfma_f32_16x16x32_bf16 v[184:187], a[228:231], a[8:11], v[184:187]
 v_mfma_f32_16x16x32_bf16 v[184:187], a[232:235], a[12:15], v[184:187]
 v_exp_f32 v176, v176
 v_mfma_f32_16x16x32_bf16 v[188:191], a[236:239], a[0:3], v[12:15]
 v_exp_f32 v177, v177
 v_mfma_f32_16x16x32_bf16 v[188:191], a[240:243], a[4:7], v[188:191]
 v_exp_f32 v178, v178
 v_mfma_f32_16x16x32_bf16 v[188:191], a[244:247], a[8:11], v[188:191]
 v_exp_f32 v179, v179
 v_mfma_f32_16x16x32_bf16 v[188:191], a[248:251], a[12:15], v[188:191]
 v_cvt_pk_bf16_f32 v28, v176, v177
 v_cvt_pk_bf16_f32 v29, v178, v179
 v_exp_f32 v180, v180
 v_exp_f32 v181, v181
 v_exp_f32 v182, v182
 v_exp_f32 v183, v183
 v_cvt_pk_bf16_f32 v30, v180, v181
 v_cvt_pk_bf16_f32 v31, v182, v183
 v_exp_f32 v184, v184
 v_exp_f32 v185, v185
 s_waitcnt vmcnt(8)
 ds_read_b128 v[152:155], v11 offset:4096
 ds_read_b128 v[156:159], v11 offset:4608
 ds_read_b128 v[160:163], v11 offset:5120
 ds_read_b128 v[164:167], v11 offset:5632
 s_add_u32 m0, s34, 0
 s_add_u32 s36, s35, 16384
 buffer_load_dwordx4 v3, s[4:7], s36 offen offset:0 nt lds
 buffer_load_dwordx4 v3, s[4:7], s36 offen offset:2048 nt lds
 s_add_u32 m0, s34, 896
 s_nop 0
 buffer_load_dwordx4 v3, s[4:7], s36 offen offset:128 nt lds
 buffer_load_dwordx4 v3, s[4:7], s36 offen offset:2176 nt lds
 s_waitcnt lgkmcnt(3)
 v_mfma_f32_16x16x32_bf16 v[248:251], a[114:117], v[152:155], 0
 v_exp_f32 v186, v186
 v_mfma_f32_16x16x32_bf16 v[248:251], a[118:121], v[152:155], v[248:251]
 v_exp_f32 v187, v187
 v_mfma_f32_16x16x32_bf16 v[252:255], a[112:115], v[152:155], 0
 v_cvt_pk_bf16_f32 v80, v184, v185
 v_cvt_pk_bf16_f32 v81, v186, v187
 v_mfma_f32_16x16x32_bf16 v[252:255], a[116:119], v[152:155], v[252:255]
 s_waitcnt lgkmcnt(2)
 v_exp_f32 v188, v188
 v_mfma_f32_16x16x32_bf16 v[16:19], a[114:117], v[156:159], 0
 v_exp_f32 v189, v189
 v_mfma_f32_16x16x32_bf16 v[16:19], a[118:121], v[156:159], v[16:19]
 v_cvt_pk_bf16_f32 v192, v248, v249
 v_cvt_pk_bf16_f32 v193, v250, v251
 v_mfma_f32_16x16x32_bf16 v[20:23], a[112:115], v[156:159], 0
 v_accvgpr_write_b32 a16, v192
 v_accvgpr_write_b32 a17, v193
 v_mfma_f32_16x16x32_bf16 v[20:23], a[116:119], v[156:159], v[20:23]
 s_waitcnt lgkmcnt(0)
 v_cvt_pk_bf16_f32 v194, v252, v253
 v_cvt_pk_bf16_f32 v195, v254, v255
 v_mfma_f32_16x16x32_bf16 v[248:251], a[114:117], v[160:163], 0
 v_accvgpr_write_b32 a18, v194
 v_accvgpr_write_b32 a19, v195
 v_mfma_f32_16x16x32_bf16 v[248:251], a[118:121], v[160:163], v[248:251]
 v_cvt_pk_bf16_f32 v192, v16, v17
 v_cvt_pk_bf16_f32 v193, v18, v19
 v_mfma_f32_16x16x32_bf16 v[252:255], a[112:115], v[160:163], 0
 v_accvgpr_write_b32 a20, v192
 v_accvgpr_write_b32 a21, v193
 v_mfma_f32_16x16x32_bf16 v[252:255], a[116:119], v[160:163], v[252:255]
 v_cvt_pk_bf16_f32 v194, v20, v21
 v_cvt_pk_bf16_f32 v195, v22, v23
 v_mfma_f32_16x16x32_bf16 v[16:19], a[114:117], v[164:167], 0
 v_accvgpr_write_b32 a22, v194
 v_accvgpr_write_b32 a23, v195
 v_mfma_f32_16x16x32_bf16 v[16:19], a[118:121], v[164:167], v[16:19]
 v_cvt_pk_bf16_f32 v192, v248, v249
 v_cvt_pk_bf16_f32 v193, v250, v251
 v_mfma_f32_16x16x32_bf16 v[20:23], a[112:115], v[164:167], 0
 v_accvgpr_write_b32 a24, v192
 v_accvgpr_write_b32 a25, v193
 v_mfma_f32_16x16x32_bf16 v[20:23], a[116:119], v[164:167], v[20:23]
 v_cvt_pk_bf16_f32 v194, v252, v253
 v_cvt_pk_bf16_f32 v195, v254, v255
 v_mfma_f32_16x16x32_bf16 v[204:207], a[152:155], a[16:19], v[12:15]
 v_accvgpr_write_b32 a26, v194
 v_accvgpr_write_b32 a27, v195
 v_mfma_f32_16x16x32_bf16 v[204:207], a[156:159], a[20:23], v[204:207]
 v_cvt_pk_bf16_f32 v192, v16, v17
 v_cvt_pk_bf16_f32 v193, v18, v19
 v_mfma_f32_16x16x32_bf16 v[208:211], a[168:171], a[16:19], v[12:15]
 v_accvgpr_write_b32 a28, v192
 v_accvgpr_write_b32 a29, v193
 v_mfma_f32_16x16x32_bf16 v[208:211], a[172:175], a[20:23], v[208:211]
 v_cvt_pk_bf16_f32 v194, v20, v21
 v_cvt_pk_bf16_f32 v195, v22, v23
 v_mfma_f32_16x16x32_bf16 v[204:207], a[160:163], a[24:27], v[204:207]
 v_accvgpr_write_b32 a30, v194
 v_accvgpr_write_b32 a31, v195
 v_mfma_f32_16x16x32_bf16 v[208:211], a[176:179], a[24:27], v[208:211]
 v_exp_f32 v190, v190
 v_mfma_f32_16x16x32_bf16 v[204:207], a[164:167], a[28:31], v[204:207]
 v_exp_f32 v191, v191
 v_mfma_f32_16x16x32_bf16 v[208:211], a[180:183], a[28:31], v[208:211]
 v_cvt_pk_bf16_f32 v82, v188, v189
 v_cvt_pk_bf16_f32 v83, v190, v191
 v_mfma_f32_16x16x32_bf16 v[212:215], a[184:187], a[16:19], v[12:15]
 s_nop 0
 v_mfma_f32_16x16x32_bf16 v[212:215], a[188:191], a[20:23], v[212:215]
 s_nop 0
 v_exp_f32 v204, v204
 v_mfma_f32_16x16x32_bf16 v[212:215], a[192:195], a[24:27], v[212:215]
 v_exp_f32 v205, v205
 v_mfma_f32_16x16x32_bf16 v[212:215], a[196:199], a[28:31], v[212:215]
 v_exp_f32 v206, v206
 v_mfma_f32_16x16x32_bf16 v[216:219], a[200:203], a[16:19], v[12:15]
 v_exp_f32 v207, v207
 v_mfma_f32_16x16x32_bf16 v[216:219], a[204:207], a[20:23], v[216:219]
 v_cvt_pk_bf16_f32 v32, v204, v205
 v_cvt_pk_bf16_f32 v33, v206, v207
 v_mfma_f32_16x16x32_bf16 v[216:219], a[208:211], a[24:27], v[216:219]
 v_exp_f32 v208, v208
 v_mfma_f32_16x16x32_bf16 v[216:219], a[212:215], a[28:31], v[216:219]
 v_exp_f32 v209, v209
 v_mfma_f32_16x16x32_bf16 v[220:223], a[216:219], a[16:19], v[12:15]
 v_exp_f32 v210, v210
 v_mfma_f32_16x16x32_bf16 v[220:223], a[224:227], a[20:23], v[220:223]
 v_exp_f32 v211, v211
 v_mfma_f32_16x16x32_bf16 v[220:223], a[228:231], a[24:27], v[220:223]
 v_cvt_pk_bf16_f32 v34, v208, v209
 v_cvt_pk_bf16_f32 v35, v210, v211
 v_mfma_f32_16x16x32_bf16 v[220:223], a[232:235], a[28:31], v[220:223]
 v_exp_f32 v212, v212
 v_mfma_f32_16x16x32_bf16 v[224:227], a[236:239], a[16:19], v[12:15]
 v_exp_f32 v213, v213
 v_mfma_f32_16x16x32_bf16 v[224:227], a[240:243], a[20:23], v[224:227]
 v_exp_f32 v214, v214
 v_mfma_f32_16x16x32_bf16 v[224:227], a[244:247], a[24:27], v[224:227]
 v_exp_f32 v215, v215
 v_mfma_f32_16x16x32_bf16 v[224:227], a[248:251], a[28:31], v[224:227]
 v_cvt_pk_bf16_f32 v36, v212, v213
 v_cvt_pk_bf16_f32 v37, v214, v215
 v_mfma_f32_16x16x32_bf16 v[244:247], v[240:243], v[24:27], 0
 v_exp_f32 v216, v216
 v_mfma_f32_16x16x32_bf16 v[244:247], v[240:243], v[28:31], v[244:247]
 v_exp_f32 v217, v217
 v_mfma_f32_16x16x32_bf16 v[244:247], v[240:243], v[80:83], v[244:247]
 v_exp_f32 v218, v218
 v_exp_f32 v219, v219
 v_cvt_pk_bf16_f32 v38, v216, v217
 v_cvt_pk_bf16_f32 v39, v218, v219
 v_exp_f32 v220, v220
 v_exp_f32 v221, v221
 v_exp_f32 v222, v222
 s_waitcnt vmcnt(8)
 ds_read_b128 v[136:139], v11 offset:8192
 ds_read_b128 v[140:143], v11 offset:8704
 ds_read_b128 v[144:147], v11 offset:9216
 ds_read_b128 v[148:151], v11 offset:9728
 s_add_u32 m0, s34, 4096
 s_add_u32 s36, s35, 20480
 buffer_load_dwordx4 v3, s[4:7], s36 offen offset:0 nt lds
 buffer_load_dwordx4 v3, s[4:7], s36 offen offset:2048 nt lds
 s_add_u32 m0, s34, 4992
 s_nop 0
 buffer_load_dwordx4 v3, s[4:7], s36 offen offset:128 nt lds
 buffer_load_dwordx4 v3, s[4:7], s36 offen offset:2176 nt lds
L_merge:
 s_cmp_eq_u32 s24, 3
 s_cbranch_scc1 L_w6
 s_waitcnt lgkmcnt(3)
 v_mfma_f32_16x16x32_bf16 v[248:251], a[114:117], v[136:139], 0
 v_exp_f32 v223, v223
 v_mfma_f32_16x16x32_bf16 v[248:251], a[118:121], v[136:139], v[248:251]
 v_cvt_pk_bf16_f32 v88, v220, v221
 v_mov_b32 v4, v244
 v_mfma_f32_16x16x32_bf16 v[252:255], a[112:115], v[136:139], 0
 v_cvt_pk_bf16_f32 v89, v222, v223
 v_mfma_f32_16x16x32_bf16 v[252:255], a[116:119], v[136:139], v[252:255]
 s_waitcnt lgkmcnt(2)
 v_exp_f32 v224, v224
 v_mfma_f32_16x16x32_bf16 v[16:19], a[114:117], v[140:143], 0
 v_exp_f32 v225, v225
 v_mfma_f32_16x16x32_bf16 v[16:19], a[118:121], v[140:143], v[16:19]
 v_cvt_pk_bf16_f32 v192, v248, v249
 v_cvt_pk_bf16_f32 v193, v250, v251
 v_mfma_f32_16x16x32_bf16 v[20:23], a[112:115], v[140:143], 0
 v_accvgpr_write_b32 a32, v192
 v_accvgpr_write_b32 a33, v193
 v_mfma_f32_16x16x32_bf16 v[20:23], a[116:119], v[140:143], v[20:23]
 s_waitcnt lgkmcnt(0)
 v_cvt_pk_bf16_f32 v194, v252, v253
 v_cvt_pk_bf16_f32 v195, v254, v255
 v_mfma_f32_16x16x32_bf16 v[248:251], a[114:117], v[144:147], 0
 v_accvgpr_write_b32 a34, v194
 v_accvgpr_write_b32 a35, v195
 v_mfma_f32_16x16x32_bf16 v[248:251], a[118:121], v[144:147], v[248:251]
 v_cvt_pk_bf16_f32 v192, v16, v17
 v_cvt_pk_bf16_f32 v193, v18, v19
 v_mfma_f32_16x16x32_bf16 v[252:255], a[112:115], v[144:147], 0
 v_accvgpr_write_b32 a36, v192
 v_accvgpr_write_b32 a37, v193
 v_mfma_f32_16x16x32_bf16 v[252:255], a[116:119], v[144:147], v[252:255]
 v_cvt_pk_bf16_f32 v194, v20, v21
 v_cvt_pk_bf16_f32 v195, v22, v23
 v_mfma_f32_16x16x32_bf16 v[16:19], a[114:117], v[148:151], 0
 v_accvgpr_write_b32 a38, v194
 v_accvgpr_write_b32 a39, v195
 v_mfma_f32_16x16x32_bf16 v[16:19], a[118:121], v[148:151], v[16:19]
 v_cvt_pk_bf16_f32 v192, v248, v249
 v_cvt_pk_bf16_f32 v193, v250, v251
 v_mfma_f32_16x16x32_bf16 v[20:23], a[112:115], v[148:151], 0
 v_accvgpr_write_b32 a40, v192
 v_accvgpr_write_b32 a41, v193
 v_mfma_f32_16x16x32_bf16 v[20:23], a[116:119], v[148:151], v[20:23]
 v_cvt_pk_bf16_f32 v194, v252, v253
 v_cvt_pk_bf16_f32 v195, v254, v255
 v_mfma_f32_16x16x32_bf16 v[168:171], a[152:155], a[32:35], v[12:15]
 v_accvgpr_write_b32 a42, v194
 v_accvgpr_write_b32 a43, v195
 v_mfma_f32_16x16x32_bf16 v[168:171], a[156:159], a[36:39], v[168:171]
 v_cvt_pk_bf16_f32 v192, v16, v17
 v_cvt_pk_bf16_f32 v193, v18, v19
 v_mfma_f32_16x16x32_bf16 v[172:175], a[168:171], a[32:35], v[12:15]
 v_accvgpr_write_b32 a44, v192
 v_accvgpr_write_b32 a45, v193
 v_mfma_f32_16x16x32_bf16 v[172:175], a[172:175], a[36:39], v[172:175]
 v_cvt_pk_bf16_f32 v194, v20, v21
 v_cvt_pk_bf16_f32 v195, v22, v23
 v_mfma_f32_16x16x32_bf16 v[168:171], a[160:163], a[40:43], v[168:171]
 v_accvgpr_write_b32 a46, v194
 v_accvgpr_write_b32 a47, v195
 v_mfma_f32_16x16x32_bf16 v[172:175], a[176:179], a[40:43], v[172:175]
 v_exp_f32 v226, v226
 v_mfma_f32_16x16x32_bf16 v[168:171], a[164:167], a[44:47], v[168:171]
 v_exp_f32 v227, v227
 v_mfma_f32_16x16x32_bf16 v[172:175], a[180:183], a[44:47], v[172:175]
 v_cvt_pk_bf16_f32 v90, v224, v225
 v_cvt_pk_bf16_f32 v91, v226, v227
 v_mfma_f32_16x16x32_bf16 v[176:179], a[184:187], a[32:35], v[12:15]
 s_nop 0
 v_mfma_f32_16x16x32_bf16 v[176:179], a[188:191], a[36:39], v[176:179]
 s_nop 0
 v_exp_f32 v168, v168
 v_mfma_f32_16x16x32_bf16 v[176:179], a[192:195], a[40:43], v[176:179]
 v_exp_f32 v169, v169
 v_mfma_f32_16x16x32_bf16 v[176:179], a[196:199], a[44:47], v[176:179]
 v_exp_f32 v170, v170
 v_mfma_f32_16x16x32_bf16 v[180:183], a[200:203], a[32:35], v[12:15]
 v_exp_f32 v171, v171
 v_mfma_f32_16x16x32_bf16 v[180:183], a[204:207], a[36:39], v[180:183]
 v_cvt_pk_bf16_f32 v40, v168, v169
 v_cvt_pk_bf16_f32 v41, v170, v171
 v_mfma_f32_16x16x32_bf16 v[180:183], a[208:211], a[40:43], v[180:183]
 v_exp_f32 v172, v172
 v_mfma_f32_16x16x32_bf16 v[180:183], a[212:215], a[44:47], v[180:183]
 v_exp_f32 v173, v173
 v_mfma_f32_16x16x32_bf16 v[184:187], a[216:219], a[32:35], v[12:15]
 v_exp_f32 v174, v174
 v_mfma_f32_16x16x32_bf16 v[184:187], a[224:227], a[36:39], v[184:187]
 v_exp_f32 v175, v175
 v_mfma_f32_16x16x32_bf16 v[184:187], a[228:231], a[40:43], v[184:187]
 v_cvt_pk_bf16_f32 v42, v172, v173
 v_cvt_pk_bf16_f32 v43, v174, v175
 v_mfma_f32_16x16x32_bf16 v[184:187], a[232:235], a[44:47], v[184:187]
 v_exp_f32 v176, v176
 v_mfma_f32_16x16x32_bf16 v[188:191], a[236:239], a[32:35], v[12:15]
 v_exp_f32 v177, v177
 v_mfma_f32_16x16x32_bf16 v[188:191], a[240:243], a[36:39], v[188:191]
 v_exp_f32 v178, v178
 v_mfma_f32_16x16x32_bf16 v[188:191], a[244:247], a[40:43], v[188:191]
 v_exp_f32 v179, v179
 v_mfma_f32_16x16x32_bf16 v[188:191], a[248:251], a[44:47], v[188:191]
 v_cvt_pk_bf16_f32 v44, v176, v177
 v_cvt_pk_bf16_f32 v45, v178, v179
 v_mfma_f32_16x16x32_bf16 v[244:247], v[240:243], v[32:35], 0
 v_exp_f32 v180, v180
 v_mfma_f32_16x16x32_bf16 v[244:247], v[240:243], v[36:39], v[244:247]
 v_exp_f32 v181, v181
 v_mfma_f32_16x16x32_bf16 v[244:247], v[240:243], v[88:91], v[244:247]
 v_exp_f32 v182, v182
 v_exp_f32 v183, v183
 v_cvt_pk_bf16_f32 v46, v180, v181
 v_cvt_pk_bf16_f32 v47, v182, v183
 v_exp_f32 v184, v184
 v_exp_f32 v185, v185
 v_exp_f32 v186, v186
 s_waitcnt vmcnt(8)
 ds_read_b128 v[152:155], v11 offset:12288
 ds_read_b128 v[156:159], v11 offset:12800
 ds_read_b128 v[160:163], v11 offset:13312
 ds_read_b128 v[164:167], v11 offset:13824
 s_add_u32 m0, s34, 8192
 s_add_u32 s36, s35, 24576
 buffer_load_dwordx4 v3, s[4:7], s36 offen offset:0 nt lds
 buffer_load_dwordx4 v3, s[4:7], s36 offen offset:2048 nt lds
 s_add_u32 m0, s34, 9088
 s_nop 0
 buffer_load_dwordx4 v3, s[4:7], s36 offen offset:128 nt lds
 buffer_load_dwordx4 v3, s[4:7], s36 offen offset:2176 nt lds
 s_waitcnt lgkmcnt(3)
 v_mfma_f32_16x16x32_bf16 v[248:251], a[114:117], v[152:155], 0
 v_exp_f32 v187, v187
 v_mfma_f32_16x16x32_bf16 v[248:251], a[118:121], v[152:155], v[248:251]
 v_cvt_pk_bf16_f32 v96, v184, v185
 v_mov_b32 v5, v244
 v_mfma_f32_16x16x32_bf16 v[252:255], a[112:115], v[152:155], 0
 v_cvt_pk_bf16_f32 v97, v186, v187
 v_mfma_f32_16x16x32_bf16 v[252:255], a[116:119], v[152:155], v[252:255]
 s_waitcnt lgkmcnt(2)
 v_exp_f32 v188, v188
 v_mfma_f32_16x16x32_bf16 v[16:19], a[114:117], v[156:159], 0
 v_exp_f32 v189, v189
 v_mfma_f32_16x16x32_bf16 v[16:19], a[118:121], v[156:159], v[16:19]
 v_cvt_pk_bf16_f32 v192, v248, v249
 v_cvt_pk_bf16_f32 v193, v250, v251
 v_mfma_f32_16x16x32_bf16 v[20:23], a[112:115], v[156:159], 0
 v_accvgpr_write_b32 a48, v192
 v_accvgpr_write_b32 a49, v193
 v_mfma_f32_16x16x32_bf16 v[20:23], a[116:119], v[156:159], v[20:23]
 s_waitcnt lgkmcnt(0)
 v_cvt_pk_bf16_f32 v194, v252, v253
 v_cvt_pk_bf16_f32 v195, v254, v255
 v_mfma_f32_16x16x32_bf16 v[248:251], a[114:117], v[160:163], 0
 v_accvgpr_write_b32 a50, v194
 v_accvgpr_write_b32 a51, v195
 v_mfma_f32_16x16x32_bf16 v[248:251], a[118:121], v[160:163], v[248:251]
 v_cvt_pk_bf16_f32 v192, v16, v17
 v_cvt_pk_bf16_f32 v193, v18, v19
 v_mfma_f32_16x16x32_bf16 v[252:255], a[112:115], v[160:163], 0
 v_accvgpr_write_b32 a52, v192
 v_accvgpr_write_b32 a53, v193
 v_mfma_f32_16x16x32_bf16 v[252:255], a[116:119], v[160:163], v[252:255]
 v_cvt_pk_bf16_f32 v194, v20, v21
 v_cvt_pk_bf16_f32 v195, v22, v23
 v_mfma_f32_16x16x32_bf16 v[16:19], a[114:117], v[164:167], 0
 v_accvgpr_write_b32 a54, v194
 v_accvgpr_write_b32 a55, v195
 v_mfma_f32_16x16x32_bf16 v[16:19], a[118:121], v[164:167], v[16:19]
 v_cvt_pk_bf16_f32 v192, v248, v249
 v_cvt_pk_bf16_f32 v193, v250, v251
 v_mfma_f32_16x16x32_bf16 v[20:23], a[112:115], v[164:167], 0
 v_accvgpr_write_b32 a56, v192
 v_accvgpr_write_b32 a57, v193
 v_mfma_f32_16x16x32_bf16 v[20:23], a[116:119], v[164:167], v[20:23]
 v_cvt_pk_bf16_f32 v194, v252, v253
 v_cvt_pk_bf16_f32 v195, v254, v255
 v_mfma_f32_16x16x32_bf16 v[204:207], a[152:155], a[48:51], v[12:15]
 v_accvgpr_write_b32 a58, v194
 v_accvgpr_write_b32 a59, v195
 v_mfma_f32_16x16x32_bf16 v[204:207], a[156:159], a[52:55], v[204:207]
 v_cvt_pk_bf16_f32 v192, v16, v17
 v_cvt_pk_bf16_f32 v193, v18, v19
 v_mfma_f32_16x16x32_bf16 v[208:211], a[168:171], a[48:51], v[12:15]
 v_accvgpr_write_b32 a60, v192
 v_accvgpr_write_b32 a61, v193
 v_mfma_f32_16x16x32_bf16 v[208:211], a[172:175], a[52:55], v[208:211]
 v_cvt_pk_bf16_f32 v194, v20, v21
 v_cvt_pk_bf16_f32 v195, v22, v23
 v_mfma_f32_16x16x32_bf16 v[204:207], a[160:163], a[56:59], v[204:207]
 v_accvgpr_write_b32 a62, v194
 v_accvgpr_write_b32 a63, v195
 v_mfma_f32_16x16x32_bf16 v[208:211], a[176:179], a[56:59], v[208:211]
 v_exp_f32 v190, v190
 v_mfma_f32_16x16x32_bf16 v[204:207], a[164:167], a[60:63], v[204:207]
 v_exp_f32 v191, v191
 v_mfma_f32_16x16x32_bf16 v[208:211], a[180:183], a[60:63], v[208:211]
 v_cvt_pk_bf16_f32 v98, v188, v189
 v_cvt_pk_bf16_f32 v99, v190, v191
 v_mfma_f32_16x16x32_bf16 v[212:215], a[184:187], a[48:51], v[12:15]
 s_nop 0
 v_mfma_f32_16x16x32_bf16 v[212:215], a[188:191], a[52:55], v[212:215]
 s_nop 0
 v_exp_f32 v204, v204
 v_mfma_f32_16x16x32_bf16 v[212:215], a[192:195], a[56:59], v[212:215]
 v_exp_f32 v205, v205
 v_mfma_f32_16x16x32_bf16 v[212:215], a[196:199], a[60:63], v[212:215]
 v_exp_f32 v206, v206
 v_mfma_f32_16x16x32_bf16 v[216:219], a[200:203], a[48:51], v[12:15]
 v_exp_f32 v207, v207
 v_mfma_f32_16x16x32_bf16 v[216:219], a[204:207], a[52:55], v[216:219]
 v_cvt_pk_bf16_f32 v48, v204, v205
 v_cvt_pk_bf16_f32 v49, v206, v207
 v_mfma_f32_16x16x32_bf16 v[216:219], a[208:211], a[56:59], v[216:219]
 v_exp_f32 v208, v208
 v_mfma_f32_16x16x32_bf16 v[216:219], a[212:215], a[60:63], v[216:219]
 v_exp_f32 v209, v209
 v_mfma_f32_16x16x32_bf16 v[220:223], a[216:219], a[48:51], v[12:15]
 v_exp_f32 v210, v210
 v_mfma_f32_16x16x32_bf16 v[220:223], a[224:227], a[52:55], v[220:223]
 v_exp_f32 v211, v211
 v_mfma_f32_16x16x32_bf16 v[220:223], a[228:231], a[56:59], v[220:223]
 v_cvt_pk_bf16_f32 v50, v208, v209
 v_cvt_pk_bf16_f32 v51, v210, v211
 v_mfma_f32_16x16x32_bf16 v[220:223], a[232:235], a[60:63], v[220:223]
 v_exp_f32 v212, v212
 v_mfma_f32_16x16x32_bf16 v[224:227], a[236:239], a[48:51], v[12:15]
 v_exp_f32 v213, v213
 v_mfma_f32_16x16x32_bf16 v[224:227], a[240:243], a[52:55], v[224:227]
 v_exp_f32 v214, v214
 v_mfma_f32_16x16x32_bf16 v[224:227], a[244:247], a[56:59], v[224:227]
 v_exp_f32 v215, v215
 v_mfma_f32_16x16x32_bf16 v[224:227], a[248:251], a[60:63], v[224:227]
 v_cvt_pk_bf16_f32 v52, v212, v213
 v_cvt_pk_bf16_f32 v53, v214, v215
 v_mfma_f32_16x16x32_bf16 v[244:247], v[240:243], v[40:43], 0
 v_exp_f32 v216, v216
 v_mfma_f32_16x16x32_bf16 v[244:247], v[240:243], v[44:47], v[244:247]
 v_exp_f32 v217, v217
 v_mfma_f32_16x16x32_bf16 v[244:247], v[240:243], v[96:99], v[244:247]
 v_exp_f32 v218, v218
 v_exp_f32 v219, v219
 v_cvt_pk_bf16_f32 v54, v216, v217
 v_cvt_pk_bf16_f32 v55, v218, v219
 v_exp_f32 v220, v220
 v_exp_f32 v221, v221
 v_exp_f32 v222, v222
 s_waitcnt vmcnt(8)
 ds_read_b128 v[136:139], v11 offset:0
 ds_read_b128 v[140:143], v11 offset:512
 ds_read_b128 v[144:147], v11 offset:1024
 ds_read_b128 v[148:151], v11 offset:1536
 s_add_u32 m0, s28, 65536
 s_add_u32 s36, s28, 0
 buffer_load_dwordx4 v3, s[12:15], s36 offen offset:0 nt lds
 s_add_u32 m0, s28, 66432
 s_nop 0
 buffer_load_dwordx4 v3, s[12:15], s36 offen offset:128 nt lds
 s_add_u32 m0, s28, 24576
 s_add_u32 s36, s28, 24576
 buffer_load_dwordx4 v3, s[8:11], s36 offen offset:0 nt lds
 s_add_u32 m0, s28, 25472
 s_nop 0
 buffer_load_dwordx4 v3, s[8:11], s36 offen offset:128 nt lds
 s_waitcnt lgkmcnt(3)
 v_mfma_f32_16x16x32_bf16 v[248:251], a[114:117], v[136:139], 0
 v_exp_f32 v223, v223
 v_mfma_f32_16x16x32_bf16 v[248:251], a[118:121], v[136:139], v[248:251]
 v_cvt_pk_bf16_f32 v104, v220, v221
 v_mov_b32 v6, v244
 v_mfma_f32_16x16x32_bf16 v[252:255], a[112:115], v[136:139], 0
 v_cvt_pk_bf16_f32 v105, v222, v223
 v_mfma_f32_16x16x32_bf16 v[252:255], a[116:119], v[136:139], v[252:255]
 s_waitcnt lgkmcnt(2)
 v_exp_f32 v224, v224
 v_mfma_f32_16x16x32_bf16 v[16:19], a[114:117], v[140:143], 0
 v_exp_f32 v225, v225
 v_mfma_f32_16x16x32_bf16 v[16:19], a[118:121], v[140:143], v[16:19]
 v_cvt_pk_bf16_f32 v192, v248, v249
 v_cvt_pk_bf16_f32 v193, v250, v251
 v_mfma_f32_16x16x32_bf16 v[20:23], a[112:115], v[140:143], 0
 v_accvgpr_write_b32 a64, v192
 v_accvgpr_write_b32 a65, v193
 v_mfma_f32_16x16x32_bf16 v[20:23], a[116:119], v[140:143], v[20:23]
 s_waitcnt lgkmcnt(0)
 v_cvt_pk_bf16_f32 v194, v252, v253
 v_cvt_pk_bf16_f32 v195, v254, v255
 v_mfma_f32_16x16x32_bf16 v[248:251], a[114:117], v[144:147], 0
 v_accvgpr_write_b32 a66, v194
 v_accvgpr_write_b32 a67, v195
 v_mfma_f32_16x16x32_bf16 v[248:251], a[118:121], v[144:147], v[248:251]
 v_cvt_pk_bf16_f32 v192, v16, v17
 v_cvt_pk_bf16_f32 v193, v18, v19
 v_mfma_f32_16x16x32_bf16 v[252:255], a[112:115], v[144:147], 0
 v_accvgpr_write_b32 a68, v192
 v_accvgpr_write_b32 a69, v193
 v_mfma_f32_16x16x32_bf16 v[252:255], a[116:119], v[144:147], v[252:255]
 v_cvt_pk_bf16_f32 v194, v20, v21
 v_cvt_pk_bf16_f32 v195, v22, v23
 v_mfma_f32_16x16x32_bf16 v[16:19], a[114:117], v[148:151], 0
 v_accvgpr_write_b32 a70, v194
 v_accvgpr_write_b32 a71, v195
 v_mfma_f32_16x16x32_bf16 v[16:19], a[118:121], v[148:151], v[16:19]
 v_cvt_pk_bf16_f32 v192, v248, v249
 v_cvt_pk_bf16_f32 v193, v250, v251
 v_mfma_f32_16x16x32_bf16 v[20:23], a[112:115], v[148:151], 0
 v_accvgpr_write_b32 a72, v192
 v_accvgpr_write_b32 a73, v193
 v_mfma_f32_16x16x32_bf16 v[20:23], a[116:119], v[148:151], v[20:23]
 v_cvt_pk_bf16_f32 v194, v252, v253
 v_cvt_pk_bf16_f32 v195, v254, v255
 v_mfma_f32_16x16x32_bf16 v[168:171], a[152:155], a[64:67], v[12:15]
 v_accvgpr_write_b32 a74, v194
 v_accvgpr_write_b32 a75, v195
 v_mfma_f32_16x16x32_bf16 v[168:171], a[156:159], a[68:71], v[168:171]
 v_cvt_pk_bf16_f32 v192, v16, v17
 v_cvt_pk_bf16_f32 v193, v18, v19
 v_mfma_f32_16x16x32_bf16 v[172:175], a[168:171], a[64:67], v[12:15]
 v_accvgpr_write_b32 a76, v192
 v_accvgpr_write_b32 a77, v193
 v_mfma_f32_16x16x32_bf16 v[172:175], a[172:175], a[68:71], v[172:175]
 v_cvt_pk_bf16_f32 v194, v20, v21
 v_cvt_pk_bf16_f32 v195, v22, v23
 v_mfma_f32_16x16x32_bf16 v[168:171], a[160:163], a[72:75], v[168:171]
 v_accvgpr_write_b32 a78, v194
 v_accvgpr_write_b32 a79, v195
 v_mfma_f32_16x16x32_bf16 v[172:175], a[176:179], a[72:75], v[172:175]
 v_exp_f32 v226, v226
 v_mfma_f32_16x16x32_bf16 v[168:171], a[164:167], a[76:79], v[168:171]
 v_exp_f32 v227, v227
 v_mfma_f32_16x16x32_bf16 v[172:175], a[180:183], a[76:79], v[172:175]
 v_cvt_pk_bf16_f32 v106, v224, v225
 v_cvt_pk_bf16_f32 v107, v226, v227
 v_mfma_f32_16x16x32_bf16 v[176:179], a[184:187], a[64:67], v[12:15]
 s_nop 0
 v_mfma_f32_16x16x32_bf16 v[176:179], a[188:191], a[68:71], v[176:179]
 s_nop 0
 v_exp_f32 v168, v168
 v_mfma_f32_16x16x32_bf16 v[176:179], a[192:195], a[72:75], v[176:179]
 v_exp_f32 v169, v169
 v_mfma_f32_16x16x32_bf16 v[176:179], a[196:199], a[76:79], v[176:179]
 v_exp_f32 v170, v170
 v_mfma_f32_16x16x32_bf16 v[180:183], a[200:203], a[64:67], v[12:15]
 v_exp_f32 v171, v171
 v_mfma_f32_16x16x32_bf16 v[180:183], a[204:207], a[68:71], v[180:183]
 v_cvt_pk_bf16_f32 v56, v168, v169
 v_cvt_pk_bf16_f32 v57, v170, v171
 v_mfma_f32_16x16x32_bf16 v[180:183], a[208:211], a[72:75], v[180:183]
 v_exp_f32 v172, v172
 v_mfma_f32_16x16x32_bf16 v[180:183], a[212:215], a[76:79], v[180:183]
 v_exp_f32 v173, v173
 v_mfma_f32_16x16x32_bf16 v[184:187], a[216:219], a[64:67], v[12:15]
 v_exp_f32 v174, v174
 v_mfma_f32_16x16x32_bf16 v[184:187], a[224:227], a[68:71], v[184:187]
 v_exp_f32 v175, v175
 v_mfma_f32_16x16x32_bf16 v[184:187], a[228:231], a[72:75], v[184:187]
 v_cvt_pk_bf16_f32 v58, v172, v173
 v_cvt_pk_bf16_f32 v59, v174, v175
 v_mfma_f32_16x16x32_bf16 v[184:187], a[232:235], a[76:79], v[184:187]
 v_exp_f32 v176, v176
 v_mfma_f32_16x16x32_bf16 v[188:191], a[236:239], a[64:67], v[12:15]
 v_exp_f32 v177, v177
 v_mfma_f32_16x16x32_bf16 v[188:191], a[240:243], a[68:71], v[188:191]
 v_exp_f32 v178, v178
 v_mfma_f32_16x16x32_bf16 v[188:191], a[244:247], a[72:75], v[188:191]
 v_exp_f32 v179, v179
 v_mfma_f32_16x16x32_bf16 v[188:191], a[248:251], a[76:79], v[188:191]
 v_cvt_pk_bf16_f32 v60, v176, v177
 v_cvt_pk_bf16_f32 v61, v178, v179
 v_mfma_f32_16x16x32_bf16 v[244:247], v[240:243], v[48:51], 0
 v_exp_f32 v180, v180
 v_mfma_f32_16x16x32_bf16 v[244:247], v[240:243], v[52:55], v[244:247]
 v_exp_f32 v181, v181
 v_mfma_f32_16x16x32_bf16 v[244:247], v[240:243], v[104:107], v[244:247]
 v_exp_f32 v182, v182
 v_exp_f32 v183, v183
 v_cvt_pk_bf16_f32 v62, v180, v181
 v_cvt_pk_bf16_f32 v63, v182, v183
 v_exp_f32 v184, v184
 v_exp_f32 v185, v185
 v_exp_f32 v186, v186
 s_waitcnt vmcnt(8)
 ds_read_b128 v[152:155], v11 offset:4096
 ds_read_b128 v[156:159], v11 offset:4608
 ds_read_b128 v[160:163], v11 offset:5120
 ds_read_b128 v[164:167], v11 offset:5632
 s_add_u32 m0, s28, 73728
 s_add_u32 s36, s28, 8192
 buffer_load_dwordx4 v3, s[12:15], s36 offen offset:0 nt lds
 s_add_u32 m0, s28, 74624
 s_nop 0
 buffer_load_dwordx4 v3, s[12:15], s36 offen offset:128 nt lds
 s_add_u32 m0, s28, 32768
 s_add_u32 s36, s28, 32768
 buffer_load_dwordx4 v3, s[8:11], s36 offen offset:0 nt lds
 s_add_u32 m0, s28, 33664
 s_nop 0
 buffer_load_dwordx4 v3, s[8:11], s36 offen offset:128 nt lds
 s_waitcnt lgkmcnt(3)
 v_mfma_f32_16x16x32_bf16 v[248:251], a[114:117], v[152:155], 0
 v_exp_f32 v187, v187
 v_mfma_f32_16x16x32_bf16 v[248:251], a[118:121], v[152:155], v[248:251]
 v_cvt_pk_bf16_f32 v112, v184, v185
 v_mov_b32 v7, v244
 v_mfma_f32_16x16x32_bf16 v[252:255], a[112:115], v[152:155], 0
 v_cvt_pk_bf16_f32 v113, v186, v187
 v_mfma_f32_16x16x32_bf16 v[252:255], a[116:119], v[152:155], v[252:255]
 s_waitcnt lgkmcnt(2)
 v_exp_f32 v188, v188
 v_mfma_f32_16x16x32_bf16 v[16:19], a[114:117], v[156:159], 0
 v_exp_f32 v189, v189
 v_mfma_f32_16x16x32_bf16 v[16:19], a[118:121], v[156:159], v[16:19]
 v_cvt_pk_bf16_f32 v192, v248, v249
 v_cvt_pk_bf16_f32 v193, v250, v251
 v_mfma_f32_16x16x32_bf16 v[20:23], a[112:115], v[156:159], 0
 v_accvgpr_write_b32 a80, v192
 v_accvgpr_write_b32 a81, v193
 v_mfma_f32_16x16x32_bf16 v[20:23], a[116:119], v[156:159], v[20:23]
 s_waitcnt lgkmcnt(0)
 v_cvt_pk_bf16_f32 v194, v252, v253
 v_cvt_pk_bf16_f32 v195, v254, v255
 v_mfma_f32_16x16x32_bf16 v[248:251], a[114:117], v[160:163], 0
 v_accvgpr_write_b32 a82, v194
 v_accvgpr_write_b32 a83, v195
 v_mfma_f32_16x16x32_bf16 v[248:251], a[118:121], v[160:163], v[248:251]
 v_cvt_pk_bf16_f32 v192, v16, v17
 v_cvt_pk_bf16_f32 v193, v18, v19
 v_mfma_f32_16x16x32_bf16 v[252:255], a[112:115], v[160:163], 0
 v_accvgpr_write_b32 a84, v192
 v_accvgpr_write_b32 a85, v193
 v_mfma_f32_16x16x32_bf16 v[252:255], a[116:119], v[160:163], v[252:255]
 v_cvt_pk_bf16_f32 v194, v20, v21
 v_cvt_pk_bf16_f32 v195, v22, v23
 v_mfma_f32_16x16x32_bf16 v[16:19], a[114:117], v[164:167], 0
 v_accvgpr_write_b32 a86, v194
 v_accvgpr_write_b32 a87, v195
 v_mfma_f32_16x16x32_bf16 v[16:19], a[118:121], v[164:167], v[16:19]
 v_cvt_pk_bf16_f32 v192, v248, v249
 v_cvt_pk_bf16_f32 v193, v250, v251
 v_mfma_f32_16x16x32_bf16 v[20:23], a[112:115], v[164:167], 0
 v_accvgpr_write_b32 a88, v192
 v_accvgpr_write_b32 a89, v193
 v_mfma_f32_16x16x32_bf16 v[20:23], a[116:119], v[164:167], v[20:23]
 v_cvt_pk_bf16_f32 v194, v252, v253
 v_cvt_pk_bf16_f32 v195, v254, v255
 v_mfma_f32_16x16x32_bf16 v[204:207], a[152:155], a[80:83], v[12:15]
 v_accvgpr_write_b32 a90, v194
 v_accvgpr_write_b32 a91, v195
 v_mfma_f32_16x16x32_bf16 v[204:207], a[156:159], a[84:87], v[204:207]
 v_cvt_pk_bf16_f32 v192, v16, v17
 v_cvt_pk_bf16_f32 v193, v18, v19
 v_mfma_f32_16x16x32_bf16 v[208:211], a[168:171], a[80:83], v[12:15]
 v_accvgpr_write_b32 a92, v192
 v_accvgpr_write_b32 a93, v193
 v_mfma_f32_16x16x32_bf16 v[208:211], a[172:175], a[84:87], v[208:211]
 v_cvt_pk_bf16_f32 v194, v20, v21
 v_cvt_pk_bf16_f32 v195, v22, v23
 v_mfma_f32_16x16x32_bf16 v[204:207], a[160:163], a[88:91], v[204:207]
 v_accvgpr_write_b32 a94, v194
 v_accvgpr_write_b32 a95, v195
 v_mfma_f32_16x16x32_bf16 v[208:211], a[176:179], a[88:91], v[208:211]
 v_exp_f32 v190, v190
 v_mfma_f32_16x16x32_bf16 v[204:207], a[164:167], a[92:95], v[204:207]
 v_exp_f32 v191, v191
 v_mfma_f32_16x16x32_bf16 v[208:211], a[180:183], a[92:95], v[208:211]
 v_cvt_pk_bf16_f32 v114, v188, v189
 v_cvt_pk_bf16_f32 v115, v190, v191
 v_mfma_f32_16x16x32_bf16 v[212:215], a[184:187], a[80:83], v[12:15]
 s_nop 0
 v_mfma_f32_16x16x32_bf16 v[212:215], a[188:191], a[84:87], v[212:215]
 s_nop 0
 v_exp_f32 v204, v204
 v_mfma_f32_16x16x32_bf16 v[212:215], a[192:195], a[88:91], v[212:215]
 v_exp_f32 v205, v205
 v_mfma_f32_16x16x32_bf16 v[212:215], a[196:199], a[92:95], v[212:215]
 v_exp_f32 v206, v206
 v_mfma_f32_16x16x32_bf16 v[216:219], a[200:203], a[80:83], v[12:15]
 v_exp_f32 v207, v207
 v_mfma_f32_16x16x32_bf16 v[216:219], a[204:207], a[84:87], v[216:219]
 v_cvt_pk_bf16_f32 v64, v204, v205
 v_cvt_pk_bf16_f32 v65, v206, v207
 v_mfma_f32_16x16x32_bf16 v[216:219], a[208:211], a[88:91], v[216:219]
 v_exp_f32 v208, v208
 v_mfma_f32_16x16x32_bf16 v[216:219], a[212:215], a[92:95], v[216:219]
 v_exp_f32 v209, v209
 v_mfma_f32_16x16x32_bf16 v[220:223], a[216:219], a[80:83], v[12:15]
 v_exp_f32 v210, v210
 v_mfma_f32_16x16x32_bf16 v[220:223], a[224:227], a[84:87], v[220:223]
 v_exp_f32 v211, v211
 v_mfma_f32_16x16x32_bf16 v[220:223], a[228:231], a[88:91], v[220:223]
 v_cvt_pk_bf16_f32 v66, v208, v209
 v_cvt_pk_bf16_f32 v67, v210, v211
 v_mfma_f32_16x16x32_bf16 v[220:223], a[232:235], a[92:95], v[220:223]
 v_exp_f32 v212, v212
 v_mfma_f32_16x16x32_bf16 v[224:227], a[236:239], a[80:83], v[12:15]
 v_exp_f32 v213, v213
 v_mfma_f32_16x16x32_bf16 v[224:227], a[240:243], a[84:87], v[224:227]
 v_exp_f32 v214, v214
 v_mfma_f32_16x16x32_bf16 v[224:227], a[244:247], a[88:91], v[224:227]
 v_exp_f32 v215, v215
 v_mfma_f32_16x16x32_bf16 v[224:227], a[248:251], a[92:95], v[224:227]
 v_cvt_pk_bf16_f32 v68, v212, v213
 v_cvt_pk_bf16_f32 v69, v214, v215
 v_mfma_f32_16x16x32_bf16 v[244:247], v[240:243], v[56:59], 0
 v_exp_f32 v216, v216
 v_mfma_f32_16x16x32_bf16 v[244:247], v[240:243], v[60:63], v[244:247]
 v_exp_f32 v217, v217
 v_mfma_f32_16x16x32_bf16 v[244:247], v[240:243], v[112:115], v[244:247]
 v_exp_f32 v218, v218
 v_exp_f32 v219, v219
 v_cvt_pk_bf16_f32 v70, v216, v217
 v_cvt_pk_bf16_f32 v71, v218, v219
 v_exp_f32 v220, v220
 v_exp_f32 v221, v221
 v_exp_f32 v222, v222
 v_min_f32 v196, v4, v7
 v_min3_f32 v196, v196, v5, v6
 s_nop 1
 v_min_f32_dpp v196, v196, v196 row_ror:8 row_mask:0xf bank_mask:0xf
 s_nop 1
 v_min_f32_dpp v196, v196, v196 row_ror:4 row_mask:0xf bank_mask:0xf
 s_nop 1
 v_min_f32_dpp v196, v196, v196 row_ror:2 row_mask:0xf bank_mask:0xf
 s_nop 1
 v_min_f32_dpp v196, v196, v196 row_ror:1 row_mask:0xf bank_mask:0xf
 v_mul_f32 v198, v198, v196
 v_min_u32 v198, 0x7b000000, v198
 v_readfirstlane_b32 s94, v196
 v_and_b32 v198, 0x7f800000, v198
 v_mul_f32 v228, 0x3fc00000, v198
 v_mul_f32 v229, 0x3fc00000, v198
 v_mul_f32 v230, 0x3fc00000, v198
 v_mul_f32 v231, 0x3fc00000, v198
 v_accvgpr_write_b32 a252, v228
 v_accvgpr_write_b32 a253, v228
 v_accvgpr_write_b32 a254, v228
 v_accvgpr_write_b32 a255, v228
 v_readfirstlane_b32 s95, v228
 s_sub_u32 s94, s94, 0x2000000
 s_max_u32 s88, s88, s94
 s_waitcnt vmcnt(8)
 ds_read_b128 v[136:139], v11 offset:8192
 ds_read_b128 v[140:143], v11 offset:8704
 ds_read_b128 v[144:147], v11 offset:9216
 ds_read_b128 v[148:151], v11 offset:9728
 s_waitcnt lgkmcnt(3)
 v_mfma_f32_16x16x32_bf16 v[248:251], a[114:117], v[136:139], 0
 v_exp_f32 v223, v223
 v_mfma_f32_16x16x32_bf16 v[248:251], a[118:121], v[136:139], v[248:251]
 v_cvt_pk_bf16_f32 v120, v220, v221
 v_mov_b32 v8, v244
 v_mfma_f32_16x16x32_bf16 v[252:255], a[112:115], v[136:139], 0
 v_cvt_pk_bf16_f32 v121, v222, v223
 v_mfma_f32_16x16x32_bf16 v[252:255], a[116:119], v[136:139], v[252:255]
 s_waitcnt lgkmcnt(2)
 v_exp_f32 v224, v224
 v_mfma_f32_16x16x32_bf16 v[16:19], a[114:117], v[140:143], 0
 v_exp_f32 v225, v225
 v_mfma_f32_16x16x32_bf16 v[16:19], a[118:121], v[140:143], v[16:19]
 v_cvt_pk_bf16_f32 v192, v248, v249
 v_cvt_pk_bf16_f32 v193, v250, v251
 v_mfma_f32_16x16x32_bf16 v[20:23], a[112:115], v[140:143], 0
 v_accvgpr_write_b32 a96, v192
 v_accvgpr_write_b32 a97, v193
 v_mfma_f32_16x16x32_bf16 v[20:23], a[116:119], v[140:143], v[20:23]
 s_waitcnt lgkmcnt(0)
 v_cvt_pk_bf16_f32 v194, v252, v253
 v_cvt_pk_bf16_f32 v195, v254, v255
 v_mfma_f32_16x16x32_bf16 v[248:251], a[114:117], v[144:147], 0
 v_accvgpr_write_b32 a98, v194
 v_accvgpr_write_b32 a99, v195
 v_mfma_f32_16x16x32_bf16 v[248:251], a[118:121], v[144:147], v[248:251]
 v_cvt_pk_bf16_f32 v192, v16, v17
 v_cvt_pk_bf16_f32 v193, v18, v19
 v_mfma_f32_16x16x32_bf16 v[252:255], a[112:115], v[144:147], 0
 v_accvgpr_write_b32 a100, v192
 v_accvgpr_write_b32 a101, v193
 v_mfma_f32_16x16x32_bf16 v[252:255], a[116:119], v[144:147], v[252:255]
 v_cvt_pk_bf16_f32 v194, v20, v21
 v_cvt_pk_bf16_f32 v195, v22, v23
 v_mfma_f32_16x16x32_bf16 v[16:19], a[114:117], v[148:151], 0
 v_accvgpr_write_b32 a102, v194
 v_accvgpr_write_b32 a103, v195
 v_mfma_f32_16x16x32_bf16 v[16:19], a[118:121], v[148:151], v[16:19]
 v_cvt_pk_bf16_f32 v192, v248, v249
 v_cvt_pk_bf16_f32 v193, v250, v251
 v_mfma_f32_16x16x32_bf16 v[20:23], a[112:115], v[148:151], 0
 v_accvgpr_write_b32 a104, v192
 v_accvgpr_write_b32 a105, v193
 v_mfma_f32_16x16x32_bf16 v[20:23], a[116:119], v[148:151], v[20:23]
 v_cvt_pk_bf16_f32 v194, v252, v253
 v_cvt_pk_bf16_f32 v195, v254, v255
 v_mfma_f32_16x16x32_bf16 v[168:171], a[152:155], a[96:99], v[12:15]
 v_accvgpr_write_b32 a106, v194
 v_accvgpr_write_b32 a107, v195
 v_mfma_f32_16x16x32_bf16 v[168:171], a[156:159], a[100:103], v[168:171]
 v_cvt_pk_bf16_f32 v192, v16, v17
 v_cvt_pk_bf16_f32 v193, v18, v19
 v_mfma_f32_16x16x32_bf16 v[172:175], a[168:171], a[96:99], v[12:15]
 v_accvgpr_write_b32 a108, v192
 v_accvgpr_write_b32 a109, v193
 v_mfma_f32_16x16x32_bf16 v[172:175], a[172:175], a[100:103], v[172:175]
 v_cvt_pk_bf16_f32 v194, v20, v21
 v_cvt_pk_bf16_f32 v195, v22, v23
 v_mfma_f32_16x16x32_bf16 v[168:171], a[160:163], a[104:107], v[168:171]
 v_accvgpr_write_b32 a110, v194
 v_accvgpr_write_b32 a111, v195
 v_mfma_f32_16x16x32_bf16 v[172:175], a[176:179], a[104:107], v[172:175]
 v_exp_f32 v226, v226
 v_mfma_f32_16x16x32_bf16 v[168:171], a[164:167], a[108:111], v[168:171]
 v_exp_f32 v227, v227
 v_mfma_f32_16x16x32_bf16 v[172:175], a[180:183], a[108:111], v[172:175]
 v_cvt_pk_bf16_f32 v122, v224, v225
 v_cvt_pk_bf16_f32 v123, v226, v227
 v_mfma_f32_16x16x32_bf16 v[84:87], a[184:187], a[96:99], v[12:15]
 s_nop 0
 v_mfma_f32_16x16x32_bf16 v[84:87], a[188:191], a[100:103], v[84:87]
 s_nop 0
 v_exp_f32 v168, v168
 v_mfma_f32_16x16x32_bf16 v[84:87], a[192:195], a[104:107], v[84:87]
 v_exp_f32 v169, v169
 v_mfma_f32_16x16x32_bf16 v[84:87], a[196:199], a[108:111], v[84:87]
 v_exp_f32 v170, v170
 v_mfma_f32_16x16x32_bf16 v[92:95], a[200:203], a[96:99], v[12:15]
 v_exp_f32 v171, v171
 v_mfma_f32_16x16x32_bf16 v[92:95], a[204:207], a[100:103], v[92:95]
 v_cvt_pk_bf16_f32 v72, v168, v169
 v_add_f32 v10, v168, v169
 v_mfma_f32_16x16x32_bf16 v[92:95], a[208:211], a[104:107], v[92:95]
 v_cvt_pk_bf16_f32 v73, v170, v171
 v_add_f32 v10, v170, v10
 v_mfma_f32_16x16x32_bf16 v[92:95], a[212:215], a[108:111], v[92:95]
 s_waitcnt vmcnt(6)
 s_barrier
 ds_read_b64_tr_b16 a[136:137], v1 offset:0
 ds_read_b64_tr_b16 a[138:139], v1 offset:4096
 ds_read_b64_tr_b16 a[140:141], v2 offset:0
 ds_read_b64_tr_b16 a[142:143], v2 offset:4096
 ds_read_b64_tr_b16 a[144:145], v1 offset:512
 ds_read_b64_tr_b16 a[146:147], v1 offset:4608
 v_mfma_f32_16x16x32_bf16 v[100:103], a[216:219], a[96:99], v[12:15]
 v_add_f32 v10, v171, v10
 v_exp_f32 v172, v172
 v_mfma_f32_16x16x32_bf16 v[100:103], a[224:227], a[100:103], v[100:103]
 v_exp_f32 v173, v173
 v_mfma_f32_16x16x32_bf16 v[100:103], a[228:231], a[104:107], v[100:103]
 v_exp_f32 v174, v174
 v_mfma_f32_16x16x32_bf16 v[100:103], a[232:235], a[108:111], v[100:103]
 v_exp_f32 v175, v175
 v_mfma_f32_16x16x32_bf16 v[108:111], a[236:239], a[96:99], v[12:15]
 v_cvt_pk_bf16_f32 v74, v172, v173
 v_add_f32 v10, v172, v10
 v_mfma_f32_16x16x32_bf16 v[108:111], a[240:243], a[100:103], v[108:111]
 v_add_f32 v10, v173, v10
 v_cvt_pk_bf16_f32 v75, v174, v175
 v_mfma_f32_16x16x32_bf16 v[108:111], a[244:247], a[104:107], v[108:111]
 v_add_f32 v10, v174, v10
 v_add_f32 v10, v175, v10
 v_mfma_f32_16x16x32_bf16 v[108:111], a[248:251], a[108:111], v[108:111]
 v_exp_f32 v84, v84
 v_mfma_f32_16x16x32_bf16 v[244:247], v[240:243], v[64:67], 0
 v_exp_f32 v85, v85
 v_mfma_f32_16x16x32_bf16 v[244:247], v[240:243], v[68:71], v[244:247]
 v_exp_f32 v86, v86
 v_mfma_f32_16x16x32_bf16 v[244:247], v[240:243], v[120:123], v[244:247]
 s_waitcnt lgkmcnt(0)
 v_exp_f32 v87, v87
 v_cvt_pk_bf16_f32 v76, v84, v85
 v_add_f32 v10, v84, v10
 v_add_f32 v10, v85, v10
 v_cvt_pk_bf16_f32 v77, v86, v87
 v_add_f32 v10, v86, v10
 v_add_f32 v10, v87, v10
 v_exp_f32 v92, v92
 v_exp_f32 v93, v93
 v_mov_b32 v9, v244
 s_mov_b32 s25, 81920
 s_mov_b32 s26, 49152
 s_mov_b32 s27, 8
 v_mfma_f32_16x16x32_bf16 v[136:139], v[24:27], a[136:139], v[228:231]
 v_exp_f32 v94, v94
 v_mfma_f32_16x16x32_bf16 v[168:171], v[32:35], a[136:139], v[228:231]
 s_add_u32 s36, s28, 16384
 ds_read_b64_tr_b16 a[148:149], v2 offset:512
 ds_read_b64_tr_b16 a[150:151], v2 offset:4608
 v_mfma_f32_16x16x32_bf16 v[200:203], v[40:43], a[136:139], v[228:231]
 s_add_u32 m0, s28, 81920
 v_exp_f32 v95, v95
 v_mfma_f32_16x16x32_bf16 v[232:235], v[48:51], a[136:139], v[228:231]
 buffer_load_dwordx4 v3, s[12:15], s36 offen offset:0 nt lds
 v_mfma_f32_16x16x32_bf16 a[160:163], v[56:59], a[136:139], a[252:255]
 v_cvt_pk_bf16_f32 v78, v92, v93
 v_add_f32 v10, v92, v10
 v_mfma_f32_16x16x32_bf16 a[192:195], v[64:67], a[136:139], a[252:255]
 v_mfma_f32_16x16x32_bf16 a[224:227], v[72:75], a[136:139], a[252:255]
 s_add_u32 m0, s28, 82816
 v_add_f32 v10, v93, v10
 v_cvt_pk_bf16_f32 v79, v94, v95
 v_mfma_f32_16x16x32_bf16 v[140:143], v[24:27], a[140:143], v[228:231]
 buffer_load_dwordx4 v3, s[12:15], s36 offen offset:128 nt lds
 v_mfma_f32_16x16x32_bf16 v[172:175], v[32:35], a[140:143], v[228:231]
 v_add_f32 v10, v94, v10
 v_add_f32 v10, v95, v10
 v_mfma_f32_16x16x32_bf16 v[204:207], v[40:43], a[140:143], v[228:231]
 s_add_u32 s36, s28, 24576
 ds_read_b64_tr_b16 a[136:137], v1 offset:1024
 ds_read_b64_tr_b16 a[138:139], v1 offset:5120
 v_mfma_f32_16x16x32_bf16 v[236:239], v[48:51], a[140:143], v[228:231]
 s_add_u32 m0, s28, 90112
 v_exp_f32 v100, v100
 v_mfma_f32_16x16x32_bf16 a[164:167], v[56:59], a[140:143], a[252:255]
 buffer_load_dwordx4 v3, s[12:15], s36 offen offset:0 nt lds
 v_mfma_f32_16x16x32_bf16 a[196:199], v[64:67], a[140:143], a[252:255]
 v_exp_f32 v101, v101
 v_mfma_f32_16x16x32_bf16 a[228:231], v[72:75], a[140:143], a[252:255]
 ds_read_b64_tr_b16 a[140:141], v2 offset:1024
 ds_read_b64_tr_b16 a[142:143], v2 offset:5120
 v_mfma_f32_16x16x32_bf16 v[144:147], v[24:27], a[144:147], v[228:231]
 s_add_u32 m0, s28, 91008
 v_exp_f32 v102, v102
 v_mfma_f32_16x16x32_bf16 v[176:179], v[32:35], a[144:147], v[228:231]
 buffer_load_dwordx4 v3, s[12:15], s36 offen offset:128 nt lds
 v_mfma_f32_16x16x32_bf16 v[208:211], v[40:43], a[144:147], v[228:231]
 v_exp_f32 v103, v103
 v_mfma_f32_16x16x32_bf16 v[240:243], v[48:51], a[144:147], v[228:231]
 s_add_u32 s36, s28, 40960
 v_mfma_f32_16x16x32_bf16 a[168:171], v[56:59], a[144:147], a[252:255]
 s_add_u32 m0, s28, 40960
 v_cvt_pk_bf16_f32 v128, v100, v101
 v_add_f32 v10, v100, v10
 v_mfma_f32_16x16x32_bf16 a[200:203], v[64:67], a[144:147], a[252:255]
 buffer_load_dwordx4 v3, s[8:11], s36 offen offset:0 nt lds
 v_mfma_f32_16x16x32_bf16 a[232:235], v[72:75], a[144:147], a[252:255]
 s_waitcnt lgkmcnt(0)
 v_add_f32 v10, v101, v10
 v_cvt_pk_bf16_f32 v129, v102, v103
 v_mfma_f32_16x16x32_bf16 v[148:151], v[24:27], a[148:151], v[228:231]
 ds_read_b64_tr_b16 a[144:145], v1 offset:1536
 ds_read_b64_tr_b16 a[146:147], v1 offset:5632
 v_mfma_f32_16x16x32_bf16 v[180:183], v[32:35], a[148:151], v[228:231]
 s_add_u32 m0, s28, 41856
 v_add_f32 v10, v102, v10
 v_add_f32 v10, v103, v10
 v_mfma_f32_16x16x32_bf16 v[212:215], v[40:43], a[148:151], v[228:231]
 buffer_load_dwordx4 v3, s[8:11], s36 offen offset:128 nt lds
 v_mfma_f32_16x16x32_bf16 v[244:247], v[48:51], a[148:151], v[228:231]
 v_exp_f32 v108, v108
 v_mfma_f32_16x16x32_bf16 a[172:175], v[56:59], a[148:151], a[252:255]
 s_add_u32 s36, s28, 32768
 v_mfma_f32_16x16x32_bf16 a[204:207], v[64:67], a[148:151], a[252:255]
 s_add_u32 m0, s28, 98304
 v_exp_f32 v109, v109
 v_mfma_f32_16x16x32_bf16 a[236:239], v[72:75], a[148:151], a[252:255]
 buffer_load_dwordx4 v3, s[12:15], s36 offen offset:0 nt lds
 v_mfma_f32_16x16x32_bf16 v[152:155], v[24:27], a[136:139], v[228:231]
 v_exp_f32 v110, v110
 v_mfma_f32_16x16x32_bf16 v[184:187], v[32:35], a[136:139], v[228:231]
 ds_read_b64_tr_b16 a[148:149], v2 offset:1536
 ds_read_b64_tr_b16 a[150:151], v2 offset:5632
 v_mfma_f32_16x16x32_bf16 v[216:219], v[40:43], a[136:139], v[228:231]
 s_add_u32 m0, s28, 99200
 v_exp_f32 v111, v111
 v_mfma_f32_16x16x32_bf16 v[248:251], v[48:51], a[136:139], v[228:231]
 buffer_load_dwordx4 v3, s[12:15], s36 offen offset:128 nt lds
 v_mfma_f32_16x16x32_bf16 a[176:179], v[56:59], a[136:139], a[252:255]
 v_cvt_pk_bf16_f32 v130, v108, v109
 v_add_f32 v10, v108, v10
 v_mfma_f32_16x16x32_bf16 a[208:211], v[64:67], a[136:139], a[252:255]
 v_mfma_f32_16x16x32_bf16 a[240:243], v[72:75], a[136:139], a[252:255]
 v_add_f32 v10, v109, v10
 v_cvt_pk_bf16_f32 v131, v110, v111
 v_mfma_f32_16x16x32_bf16 v[156:159], v[24:27], a[140:143], v[228:231]
 v_mfma_f32_16x16x32_bf16 v[188:191], v[32:35], a[140:143], v[228:231]
 v_add_f32 v10, v110, v10
 v_add_f32 v10, v111, v10
 v_mfma_f32_16x16x32_bf16 v[220:223], v[40:43], a[140:143], v[228:231]
 v_mfma_f32_16x16x32_bf16 v[252:255], v[48:51], a[140:143], v[228:231]
 v_mfma_f32_16x16x32_bf16 a[180:183], v[56:59], a[140:143], a[252:255]
 v_mfma_f32_16x16x32_bf16 a[212:215], v[64:67], a[140:143], a[252:255]
 v_mfma_f32_16x16x32_bf16 a[244:247], v[72:75], a[140:143], a[252:255]
 s_waitcnt lgkmcnt(0)
 s_waitcnt vmcnt(10)
 v_mfma_f32_16x16x32_bf16 v[160:163], v[24:27], a[144:147], v[228:231]
 s_barrier
 ds_read_b128 v[124:127], v0 offset:24576
 ds_read_b128 v[132:135], v0 offset:25088
 v_mfma_f32_16x16x32_bf16 v[192:195], v[32:35], a[144:147], v[228:231]
 ds_read_b128 a[128:131], v0 offset:25600
 ds_read_b128 a[132:135], v0 offset:26112
 v_mfma_f32_16x16x32_bf16 v[224:227], v[40:43], a[144:147], v[228:231]
 ds_read_b64_tr_b16 a[136:137], v1 offset:8192
 ds_read_b64_tr_b16 a[138:139], v1 offset:12288
 v_mfma_f32_16x16x32_bf16 a[152:155], v[48:51], a[144:147], a[252:255]
 ds_read_b64_tr_b16 a[140:141], v2 offset:8192
 ds_read_b64_tr_b16 a[142:143], v2 offset:12288
 v_mfma_f32_16x16x32_bf16 a[184:187], v[56:59], a[144:147], a[252:255]
 ds_read_b128 a[124:127], v0 offset:30208
 ds_read_b128 a[120:123], v0 offset:29696
 v_mfma_f32_16x16x32_bf16 a[216:219], v[64:67], a[144:147], a[252:255]
 ds_read_b128 a[116:119], v0 offset:29184
 ds_read_b128 a[112:115], v0 offset:28672
 v_mfma_f32_16x16x32_bf16 a[248:251], v[72:75], a[144:147], a[252:255]
 ds_read_b64_tr_b16 a[144:145], v1 offset:8704
 ds_read_b64_tr_b16 a[146:147], v1 offset:12800
 v_mfma_f32_16x16x32_bf16 v[164:167], v[24:27], a[148:151], v[228:231]
 v_mfma_f32_16x16x32_bf16 v[196:199], v[32:35], a[148:151], v[228:231]
 v_mfma_f32_16x16x32_bf16 v[228:231], v[40:43], a[148:151], v[228:231]
 v_mfma_f32_16x16x32_bf16 a[156:159], v[48:51], a[148:151], a[252:255]
 v_mfma_f32_16x16x32_bf16 a[188:191], v[56:59], a[148:151], a[252:255]
 v_mfma_f32_16x16x32_bf16 a[220:223], v[64:67], a[148:151], a[252:255]
 v_mfma_f32_16x16x32_bf16 a[252:255], v[72:75], a[148:151], a[252:255]
 s_waitcnt lgkmcnt(0)
 ds_read_b64_tr_b16 a[148:149], v2 offset:8704
 ds_read_b64_tr_b16 a[150:151], v2 offset:12800
 v_mfma_f32_16x16x32_bf16 v[16:19], v[124:127], a[0:3], v[12:15]
 v_mfma_f32_16x16x32_bf16 v[16:19], v[132:135], a[4:7], v[16:19]
 v_mfma_f32_16x16x32_bf16 v[16:19], a[128:131], a[8:11], v[16:19]
 v_mfma_f32_16x16x32_bf16 v[16:19], a[132:135], a[12:15], v[16:19]
 s_nop 0
 v_mfma_f32_16x16x32_bf16 v[20:23], a[132:135], a[28:31], v[12:15]
 s_nop 0
 v_mfma_f32_16x16x32_bf16 v[20:23], a[128:131], a[24:27], v[20:23]
 s_nop 0
 s_nop 0
 v_mfma_f32_16x16x32_bf16 v[20:23], v[132:135], a[20:23], v[20:23]
 s_nop 0
 v_exp_f32 v16, v16
 v_mfma_f32_16x16x32_bf16 v[20:23], v[124:127], a[16:19], v[20:23]
 v_exp_f32 v17, v17
 v_mfma_f32_16x16x32_bf16 v[136:139], v[28:31], a[136:139], v[136:139]
 v_exp_f32 v18, v18
 v_mfma_f32_16x16x32_bf16 v[168:171], v[36:39], a[136:139], v[168:171]
 v_add_f32 v4, v16, v4
 v_cvt_pk_bf16_f32 v84, v16, v17
 v_mfma_f32_16x16x32_bf16 v[200:203], v[44:47], a[136:139], v[200:203]
 v_exp_f32 v19, v19
 v_mfma_f32_16x16x32_bf16 v[232:235], v[52:55], a[136:139], v[232:235]
 v_add_f32 v4, v17, v4
 v_add_f32 v4, v18, v4
 v_mfma_f32_16x16x32_bf16 a[160:163], v[60:63], a[136:139], a[160:163]
 v_exp_f32 v20, v20
 v_mfma_f32_16x16x32_bf16 a[192:195], v[68:71], a[136:139], a[192:195]
 v_add_f32 v4, v19, v4
 v_cvt_pk_bf16_f32 v85, v18, v19
 v_mfma_f32_16x16x32_bf16 a[224:227], v[76:79], a[136:139], a[224:227]
 v_exp_f32 v21, v21
 v_mfma_f32_16x16x32_bf16 v[140:143], v[28:31], a[140:143], v[140:143]
 ds_read_b64_tr_b16 a[136:137], v1 offset:9216
 v_add_f32 v3, v20, v21
 v_mfma_f32_16x16x32_bf16 v[16:19], v[124:127], a[32:35], v[12:15]
 v_exp_f32 v22, v22
 v_mfma_f32_16x16x32_bf16 v[16:19], v[132:135], a[36:39], v[16:19]
 ds_read_b64_tr_b16 a[138:139], v1 offset:13312
 v_cvt_pk_bf16_f32 v92, v20, v21
 v_mfma_f32_16x16x32_bf16 v[16:19], a[128:131], a[40:43], v[16:19]
 v_exp_f32 v23, v23
 v_mfma_f32_16x16x32_bf16 v[16:19], a[132:135], a[44:47], v[16:19]
 v_add_f32 v11, v22, v23
 v_cvt_pk_bf16_f32 v93, v22, v23
 v_mfma_f32_16x16x32_bf16 v[20:23], a[132:135], a[60:63], v[12:15]
 v_add_f32 v5, v3, v5
 v_mfma_f32_16x16x32_bf16 v[20:23], a[128:131], a[56:59], v[20:23]
 s_nop 0
 v_add_f32 v5, v11, v5
 v_mfma_f32_16x16x32_bf16 v[20:23], v[132:135], a[52:55], v[20:23]
 v_exp_f32 v16, v16
 v_mfma_f32_16x16x32_bf16 v[20:23], v[124:127], a[48:51], v[20:23]
 v_exp_f32 v17, v17
 v_mfma_f32_16x16x32_bf16 v[172:175], v[36:39], a[140:143], v[172:175]
 v_exp_f32 v18, v18
 v_mfma_f32_16x16x32_bf16 v[204:207], v[44:47], a[140:143], v[204:207]
 v_add_f32 v6, v16, v6
 v_cvt_pk_bf16_f32 v100, v16, v17
 v_mfma_f32_16x16x32_bf16 v[236:239], v[52:55], a[140:143], v[236:239]
 v_exp_f32 v19, v19
 v_mfma_f32_16x16x32_bf16 a[164:167], v[60:63], a[140:143], a[164:167]
 v_add_f32 v6, v17, v6
 v_add_f32 v6, v18, v6
 v_mfma_f32_16x16x32_bf16 a[196:199], v[68:71], a[140:143], a[196:199]
 v_exp_f32 v20, v20
 v_mfma_f32_16x16x32_bf16 a[228:231], v[76:79], a[140:143], a[228:231]
 v_add_f32 v6, v19, v6
 v_cvt_pk_bf16_f32 v101, v18, v19
 v_mfma_f32_16x16x32_bf16 v[144:147], v[28:31], a[144:147], v[144:147]
 v_exp_f32 v21, v21
 v_mfma_f32_16x16x32_bf16 v[176:179], v[36:39], a[144:147], v[176:179]
 ds_read_b64_tr_b16 a[140:141], v2 offset:9216
 v_add_f32 v3, v20, v21
 v_mfma_f32_16x16x32_bf16 v[16:19], v[124:127], a[64:67], v[12:15]
 v_exp_f32 v22, v22
 v_mfma_f32_16x16x32_bf16 v[16:19], v[132:135], a[68:71], v[16:19]
 ds_read_b64_tr_b16 a[142:143], v2 offset:13312
 v_cvt_pk_bf16_f32 v108, v20, v21
 v_mfma_f32_16x16x32_bf16 v[16:19], a[128:131], a[72:75], v[16:19]
 v_exp_f32 v23, v23
 v_mfma_f32_16x16x32_bf16 v[16:19], a[132:135], a[76:79], v[16:19]
 v_add_f32 v11, v22, v23
 v_cvt_pk_bf16_f32 v109, v22, v23
 v_mfma_f32_16x16x32_bf16 v[20:23], a[132:135], a[92:95], v[12:15]
 v_add_f32 v7, v3, v7
 v_mfma_f32_16x16x32_bf16 v[20:23], a[128:131], a[88:91], v[20:23]
 s_nop 0
 v_add_f32 v7, v11, v7
 v_mfma_f32_16x16x32_bf16 v[20:23], v[132:135], a[84:87], v[20:23]
 v_exp_f32 v16, v16
 v_mfma_f32_16x16x32_bf16 v[20:23], v[124:127], a[80:83], v[20:23]
 v_exp_f32 v17, v17
 v_mfma_f32_16x16x32_bf16 v[208:211], v[44:47], a[144:147], v[208:211]
 v_exp_f32 v18, v18
 v_mfma_f32_16x16x32_bf16 v[240:243], v[52:55], a[144:147], v[240:243]
 v_add_f32 v8, v16, v8
 v_cvt_pk_bf16_f32 v116, v16, v17
 v_mfma_f32_16x16x32_bf16 a[168:171], v[60:63], a[144:147], a[168:171]
 v_exp_f32 v19, v19
 v_mfma_f32_16x16x32_bf16 a[200:203], v[68:71], a[144:147], a[200:203]
 v_add_f32 v8, v17, v8
 v_add_f32 v8, v18, v8
 v_mfma_f32_16x16x32_bf16 a[232:235], v[76:79], a[144:147], a[232:235]
 s_waitcnt lgkmcnt(0)
 v_exp_f32 v20, v20
 v_mfma_f32_16x16x32_bf16 v[148:151], v[28:31], a[148:151], v[148:151]
 v_add_f32 v8, v19, v8
 v_cvt_pk_bf16_f32 v117, v18, v19
 v_mfma_f32_16x16x32_bf16 v[180:183], v[36:39], a[148:151], v[180:183]
 v_exp_f32 v21, v21
 v_mfma_f32_16x16x32_bf16 v[212:215], v[44:47], a[148:151], v[212:215]
 ds_read_b64_tr_b16 a[144:145], v1 offset:9728
 v_add_f32 v3, v20, v21
 v_mfma_f32_16x16x32_bf16 v[16:19], v[124:127], a[96:99], v[12:15]
 v_exp_f32 v22, v22
 v_mfma_f32_16x16x32_bf16 v[16:19], v[132:135], a[100:103], v[16:19]
 ds_read_b64_tr_b16 a[146:147], v1 offset:13824
 v_cvt_pk_bf16_f32 v124, v20, v21
 v_mfma_f32_16x16x32_bf16 v[16:19], a[128:131], a[104:107], v[16:19]
 v_exp_f32 v23, v23
 v_mfma_f32_16x16x32_bf16 v[16:19], a[132:135], a[108:111], v[16:19]
 v_add_f32 v11, v22, v23
 v_cvt_pk_bf16_f32 v125, v22, v23
 v_mfma_f32_16x16x32_bf16 v[20:23], a[124:127], a[12:15], v[12:15]
 v_add_f32 v9, v3, v9
 v_mfma_f32_16x16x32_bf16 v[20:23], a[120:123], a[8:11], v[20:23]
 s_nop 0
 v_add_f32 v9, v11, v9
 v_mfma_f32_16x16x32_bf16 v[20:23], a[116:119], a[4:7], v[20:23]
 v_exp_f32 v16, v16
 v_mfma_f32_16x16x32_bf16 v[20:23], a[112:115], a[0:3], v[20:23]
 v_exp_f32 v17, v17
 v_mfma_f32_16x16x32_bf16 v[244:247], v[52:55], a[148:151], v[244:247]
 v_exp_f32 v18, v18
 v_mfma_f32_16x16x32_bf16 a[172:175], v[60:63], a[148:151], a[172:175]
 v_add_f32 v10, v16, v10
 v_cvt_pk_bf16_f32 v132, v16, v17
 v_mfma_f32_16x16x32_bf16 a[204:207], v[68:71], a[148:151], a[204:207]
 v_exp_f32 v19, v19
 v_mfma_f32_16x16x32_bf16 a[236:239], v[76:79], a[148:151], a[236:239]
 v_add_f32 v10, v17, v10
 v_add_f32 v10, v18, v10
 v_mfma_f32_16x16x32_bf16 v[152:155], v[28:31], a[136:139], v[152:155]
 v_exp_f32 v20, v20
 v_mfma_f32_16x16x32_bf16 v[184:187], v[36:39], a[136:139], v[184:187]
 v_add_f32 v10, v19, v10
 v_cvt_pk_bf16_f32 v133, v18, v19
 v_mfma_f32_16x16x32_bf16 v[216:219], v[44:47], a[136:139], v[216:219]
 v_exp_f32 v21, v21
 v_mfma_f32_16x16x32_bf16 v[248:251], v[52:55], a[136:139], v[248:251]
 ds_read_b64_tr_b16 a[148:149], v2 offset:9728
 v_add_f32 v3, v20, v21
 v_mfma_f32_16x16x32_bf16 v[16:19], a[112:115], a[16:19], v[12:15]
 v_exp_f32 v22, v22
 v_mfma_f32_16x16x32_bf16 v[16:19], a[116:119], a[20:23], v[16:19]
 ds_read_b64_tr_b16 a[150:151], v2 offset:13824
 v_cvt_pk_bf16_f32 v86, v20, v21
 v_mfma_f32_16x16x32_bf16 v[16:19], a[120:123], a[24:27], v[16:19]
 v_exp_f32 v23, v23
 v_mfma_f32_16x16x32_bf16 v[16:19], a[124:127], a[28:31], v[16:19]
 v_add_f32 v11, v22, v23
 v_cvt_pk_bf16_f32 v87, v22, v23
 v_mfma_f32_16x16x32_bf16 v[20:23], a[124:127], a[44:47], v[12:15]
 v_add_f32 v4, v3, v4
 v_mfma_f32_16x16x32_bf16 v[20:23], a[120:123], a[40:43], v[20:23]
 s_nop 0
 v_add_f32 v4, v11, v4
 v_mfma_f32_16x16x32_bf16 v[20:23], a[116:119], a[36:39], v[20:23]
 v_exp_f32 v16, v16
 v_mfma_f32_16x16x32_bf16 v[20:23], a[112:115], a[32:35], v[20:23]
 v_exp_f32 v17, v17
 v_mfma_f32_16x16x32_bf16 a[176:179], v[60:63], a[136:139], a[176:179]
 v_exp_f32 v18, v18
 v_mfma_f32_16x16x32_bf16 a[208:211], v[68:71], a[136:139], a[208:211]
 v_add_f32 v5, v16, v5
 v_cvt_pk_bf16_f32 v94, v16, v17
 v_mfma_f32_16x16x32_bf16 a[240:243], v[76:79], a[136:139], a[240:243]
 v_exp_f32 v19, v19
 v_mfma_f32_16x16x32_bf16 v[156:159], v[28:31], a[140:143], v[156:159]
 v_add_f32 v5, v17, v5
 v_add_f32 v5, v18, v5
 v_mfma_f32_16x16x32_bf16 v[188:191], v[36:39], a[140:143], v[188:191]
 v_exp_f32 v20, v20
 v_mfma_f32_16x16x32_bf16 v[220:223], v[44:47], a[140:143], v[220:223]
 v_add_f32 v5, v19, v5
 v_cvt_pk_bf16_f32 v95, v18, v19
 v_mfma_f32_16x16x32_bf16 v[252:255], v[52:55], a[140:143], v[252:255]
 v_exp_f32 v21, v21
 v_mfma_f32_16x16x32_bf16 a[180:183], v[60:63], a[140:143], a[180:183]
 v_add_f32 v3, v20, v21
 v_mfma_f32_16x16x32_bf16 v[16:19], a[112:115], a[48:51], v[12:15]
 v_exp_f32 v22, v22
 v_mfma_f32_16x16x32_bf16 v[16:19], a[116:119], a[52:55], v[16:19]
 v_cvt_pk_bf16_f32 v102, v20, v21
 v_mfma_f32_16x16x32_bf16 v[16:19], a[120:123], a[56:59], v[16:19]
 v_exp_f32 v23, v23
 v_mfma_f32_16x16x32_bf16 v[16:19], a[124:127], a[60:63], v[16:19]
 v_add_f32 v11, v22, v23
 v_cvt_pk_bf16_f32 v103, v22, v23
 v_mfma_f32_16x16x32_bf16 v[20:23], a[124:127], a[76:79], v[12:15]
 s_waitcnt vmcnt(2)
 v_add_f32 v6, v3, v6
 v_add_f32 v6, v11, v6
 v_mfma_f32_16x16x32_bf16 v[20:23], a[120:123], a[72:75], v[20:23]
 s_barrier
 v_mfma_f32_16x16x32_bf16 v[20:23], a[116:119], a[68:71], v[20:23]
 v_exp_f32 v16, v16
 v_mfma_f32_16x16x32_bf16 v[20:23], a[112:115], a[64:67], v[20:23]
 v_exp_f32 v17, v17
 v_mfma_f32_16x16x32_bf16 a[212:215], v[68:71], a[140:143], a[212:215]
 v_exp_f32 v18, v18
 v_mfma_f32_16x16x32_bf16 a[244:247], v[76:79], a[140:143], a[244:247]
 s_waitcnt lgkmcnt(0)
 v_add_f32 v7, v16, v7
 v_cvt_pk_bf16_f32 v110, v16, v17
 v_mfma_f32_16x16x32_bf16 v[160:163], v[28:31], a[144:147], v[160:163]
 v_exp_f32 v19, v19
 v_mfma_f32_16x16x32_bf16 v[192:195], v[36:39], a[144:147], v[192:195]
 v_add_f32 v7, v17, v7
 v_add_f32 v7, v18, v7
 v_mfma_f32_16x16x32_bf16 v[164:167], v[28:31], a[148:151], v[164:167]
 v_exp_f32 v20, v20
 v_mfma_f32_16x16x32_bf16 v[196:199], v[36:39], a[148:151], v[196:199]
 v_add_f32 v7, v19, v7
 v_cvt_pk_bf16_f32 v111, v18, v19
 v_mfma_f32_16x16x32_bf16 v[224:227], v[44:47], a[144:147], v[224:227]
 v_exp_f32 v21, v21
 v_mfma_f32_16x16x32_bf16 a[152:155], v[52:55], a[144:147], a[152:155]
 ds_read_b128 a[128:131], v0 offset:32768
 v_add_f32 v3, v20, v21
 v_mfma_f32_16x16x32_bf16 v[16:19], a[112:115], a[80:83], v[12:15]
 v_exp_f32 v22, v22
 v_mfma_f32_16x16x32_bf16 v[16:19], a[116:119], a[84:87], v[16:19]
 ds_read_b128 a[132:135], v0 offset:33280
 v_cvt_pk_bf16_f32 v118, v20, v21
 v_mfma_f32_16x16x32_bf16 v[16:19], a[120:123], a[88:91], v[16:19]
 v_exp_f32 v23, v23
 v_mfma_f32_16x16x32_bf16 v[16:19], a[124:127], a[92:95], v[16:19]
 v_add_f32 v11, v22, v23
 v_cvt_pk_bf16_f32 v119, v22, v23
 v_mfma_f32_16x16x32_bf16 v[20:23], a[124:127], a[108:111], v[12:15]
 ds_read_b128 v[28:31], v0 offset:33792
 v_add_f32 v8, v3, v8
 v_mfma_f32_16x16x32_bf16 v[20:23], a[120:123], a[104:107], v[20:23]
 ds_read_b128 v[36:39], v0 offset:34304
 v_add_f32 v8, v11, v8
 v_mfma_f32_16x16x32_bf16 v[20:23], a[116:119], a[100:103], v[20:23]
 v_exp_f32 v16, v16
 v_mfma_f32_16x16x32_bf16 v[20:23], a[112:115], a[96:99], v[20:23]
 v_exp_f32 v17, v17
 v_mfma_f32_16x16x32_bf16 a[184:187], v[60:63], a[144:147], a[184:187]
 v_exp_f32 v18, v18
 v_mfma_f32_16x16x32_bf16 a[216:219], v[68:71], a[144:147], a[216:219]
 v_add_f32 v9, v16, v9
 v_cvt_pk_bf16_f32 v126, v16, v17
 v_mfma_f32_16x16x32_bf16 a[248:251], v[76:79], a[144:147], a[248:251]
 v_exp_f32 v19, v19
 v_mfma_f32_16x16x32_bf16 v[228:231], v[44:47], a[148:151], v[228:231]
 v_add_f32 v9, v17, v9
 v_add_f32 v9, v18, v9
 v_mfma_f32_16x16x32_bf16 a[156:159], v[52:55], a[148:151], a[156:159]
 v_exp_f32 v20, v20
 v_mfma_f32_16x16x32_bf16 a[188:191], v[60:63], a[148:151], a[188:191]
 ds_read_b64_tr_b16 a[136:137], v1 offset:16384
 v_add_f32 v9, v19, v9
 v_cvt_pk_bf16_f32 v127, v18, v19
 v_mfma_f32_16x16x32_bf16 a[220:223], v[68:71], a[148:151], a[220:223]
 v_exp_f32 v21, v21
 v_mfma_f32_16x16x32_bf16 a[252:255], v[76:79], a[148:151], a[252:255]
 s_waitcnt lgkmcnt(1)
 ds_read_b64_tr_b16 a[138:139], v1 offset:20480
 v_add_f32 v3, v20, v21
 s_branch L_sub1_7
.p2align 6
L_loop_7:
 v_mfma_f32_16x16x32_bf16 v[16:19], a[128:131], a[0:3], v[12:15]
 v_exp_f32 v22, v22
 v_mfma_f32_16x16x32_bf16 v[16:19], a[132:135], a[4:7], v[16:19]
 ds_read_b64_tr_b16 a[140:141], v1 offset:40960
 v_cvt_pk_bf16_f32 v78, v20, v21
 v_mfma_f32_16x16x32_bf16 v[16:19], v[84:87], a[8:11], v[16:19]
 v_exp_f32 v23, v23
 v_mfma_f32_16x16x32_bf16 v[16:19], v[92:95], a[12:15], v[16:19]
 v_add_f32 v11, v22, v23
 v_cvt_pk_bf16_f32 v79, v22, v23
 v_mfma_f32_16x16x32_bf16 v[88:91], v[92:95], a[28:31], v[12:15]
 ds_read_b64_tr_b16 a[142:143], v1 offset:45056
 v_add_f32 v10, v3, v10
 v_mfma_f32_16x16x32_bf16 v[88:91], v[84:87], a[24:27], v[88:91]
 ds_read_b64_tr_b16 a[148:149], v2 offset:40960
 v_add_f32 v10, v11, v10
 v_mfma_f32_16x16x32_bf16 v[88:91], a[132:135], a[20:23], v[88:91]
 v_exp_f32 v16, v16
 v_mfma_f32_16x16x32_bf16 v[88:91], a[128:131], a[16:19], v[88:91]
 v_exp_f32 v17, v17
 v_mfma_f32_16x16x32_bf16 v[96:99], a[128:131], a[32:35], v[12:15]
 v_add_f32 v4, v16, v4
 v_cvt_pk_bf16_f32 v80, v16, v17
 v_mfma_f32_16x16x32_bf16 v[96:99], a[132:135], a[36:39], v[96:99]
 v_exp_f32 v18, v18
 v_mfma_f32_16x16x32_bf16 v[96:99], v[84:87], a[40:43], v[96:99]
 ds_read_b64_tr_b16 a[150:151], v2 offset:45056
 v_add_f32 v4, v17, v4
 v_mfma_f32_16x16x32_bf16 v[96:99], v[92:95], a[44:47], v[96:99]
 v_exp_f32 v19, v19
 v_mfma_f32_16x16x32_bf16 v[104:107], v[92:95], a[60:63], v[12:15]
 v_add_f32 v4, v18, v4
 v_cvt_pk_bf16_f32 v81, v18, v19
 v_mfma_f32_16x16x32_bf16 v[104:107], v[84:87], a[56:59], v[104:107]
 ds_read_b64_tr_b16 a[144:145], v2 offset:32768
 v_add_f32 v4, v19, v4
 v_mfma_f32_16x16x32_bf16 v[104:107], a[132:135], a[52:55], v[104:107]
 v_exp_f32 v88, v88
 v_mfma_f32_16x16x32_bf16 v[104:107], a[128:131], a[48:51], v[104:107]
 v_exp_f32 v89, v89
 v_mfma_f32_16x16x32_bf16 v[112:115], a[128:131], a[64:67], v[12:15]
 v_add_f32 v5, v88, v5
 v_cvt_pk_bf16_f32 v88, v88, v89
 v_mfma_f32_16x16x32_bf16 v[112:115], a[132:135], a[68:71], v[112:115]
 v_exp_f32 v90, v90
 v_mfma_f32_16x16x32_bf16 v[112:115], v[84:87], a[72:75], v[112:115]
 ds_read_b64_tr_b16 a[146:147], v2 offset:36864
 v_add_f32 v5, v89, v5
 v_mfma_f32_16x16x32_bf16 v[112:115], v[92:95], a[76:79], v[112:115]
 v_exp_f32 v91, v91
 v_mfma_f32_16x16x32_bf16 v[120:123], v[92:95], a[92:95], v[12:15]
 v_add_f32 v5, v90, v5
 v_cvt_pk_bf16_f32 v89, v90, v91
 v_mfma_f32_16x16x32_bf16 v[120:123], v[84:87], a[88:91], v[120:123]
 ds_read_b128 a[112:115], v0 offset:53248
 v_add_f32 v5, v91, v5
 v_mfma_f32_16x16x32_bf16 v[120:123], a[132:135], a[84:87], v[120:123]
 v_exp_f32 v96, v96
 v_mfma_f32_16x16x32_bf16 v[120:123], a[128:131], a[80:83], v[120:123]
 v_exp_f32 v97, v97
 v_mfma_f32_16x16x32_bf16 v[20:23], a[128:131], a[96:99], v[12:15]
 v_add_f32 v6, v96, v6
 v_cvt_pk_bf16_f32 v96, v96, v97
 v_mfma_f32_16x16x32_bf16 v[20:23], a[132:135], a[100:103], v[20:23]
 v_exp_f32 v98, v98
 v_mfma_f32_16x16x32_bf16 v[20:23], v[84:87], a[104:107], v[20:23]
 ds_read_b128 a[116:119], v0 offset:53760
 v_add_f32 v6, v97, v6
 v_mfma_f32_16x16x32_bf16 v[20:23], v[92:95], a[108:111], v[20:23]
 v_exp_f32 v99, v99
 v_mfma_f32_16x16x32_bf16 v[136:139], v[24:27], a[136:139], v[136:139]
 s_waitcnt lgkmcnt(1)
 v_add_f32 v6, v98, v6
 v_cvt_pk_bf16_f32 v97, v98, v99
 v_mfma_f32_16x16x32_bf16 v[136:139], v[28:31], a[140:143], v[136:139]
 ds_read_b128 a[120:123], v0 offset:54272
 v_add_f32 v6, v99, v6
 v_mfma_f32_16x16x32_bf16 v[168:171], v[36:39], a[140:143], v[168:171]
 v_exp_f32 v104, v104
 v_mfma_f32_16x16x32_bf16 v[168:171], v[32:35], a[136:139], v[168:171]
 v_exp_f32 v105, v105
 v_mfma_f32_16x16x32_bf16 v[200:203], v[40:43], a[136:139], v[200:203]
 v_add_f32 v7, v104, v7
 v_cvt_pk_bf16_f32 v104, v104, v105
 v_mfma_f32_16x16x32_bf16 v[200:203], v[44:47], a[140:143], v[200:203]
 v_exp_f32 v106, v106
 v_mfma_f32_16x16x32_bf16 v[232:235], v[52:55], a[140:143], v[232:235]
 ds_read_b128 a[124:127], v0 offset:54784
 v_add_f32 v7, v105, v7
 v_mfma_f32_16x16x32_bf16 v[232:235], v[48:51], a[136:139], v[232:235]
 v_exp_f32 v107, v107
 v_mfma_f32_16x16x32_bf16 a[160:163], v[56:59], a[136:139], a[160:163]
 v_add_f32 v7, v106, v7
 v_cvt_pk_bf16_f32 v105, v106, v107
 v_mfma_f32_16x16x32_bf16 a[160:163], v[60:63], a[140:143], a[160:163]
 ds_read_b128 v[124:127], v0 offset:57344
 v_add_f32 v7, v107, v7
 v_mfma_f32_16x16x32_bf16 a[192:195], v[68:71], a[140:143], a[192:195]
 v_exp_f32 v112, v112
 v_mfma_f32_16x16x32_bf16 a[192:195], v[64:67], a[136:139], a[192:195]
 v_exp_f32 v113, v113
 v_mfma_f32_16x16x32_bf16 a[224:227], v[72:75], a[136:139], a[224:227]
 v_add_f32 v8, v112, v8
 v_cvt_pk_bf16_f32 v112, v112, v113
 v_mfma_f32_16x16x32_bf16 a[224:227], v[76:79], a[140:143], a[224:227]
 v_exp_f32 v114, v114
 v_mfma_f32_16x16x32_bf16 v[140:143], v[28:31], a[148:151], v[140:143]
 ds_read_b64_tr_b16 a[136:137], v1 offset:33280
 v_add_f32 v8, v113, v8
 v_mfma_f32_16x16x32_bf16 v[140:143], v[24:27], a[144:147], v[140:143]
 v_exp_f32 v115, v115
 v_mfma_f32_16x16x32_bf16 v[172:175], v[32:35], a[144:147], v[172:175]
 v_add_f32 v8, v114, v8
 v_cvt_pk_bf16_f32 v113, v114, v115
 v_mfma_f32_16x16x32_bf16 v[172:175], v[36:39], a[148:151], v[172:175]
 ds_read_b64_tr_b16 a[138:139], v1 offset:37376
 v_add_f32 v8, v115, v8
 v_mfma_f32_16x16x32_bf16 v[204:207], v[44:47], a[148:151], v[204:207]
 v_exp_f32 v120, v120
 v_mfma_f32_16x16x32_bf16 v[204:207], v[40:43], a[144:147], v[204:207]
 v_exp_f32 v121, v121
 v_mfma_f32_16x16x32_bf16 v[236:239], v[48:51], a[144:147], v[236:239]
 v_exp_f32 v122, v122
 v_mfma_f32_16x16x32_bf16 v[236:239], v[52:55], a[148:151], v[236:239]
 v_add_f32 v9, v120, v9
 v_cvt_pk_bf16_f32 v120, v120, v121
 v_mfma_f32_16x16x32_bf16 a[164:167], v[60:63], a[148:151], a[164:167]
 v_exp_f32 v123, v123
 v_mfma_f32_16x16x32_bf16 a[164:167], v[56:59], a[144:147], a[164:167]
 v_add_f32 v9, v121, v9
 v_add_f32 v9, v122, v9
 v_mfma_f32_16x16x32_bf16 a[196:199], v[64:67], a[144:147], a[196:199]
 v_exp_f32 v20, v20
 v_mfma_f32_16x16x32_bf16 a[196:199], v[68:71], a[148:151], a[196:199]
 v_add_f32 v9, v123, v9
 v_cvt_pk_bf16_f32 v121, v122, v123
 v_mfma_f32_16x16x32_bf16 a[228:231], v[76:79], a[148:151], a[228:231]
 v_exp_f32 v21, v21
 v_mfma_f32_16x16x32_bf16 a[228:231], v[72:75], a[144:147], a[228:231]
 ds_read_b64_tr_b16 a[140:141], v1 offset:41472
 v_add_f32 v3, v20, v21
 v_mfma_f32_16x16x32_bf16 v[16:19], a[112:115], a[0:3], v[12:15]
 s_waitcnt lgkmcnt(1)
 v_exp_f32 v22, v22
 v_mfma_f32_16x16x32_bf16 v[16:19], a[116:119], a[4:7], v[16:19]
 ds_read_b64_tr_b16 a[142:143], v1 offset:45568
 v_cvt_pk_bf16_f32 v128, v20, v21
 v_mfma_f32_16x16x32_bf16 v[16:19], a[120:123], a[8:11], v[16:19]
 v_exp_f32 v23, v23
 v_mfma_f32_16x16x32_bf16 v[16:19], a[124:127], a[12:15], v[16:19]
 v_add_f32 v11, v22, v23
 v_cvt_pk_bf16_f32 v129, v22, v23
 v_mfma_f32_16x16x32_bf16 v[116:119], a[124:127], a[28:31], v[12:15]
 ds_read_b64_tr_b16 a[148:149], v2 offset:41472
 v_add_f32 v10, v3, v10
 v_mfma_f32_16x16x32_bf16 v[116:119], a[120:123], a[24:27], v[116:119]
 ds_read_b64_tr_b16 a[150:151], v2 offset:45568
 v_add_f32 v10, v11, v10
 v_mfma_f32_16x16x32_bf16 v[116:119], a[116:119], a[20:23], v[116:119]
 v_exp_f32 v16, v16
 v_mfma_f32_16x16x32_bf16 v[116:119], a[112:115], a[16:19], v[116:119]
 v_exp_f32 v17, v17
 v_mfma_f32_16x16x32_bf16 v[108:111], a[112:115], a[32:35], v[12:15]
 v_add_f32 v4, v16, v4
 v_cvt_pk_bf16_f32 v82, v16, v17
 v_mfma_f32_16x16x32_bf16 v[108:111], a[116:119], a[36:39], v[108:111]
 v_exp_f32 v18, v18
 v_mfma_f32_16x16x32_bf16 v[108:111], a[120:123], a[40:43], v[108:111]
 ds_read_b64_tr_b16 a[144:145], v2 offset:33280
 v_add_f32 v4, v17, v4
 v_mfma_f32_16x16x32_bf16 v[108:111], a[124:127], a[44:47], v[108:111]
 v_exp_f32 v19, v19
 v_mfma_f32_16x16x32_bf16 v[100:103], a[124:127], a[60:63], v[12:15]
 v_add_f32 v4, v18, v4
 v_cvt_pk_bf16_f32 v83, v18, v19
 v_mfma_f32_16x16x32_bf16 v[100:103], a[120:123], a[56:59], v[100:103]
 ds_read_b64_tr_b16 a[146:147], v2 offset:37376
 v_add_f32 v4, v19, v4
 v_mfma_f32_16x16x32_bf16 v[100:103], a[116:119], a[52:55], v[100:103]
 v_exp_f32 v116, v116
 v_mfma_f32_16x16x32_bf16 v[100:103], a[112:115], a[48:51], v[100:103]
 v_exp_f32 v117, v117
 v_mfma_f32_16x16x32_bf16 v[92:95], a[112:115], a[64:67], v[12:15]
 v_add_f32 v5, v116, v5
 v_cvt_pk_bf16_f32 v90, v116, v117
 v_mfma_f32_16x16x32_bf16 v[92:95], a[116:119], a[68:71], v[92:95]
 v_exp_f32 v118, v118
 v_mfma_f32_16x16x32_bf16 v[92:95], a[120:123], a[72:75], v[92:95]
 ds_read_b128 v[132:135], v0 offset:57856
 v_add_f32 v5, v117, v5
 v_mfma_f32_16x16x32_bf16 v[92:95], a[124:127], a[76:79], v[92:95]
 v_exp_f32 v119, v119
 v_mfma_f32_16x16x32_bf16 v[84:87], a[124:127], a[92:95], v[12:15]
 v_add_f32 v5, v118, v5
 v_cvt_pk_bf16_f32 v91, v118, v119
 v_mfma_f32_16x16x32_bf16 v[84:87], a[120:123], a[88:91], v[84:87]
 ds_read_b128 a[128:131], v0 offset:58368
 v_add_f32 v5, v119, v5
 v_mfma_f32_16x16x32_bf16 v[84:87], a[116:119], a[84:87], v[84:87]
 v_exp_f32 v108, v108
 v_mfma_f32_16x16x32_bf16 v[84:87], a[112:115], a[80:83], v[84:87]
 v_exp_f32 v109, v109
 v_mfma_f32_16x16x32_bf16 v[20:23], a[112:115], a[96:99], v[12:15]
 v_add_f32 v6, v108, v6
 v_cvt_pk_bf16_f32 v98, v108, v109
 v_mfma_f32_16x16x32_bf16 v[20:23], a[116:119], a[100:103], v[20:23]
 v_exp_f32 v110, v110
 v_mfma_f32_16x16x32_bf16 v[20:23], a[120:123], a[104:107], v[20:23]
 ds_read_b128 a[132:135], v0 offset:58880
 v_add_f32 v6, v109, v6
 v_mfma_f32_16x16x32_bf16 v[20:23], a[124:127], a[108:111], v[20:23]
 v_exp_f32 v111, v111
 v_mfma_f32_16x16x32_bf16 v[144:147], v[24:27], a[136:139], v[144:147]
 s_waitcnt lgkmcnt(1)
 v_add_f32 v6, v110, v6
 v_cvt_pk_bf16_f32 v99, v110, v111
 v_mfma_f32_16x16x32_bf16 v[144:147], v[28:31], a[140:143], v[144:147]
 v_add_f32 v6, v111, v6
 v_mfma_f32_16x16x32_bf16 v[176:179], v[36:39], a[140:143], v[176:179]
 v_exp_f32 v100, v100
 v_mfma_f32_16x16x32_bf16 v[176:179], v[32:35], a[136:139], v[176:179]
 v_exp_f32 v101, v101
 v_mfma_f32_16x16x32_bf16 v[208:211], v[40:43], a[136:139], v[208:211]
 v_add_f32 v7, v100, v7
 v_cvt_pk_bf16_f32 v106, v100, v101
 v_mfma_f32_16x16x32_bf16 v[208:211], v[44:47], a[140:143], v[208:211]
 v_exp_f32 v102, v102
 v_mfma_f32_16x16x32_bf16 v[240:243], v[52:55], a[140:143], v[240:243]
 ds_read_b128 a[124:127], v0 offset:62976
 v_add_f32 v7, v101, v7
 v_mfma_f32_16x16x32_bf16 v[240:243], v[48:51], a[136:139], v[240:243]
 v_exp_f32 v103, v103
 v_mfma_f32_16x16x32_bf16 a[168:171], v[56:59], a[136:139], a[168:171]
 v_add_f32 v7, v102, v7
 v_cvt_pk_bf16_f32 v107, v102, v103
 v_mfma_f32_16x16x32_bf16 a[168:171], v[60:63], a[140:143], a[168:171]
 ds_read_b128 a[120:123], v0 offset:62464
 v_add_f32 v7, v103, v7
 v_mfma_f32_16x16x32_bf16 a[200:203], v[68:71], a[140:143], a[200:203]
 v_exp_f32 v92, v92
 v_mfma_f32_16x16x32_bf16 a[200:203], v[64:67], a[136:139], a[200:203]
 v_exp_f32 v93, v93
 v_mfma_f32_16x16x32_bf16 a[232:235], v[72:75], a[136:139], a[232:235]
 v_add_f32 v8, v92, v8
 v_cvt_pk_bf16_f32 v114, v92, v93
 v_mfma_f32_16x16x32_bf16 a[232:235], v[76:79], a[140:143], a[232:235]
 v_exp_f32 v94, v94
 v_mfma_f32_16x16x32_bf16 v[148:151], v[28:31], a[148:151], v[148:151]
 ds_read_b64_tr_b16 a[136:137], v1 offset:33792
 v_add_f32 v8, v93, v8
 v_mfma_f32_16x16x32_bf16 v[148:151], v[24:27], a[144:147], v[148:151]
 v_exp_f32 v95, v95
 v_mfma_f32_16x16x32_bf16 v[180:183], v[32:35], a[144:147], v[180:183]
 v_add_f32 v8, v94, v8
 v_cvt_pk_bf16_f32 v115, v94, v95
 v_mfma_f32_16x16x32_bf16 v[180:183], v[36:39], a[148:151], v[180:183]
 ds_read_b64_tr_b16 a[138:139], v1 offset:37888
 v_add_f32 v8, v95, v8
 v_mfma_f32_16x16x32_bf16 v[212:215], v[44:47], a[148:151], v[212:215]
 v_exp_f32 v84, v84
 v_mfma_f32_16x16x32_bf16 v[212:215], v[40:43], a[144:147], v[212:215]
 v_exp_f32 v85, v85
 v_mfma_f32_16x16x32_bf16 v[244:247], v[48:51], a[144:147], v[244:247]
 v_exp_f32 v86, v86
 v_mfma_f32_16x16x32_bf16 v[244:247], v[52:55], a[148:151], v[244:247]
 v_add_f32 v9, v84, v9
 v_cvt_pk_bf16_f32 v122, v84, v85
 v_mfma_f32_16x16x32_bf16 a[172:175], v[60:63], a[148:151], a[172:175]
 v_exp_f32 v87, v87
 v_mfma_f32_16x16x32_bf16 a[172:175], v[56:59], a[144:147], a[172:175]
 v_add_f32 v9, v85, v9
 v_add_f32 v9, v86, v9
 v_mfma_f32_16x16x32_bf16 a[204:207], v[64:67], a[144:147], a[204:207]
 v_exp_f32 v20, v20
 v_mfma_f32_16x16x32_bf16 a[204:207], v[68:71], a[148:151], a[204:207]
 v_add_f32 v9, v87, v9
 v_cvt_pk_bf16_f32 v123, v86, v87
 v_mfma_f32_16x16x32_bf16 a[236:239], v[76:79], a[148:151], a[236:239]
 v_exp_f32 v21, v21
 v_mfma_f32_16x16x32_bf16 a[236:239], v[72:75], a[144:147], a[236:239]
 ds_read_b64_tr_b16 a[140:141], v1 offset:41984
 v_add_f32 v3, v20, v21
 v_mfma_f32_16x16x32_bf16 v[16:19], v[124:127], a[0:3], v[12:15]
 v_exp_f32 v22, v22
 v_mfma_f32_16x16x32_bf16 v[16:19], v[132:135], a[4:7], v[16:19]
 ds_read_b64_tr_b16 a[142:143], v1 offset:46080
 v_cvt_pk_bf16_f32 v130, v20, v21
 v_mfma_f32_16x16x32_bf16 v[16:19], a[128:131], a[8:11], v[16:19]
 s_waitcnt lgkmcnt(2)
 v_exp_f32 v23, v23
 v_mfma_f32_16x16x32_bf16 v[16:19], a[132:135], a[12:15], v[16:19]
 v_add_f32 v11, v22, v23
 v_cvt_pk_bf16_f32 v131, v22, v23
 v_mfma_f32_16x16x32_bf16 v[92:95], a[132:135], a[28:31], v[12:15]
 ds_read_b64_tr_b16 a[148:149], v2 offset:41984
 v_add_f32 v10, v3, v10
 v_mfma_f32_16x16x32_bf16 v[92:95], a[128:131], a[24:27], v[92:95]
 ds_read_b64_tr_b16 a[150:151], v2 offset:46080
 v_add_f32 v10, v11, v10
 v_mfma_f32_16x16x32_bf16 v[92:95], v[132:135], a[20:23], v[92:95]
 v_exp_f32 v16, v16
 v_mfma_f32_16x16x32_bf16 v[92:95], v[124:127], a[16:19], v[92:95]
 v_exp_f32 v17, v17
 v_mfma_f32_16x16x32_bf16 v[100:103], v[124:127], a[32:35], v[12:15]
 v_add_f32 v4, v16, v4
 v_cvt_pk_bf16_f32 v84, v16, v17
 v_mfma_f32_16x16x32_bf16 v[100:103], v[132:135], a[36:39], v[100:103]
 v_exp_f32 v18, v18
 v_mfma_f32_16x16x32_bf16 v[100:103], a[128:131], a[40:43], v[100:103]
 ds_read_b64_tr_b16 a[144:145], v2 offset:33792
 v_add_f32 v4, v17, v4
 v_mfma_f32_16x16x32_bf16 v[100:103], a[132:135], a[44:47], v[100:103]
 v_exp_f32 v19, v19
 v_mfma_f32_16x16x32_bf16 v[108:111], a[132:135], a[60:63], v[12:15]
 v_add_f32 v4, v18, v4
 v_cvt_pk_bf16_f32 v85, v18, v19
 v_mfma_f32_16x16x32_bf16 v[108:111], a[128:131], a[56:59], v[108:111]
 ds_read_b64_tr_b16 a[146:147], v2 offset:37888
 v_add_f32 v4, v19, v4
 v_mfma_f32_16x16x32_bf16 v[108:111], v[132:135], a[52:55], v[108:111]
 v_exp_f32 v92, v92
 v_mfma_f32_16x16x32_bf16 v[108:111], v[124:127], a[48:51], v[108:111]
 v_exp_f32 v93, v93
 v_mfma_f32_16x16x32_bf16 v[116:119], v[124:127], a[64:67], v[12:15]
 v_add_f32 v5, v92, v5
 v_cvt_pk_bf16_f32 v92, v92, v93
 v_mfma_f32_16x16x32_bf16 v[116:119], v[132:135], a[68:71], v[116:119]
 v_exp_f32 v94, v94
 v_mfma_f32_16x16x32_bf16 v[116:119], a[128:131], a[72:75], v[116:119]
 ds_read_b128 a[116:119], v0 offset:61952
 v_add_f32 v5, v93, v5
 v_mfma_f32_16x16x32_bf16 v[116:119], a[132:135], a[76:79], v[116:119]
 v_exp_f32 v95, v95
 v_mfma_f32_16x16x32_bf16 v[20:23], a[132:135], a[92:95], v[12:15]
 v_add_f32 v5, v94, v5
 v_cvt_pk_bf16_f32 v93, v94, v95
 v_mfma_f32_16x16x32_bf16 v[20:23], a[128:131], a[88:91], v[20:23]
 ds_read_b128 a[112:115], v0 offset:61440
 v_add_f32 v5, v95, v5
 v_mfma_f32_16x16x32_bf16 v[20:23], v[132:135], a[84:87], v[20:23]
 v_exp_f32 v100, v100
 v_mfma_f32_16x16x32_bf16 v[20:23], v[124:127], a[80:83], v[20:23]
 v_exp_f32 v101, v101
 v_mfma_f32_16x16x32_bf16 v[152:155], v[24:27], a[136:139], v[152:155]
 s_waitcnt lgkmcnt(2)
 v_add_f32 v6, v100, v6
 v_cvt_pk_bf16_f32 v100, v100, v101
 v_mfma_f32_16x16x32_bf16 v[152:155], v[28:31], a[140:143], v[152:155]
 v_exp_f32 v102, v102
 v_mfma_f32_16x16x32_bf16 v[184:187], v[36:39], a[140:143], v[184:187]
 v_add_f32 v6, v101, v6
 v_mfma_f32_16x16x32_bf16 v[184:187], v[32:35], a[136:139], v[184:187]
 v_exp_f32 v103, v103
 v_mfma_f32_16x16x32_bf16 v[216:219], v[40:43], a[136:139], v[216:219]
 v_add_f32 v6, v102, v6
 v_cvt_pk_bf16_f32 v101, v102, v103
 v_mfma_f32_16x16x32_bf16 v[216:219], v[44:47], a[140:143], v[216:219]
 v_add_f32 v6, v103, v6
 v_mfma_f32_16x16x32_bf16 v[248:251], v[52:55], a[140:143], v[248:251]
 v_exp_f32 v108, v108
 v_mfma_f32_16x16x32_bf16 v[248:251], v[48:51], a[136:139], v[248:251]
 v_exp_f32 v109, v109
 v_mfma_f32_16x16x32_bf16 a[176:179], v[56:59], a[136:139], a[176:179]
 v_add_f32 v7, v108, v7
 v_cvt_pk_bf16_f32 v108, v108, v109
 v_mfma_f32_16x16x32_bf16 a[176:179], v[60:63], a[140:143], a[176:179]
 v_exp_f32 v110, v110
 v_mfma_f32_16x16x32_bf16 a[208:211], v[68:71], a[140:143], a[208:211]
 v_add_f32 v7, v109, v7
 v_mfma_f32_16x16x32_bf16 a[208:211], v[64:67], a[136:139], a[208:211]
 v_exp_f32 v111, v111
 v_mfma_f32_16x16x32_bf16 a[240:243], v[72:75], a[136:139], a[240:243]
 v_add_f32 v7, v110, v7
 v_cvt_pk_bf16_f32 v109, v110, v111
 v_mfma_f32_16x16x32_bf16 a[240:243], v[76:79], a[140:143], a[240:243]
 ds_read_b64_tr_b16 a[136:137], v1 offset:34304
 v_add_f32 v7, v111, v7
 v_mfma_f32_16x16x32_bf16 v[156:159], v[28:31], a[148:151], v[156:159]
 v_exp_f32 v116, v116
 v_mfma_f32_16x16x32_bf16 v[156:159], v[24:27], a[144:147], v[156:159]
 v_exp_f32 v117, v117
 v_mfma_f32_16x16x32_bf16 v[188:191], v[32:35], a[144:147], v[188:191]
 v_exp_f32 v118, v118
 v_mfma_f32_16x16x32_bf16 v[188:191], v[36:39], a[148:151], v[188:191]
 v_add_f32 v8, v116, v8
 v_cvt_pk_bf16_f32 v116, v116, v117
 v_mfma_f32_16x16x32_bf16 v[220:223], v[44:47], a[148:151], v[220:223]
 v_exp_f32 v119, v119
 v_mfma_f32_16x16x32_bf16 v[220:223], v[40:43], a[144:147], v[220:223]
 v_add_f32 v8, v117, v8
 v_add_f32 v8, v118, v8
 v_mfma_f32_16x16x32_bf16 v[252:255], v[48:51], a[144:147], v[252:255]
 v_exp_f32 v20, v20
 v_mfma_f32_16x16x32_bf16 v[252:255], v[52:55], a[148:151], v[252:255]
 v_add_f32 v8, v119, v8
 v_cvt_pk_bf16_f32 v117, v118, v119
 v_mfma_f32_16x16x32_bf16 a[180:183], v[60:63], a[148:151], a[180:183]
 v_exp_f32 v21, v21
 v_mfma_f32_16x16x32_bf16 a[180:183], v[56:59], a[144:147], a[180:183]
 ds_read_b64_tr_b16 a[138:139], v1 offset:38400
 v_add_f32 v3, v20, v21
 v_mfma_f32_16x16x32_bf16 v[16:19], v[124:127], a[96:99], v[12:15]
 v_exp_f32 v22, v22
 v_mfma_f32_16x16x32_bf16 v[16:19], v[132:135], a[100:103], v[16:19]
 ds_read_b64_tr_b16 a[140:141], v1 offset:42496
 v_cvt_pk_bf16_f32 v124, v20, v21
 v_mfma_f32_16x16x32_bf16 v[16:19], a[128:131], a[104:107], v[16:19]
 v_exp_f32 v23, v23
 v_mfma_f32_16x16x32_bf16 v[16:19], a[132:135], a[108:111], v[16:19]
 v_add_f32 v11, v22, v23
 v_cvt_pk_bf16_f32 v125, v22, v23
 v_mfma_f32_16x16x32_bf16 v[20:23], a[124:127], a[12:15], v[12:15]
 ds_read_b64_tr_b16 a[142:143], v1 offset:46592
 v_add_f32 v9, v3, v9
 v_mfma_f32_16x16x32_bf16 v[20:23], a[120:123], a[8:11], v[20:23]
 s_waitcnt lgkmcnt(3)
 v_add_f32 v9, v11, v9
 v_mfma_f32_16x16x32_bf16 v[20:23], a[116:119], a[4:7], v[20:23]
 v_exp_f32 v16, v16
 v_mfma_f32_16x16x32_bf16 v[20:23], a[112:115], a[0:3], v[20:23]
 v_exp_f32 v17, v17
 v_mfma_f32_16x16x32_bf16 a[212:215], v[64:67], a[144:147], a[212:215]
 v_exp_f32 v18, v18
 v_mfma_f32_16x16x32_bf16 a[212:215], v[68:71], a[148:151], a[212:215]
 v_add_f32 v10, v16, v10
 v_cvt_pk_bf16_f32 v132, v16, v17
 v_mfma_f32_16x16x32_bf16 a[244:247], v[76:79], a[148:151], a[244:247]
 v_exp_f32 v19, v19
 v_mfma_f32_16x16x32_bf16 a[244:247], v[72:75], a[144:147], a[244:247]
 s_waitcnt lgkmcnt(0)
 v_add_f32 v10, v17, v10
 v_add_f32 v10, v18, v10
 v_mfma_f32_16x16x32_bf16 v[160:163], v[24:27], a[136:139], v[160:163]
 v_exp_f32 v20, v20
 v_mfma_f32_16x16x32_bf16 v[160:163], v[28:31], a[140:143], v[160:163]
 v_add_f32 v10, v19, v10
 v_cvt_pk_bf16_f32 v133, v18, v19
 v_mfma_f32_16x16x32_bf16 v[192:195], v[36:39], a[140:143], v[192:195]
 v_exp_f32 v21, v21
 v_mfma_f32_16x16x32_bf16 v[192:195], v[32:35], a[136:139], v[192:195]
 ds_read_b64_tr_b16 a[148:149], v2 offset:42496
 v_add_f32 v3, v20, v21
 v_mfma_f32_16x16x32_bf16 v[16:19], a[112:115], a[16:19], v[12:15]
 v_exp_f32 v22, v22
 v_mfma_f32_16x16x32_bf16 v[16:19], a[116:119], a[20:23], v[16:19]
 ds_read_b64_tr_b16 a[150:151], v2 offset:46592
 v_cvt_pk_bf16_f32 v86, v20, v21
 v_mfma_f32_16x16x32_bf16 v[16:19], a[120:123], a[24:27], v[16:19]
 v_exp_f32 v23, v23
 v_mfma_f32_16x16x32_bf16 v[16:19], a[124:127], a[28:31], v[16:19]
 v_add_f32 v11, v22, v23
 v_cvt_pk_bf16_f32 v87, v22, v23
 v_mfma_f32_16x16x32_bf16 v[20:23], a[124:127], a[44:47], v[12:15]
 s_waitcnt vmcnt(0)
 v_add_f32 v4, v3, v4
 v_add_f32 v4, v11, v4
 v_mfma_f32_16x16x32_bf16 v[20:23], a[120:123], a[40:43], v[20:23]
 s_barrier
 v_mfma_f32_16x16x32_bf16 v[20:23], a[116:119], a[36:39], v[20:23]
 v_exp_f32 v16, v16
 v_mfma_f32_16x16x32_bf16 v[20:23], a[112:115], a[32:35], v[20:23]
 v_exp_f32 v17, v17
 v_mfma_f32_16x16x32_bf16 v[224:227], v[40:43], a[136:139], v[224:227]
 v_exp_f32 v18, v18
 v_mfma_f32_16x16x32_bf16 v[224:227], v[44:47], a[140:143], v[224:227]
 v_add_f32 v5, v16, v5
 v_cvt_pk_bf16_f32 v94, v16, v17
 v_mfma_f32_16x16x32_bf16 a[152:155], v[52:55], a[140:143], a[152:155]
 v_exp_f32 v19, v19
 v_mfma_f32_16x16x32_bf16 a[152:155], v[48:51], a[136:139], a[152:155]
 v_add_f32 v5, v17, v5
 v_add_f32 v5, v18, v5
 v_mfma_f32_16x16x32_bf16 a[184:187], v[56:59], a[136:139], a[184:187]
 v_exp_f32 v20, v20
 v_mfma_f32_16x16x32_bf16 a[184:187], v[60:63], a[140:143], a[184:187]
 v_add_f32 v5, v19, v5
 v_cvt_pk_bf16_f32 v95, v18, v19
 v_mfma_f32_16x16x32_bf16 a[216:219], v[68:71], a[140:143], a[216:219]
 v_exp_f32 v21, v21
 v_mfma_f32_16x16x32_bf16 a[216:219], v[64:67], a[136:139], a[216:219]
 ds_read_b64_tr_b16 a[144:145], v2 offset:34304
 v_add_f32 v3, v20, v21
 v_mfma_f32_16x16x32_bf16 v[16:19], a[112:115], a[48:51], v[12:15]
 v_exp_f32 v22, v22
 v_mfma_f32_16x16x32_bf16 v[16:19], a[116:119], a[52:55], v[16:19]
 ds_read_b64_tr_b16 a[146:147], v2 offset:38400
 v_cvt_pk_bf16_f32 v102, v20, v21
 v_mfma_f32_16x16x32_bf16 v[16:19], a[120:123], a[56:59], v[16:19]
 v_exp_f32 v23, v23
 v_mfma_f32_16x16x32_bf16 v[16:19], a[124:127], a[60:63], v[16:19]
 v_add_f32 v11, v22, v23
 v_cvt_pk_bf16_f32 v103, v22, v23
 v_mfma_f32_16x16x32_bf16 v[20:23], a[124:127], a[76:79], v[12:15]
 ds_read_b128 a[128:131], v0 offset:0
 v_add_f32 v6, v3, v6
 v_mfma_f32_16x16x32_bf16 v[20:23], a[120:123], a[72:75], v[20:23]
 ds_read_b128 a[132:135], v0 offset:512
 v_add_f32 v6, v11, v6
 v_mfma_f32_16x16x32_bf16 v[20:23], a[116:119], a[68:71], v[20:23]
 v_exp_f32 v16, v16
 v_mfma_f32_16x16x32_bf16 v[20:23], a[112:115], a[64:67], v[20:23]
 v_exp_f32 v17, v17
 v_mfma_f32_16x16x32_bf16 a[248:251], v[72:75], a[136:139], a[248:251]
 v_exp_f32 v18, v18
 v_mfma_f32_16x16x32_bf16 a[248:251], v[76:79], a[140:143], a[248:251]
 s_waitcnt lgkmcnt(2)
 v_add_f32 v7, v16, v7
 v_cvt_pk_bf16_f32 v110, v16, v17
 v_mfma_f32_16x16x32_bf16 v[164:167], v[28:31], a[148:151], v[164:167]
 v_exp_f32 v19, v19
 v_mfma_f32_16x16x32_bf16 v[164:167], v[24:27], a[144:147], v[164:167]
 v_add_f32 v7, v17, v7
 v_add_f32 v7, v18, v7
 v_mfma_f32_16x16x32_bf16 v[196:199], v[32:35], a[144:147], v[196:199]
 v_exp_f32 v20, v20
 v_mfma_f32_16x16x32_bf16 v[196:199], v[36:39], a[148:151], v[196:199]
 v_add_f32 v7, v19, v7
 v_cvt_pk_bf16_f32 v111, v18, v19
 v_mfma_f32_16x16x32_bf16 v[228:231], v[44:47], a[148:151], v[228:231]
 v_exp_f32 v21, v21
 v_mfma_f32_16x16x32_bf16 v[228:231], v[40:43], a[144:147], v[228:231]
 ds_read_b128 v[28:31], v0 offset:1024
 v_add_f32 v3, v20, v21
 v_mfma_f32_16x16x32_bf16 v[16:19], a[112:115], a[80:83], v[12:15]
 v_exp_f32 v22, v22
 v_mfma_f32_16x16x32_bf16 v[16:19], a[116:119], a[84:87], v[16:19]
 ds_read_b128 v[36:39], v0 offset:1536
 v_cvt_pk_bf16_f32 v118, v20, v21
 v_mfma_f32_16x16x32_bf16 v[16:19], a[120:123], a[88:91], v[16:19]
 v_exp_f32 v23, v23
 v_mfma_f32_16x16x32_bf16 v[16:19], a[124:127], a[92:95], v[16:19]
 v_add_f32 v11, v22, v23
 v_cvt_pk_bf16_f32 v119, v22, v23
 v_mfma_f32_16x16x32_bf16 v[20:23], a[124:127], a[108:111], v[12:15]
 ds_read_b64_tr_b16 a[136:137], v1 offset:49152
 v_add_f32 v8, v3, v8
 v_mfma_f32_16x16x32_bf16 v[20:23], a[120:123], a[104:107], v[20:23]
 ds_read_b64_tr_b16 a[138:139], v1 offset:53248
 v_add_f32 v8, v11, v8
 v_mfma_f32_16x16x32_bf16 v[20:23], a[116:119], a[100:103], v[20:23]
 v_exp_f32 v16, v16
 v_mfma_f32_16x16x32_bf16 v[20:23], a[112:115], a[96:99], v[20:23]
 v_exp_f32 v17, v17
 v_mfma_f32_16x16x32_bf16 a[156:159], v[48:51], a[144:147], a[156:159]
 v_exp_f32 v18, v18
 v_mfma_f32_16x16x32_bf16 a[156:159], v[52:55], a[148:151], a[156:159]
 v_add_f32 v9, v16, v9
 v_cvt_pk_bf16_f32 v126, v16, v17
 v_mfma_f32_16x16x32_bf16 a[188:191], v[60:63], a[148:151], a[188:191]
 v_exp_f32 v19, v19
 v_mfma_f32_16x16x32_bf16 a[188:191], v[56:59], a[144:147], a[188:191]
 v_add_f32 v9, v17, v9
 v_add_f32 v9, v18, v9
 v_mfma_f32_16x16x32_bf16 a[220:223], v[64:67], a[144:147], a[220:223]
 v_exp_f32 v20, v20
 v_mfma_f32_16x16x32_bf16 a[220:223], v[68:71], a[148:151], a[220:223]
 v_add_f32 v9, v19, v9
 v_cvt_pk_bf16_f32 v127, v18, v19
 v_mfma_f32_16x16x32_bf16 a[252:255], v[76:79], a[148:151], a[252:255]
 v_exp_f32 v21, v21
 v_mfma_f32_16x16x32_bf16 a[252:255], v[72:75], a[144:147], a[252:255]
 s_waitcnt lgkmcnt(0)
 v_add_f32 v3, v20, v21
 v_mfma_f32_16x16x32_bf16 v[16:19], a[128:131], a[0:3], v[12:15]
 v_exp_f32 v22, v22
 v_mfma_f32_16x16x32_bf16 v[16:19], a[132:135], a[4:7], v[16:19]
 ds_read_b64_tr_b16 a[140:141], v1 offset:57344
 v_cvt_pk_bf16_f32 v134, v20, v21
 v_mfma_f32_16x16x32_bf16 v[16:19], v[28:31], a[8:11], v[16:19]
 v_exp_f32 v23, v23
 v_mfma_f32_16x16x32_bf16 v[16:19], v[36:39], a[12:15], v[16:19]
 v_add_f32 v11, v22, v23
 v_cvt_pk_bf16_f32 v135, v22, v23
 v_mfma_f32_16x16x32_bf16 v[32:35], v[36:39], a[28:31], v[12:15]
 ds_read_b64_tr_b16 a[142:143], v1 offset:61440
 v_add_f32 v10, v3, v10
 v_mfma_f32_16x16x32_bf16 v[32:35], v[28:31], a[24:27], v[32:35]
 ds_read_b64_tr_b16 a[148:149], v2 offset:57344
 v_add_f32 v10, v11, v10
 v_mfma_f32_16x16x32_bf16 v[32:35], a[132:135], a[20:23], v[32:35]
 v_exp_f32 v16, v16
 v_mfma_f32_16x16x32_bf16 v[32:35], a[128:131], a[16:19], v[32:35]
 v_exp_f32 v17, v17
 v_mfma_f32_16x16x32_bf16 v[40:43], a[128:131], a[32:35], v[12:15]
 v_add_f32 v4, v16, v4
 v_cvt_pk_bf16_f32 v24, v16, v17
 v_mfma_f32_16x16x32_bf16 v[40:43], a[132:135], a[36:39], v[40:43]
 v_exp_f32 v18, v18
 v_mfma_f32_16x16x32_bf16 v[40:43], v[28:31], a[40:43], v[40:43]
 ds_read_b64_tr_b16 a[150:151], v2 offset:61440
 v_add_f32 v4, v17, v4
 v_mfma_f32_16x16x32_bf16 v[40:43], v[36:39], a[44:47], v[40:43]
 v_exp_f32 v19, v19
 v_mfma_f32_16x16x32_bf16 v[48:51], v[36:39], a[60:63], v[12:15]
 v_add_f32 v4, v18, v4
 v_cvt_pk_bf16_f32 v25, v18, v19
 v_mfma_f32_16x16x32_bf16 v[48:51], v[28:31], a[56:59], v[48:51]
 ds_read_b64_tr_b16 a[144:145], v2 offset:49152
 v_add_f32 v4, v19, v4
 v_mfma_f32_16x16x32_bf16 v[48:51], a[132:135], a[52:55], v[48:51]
 v_exp_f32 v32, v32
 v_mfma_f32_16x16x32_bf16 v[48:51], a[128:131], a[48:51], v[48:51]
 v_exp_f32 v33, v33
 v_mfma_f32_16x16x32_bf16 v[56:59], a[128:131], a[64:67], v[12:15]
 v_add_f32 v5, v32, v5
 v_cvt_pk_bf16_f32 v32, v32, v33
 v_mfma_f32_16x16x32_bf16 v[56:59], a[132:135], a[68:71], v[56:59]
 v_exp_f32 v34, v34
 v_mfma_f32_16x16x32_bf16 v[56:59], v[28:31], a[72:75], v[56:59]
 ds_read_b64_tr_b16 a[146:147], v2 offset:53248
 v_add_f32 v5, v33, v5
 v_mfma_f32_16x16x32_bf16 v[56:59], v[36:39], a[76:79], v[56:59]
 v_exp_f32 v35, v35
 v_mfma_f32_16x16x32_bf16 v[64:67], v[36:39], a[92:95], v[12:15]
 v_add_f32 v5, v34, v5
 v_cvt_pk_bf16_f32 v33, v34, v35
 v_mfma_f32_16x16x32_bf16 v[64:67], v[28:31], a[88:91], v[64:67]
 ds_read_b128 a[112:115], v0 offset:4096
 v_add_f32 v5, v35, v5
 v_mfma_f32_16x16x32_bf16 v[64:67], a[132:135], a[84:87], v[64:67]
 v_exp_f32 v40, v40
 v_mfma_f32_16x16x32_bf16 v[64:67], a[128:131], a[80:83], v[64:67]
 v_exp_f32 v41, v41
 v_mfma_f32_16x16x32_bf16 v[20:23], a[128:131], a[96:99], v[12:15]
 v_add_f32 v6, v40, v6
 v_cvt_pk_bf16_f32 v40, v40, v41
 v_mfma_f32_16x16x32_bf16 v[20:23], a[132:135], a[100:103], v[20:23]
 v_exp_f32 v42, v42
 v_mfma_f32_16x16x32_bf16 v[20:23], v[28:31], a[104:107], v[20:23]
 ds_read_b128 a[116:119], v0 offset:4608
 v_add_f32 v6, v41, v6
 v_mfma_f32_16x16x32_bf16 v[20:23], v[36:39], a[108:111], v[20:23]
 v_exp_f32 v43, v43
 v_mfma_f32_16x16x32_bf16 v[136:139], v[80:83], a[136:139], v[136:139]
 s_waitcnt lgkmcnt(1)
 v_add_f32 v6, v42, v6
 v_cvt_pk_bf16_f32 v41, v42, v43
 v_mfma_f32_16x16x32_bf16 v[136:139], v[84:87], a[140:143], v[136:139]
 ds_read_b128 a[120:123], v0 offset:5120
 v_add_f32 v6, v43, v6
 v_mfma_f32_16x16x32_bf16 v[168:171], v[92:95], a[140:143], v[168:171]
 v_exp_f32 v48, v48
 v_mfma_f32_16x16x32_bf16 v[168:171], v[88:91], a[136:139], v[168:171]
 v_exp_f32 v49, v49
 v_mfma_f32_16x16x32_bf16 v[200:203], v[96:99], a[136:139], v[200:203]
 v_add_f32 v7, v48, v7
 v_cvt_pk_bf16_f32 v48, v48, v49
 v_mfma_f32_16x16x32_bf16 v[200:203], v[100:103], a[140:143], v[200:203]
 v_exp_f32 v50, v50
 v_mfma_f32_16x16x32_bf16 v[232:235], v[108:111], a[140:143], v[232:235]
 ds_read_b128 a[124:127], v0 offset:5632
 v_add_f32 v7, v49, v7
 v_mfma_f32_16x16x32_bf16 v[232:235], v[104:107], a[136:139], v[232:235]
 v_exp_f32 v51, v51
 v_mfma_f32_16x16x32_bf16 a[160:163], v[112:115], a[136:139], a[160:163]
 v_add_f32 v7, v50, v7
 v_cvt_pk_bf16_f32 v49, v50, v51
 v_mfma_f32_16x16x32_bf16 a[160:163], v[116:119], a[140:143], a[160:163]
 ds_read_b128 v[68:71], v0 offset:8192
 v_add_f32 v7, v51, v7
 v_mfma_f32_16x16x32_bf16 a[192:195], v[124:127], a[140:143], a[192:195]
 v_exp_f32 v56, v56
 v_mfma_f32_16x16x32_bf16 a[192:195], v[120:123], a[136:139], a[192:195]
 v_exp_f32 v57, v57
 v_mfma_f32_16x16x32_bf16 a[224:227], v[128:131], a[136:139], a[224:227]
 v_add_f32 v8, v56, v8
 v_cvt_pk_bf16_f32 v56, v56, v57
 v_mfma_f32_16x16x32_bf16 a[224:227], v[132:135], a[140:143], a[224:227]
 v_exp_f32 v58, v58
 v_mfma_f32_16x16x32_bf16 v[140:143], v[84:87], a[148:151], v[140:143]
 ds_read_b64_tr_b16 a[136:137], v1 offset:49664
 v_add_f32 v8, v57, v8
 v_mfma_f32_16x16x32_bf16 v[140:143], v[80:83], a[144:147], v[140:143]
 v_exp_f32 v59, v59
 v_mfma_f32_16x16x32_bf16 v[172:175], v[88:91], a[144:147], v[172:175]
 v_add_f32 v8, v58, v8
 v_cvt_pk_bf16_f32 v57, v58, v59
 v_mfma_f32_16x16x32_bf16 v[172:175], v[92:95], a[148:151], v[172:175]
 ds_read_b64_tr_b16 a[138:139], v1 offset:53760
 v_add_f32 v8, v59, v8
 v_mfma_f32_16x16x32_bf16 v[204:207], v[100:103], a[148:151], v[204:207]
 v_exp_f32 v64, v64
 v_mfma_f32_16x16x32_bf16 v[204:207], v[96:99], a[144:147], v[204:207]
 v_exp_f32 v65, v65
 v_mfma_f32_16x16x32_bf16 v[236:239], v[104:107], a[144:147], v[236:239]
 v_exp_f32 v66, v66
 v_mfma_f32_16x16x32_bf16 v[236:239], v[108:111], a[148:151], v[236:239]
 v_add_f32 v9, v64, v9
 v_cvt_pk_bf16_f32 v64, v64, v65
 v_mfma_f32_16x16x32_bf16 a[164:167], v[116:119], a[148:151], a[164:167]
 v_exp_f32 v67, v67
 v_mfma_f32_16x16x32_bf16 a[164:167], v[112:115], a[144:147], a[164:167]
 v_add_f32 v9, v65, v9
 v_add_f32 v9, v66, v9
 v_mfma_f32_16x16x32_bf16 a[196:199], v[120:123], a[144:147], a[196:199]
 v_exp_f32 v20, v20
 v_mfma_f32_16x16x32_bf16 a[196:199], v[124:127], a[148:151], a[196:199]
 v_add_f32 v9, v67, v9
 v_cvt_pk_bf16_f32 v65, v66, v67
 v_mfma_f32_16x16x32_bf16 a[228:231], v[132:135], a[148:151], a[228:231]
 v_exp_f32 v21, v21
 v_mfma_f32_16x16x32_bf16 a[228:231], v[128:131], a[144:147], a[228:231]
 ds_read_b64_tr_b16 a[140:141], v1 offset:57856
 v_add_f32 v3, v20, v21
 v_mfma_f32_16x16x32_bf16 v[16:19], a[112:115], a[0:3], v[12:15]
 s_waitcnt lgkmcnt(1)
 v_exp_f32 v22, v22
 v_mfma_f32_16x16x32_bf16 v[16:19], a[116:119], a[4:7], v[16:19]
 ds_read_b64_tr_b16 a[142:143], v1 offset:61952
 v_cvt_pk_bf16_f32 v72, v20, v21
 v_mfma_f32_16x16x32_bf16 v[16:19], a[120:123], a[8:11], v[16:19]
 v_exp_f32 v23, v23
 v_mfma_f32_16x16x32_bf16 v[16:19], a[124:127], a[12:15], v[16:19]
 v_add_f32 v11, v22, v23
 v_cvt_pk_bf16_f32 v73, v22, v23
 v_mfma_f32_16x16x32_bf16 v[60:63], a[124:127], a[28:31], v[12:15]
 ds_read_b64_tr_b16 a[148:149], v2 offset:57856
 v_add_f32 v10, v3, v10
 v_mfma_f32_16x16x32_bf16 v[60:63], a[120:123], a[24:27], v[60:63]
 ds_read_b64_tr_b16 a[150:151], v2 offset:61952
 v_add_f32 v10, v11, v10
 v_mfma_f32_16x16x32_bf16 v[60:63], a[116:119], a[20:23], v[60:63]
 v_exp_f32 v16, v16
 v_mfma_f32_16x16x32_bf16 v[60:63], a[112:115], a[16:19], v[60:63]
 v_exp_f32 v17, v17
 v_mfma_f32_16x16x32_bf16 v[52:55], a[112:115], a[32:35], v[12:15]
 v_add_f32 v4, v16, v4
 v_cvt_pk_bf16_f32 v26, v16, v17
 v_mfma_f32_16x16x32_bf16 v[52:55], a[116:119], a[36:39], v[52:55]
 v_exp_f32 v18, v18
 v_mfma_f32_16x16x32_bf16 v[52:55], a[120:123], a[40:43], v[52:55]
 ds_read_b64_tr_b16 a[144:145], v2 offset:49664
 v_add_f32 v4, v17, v4
 v_mfma_f32_16x16x32_bf16 v[52:55], a[124:127], a[44:47], v[52:55]
 v_exp_f32 v19, v19
 v_mfma_f32_16x16x32_bf16 v[44:47], a[124:127], a[60:63], v[12:15]
 v_add_f32 v4, v18, v4
 v_cvt_pk_bf16_f32 v27, v18, v19
 v_mfma_f32_16x16x32_bf16 v[44:47], a[120:123], a[56:59], v[44:47]
 ds_read_b64_tr_b16 a[146:147], v2 offset:53760
 v_add_f32 v4, v19, v4
 v_mfma_f32_16x16x32_bf16 v[44:47], a[116:119], a[52:55], v[44:47]
 v_exp_f32 v60, v60
 v_mfma_f32_16x16x32_bf16 v[44:47], a[112:115], a[48:51], v[44:47]
 v_exp_f32 v61, v61
 v_mfma_f32_16x16x32_bf16 v[36:39], a[112:115], a[64:67], v[12:15]
 v_add_f32 v5, v60, v5
 v_cvt_pk_bf16_f32 v34, v60, v61
 v_mfma_f32_16x16x32_bf16 v[36:39], a[116:119], a[68:71], v[36:39]
 v_exp_f32 v62, v62
 v_mfma_f32_16x16x32_bf16 v[36:39], a[120:123], a[72:75], v[36:39]
 ds_read_b128 v[76:79], v0 offset:8704
 v_add_f32 v5, v61, v5
 v_mfma_f32_16x16x32_bf16 v[36:39], a[124:127], a[76:79], v[36:39]
 v_exp_f32 v63, v63
 v_mfma_f32_16x16x32_bf16 v[28:31], a[124:127], a[92:95], v[12:15]
 v_add_f32 v5, v62, v5
 v_cvt_pk_bf16_f32 v35, v62, v63
 v_mfma_f32_16x16x32_bf16 v[28:31], a[120:123], a[88:91], v[28:31]
 ds_read_b128 a[128:131], v0 offset:9216
 v_add_f32 v5, v63, v5
 v_mfma_f32_16x16x32_bf16 v[28:31], a[116:119], a[84:87], v[28:31]
 v_exp_f32 v52, v52
 v_mfma_f32_16x16x32_bf16 v[28:31], a[112:115], a[80:83], v[28:31]
 v_exp_f32 v53, v53
 v_mfma_f32_16x16x32_bf16 v[20:23], a[112:115], a[96:99], v[12:15]
 v_add_f32 v6, v52, v6
 v_cvt_pk_bf16_f32 v42, v52, v53
 v_mfma_f32_16x16x32_bf16 v[20:23], a[116:119], a[100:103], v[20:23]
 v_exp_f32 v54, v54
 v_mfma_f32_16x16x32_bf16 v[20:23], a[120:123], a[104:107], v[20:23]
 ds_read_b128 a[132:135], v0 offset:9728
 v_add_f32 v6, v53, v6
 v_mfma_f32_16x16x32_bf16 v[20:23], a[124:127], a[108:111], v[20:23]
 v_exp_f32 v55, v55
 v_mfma_f32_16x16x32_bf16 v[144:147], v[80:83], a[136:139], v[144:147]
 s_waitcnt lgkmcnt(1)
 v_add_f32 v6, v54, v6
 v_cvt_pk_bf16_f32 v43, v54, v55
 v_mfma_f32_16x16x32_bf16 v[144:147], v[84:87], a[140:143], v[144:147]
 v_add_f32 v6, v55, v6
 v_mfma_f32_16x16x32_bf16 v[176:179], v[92:95], a[140:143], v[176:179]
 v_exp_f32 v44, v44
 v_mfma_f32_16x16x32_bf16 v[176:179], v[88:91], a[136:139], v[176:179]
 v_exp_f32 v45, v45
 v_mfma_f32_16x16x32_bf16 v[208:211], v[96:99], a[136:139], v[208:211]
 v_add_f32 v7, v44, v7
 v_cvt_pk_bf16_f32 v50, v44, v45
 v_mfma_f32_16x16x32_bf16 v[208:211], v[100:103], a[140:143], v[208:211]
 v_exp_f32 v46, v46
 v_mfma_f32_16x16x32_bf16 v[240:243], v[108:111], a[140:143], v[240:243]
 ds_read_b128 a[124:127], v0 offset:13824
 v_add_f32 v7, v45, v7
 v_mfma_f32_16x16x32_bf16 v[240:243], v[104:107], a[136:139], v[240:243]
 v_exp_f32 v47, v47
 v_mfma_f32_16x16x32_bf16 a[168:171], v[112:115], a[136:139], a[168:171]
 v_add_f32 v7, v46, v7
 v_cvt_pk_bf16_f32 v51, v46, v47
 v_mfma_f32_16x16x32_bf16 a[168:171], v[116:119], a[140:143], a[168:171]
 ds_read_b128 a[120:123], v0 offset:13312
 v_add_f32 v7, v47, v7
 v_mfma_f32_16x16x32_bf16 a[200:203], v[124:127], a[140:143], a[200:203]
 v_exp_f32 v36, v36
 v_mfma_f32_16x16x32_bf16 a[200:203], v[120:123], a[136:139], a[200:203]
 v_exp_f32 v37, v37
 v_mfma_f32_16x16x32_bf16 a[232:235], v[128:131], a[136:139], a[232:235]
 v_add_f32 v8, v36, v8
 v_cvt_pk_bf16_f32 v58, v36, v37
 v_mfma_f32_16x16x32_bf16 a[232:235], v[132:135], a[140:143], a[232:235]
 v_exp_f32 v38, v38
 v_mfma_f32_16x16x32_bf16 v[148:151], v[84:87], a[148:151], v[148:151]
 ds_read_b64_tr_b16 a[136:137], v1 offset:50176
 v_add_f32 v8, v37, v8
 v_mfma_f32_16x16x32_bf16 v[148:151], v[80:83], a[144:147], v[148:151]
 v_exp_f32 v39, v39
 v_mfma_f32_16x16x32_bf16 v[180:183], v[88:91], a[144:147], v[180:183]
 v_add_f32 v8, v38, v8
 v_cvt_pk_bf16_f32 v59, v38, v39
 v_mfma_f32_16x16x32_bf16 v[180:183], v[92:95], a[148:151], v[180:183]
 ds_read_b64_tr_b16 a[138:139], v1 offset:54272
 v_add_f32 v8, v39, v8
 v_mfma_f32_16x16x32_bf16 v[212:215], v[100:103], a[148:151], v[212:215]
 v_exp_f32 v28, v28
 v_mfma_f32_16x16x32_bf16 v[212:215], v[96:99], a[144:147], v[212:215]
 v_exp_f32 v29, v29
 v_mfma_f32_16x16x32_bf16 v[244:247], v[104:107], a[144:147], v[244:247]
 v_exp_f32 v30, v30
 v_mfma_f32_16x16x32_bf16 v[244:247], v[108:111], a[148:151], v[244:247]
 v_add_f32 v9, v28, v9
 v_cvt_pk_bf16_f32 v66, v28, v29
 v_mfma_f32_16x16x32_bf16 a[172:175], v[116:119], a[148:151], a[172:175]
 v_exp_f32 v31, v31
 v_mfma_f32_16x16x32_bf16 a[172:175], v[112:115], a[144:147], a[172:175]
 v_add_f32 v9, v29, v9
 v_add_f32 v9, v30, v9
 v_mfma_f32_16x16x32_bf16 a[204:207], v[120:123], a[144:147], a[204:207]
 v_exp_f32 v20, v20
 v_mfma_f32_16x16x32_bf16 a[204:207], v[124:127], a[148:151], a[204:207]
 v_add_f32 v9, v31, v9
 v_cvt_pk_bf16_f32 v67, v30, v31
 v_mfma_f32_16x16x32_bf16 a[236:239], v[132:135], a[148:151], a[236:239]
 v_exp_f32 v21, v21
 v_mfma_f32_16x16x32_bf16 a[236:239], v[128:131], a[144:147], a[236:239]
 ds_read_b64_tr_b16 a[140:141], v1 offset:58368
 v_add_f32 v3, v20, v21
 v_mfma_f32_16x16x32_bf16 v[16:19], v[68:71], a[0:3], v[12:15]
 v_exp_f32 v22, v22
 v_mfma_f32_16x16x32_bf16 v[16:19], v[76:79], a[4:7], v[16:19]
 ds_read_b64_tr_b16 a[142:143], v1 offset:62464
 v_cvt_pk_bf16_f32 v74, v20, v21
 v_mfma_f32_16x16x32_bf16 v[16:19], a[128:131], a[8:11], v[16:19]
 s_waitcnt lgkmcnt(2)
 v_exp_f32 v23, v23
 v_mfma_f32_16x16x32_bf16 v[16:19], a[132:135], a[12:15], v[16:19]
 v_add_f32 v11, v22, v23
 v_cvt_pk_bf16_f32 v75, v22, v23
 v_mfma_f32_16x16x32_bf16 v[36:39], a[132:135], a[28:31], v[12:15]
 ds_read_b64_tr_b16 a[148:149], v2 offset:58368
 v_add_f32 v10, v3, v10
 v_mfma_f32_16x16x32_bf16 v[36:39], a[128:131], a[24:27], v[36:39]
 ds_read_b64_tr_b16 a[150:151], v2 offset:62464
 v_add_f32 v10, v11, v10
 v_mfma_f32_16x16x32_bf16 v[36:39], v[76:79], a[20:23], v[36:39]
 v_exp_f32 v16, v16
 v_mfma_f32_16x16x32_bf16 v[36:39], v[68:71], a[16:19], v[36:39]
 v_exp_f32 v17, v17
 v_mfma_f32_16x16x32_bf16 v[44:47], v[68:71], a[32:35], v[12:15]
 v_add_f32 v4, v16, v4
 v_cvt_pk_bf16_f32 v28, v16, v17
 v_mfma_f32_16x16x32_bf16 v[44:47], v[76:79], a[36:39], v[44:47]
 v_exp_f32 v18, v18
 v_mfma_f32_16x16x32_bf16 v[44:47], a[128:131], a[40:43], v[44:47]
 ds_read_b64_tr_b16 a[144:145], v2 offset:50176
 v_add_f32 v4, v17, v4
 v_mfma_f32_16x16x32_bf16 v[44:47], a[132:135], a[44:47], v[44:47]
 v_exp_f32 v19, v19
 v_mfma_f32_16x16x32_bf16 v[52:55], a[132:135], a[60:63], v[12:15]
 v_add_f32 v4, v18, v4
 v_cvt_pk_bf16_f32 v29, v18, v19
 v_mfma_f32_16x16x32_bf16 v[52:55], a[128:131], a[56:59], v[52:55]
 ds_read_b64_tr_b16 a[146:147], v2 offset:54272
 v_add_f32 v4, v19, v4
 v_mfma_f32_16x16x32_bf16 v[52:55], v[76:79], a[52:55], v[52:55]
 v_exp_f32 v36, v36
 v_mfma_f32_16x16x32_bf16 v[52:55], v[68:71], a[48:51], v[52:55]
 v_exp_f32 v37, v37
 v_mfma_f32_16x16x32_bf16 v[60:63], v[68:71], a[64:67], v[12:15]
 v_add_f32 v5, v36, v5
 v_cvt_pk_bf16_f32 v36, v36, v37
 v_mfma_f32_16x16x32_bf16 v[60:63], v[76:79], a[68:71], v[60:63]
 v_exp_f32 v38, v38
 v_mfma_f32_16x16x32_bf16 v[60:63], a[128:131], a[72:75], v[60:63]
 ds_read_b128 a[116:119], v0 offset:12800
 v_add_f32 v5, v37, v5
 v_mfma_f32_16x16x32_bf16 v[60:63], a[132:135], a[76:79], v[60:63]
 v_exp_f32 v39, v39
 v_mfma_f32_16x16x32_bf16 v[20:23], a[132:135], a[92:95], v[12:15]
 v_add_f32 v5, v38, v5
 v_cvt_pk_bf16_f32 v37, v38, v39
 v_mfma_f32_16x16x32_bf16 v[20:23], a[128:131], a[88:91], v[20:23]
 ds_read_b128 a[112:115], v0 offset:12288
 v_add_f32 v5, v39, v5
 v_mfma_f32_16x16x32_bf16 v[20:23], v[76:79], a[84:87], v[20:23]
 v_exp_f32 v44, v44
 v_mfma_f32_16x16x32_bf16 v[20:23], v[68:71], a[80:83], v[20:23]
 v_exp_f32 v45, v45
 v_mfma_f32_16x16x32_bf16 v[152:155], v[80:83], a[136:139], v[152:155]
 s_waitcnt lgkmcnt(2)
 v_add_f32 v6, v44, v6
 v_cvt_pk_bf16_f32 v44, v44, v45
 v_mfma_f32_16x16x32_bf16 v[152:155], v[84:87], a[140:143], v[152:155]
 v_exp_f32 v46, v46
 v_mfma_f32_16x16x32_bf16 v[184:187], v[92:95], a[140:143], v[184:187]
 v_add_f32 v6, v45, v6
 v_mfma_f32_16x16x32_bf16 v[184:187], v[88:91], a[136:139], v[184:187]
 v_exp_f32 v47, v47
 v_mfma_f32_16x16x32_bf16 v[216:219], v[96:99], a[136:139], v[216:219]
 v_add_f32 v6, v46, v6
 v_cvt_pk_bf16_f32 v45, v46, v47
 v_mfma_f32_16x16x32_bf16 v[216:219], v[100:103], a[140:143], v[216:219]
 v_add_f32 v6, v47, v6
 v_mfma_f32_16x16x32_bf16 v[248:251], v[108:111], a[140:143], v[248:251]
 v_exp_f32 v52, v52
 v_mfma_f32_16x16x32_bf16 v[248:251], v[104:107], a[136:139], v[248:251]
 v_exp_f32 v53, v53
 v_mfma_f32_16x16x32_bf16 a[176:179], v[112:115], a[136:139], a[176:179]
 v_add_f32 v7, v52, v7
 v_cvt_pk_bf16_f32 v52, v52, v53
 v_mfma_f32_16x16x32_bf16 a[176:179], v[116:119], a[140:143], a[176:179]
 v_exp_f32 v54, v54
 v_mfma_f32_16x16x32_bf16 a[208:211], v[124:127], a[140:143], a[208:211]
 v_add_f32 v7, v53, v7
 v_mfma_f32_16x16x32_bf16 a[208:211], v[120:123], a[136:139], a[208:211]
 v_exp_f32 v55, v55
 v_mfma_f32_16x16x32_bf16 a[240:243], v[128:131], a[136:139], a[240:243]
 v_add_f32 v7, v54, v7
 v_cvt_pk_bf16_f32 v53, v54, v55
 v_mfma_f32_16x16x32_bf16 a[240:243], v[132:135], a[140:143], a[240:243]
 ds_read_b64_tr_b16 a[136:137], v1 offset:50688
 v_add_f32 v7, v55, v7
 v_mfma_f32_16x16x32_bf16 v[156:159], v[84:87], a[148:151], v[156:159]
 v_exp_f32 v60, v60
 v_mfma_f32_16x16x32_bf16 v[156:159], v[80:83], a[144:147], v[156:159]
 v_exp_f32 v61, v61
 v_mfma_f32_16x16x32_bf16 v[188:191], v[88:91], a[144:147], v[188:191]
 v_exp_f32 v62, v62
 v_mfma_f32_16x16x32_bf16 v[188:191], v[92:95], a[148:151], v[188:191]
 v_add_f32 v8, v60, v8
 v_cvt_pk_bf16_f32 v60, v60, v61
 v_mfma_f32_16x16x32_bf16 v[220:223], v[100:103], a[148:151], v[220:223]
 v_exp_f32 v63, v63
 v_mfma_f32_16x16x32_bf16 v[220:223], v[96:99], a[144:147], v[220:223]
 v_add_f32 v8, v61, v8
 v_add_f32 v8, v62, v8
 v_mfma_f32_16x16x32_bf16 v[252:255], v[104:107], a[144:147], v[252:255]
 v_exp_f32 v20, v20
 v_mfma_f32_16x16x32_bf16 v[252:255], v[108:111], a[148:151], v[252:255]
 v_add_f32 v8, v63, v8
 v_cvt_pk_bf16_f32 v61, v62, v63
 v_mfma_f32_16x16x32_bf16 a[180:183], v[116:119], a[148:151], a[180:183]
 v_exp_f32 v21, v21
 v_mfma_f32_16x16x32_bf16 a[180:183], v[112:115], a[144:147], a[180:183]
 ds_read_b64_tr_b16 a[138:139], v1 offset:54784
 v_add_f32 v3, v20, v21
 v_mfma_f32_16x16x32_bf16 v[16:19], v[68:71], a[96:99], v[12:15]
 v_exp_f32 v22, v22
 v_mfma_f32_16x16x32_bf16 v[16:19], v[76:79], a[100:103], v[16:19]
 ds_read_b64_tr_b16 a[140:141], v1 offset:58880
 v_cvt_pk_bf16_f32 v68, v20, v21
 v_mfma_f32_16x16x32_bf16 v[16:19], a[128:131], a[104:107], v[16:19]
 v_exp_f32 v23, v23
 v_mfma_f32_16x16x32_bf16 v[16:19], a[132:135], a[108:111], v[16:19]
 v_add_f32 v11, v22, v23
 v_cvt_pk_bf16_f32 v69, v22, v23
 v_mfma_f32_16x16x32_bf16 v[20:23], a[124:127], a[12:15], v[12:15]
 ds_read_b64_tr_b16 a[142:143], v1 offset:62976
 v_add_f32 v9, v3, v9
 v_mfma_f32_16x16x32_bf16 v[20:23], a[120:123], a[8:11], v[20:23]
 s_waitcnt lgkmcnt(3)
 v_add_f32 v9, v11, v9
 v_mfma_f32_16x16x32_bf16 v[20:23], a[116:119], a[4:7], v[20:23]
 v_exp_f32 v16, v16
 v_mfma_f32_16x16x32_bf16 v[20:23], a[112:115], a[0:3], v[20:23]
 v_exp_f32 v17, v17
 v_mfma_f32_16x16x32_bf16 a[212:215], v[120:123], a[144:147], a[212:215]
 v_exp_f32 v18, v18
 v_mfma_f32_16x16x32_bf16 a[212:215], v[124:127], a[148:151], a[212:215]
 v_add_f32 v10, v16, v10
 v_cvt_pk_bf16_f32 v76, v16, v17
 v_mfma_f32_16x16x32_bf16 a[244:247], v[132:135], a[148:151], a[244:247]
 v_exp_f32 v19, v19
 v_mfma_f32_16x16x32_bf16 a[244:247], v[128:131], a[144:147], a[244:247]
 s_waitcnt lgkmcnt(0)
 v_add_f32 v10, v17, v10
 v_add_f32 v10, v18, v10
 v_mfma_f32_16x16x32_bf16 v[160:163], v[80:83], a[136:139], v[160:163]
 v_exp_f32 v20, v20
 v_mfma_f32_16x16x32_bf16 v[160:163], v[84:87], a[140:143], v[160:163]
 v_add_f32 v10, v19, v10
 v_cvt_pk_bf16_f32 v77, v18, v19
 v_mfma_f32_16x16x32_bf16 v[192:195], v[92:95], a[140:143], v[192:195]
 v_exp_f32 v21, v21
 v_mfma_f32_16x16x32_bf16 v[192:195], v[88:91], a[136:139], v[192:195]
 ds_read_b64_tr_b16 a[148:149], v2 offset:58880
 v_add_f32 v3, v20, v21
 v_mfma_f32_16x16x32_bf16 v[16:19], a[112:115], a[16:19], v[12:15]
 v_exp_f32 v22, v22
 v_mfma_f32_16x16x32_bf16 v[16:19], a[116:119], a[20:23], v[16:19]
 ds_read_b64_tr_b16 a[150:151], v2 offset:62976
 v_cvt_pk_bf16_f32 v30, v20, v21
 v_mfma_f32_16x16x32_bf16 v[16:19], a[120:123], a[24:27], v[16:19]
 v_exp_f32 v23, v23
 v_mfma_f32_16x16x32_bf16 v[16:19], a[124:127], a[28:31], v[16:19]
 v_add_f32 v11, v22, v23
 v_cvt_pk_bf16_f32 v31, v22, v23
 v_mfma_f32_16x16x32_bf16 v[20:23], a[124:127], a[44:47], v[12:15]
 s_waitcnt vmcnt(0)
 v_add_f32 v4, v3, v4
 v_add_f32 v4, v11, v4
 v_mfma_f32_16x16x32_bf16 v[20:23], a[120:123], a[40:43], v[20:23]
 s_barrier
 v_mfma_f32_16x16x32_bf16 v[20:23], a[116:119], a[36:39], v[20:23]
 v_exp_f32 v16, v16
 v_mfma_f32_16x16x32_bf16 v[20:23], a[112:115], a[32:35], v[20:23]
 v_exp_f32 v17, v17
 v_mfma_f32_16x16x32_bf16 v[224:227], v[96:99], a[136:139], v[224:227]
 v_exp_f32 v18, v18
 v_mfma_f32_16x16x32_bf16 v[224:227], v[100:103], a[140:143], v[224:227]
 v_add_f32 v5, v16, v5
 v_cvt_pk_bf16_f32 v38, v16, v17
 v_mfma_f32_16x16x32_bf16 a[152:155], v[108:111], a[140:143], a[152:155]
 v_exp_f32 v19, v19
 v_mfma_f32_16x16x32_bf16 a[152:155], v[104:107], a[136:139], a[152:155]
 v_add_f32 v5, v17, v5
 v_add_f32 v5, v18, v5
 v_mfma_f32_16x16x32_bf16 a[184:187], v[112:115], a[136:139], a[184:187]
 v_exp_f32 v20, v20
 v_mfma_f32_16x16x32_bf16 a[184:187], v[116:119], a[140:143], a[184:187]
 v_add_f32 v5, v19, v5
 v_cvt_pk_bf16_f32 v39, v18, v19
 v_mfma_f32_16x16x32_bf16 a[216:219], v[124:127], a[140:143], a[216:219]
 v_exp_f32 v21, v21
 v_mfma_f32_16x16x32_bf16 a[216:219], v[120:123], a[136:139], a[216:219]
 ds_read_b64_tr_b16 a[144:145], v2 offset:50688
 v_add_f32 v3, v20, v21
 v_mfma_f32_16x16x32_bf16 v[16:19], a[112:115], a[48:51], v[12:15]
 v_exp_f32 v22, v22
 v_mfma_f32_16x16x32_bf16 v[16:19], a[116:119], a[52:55], v[16:19]
 ds_read_b64_tr_b16 a[146:147], v2 offset:54784
 v_cvt_pk_bf16_f32 v46, v20, v21
 v_mfma_f32_16x16x32_bf16 v[16:19], a[120:123], a[56:59], v[16:19]
 v_exp_f32 v23, v23
 v_mfma_f32_16x16x32_bf16 v[16:19], a[124:127], a[60:63], v[16:19]
 v_add_f32 v11, v22, v23
 v_cvt_pk_bf16_f32 v47, v22, v23
 v_mfma_f32_16x16x32_bf16 v[20:23], a[124:127], a[76:79], v[12:15]
 ds_read_b128 a[128:131], v0 offset:16384
 v_add_f32 v6, v3, v6
 v_mfma_f32_16x16x32_bf16 v[20:23], a[120:123], a[72:75], v[20:23]
 ds_read_b128 a[132:135], v0 offset:16896
 v_add_f32 v6, v11, v6
 v_mfma_f32_16x16x32_bf16 v[20:23], a[116:119], a[68:71], v[20:23]
 v_exp_f32 v16, v16
 v_mfma_f32_16x16x32_bf16 v[20:23], a[112:115], a[64:67], v[20:23]
 v_exp_f32 v17, v17
 v_mfma_f32_16x16x32_bf16 a[248:251], v[128:131], a[136:139], a[248:251]
 v_exp_f32 v18, v18
 v_mfma_f32_16x16x32_bf16 a[248:251], v[132:135], a[140:143], a[248:251]
 s_waitcnt lgkmcnt(2)
 v_add_f32 v7, v16, v7
 v_cvt_pk_bf16_f32 v54, v16, v17
 v_mfma_f32_16x16x32_bf16 v[164:167], v[84:87], a[148:151], v[164:167]
 v_exp_f32 v19, v19
 v_mfma_f32_16x16x32_bf16 v[164:167], v[80:83], a[144:147], v[164:167]
 v_add_f32 v7, v17, v7
 v_add_f32 v7, v18, v7
 v_mfma_f32_16x16x32_bf16 v[196:199], v[88:91], a[144:147], v[196:199]
 v_exp_f32 v20, v20
 v_mfma_f32_16x16x32_bf16 v[196:199], v[92:95], a[148:151], v[196:199]
 v_add_f32 v7, v19, v7
 v_cvt_pk_bf16_f32 v55, v18, v19
 v_mfma_f32_16x16x32_bf16 v[228:231], v[100:103], a[148:151], v[228:231]
 v_exp_f32 v21, v21
 v_mfma_f32_16x16x32_bf16 v[228:231], v[96:99], a[144:147], v[228:231]
 ds_read_b128 v[84:87], v0 offset:17408
 v_add_f32 v3, v20, v21
 v_mfma_f32_16x16x32_bf16 v[16:19], a[112:115], a[80:83], v[12:15]
 v_exp_f32 v22, v22
 v_mfma_f32_16x16x32_bf16 v[16:19], a[116:119], a[84:87], v[16:19]
 ds_read_b128 v[92:95], v0 offset:17920
 v_cvt_pk_bf16_f32 v62, v20, v21
 v_mfma_f32_16x16x32_bf16 v[16:19], a[120:123], a[88:91], v[16:19]
 v_exp_f32 v23, v23
 v_mfma_f32_16x16x32_bf16 v[16:19], a[124:127], a[92:95], v[16:19]
 v_add_f32 v11, v22, v23
 v_cvt_pk_bf16_f32 v63, v22, v23
 v_mfma_f32_16x16x32_bf16 v[20:23], a[124:127], a[108:111], v[12:15]
 ds_read_b64_tr_b16 a[136:137], v1 offset:0
 v_add_f32 v8, v3, v8
 v_mfma_f32_16x16x32_bf16 v[20:23], a[120:123], a[104:107], v[20:23]
 ds_read_b64_tr_b16 a[138:139], v1 offset:4096
 v_add_f32 v8, v11, v8
 v_mfma_f32_16x16x32_bf16 v[20:23], a[116:119], a[100:103], v[20:23]
 v_exp_f32 v16, v16
 v_mfma_f32_16x16x32_bf16 v[20:23], a[112:115], a[96:99], v[20:23]
 v_exp_f32 v17, v17
 v_mfma_f32_16x16x32_bf16 a[156:159], v[104:107], a[144:147], a[156:159]
 v_exp_f32 v18, v18
 v_mfma_f32_16x16x32_bf16 a[156:159], v[108:111], a[148:151], a[156:159]
 v_add_f32 v9, v16, v9
 v_cvt_pk_bf16_f32 v70, v16, v17
 v_mfma_f32_16x16x32_bf16 a[188:191], v[116:119], a[148:151], a[188:191]
 v_exp_f32 v19, v19
 v_mfma_f32_16x16x32_bf16 a[188:191], v[112:115], a[144:147], a[188:191]
 v_add_f32 v9, v17, v9
 v_add_f32 v9, v18, v9
 v_mfma_f32_16x16x32_bf16 a[220:223], v[120:123], a[144:147], a[220:223]
 v_exp_f32 v20, v20
 v_mfma_f32_16x16x32_bf16 a[220:223], v[124:127], a[148:151], a[220:223]
 v_add_f32 v9, v19, v9
 v_cvt_pk_bf16_f32 v71, v18, v19
 v_mfma_f32_16x16x32_bf16 a[252:255], v[132:135], a[148:151], a[252:255]
 v_exp_f32 v21, v21
 v_mfma_f32_16x16x32_bf16 a[252:255], v[128:131], a[144:147], a[252:255]
 s_waitcnt lgkmcnt(0)
 v_add_f32 v3, v20, v21
 v_mfma_f32_16x16x32_bf16 v[16:19], a[128:131], a[0:3], v[12:15]
 v_exp_f32 v22, v22
 v_mfma_f32_16x16x32_bf16 v[16:19], a[132:135], a[4:7], v[16:19]
 ds_read_b64_tr_b16 a[140:141], v1 offset:8192
 v_cvt_pk_bf16_f32 v78, v20, v21
 v_mfma_f32_16x16x32_bf16 v[16:19], v[84:87], a[8:11], v[16:19]
 v_exp_f32 v23, v23
 v_mfma_f32_16x16x32_bf16 v[16:19], v[92:95], a[12:15], v[16:19]
 v_add_f32 v11, v22, v23
 v_cvt_pk_bf16_f32 v79, v22, v23
 v_mfma_f32_16x16x32_bf16 v[88:91], v[92:95], a[28:31], v[12:15]
 ds_read_b64_tr_b16 a[142:143], v1 offset:12288
 v_add_f32 v10, v3, v10
 v_mfma_f32_16x16x32_bf16 v[88:91], v[84:87], a[24:27], v[88:91]
 ds_read_b64_tr_b16 a[148:149], v2 offset:8192
 v_add_f32 v10, v11, v10
 v_mfma_f32_16x16x32_bf16 v[88:91], a[132:135], a[20:23], v[88:91]
 v_exp_f32 v16, v16
 v_mfma_f32_16x16x32_bf16 v[88:91], a[128:131], a[16:19], v[88:91]
 v_exp_f32 v17, v17
 v_mfma_f32_16x16x32_bf16 v[96:99], a[128:131], a[32:35], v[12:15]
 v_add_f32 v4, v16, v4
 v_cvt_pk_bf16_f32 v80, v16, v17
 v_mfma_f32_16x16x32_bf16 v[96:99], a[132:135], a[36:39], v[96:99]
 v_exp_f32 v18, v18
 v_mfma_f32_16x16x32_bf16 v[96:99], v[84:87], a[40:43], v[96:99]
 ds_read_b64_tr_b16 a[150:151], v2 offset:12288
 v_add_f32 v4, v17, v4
 v_mfma_f32_16x16x32_bf16 v[96:99], v[92:95], a[44:47], v[96:99]
 v_exp_f32 v19, v19
 v_mfma_f32_16x16x32_bf16 v[104:107], v[92:95], a[60:63], v[12:15]
 v_add_f32 v4, v18, v4
 v_cvt_pk_bf16_f32 v81, v18, v19
 v_mfma_f32_16x16x32_bf16 v[104:107], v[84:87], a[56:59], v[104:107]
 ds_read_b64_tr_b16 a[144:145], v2 offset:0
 v_add_f32 v4, v19, v4
 v_mfma_f32_16x16x32_bf16 v[104:107], a[132:135], a[52:55], v[104:107]
 v_exp_f32 v88, v88
 v_mfma_f32_16x16x32_bf16 v[104:107], a[128:131], a[48:51], v[104:107]
 v_exp_f32 v89, v89
 v_mfma_f32_16x16x32_bf16 v[112:115], a[128:131], a[64:67], v[12:15]
 v_add_f32 v5, v88, v5
 v_cvt_pk_bf16_f32 v88, v88, v89
 v_mfma_f32_16x16x32_bf16 v[112:115], a[132:135], a[68:71], v[112:115]
 v_exp_f32 v90, v90
 v_mfma_f32_16x16x32_bf16 v[112:115], v[84:87], a[72:75], v[112:115]
 ds_read_b64_tr_b16 a[146:147], v2 offset:4096
 v_add_f32 v5, v89, v5
 v_mfma_f32_16x16x32_bf16 v[112:115], v[92:95], a[76:79], v[112:115]
 v_exp_f32 v91, v91
 v_mfma_f32_16x16x32_bf16 v[120:123], v[92:95], a[92:95], v[12:15]
 v_add_f32 v5, v90, v5
 v_cvt_pk_bf16_f32 v89, v90, v91
 v_mfma_f32_16x16x32_bf16 v[120:123], v[84:87], a[88:91], v[120:123]
 ds_read_b128 a[112:115], v0 offset:20480
 v_add_f32 v5, v91, v5
 v_mfma_f32_16x16x32_bf16 v[120:123], a[132:135], a[84:87], v[120:123]
 v_exp_f32 v96, v96
 v_mfma_f32_16x16x32_bf16 v[120:123], a[128:131], a[80:83], v[120:123]
 v_exp_f32 v97, v97
 v_mfma_f32_16x16x32_bf16 v[20:23], a[128:131], a[96:99], v[12:15]
 v_add_f32 v6, v96, v6
 v_cvt_pk_bf16_f32 v96, v96, v97
 v_mfma_f32_16x16x32_bf16 v[20:23], a[132:135], a[100:103], v[20:23]
 v_exp_f32 v98, v98
 v_mfma_f32_16x16x32_bf16 v[20:23], v[84:87], a[104:107], v[20:23]
 ds_read_b128 a[116:119], v0 offset:20992
 v_add_f32 v6, v97, v6
 v_mfma_f32_16x16x32_bf16 v[20:23], v[92:95], a[108:111], v[20:23]
 v_exp_f32 v99, v99
 v_mfma_f32_16x16x32_bf16 v[136:139], v[24:27], a[136:139], v[136:139]
 s_waitcnt lgkmcnt(1)
 v_add_f32 v6, v98, v6
 v_cvt_pk_bf16_f32 v97, v98, v99
 v_mfma_f32_16x16x32_bf16 v[136:139], v[28:31], a[140:143], v[136:139]
 ds_read_b128 a[120:123], v0 offset:21504
 v_add_f32 v6, v99, v6
 v_mfma_f32_16x16x32_bf16 v[168:171], v[36:39], a[140:143], v[168:171]
 v_exp_f32 v104, v104
 v_mfma_f32_16x16x32_bf16 v[168:171], v[32:35], a[136:139], v[168:171]
 v_exp_f32 v105, v105
 v_mfma_f32_16x16x32_bf16 v[200:203], v[40:43], a[136:139], v[200:203]
 v_add_f32 v7, v104, v7
 v_cvt_pk_bf16_f32 v104, v104, v105
 v_mfma_f32_16x16x32_bf16 v[200:203], v[44:47], a[140:143], v[200:203]
 v_exp_f32 v106, v106
 v_mfma_f32_16x16x32_bf16 v[232:235], v[52:55], a[140:143], v[232:235]
 ds_read_b128 a[124:127], v0 offset:22016
 v_add_f32 v7, v105, v7
 v_mfma_f32_16x16x32_bf16 v[232:235], v[48:51], a[136:139], v[232:235]
 v_exp_f32 v107, v107
 v_mfma_f32_16x16x32_bf16 a[160:163], v[56:59], a[136:139], a[160:163]
 v_add_f32 v7, v106, v7
 v_cvt_pk_bf16_f32 v105, v106, v107
 v_mfma_f32_16x16x32_bf16 a[160:163], v[60:63], a[140:143], a[160:163]
 ds_read_b128 v[124:127], v0 offset:24576
 v_add_f32 v7, v107, v7
 v_mfma_f32_16x16x32_bf16 a[192:195], v[68:71], a[140:143], a[192:195]
 v_exp_f32 v112, v112
 v_mfma_f32_16x16x32_bf16 a[192:195], v[64:67], a[136:139], a[192:195]
 v_exp_f32 v113, v113
 v_mfma_f32_16x16x32_bf16 a[224:227], v[72:75], a[136:139], a[224:227]
 v_add_f32 v8, v112, v8
 v_cvt_pk_bf16_f32 v112, v112, v113
 v_mfma_f32_16x16x32_bf16 a[224:227], v[76:79], a[140:143], a[224:227]
 v_exp_f32 v114, v114
 v_mfma_f32_16x16x32_bf16 v[140:143], v[28:31], a[148:151], v[140:143]
 ds_read_b64_tr_b16 a[136:137], v1 offset:512
 v_add_f32 v8, v113, v8
 v_mfma_f32_16x16x32_bf16 v[140:143], v[24:27], a[144:147], v[140:143]
 v_exp_f32 v115, v115
 v_mfma_f32_16x16x32_bf16 v[172:175], v[32:35], a[144:147], v[172:175]
 v_add_f32 v8, v114, v8
 v_cvt_pk_bf16_f32 v113, v114, v115
 v_mfma_f32_16x16x32_bf16 v[172:175], v[36:39], a[148:151], v[172:175]
 ds_read_b64_tr_b16 a[138:139], v1 offset:4608
 v_add_f32 v8, v115, v8
 v_mfma_f32_16x16x32_bf16 v[204:207], v[44:47], a[148:151], v[204:207]
 v_exp_f32 v120, v120
 v_mfma_f32_16x16x32_bf16 v[204:207], v[40:43], a[144:147], v[204:207]
 v_exp_f32 v121, v121
 v_mfma_f32_16x16x32_bf16 v[236:239], v[48:51], a[144:147], v[236:239]
 v_exp_f32 v122, v122
 v_mfma_f32_16x16x32_bf16 v[236:239], v[52:55], a[148:151], v[236:239]
 v_add_f32 v9, v120, v9
 v_cvt_pk_bf16_f32 v120, v120, v121
 v_mfma_f32_16x16x32_bf16 a[164:167], v[60:63], a[148:151], a[164:167]
 v_exp_f32 v123, v123
 v_mfma_f32_16x16x32_bf16 a[164:167], v[56:59], a[144:147], a[164:167]
 v_add_f32 v9, v121, v9
 v_add_f32 v9, v122, v9
 v_mfma_f32_16x16x32_bf16 a[196:199], v[64:67], a[144:147], a[196:199]
 v_exp_f32 v20, v20
 v_mfma_f32_16x16x32_bf16 a[196:199], v[68:71], a[148:151], a[196:199]
 v_add_f32 v9, v123, v9
 v_cvt_pk_bf16_f32 v121, v122, v123
 v_mfma_f32_16x16x32_bf16 a[228:231], v[76:79], a[148:151], a[228:231]
 v_exp_f32 v21, v21
 v_mfma_f32_16x16x32_bf16 a[228:231], v[72:75], a[144:147], a[228:231]
 ds_read_b64_tr_b16 a[140:141], v1 offset:8704
 v_add_f32 v3, v20, v21
 v_mfma_f32_16x16x32_bf16 v[16:19], a[112:115], a[0:3], v[12:15]
 s_waitcnt lgkmcnt(1)
 v_exp_f32 v22, v22
 v_mfma_f32_16x16x32_bf16 v[16:19], a[116:119], a[4:7], v[16:19]
 ds_read_b64_tr_b16 a[142:143], v1 offset:12800
 v_cvt_pk_bf16_f32 v128, v20, v21
 v_mfma_f32_16x16x32_bf16 v[16:19], a[120:123], a[8:11], v[16:19]
 v_exp_f32 v23, v23
 v_mfma_f32_16x16x32_bf16 v[16:19], a[124:127], a[12:15], v[16:19]
 v_add_f32 v11, v22, v23
 v_cvt_pk_bf16_f32 v129, v22, v23
 v_mfma_f32_16x16x32_bf16 v[116:119], a[124:127], a[28:31], v[12:15]
 ds_read_b64_tr_b16 a[148:149], v2 offset:8704
 v_add_f32 v10, v3, v10
 v_mfma_f32_16x16x32_bf16 v[116:119], a[120:123], a[24:27], v[116:119]
 ds_read_b64_tr_b16 a[150:151], v2 offset:12800
 v_add_f32 v10, v11, v10
 v_mfma_f32_16x16x32_bf16 v[116:119], a[116:119], a[20:23], v[116:119]
 v_exp_f32 v16, v16
 v_mfma_f32_16x16x32_bf16 v[116:119], a[112:115], a[16:19], v[116:119]
 v_exp_f32 v17, v17
 v_mfma_f32_16x16x32_bf16 v[108:111], a[112:115], a[32:35], v[12:15]
 v_add_f32 v4, v16, v4
 v_cvt_pk_bf16_f32 v82, v16, v17
 v_mfma_f32_16x16x32_bf16 v[108:111], a[116:119], a[36:39], v[108:111]
 v_exp_f32 v18, v18
 v_mfma_f32_16x16x32_bf16 v[108:111], a[120:123], a[40:43], v[108:111]
 ds_read_b64_tr_b16 a[144:145], v2 offset:512
 v_add_f32 v4, v17, v4
 v_mfma_f32_16x16x32_bf16 v[108:111], a[124:127], a[44:47], v[108:111]
 v_exp_f32 v19, v19
 v_mfma_f32_16x16x32_bf16 v[100:103], a[124:127], a[60:63], v[12:15]
 v_add_f32 v4, v18, v4
 v_cvt_pk_bf16_f32 v83, v18, v19
 v_mfma_f32_16x16x32_bf16 v[100:103], a[120:123], a[56:59], v[100:103]
 ds_read_b64_tr_b16 a[146:147], v2 offset:4608
 v_add_f32 v4, v19, v4
 v_mfma_f32_16x16x32_bf16 v[100:103], a[116:119], a[52:55], v[100:103]
 v_exp_f32 v116, v116
 v_mfma_f32_16x16x32_bf16 v[100:103], a[112:115], a[48:51], v[100:103]
 v_exp_f32 v117, v117
 v_mfma_f32_16x16x32_bf16 v[92:95], a[112:115], a[64:67], v[12:15]
 v_add_f32 v5, v116, v5
 v_cvt_pk_bf16_f32 v90, v116, v117
 v_mfma_f32_16x16x32_bf16 v[92:95], a[116:119], a[68:71], v[92:95]
 v_exp_f32 v118, v118
 v_mfma_f32_16x16x32_bf16 v[92:95], a[120:123], a[72:75], v[92:95]
 ds_read_b128 v[132:135], v0 offset:25088
 v_add_f32 v5, v117, v5
 v_mfma_f32_16x16x32_bf16 v[92:95], a[124:127], a[76:79], v[92:95]
 v_exp_f32 v119, v119
 v_mfma_f32_16x16x32_bf16 v[84:87], a[124:127], a[92:95], v[12:15]
 v_add_f32 v5, v118, v5
 v_cvt_pk_bf16_f32 v91, v118, v119
 v_mfma_f32_16x16x32_bf16 v[84:87], a[120:123], a[88:91], v[84:87]
 ds_read_b128 a[128:131], v0 offset:25600
 v_add_f32 v5, v119, v5
 v_mfma_f32_16x16x32_bf16 v[84:87], a[116:119], a[84:87], v[84:87]
 v_exp_f32 v108, v108
 v_mfma_f32_16x16x32_bf16 v[84:87], a[112:115], a[80:83], v[84:87]
 v_exp_f32 v109, v109
 v_mfma_f32_16x16x32_bf16 v[20:23], a[112:115], a[96:99], v[12:15]
 v_add_f32 v6, v108, v6
 v_cvt_pk_bf16_f32 v98, v108, v109
 v_mfma_f32_16x16x32_bf16 v[20:23], a[116:119], a[100:103], v[20:23]
 v_exp_f32 v110, v110
 v_mfma_f32_16x16x32_bf16 v[20:23], a[120:123], a[104:107], v[20:23]
 ds_read_b128 a[132:135], v0 offset:26112
 v_add_f32 v6, v109, v6
 v_mfma_f32_16x16x32_bf16 v[20:23], a[124:127], a[108:111], v[20:23]
 v_exp_f32 v111, v111
 v_mfma_f32_16x16x32_bf16 v[144:147], v[24:27], a[136:139], v[144:147]
 s_waitcnt lgkmcnt(1)
 v_add_f32 v6, v110, v6
 v_cvt_pk_bf16_f32 v99, v110, v111
 v_mfma_f32_16x16x32_bf16 v[144:147], v[28:31], a[140:143], v[144:147]
 v_add_f32 v6, v111, v6
 v_mfma_f32_16x16x32_bf16 v[176:179], v[36:39], a[140:143], v[176:179]
 v_exp_f32 v100, v100
 v_mfma_f32_16x16x32_bf16 v[176:179], v[32:35], a[136:139], v[176:179]
 v_exp_f32 v101, v101
 v_mfma_f32_16x16x32_bf16 v[208:211], v[40:43], a[136:139], v[208:211]
 v_add_f32 v7, v100, v7
 v_cvt_pk_bf16_f32 v106, v100, v101
 v_mfma_f32_16x16x32_bf16 v[208:211], v[44:47], a[140:143], v[208:211]
 v_exp_f32 v102, v102
 v_mfma_f32_16x16x32_bf16 v[240:243], v[52:55], a[140:143], v[240:243]
 ds_read_b128 a[124:127], v0 offset:30208
 v_add_f32 v7, v101, v7
 v_mfma_f32_16x16x32_bf16 v[240:243], v[48:51], a[136:139], v[240:243]
 v_exp_f32 v103, v103
 v_mfma_f32_16x16x32_bf16 a[168:171], v[56:59], a[136:139], a[168:171]
 v_add_f32 v7, v102, v7
 v_cvt_pk_bf16_f32 v107, v102, v103
 v_mfma_f32_16x16x32_bf16 a[168:171], v[60:63], a[140:143], a[168:171]
 ds_read_b128 a[120:123], v0 offset:29696
 v_add_f32 v7, v103, v7
 v_mfma_f32_16x16x32_bf16 a[200:203], v[68:71], a[140:143], a[200:203]
 v_exp_f32 v92, v92
 v_mfma_f32_16x16x32_bf16 a[200:203], v[64:67], a[136:139], a[200:203]
 v_exp_f32 v93, v93
 v_mfma_f32_16x16x32_bf16 a[232:235], v[72:75], a[136:139], a[232:235]
 v_add_f32 v8, v92, v8
 v_cvt_pk_bf16_f32 v114, v92, v93
 v_mfma_f32_16x16x32_bf16 a[232:235], v[76:79], a[140:143], a[232:235]
 v_exp_f32 v94, v94
 v_mfma_f32_16x16x32_bf16 v[148:151], v[28:31], a[148:151], v[148:151]
 ds_read_b64_tr_b16 a[136:137], v1 offset:1024
 v_add_f32 v8, v93, v8
 v_mfma_f32_16x16x32_bf16 v[148:151], v[24:27], a[144:147], v[148:151]
 v_exp_f32 v95, v95
 v_mfma_f32_16x16x32_bf16 v[180:183], v[32:35], a[144:147], v[180:183]
 v_add_f32 v8, v94, v8
 v_cvt_pk_bf16_f32 v115, v94, v95
 v_mfma_f32_16x16x32_bf16 v[180:183], v[36:39], a[148:151], v[180:183]
 ds_read_b64_tr_b16 a[138:139], v1 offset:5120
 v_add_f32 v8, v95, v8
 v_mfma_f32_16x16x32_bf16 v[212:215], v[44:47], a[148:151], v[212:215]
 v_exp_f32 v84, v84
 v_mfma_f32_16x16x32_bf16 v[212:215], v[40:43], a[144:147], v[212:215]
 v_exp_f32 v85, v85
 v_mfma_f32_16x16x32_bf16 v[244:247], v[48:51], a[144:147], v[244:247]
 v_exp_f32 v86, v86
 v_mfma_f32_16x16x32_bf16 v[244:247], v[52:55], a[148:151], v[244:247]
 v_add_f32 v9, v84, v9
 v_cvt_pk_bf16_f32 v122, v84, v85
 v_mfma_f32_16x16x32_bf16 a[172:175], v[60:63], a[148:151], a[172:175]
 v_exp_f32 v87, v87
 v_mfma_f32_16x16x32_bf16 a[172:175], v[56:59], a[144:147], a[172:175]
 v_add_f32 v9, v85, v9
 v_add_f32 v9, v86, v9
 v_mfma_f32_16x16x32_bf16 a[204:207], v[64:67], a[144:147], a[204:207]
 v_exp_f32 v20, v20
 v_mfma_f32_16x16x32_bf16 a[204:207], v[68:71], a[148:151], a[204:207]
 v_add_f32 v9, v87, v9
 v_cvt_pk_bf16_f32 v123, v86, v87
 v_mfma_f32_16x16x32_bf16 a[236:239], v[76:79], a[148:151], a[236:239]
 v_exp_f32 v21, v21
 v_mfma_f32_16x16x32_bf16 a[236:239], v[72:75], a[144:147], a[236:239]
 ds_read_b64_tr_b16 a[140:141], v1 offset:9216
 v_add_f32 v3, v20, v21
 v_mfma_f32_16x16x32_bf16 v[16:19], v[124:127], a[0:3], v[12:15]
 v_exp_f32 v22, v22
 v_mfma_f32_16x16x32_bf16 v[16:19], v[132:135], a[4:7], v[16:19]
 ds_read_b64_tr_b16 a[142:143], v1 offset:13312
 v_cvt_pk_bf16_f32 v130, v20, v21
 v_mfma_f32_16x16x32_bf16 v[16:19], a[128:131], a[8:11], v[16:19]
 s_waitcnt lgkmcnt(2)
 v_exp_f32 v23, v23
 v_mfma_f32_16x16x32_bf16 v[16:19], a[132:135], a[12:15], v[16:19]
 v_add_f32 v11, v22, v23
 v_cvt_pk_bf16_f32 v131, v22, v23
 v_mfma_f32_16x16x32_bf16 v[92:95], a[132:135], a[28:31], v[12:15]
 ds_read_b64_tr_b16 a[148:149], v2 offset:9216
 v_add_f32 v10, v3, v10
 v_mfma_f32_16x16x32_bf16 v[92:95], a[128:131], a[24:27], v[92:95]
 ds_read_b64_tr_b16 a[150:151], v2 offset:13312
 v_add_f32 v10, v11, v10
 v_mfma_f32_16x16x32_bf16 v[92:95], v[132:135], a[20:23], v[92:95]
 v_exp_f32 v16, v16
 v_mfma_f32_16x16x32_bf16 v[92:95], v[124:127], a[16:19], v[92:95]
 v_exp_f32 v17, v17
 v_mfma_f32_16x16x32_bf16 v[100:103], v[124:127], a[32:35], v[12:15]
 v_add_f32 v4, v16, v4
 v_cvt_pk_bf16_f32 v84, v16, v17
 v_mfma_f32_16x16x32_bf16 v[100:103], v[132:135], a[36:39], v[100:103]
 v_exp_f32 v18, v18
 v_mfma_f32_16x16x32_bf16 v[100:103], a[128:131], a[40:43], v[100:103]
 ds_read_b64_tr_b16 a[144:145], v2 offset:1024
 v_add_f32 v4, v17, v4
 v_mfma_f32_16x16x32_bf16 v[100:103], a[132:135], a[44:47], v[100:103]
 v_exp_f32 v19, v19
 v_mfma_f32_16x16x32_bf16 v[108:111], a[132:135], a[60:63], v[12:15]
 v_add_f32 v4, v18, v4
 v_cvt_pk_bf16_f32 v85, v18, v19
 v_mfma_f32_16x16x32_bf16 v[108:111], a[128:131], a[56:59], v[108:111]
 ds_read_b64_tr_b16 a[146:147], v2 offset:5120
 v_add_f32 v4, v19, v4
 v_mfma_f32_16x16x32_bf16 v[108:111], v[132:135], a[52:55], v[108:111]
 v_exp_f32 v92, v92
 v_mfma_f32_16x16x32_bf16 v[108:111], v[124:127], a[48:51], v[108:111]
 v_exp_f32 v93, v93
 v_mfma_f32_16x16x32_bf16 v[116:119], v[124:127], a[64:67], v[12:15]
 v_add_f32 v5, v92, v5
 v_cvt_pk_bf16_f32 v92, v92, v93
 v_mfma_f32_16x16x32_bf16 v[116:119], v[132:135], a[68:71], v[116:119]
 v_exp_f32 v94, v94
 v_mfma_f32_16x16x32_bf16 v[116:119], a[128:131], a[72:75], v[116:119]
 ds_read_b128 a[116:119], v0 offset:29184
 v_add_f32 v5, v93, v5
 v_mfma_f32_16x16x32_bf16 v[116:119], a[132:135], a[76:79], v[116:119]
 v_exp_f32 v95, v95
 v_mfma_f32_16x16x32_bf16 v[20:23], a[132:135], a[92:95], v[12:15]
 v_add_f32 v5, v94, v5
 v_cvt_pk_bf16_f32 v93, v94, v95
 v_mfma_f32_16x16x32_bf16 v[20:23], a[128:131], a[88:91], v[20:23]
 ds_read_b128 a[112:115], v0 offset:28672
 v_add_f32 v5, v95, v5
 v_mfma_f32_16x16x32_bf16 v[20:23], v[132:135], a[84:87], v[20:23]
 v_exp_f32 v100, v100
 v_mfma_f32_16x16x32_bf16 v[20:23], v[124:127], a[80:83], v[20:23]
 v_exp_f32 v101, v101
 v_mfma_f32_16x16x32_bf16 v[152:155], v[24:27], a[136:139], v[152:155]
 s_waitcnt lgkmcnt(2)
 v_add_f32 v6, v100, v6
 v_cvt_pk_bf16_f32 v100, v100, v101
 v_mfma_f32_16x16x32_bf16 v[152:155], v[28:31], a[140:143], v[152:155]
 v_exp_f32 v102, v102
 v_mfma_f32_16x16x32_bf16 v[184:187], v[36:39], a[140:143], v[184:187]
 v_add_f32 v6, v101, v6
 v_mfma_f32_16x16x32_bf16 v[184:187], v[32:35], a[136:139], v[184:187]
 v_exp_f32 v103, v103
 v_mfma_f32_16x16x32_bf16 v[216:219], v[40:43], a[136:139], v[216:219]
 v_add_f32 v6, v102, v6
 v_cvt_pk_bf16_f32 v101, v102, v103
 v_mfma_f32_16x16x32_bf16 v[216:219], v[44:47], a[140:143], v[216:219]
 v_add_f32 v6, v103, v6
 v_mfma_f32_16x16x32_bf16 v[248:251], v[52:55], a[140:143], v[248:251]
 v_exp_f32 v108, v108
 v_mfma_f32_16x16x32_bf16 v[248:251], v[48:51], a[136:139], v[248:251]
 v_exp_f32 v109, v109
 v_mfma_f32_16x16x32_bf16 a[176:179], v[56:59], a[136:139], a[176:179]
 v_add_f32 v7, v108, v7
 v_cvt_pk_bf16_f32 v108, v108, v109
 v_mfma_f32_16x16x32_bf16 a[176:179], v[60:63], a[140:143], a[176:179]
 v_exp_f32 v110, v110
 v_mfma_f32_16x16x32_bf16 a[208:211], v[68:71], a[140:143], a[208:211]
 v_add_f32 v7, v109, v7
 v_mfma_f32_16x16x32_bf16 a[208:211], v[64:67], a[136:139], a[208:211]
 v_exp_f32 v111, v111
 v_mfma_f32_16x16x32_bf16 a[240:243], v[72:75], a[136:139], a[240:243]
 v_add_f32 v7, v110, v7
 v_cvt_pk_bf16_f32 v109, v110, v111
 v_mfma_f32_16x16x32_bf16 a[240:243], v[76:79], a[140:143], a[240:243]
 ds_read_b64_tr_b16 a[136:137], v1 offset:1536
 v_add_f32 v7, v111, v7
 v_mfma_f32_16x16x32_bf16 v[156:159], v[28:31], a[148:151], v[156:159]
 v_exp_f32 v116, v116
 v_mfma_f32_16x16x32_bf16 v[156:159], v[24:27], a[144:147], v[156:159]
 v_exp_f32 v117, v117
 v_mfma_f32_16x16x32_bf16 v[188:191], v[32:35], a[144:147], v[188:191]
 v_exp_f32 v118, v118
 v_mfma_f32_16x16x32_bf16 v[188:191], v[36:39], a[148:151], v[188:191]
 v_add_f32 v8, v116, v8
 v_cvt_pk_bf16_f32 v116, v116, v117
 v_mfma_f32_16x16x32_bf16 v[220:223], v[44:47], a[148:151], v[220:223]
 v_exp_f32 v119, v119
 v_mfma_f32_16x16x32_bf16 v[220:223], v[40:43], a[144:147], v[220:223]
 v_add_f32 v8, v117, v8
 v_add_f32 v8, v118, v8
 v_mfma_f32_16x16x32_bf16 v[252:255], v[48:51], a[144:147], v[252:255]
 v_exp_f32 v20, v20
 v_mfma_f32_16x16x32_bf16 v[252:255], v[52:55], a[148:151], v[252:255]
 v_add_f32 v8, v119, v8
 v_cvt_pk_bf16_f32 v117, v118, v119
 v_mfma_f32_16x16x32_bf16 a[180:183], v[60:63], a[148:151], a[180:183]
 v_exp_f32 v21, v21
 v_mfma_f32_16x16x32_bf16 a[180:183], v[56:59], a[144:147], a[180:183]
 ds_read_b64_tr_b16 a[138:139], v1 offset:5632
 v_add_f32 v3, v20, v21
 v_mfma_f32_16x16x32_bf16 v[16:19], v[124:127], a[96:99], v[12:15]
 v_exp_f32 v22, v22
 v_mfma_f32_16x16x32_bf16 v[16:19], v[132:135], a[100:103], v[16:19]
 ds_read_b64_tr_b16 a[140:141], v1 offset:9728
 v_cvt_pk_bf16_f32 v124, v20, v21
 v_mfma_f32_16x16x32_bf16 v[16:19], a[128:131], a[104:107], v[16:19]
 v_exp_f32 v23, v23
 v_mfma_f32_16x16x32_bf16 v[16:19], a[132:135], a[108:111], v[16:19]
 v_add_f32 v11, v22, v23
 v_cvt_pk_bf16_f32 v125, v22, v23
 v_mfma_f32_16x16x32_bf16 v[20:23], a[124:127], a[12:15], v[12:15]
 ds_read_b64_tr_b16 a[142:143], v1 offset:13824
 v_add_f32 v9, v3, v9
 v_mfma_f32_16x16x32_bf16 v[20:23], a[120:123], a[8:11], v[20:23]
 s_waitcnt lgkmcnt(3)
 v_add_f32 v9, v11, v9
 v_mfma_f32_16x16x32_bf16 v[20:23], a[116:119], a[4:7], v[20:23]
 v_exp_f32 v16, v16
 v_mfma_f32_16x16x32_bf16 v[20:23], a[112:115], a[0:3], v[20:23]
 v_exp_f32 v17, v17
 v_mfma_f32_16x16x32_bf16 a[212:215], v[64:67], a[144:147], a[212:215]
 v_exp_f32 v18, v18
 v_mfma_f32_16x16x32_bf16 a[212:215], v[68:71], a[148:151], a[212:215]
 v_add_f32 v10, v16, v10
 v_cvt_pk_bf16_f32 v132, v16, v17
 v_mfma_f32_16x16x32_bf16 a[244:247], v[76:79], a[148:151], a[244:247]
 v_exp_f32 v19, v19
 v_mfma_f32_16x16x32_bf16 a[244:247], v[72:75], a[144:147], a[244:247]
 s_waitcnt lgkmcnt(0)
 v_add_f32 v10, v17, v10
 v_add_f32 v10, v18, v10
 v_mfma_f32_16x16x32_bf16 v[160:163], v[24:27], a[136:139], v[160:163]
 v_exp_f32 v20, v20
 v_mfma_f32_16x16x32_bf16 v[160:163], v[28:31], a[140:143], v[160:163]
 v_add_f32 v10, v19, v10
 v_cvt_pk_bf16_f32 v133, v18, v19
 v_mfma_f32_16x16x32_bf16 v[192:195], v[36:39], a[140:143], v[192:195]
 v_exp_f32 v21, v21
 v_mfma_f32_16x16x32_bf16 v[192:195], v[32:35], a[136:139], v[192:195]
 ds_read_b64_tr_b16 a[148:149], v2 offset:9728
 v_add_f32 v3, v20, v21
 v_mfma_f32_16x16x32_bf16 v[16:19], a[112:115], a[16:19], v[12:15]
 v_exp_f32 v22, v22
 v_mfma_f32_16x16x32_bf16 v[16:19], a[116:119], a[20:23], v[16:19]
 ds_read_b64_tr_b16 a[150:151], v2 offset:13824
 v_cvt_pk_bf16_f32 v86, v20, v21
 v_mfma_f32_16x16x32_bf16 v[16:19], a[120:123], a[24:27], v[16:19]
 v_exp_f32 v23, v23
 v_mfma_f32_16x16x32_bf16 v[16:19], a[124:127], a[28:31], v[16:19]
 v_add_f32 v11, v22, v23
 v_cvt_pk_bf16_f32 v87, v22, v23
 v_mfma_f32_16x16x32_bf16 v[20:23], a[124:127], a[44:47], v[12:15]
 s_waitcnt vmcnt(0)
 v_add_f32 v4, v3, v4
 v_add_f32 v4, v11, v4
 v_mfma_f32_16x16x32_bf16 v[20:23], a[120:123], a[40:43], v[20:23]
 s_barrier
 v_mfma_f32_16x16x32_bf16 v[20:23], a[116:119], a[36:39], v[20:23]
 v_exp_f32 v16, v16
 v_mfma_f32_16x16x32_bf16 v[20:23], a[112:115], a[32:35], v[20:23]
 v_exp_f32 v17, v17
 v_mfma_f32_16x16x32_bf16 v[224:227], v[40:43], a[136:139], v[224:227]
 v_exp_f32 v18, v18
 v_mfma_f32_16x16x32_bf16 v[224:227], v[44:47], a[140:143], v[224:227]
 v_add_f32 v5, v16, v5
 v_cvt_pk_bf16_f32 v94, v16, v17
 v_mfma_f32_16x16x32_bf16 a[152:155], v[52:55], a[140:143], a[152:155]
 v_exp_f32 v19, v19
 v_mfma_f32_16x16x32_bf16 a[152:155], v[48:51], a[136:139], a[152:155]
 v_add_f32 v5, v17, v5
 v_add_f32 v5, v18, v5
 v_mfma_f32_16x16x32_bf16 a[184:187], v[56:59], a[136:139], a[184:187]
 v_exp_f32 v20, v20
 v_mfma_f32_16x16x32_bf16 a[184:187], v[60:63], a[140:143], a[184:187]
 v_add_f32 v5, v19, v5
 v_cvt_pk_bf16_f32 v95, v18, v19
 v_mfma_f32_16x16x32_bf16 a[216:219], v[68:71], a[140:143], a[216:219]
 v_exp_f32 v21, v21
 v_mfma_f32_16x16x32_bf16 a[216:219], v[64:67], a[136:139], a[216:219]
 ds_read_b64_tr_b16 a[144:145], v2 offset:1536
 v_add_f32 v3, v20, v21
 v_mfma_f32_16x16x32_bf16 v[16:19], a[112:115], a[48:51], v[12:15]
 v_exp_f32 v22, v22
 v_mfma_f32_16x16x32_bf16 v[16:19], a[116:119], a[52:55], v[16:19]
 ds_read_b64_tr_b16 a[146:147], v2 offset:5632
 v_cvt_pk_bf16_f32 v102, v20, v21
 v_mfma_f32_16x16x32_bf16 v[16:19], a[120:123], a[56:59], v[16:19]
 v_exp_f32 v23, v23
 v_mfma_f32_16x16x32_bf16 v[16:19], a[124:127], a[60:63], v[16:19]
 v_add_f32 v11, v22, v23
 v_cvt_pk_bf16_f32 v103, v22, v23
 v_mfma_f32_16x16x32_bf16 v[20:23], a[124:127], a[76:79], v[12:15]
 ds_read_b128 a[128:131], v0 offset:32768
 v_add_f32 v6, v3, v6
 v_mfma_f32_16x16x32_bf16 v[20:23], a[120:123], a[72:75], v[20:23]
 ds_read_b128 a[132:135], v0 offset:33280
 v_add_f32 v6, v11, v6
 v_mfma_f32_16x16x32_bf16 v[20:23], a[116:119], a[68:71], v[20:23]
 v_exp_f32 v16, v16
 v_mfma_f32_16x16x32_bf16 v[20:23], a[112:115], a[64:67], v[20:23]
 v_exp_f32 v17, v17
 v_mfma_f32_16x16x32_bf16 a[248:251], v[72:75], a[136:139], a[248:251]
 v_exp_f32 v18, v18
 v_mfma_f32_16x16x32_bf16 a[248:251], v[76:79], a[140:143], a[248:251]
 s_waitcnt lgkmcnt(2)
 v_add_f32 v7, v16, v7
 v_cvt_pk_bf16_f32 v110, v16, v17
 v_mfma_f32_16x16x32_bf16 v[164:167], v[28:31], a[148:151], v[164:167]
 v_exp_f32 v19, v19
 v_mfma_f32_16x16x32_bf16 v[164:167], v[24:27], a[144:147], v[164:167]
 v_add_f32 v7, v17, v7
 v_add_f32 v7, v18, v7
 v_mfma_f32_16x16x32_bf16 v[196:199], v[32:35], a[144:147], v[196:199]
 v_exp_f32 v20, v20
 v_mfma_f32_16x16x32_bf16 v[196:199], v[36:39], a[148:151], v[196:199]
 v_add_f32 v7, v19, v7
 v_cvt_pk_bf16_f32 v111, v18, v19
 v_mfma_f32_16x16x32_bf16 v[228:231], v[44:47], a[148:151], v[228:231]
 v_exp_f32 v21, v21
 v_mfma_f32_16x16x32_bf16 v[228:231], v[40:43], a[144:147], v[228:231]
 ds_read_b128 v[28:31], v0 offset:33792
 v_add_f32 v3, v20, v21
 v_mfma_f32_16x16x32_bf16 v[16:19], a[112:115], a[80:83], v[12:15]
 v_exp_f32 v22, v22
 v_mfma_f32_16x16x32_bf16 v[16:19], a[116:119], a[84:87], v[16:19]
 ds_read_b128 v[36:39], v0 offset:34304
 v_cvt_pk_bf16_f32 v118, v20, v21
 v_mfma_f32_16x16x32_bf16 v[16:19], a[120:123], a[88:91], v[16:19]
 v_exp_f32 v23, v23
 v_mfma_f32_16x16x32_bf16 v[16:19], a[124:127], a[92:95], v[16:19]
 v_add_f32 v11, v22, v23
 v_cvt_pk_bf16_f32 v119, v22, v23
 v_mfma_f32_16x16x32_bf16 v[20:23], a[124:127], a[108:111], v[12:15]
 ds_read_b64_tr_b16 a[136:137], v1 offset:16384
 v_add_f32 v8, v3, v8
 v_mfma_f32_16x16x32_bf16 v[20:23], a[120:123], a[104:107], v[20:23]
 ds_read_b64_tr_b16 a[138:139], v1 offset:20480
 v_add_f32 v8, v11, v8
 v_mfma_f32_16x16x32_bf16 v[20:23], a[116:119], a[100:103], v[20:23]
 v_exp_f32 v16, v16
 v_mfma_f32_16x16x32_bf16 v[20:23], a[112:115], a[96:99], v[20:23]
 v_exp_f32 v17, v17
 v_mfma_f32_16x16x32_bf16 a[156:159], v[48:51], a[144:147], a[156:159]
 v_exp_f32 v18, v18
 v_mfma_f32_16x16x32_bf16 a[156:159], v[52:55], a[148:151], a[156:159]
 v_add_f32 v9, v16, v9
 v_cvt_pk_bf16_f32 v126, v16, v17
 v_mfma_f32_16x16x32_bf16 a[188:191], v[60:63], a[148:151], a[188:191]
 v_exp_f32 v19, v19
 v_mfma_f32_16x16x32_bf16 a[188:191], v[56:59], a[144:147], a[188:191]
 v_add_f32 v9, v17, v9
 v_add_f32 v9, v18, v9
 v_mfma_f32_16x16x32_bf16 a[220:223], v[64:67], a[144:147], a[220:223]
 v_exp_f32 v20, v20
 v_mfma_f32_16x16x32_bf16 a[220:223], v[68:71], a[148:151], a[220:223]
 v_add_f32 v9, v19, v9
 v_cvt_pk_bf16_f32 v127, v18, v19
 v_mfma_f32_16x16x32_bf16 a[252:255], v[76:79], a[148:151], a[252:255]
 v_exp_f32 v21, v21
 v_mfma_f32_16x16x32_bf16 a[252:255], v[72:75], a[144:147], a[252:255]
 s_waitcnt lgkmcnt(0)
 v_add_f32 v3, v20, v21
L_sub1_7:
 v_mfma_f32_16x16x32_bf16 v[16:19], a[128:131], a[0:3], v[12:15]
 v_exp_f32 v22, v22
 v_mfma_f32_16x16x32_bf16 v[16:19], a[132:135], a[4:7], v[16:19]
 ds_read_b64_tr_b16 a[140:141], v1 offset:24576
 v_cvt_pk_bf16_f32 v134, v20, v21
 v_mfma_f32_16x16x32_bf16 v[16:19], v[28:31], a[8:11], v[16:19]
 v_exp_f32 v23, v23
 v_mfma_f32_16x16x32_bf16 v[16:19], v[36:39], a[12:15], v[16:19]
 v_add_f32 v11, v22, v23
 v_cvt_pk_bf16_f32 v135, v22, v23
 v_mfma_f32_16x16x32_bf16 v[32:35], v[36:39], a[28:31], v[12:15]
 ds_read_b64_tr_b16 a[142:143], v1 offset:28672
 v_add_f32 v10, v3, v10
 v_mfma_f32_16x16x32_bf16 v[32:35], v[28:31], a[24:27], v[32:35]
 ds_read_b64_tr_b16 a[148:149], v2 offset:24576
 v_add_f32 v10, v11, v10
 v_mfma_f32_16x16x32_bf16 v[32:35], a[132:135], a[20:23], v[32:35]
 v_exp_f32 v16, v16
 v_mfma_f32_16x16x32_bf16 v[32:35], a[128:131], a[16:19], v[32:35]
 v_exp_f32 v17, v17
 v_mfma_f32_16x16x32_bf16 v[40:43], a[128:131], a[32:35], v[12:15]
 v_add_f32 v4, v16, v4
 v_cvt_pk_bf16_f32 v24, v16, v17
 v_mfma_f32_16x16x32_bf16 v[40:43], a[132:135], a[36:39], v[40:43]
 v_exp_f32 v18, v18
 v_mfma_f32_16x16x32_bf16 v[40:43], v[28:31], a[40:43], v[40:43]
 ds_read_b64_tr_b16 a[150:151], v2 offset:28672
 v_add_f32 v4, v17, v4
 v_mfma_f32_16x16x32_bf16 v[40:43], v[36:39], a[44:47], v[40:43]
 v_exp_f32 v19, v19
 v_mfma_f32_16x16x32_bf16 v[48:51], v[36:39], a[60:63], v[12:15]
 v_add_f32 v4, v18, v4
 v_cvt_pk_bf16_f32 v25, v18, v19
 v_mfma_f32_16x16x32_bf16 v[48:51], v[28:31], a[56:59], v[48:51]
 ds_read_b64_tr_b16 a[144:145], v2 offset:16384
 v_add_f32 v4, v19, v4
 v_mfma_f32_16x16x32_bf16 v[48:51], a[132:135], a[52:55], v[48:51]
 v_exp_f32 v32, v32
 v_mfma_f32_16x16x32_bf16 v[48:51], a[128:131], a[48:51], v[48:51]
 v_exp_f32 v33, v33
 v_mfma_f32_16x16x32_bf16 v[56:59], a[128:131], a[64:67], v[12:15]
 v_add_f32 v5, v32, v5
 v_cvt_pk_bf16_f32 v32, v32, v33
 v_mfma_f32_16x16x32_bf16 v[56:59], a[132:135], a[68:71], v[56:59]
 v_exp_f32 v34, v34
 v_mfma_f32_16x16x32_bf16 v[56:59], v[28:31], a[72:75], v[56:59]
 ds_read_b64_tr_b16 a[146:147], v2 offset:20480
 v_add_f32 v5, v33, v5
 v_mfma_f32_16x16x32_bf16 v[56:59], v[36:39], a[76:79], v[56:59]
 v_exp_f32 v35, v35
 v_mfma_f32_16x16x32_bf16 v[64:67], v[36:39], a[92:95], v[12:15]
 v_add_f32 v5, v34, v5
 v_cvt_pk_bf16_f32 v33, v34, v35
 v_mfma_f32_16x16x32_bf16 v[64:67], v[28:31], a[88:91], v[64:67]
 ds_read_b128 a[112:115], v0 offset:36864
 v_add_f32 v5, v35, v5
 v_mfma_f32_16x16x32_bf16 v[64:67], a[132:135], a[84:87], v[64:67]
 v_exp_f32 v40, v40
 v_mfma_f32_16x16x32_bf16 v[64:67], a[128:131], a[80:83], v[64:67]
 v_exp_f32 v41, v41
 v_mfma_f32_16x16x32_bf16 v[20:23], a[128:131], a[96:99], v[12:15]
 v_add_f32 v6, v40, v6
 v_cvt_pk_bf16_f32 v40, v40, v41
 v_mfma_f32_16x16x32_bf16 v[20:23], a[132:135], a[100:103], v[20:23]
 v_exp_f32 v42, v42
 v_mfma_f32_16x16x32_bf16 v[20:23], v[28:31], a[104:107], v[20:23]
 ds_read_b128 a[116:119], v0 offset:37376
 v_add_f32 v6, v41, v6
 v_mfma_f32_16x16x32_bf16 v[20:23], v[36:39], a[108:111], v[20:23]
 s_waitcnt lgkmcnt(2)
 v_exp_f32 v43, v43
 v_mfma_f32_16x16x32_bf16 v[136:139], v[80:83], a[136:139], v[136:139]
 v_add_f32 v6, v42, v6
 v_cvt_pk_bf16_f32 v41, v42, v43
 v_mfma_f32_16x16x32_bf16 v[136:139], v[84:87], a[140:143], v[136:139]
 ds_read_b128 a[120:123], v0 offset:37888
 v_add_f32 v6, v43, v6
 v_mfma_f32_16x16x32_bf16 v[168:171], v[92:95], a[140:143], v[168:171]
 v_exp_f32 v48, v48
 v_mfma_f32_16x16x32_bf16 v[168:171], v[88:91], a[136:139], v[168:171]
 v_exp_f32 v49, v49
 v_mfma_f32_16x16x32_bf16 v[200:203], v[96:99], a[136:139], v[200:203]
 v_add_f32 v7, v48, v7
 v_cvt_pk_bf16_f32 v48, v48, v49
 v_mfma_f32_16x16x32_bf16 v[200:203], v[100:103], a[140:143], v[200:203]
 v_exp_f32 v50, v50
 v_mfma_f32_16x16x32_bf16 v[232:235], v[108:111], a[140:143], v[232:235]
 ds_read_b128 a[124:127], v0 offset:38400
 v_add_f32 v7, v49, v7
 v_mfma_f32_16x16x32_bf16 v[232:235], v[104:107], a[136:139], v[232:235]
 v_exp_f32 v51, v51
 v_mfma_f32_16x16x32_bf16 a[160:163], v[112:115], a[136:139], a[160:163]
 v_add_f32 v7, v50, v7
 v_cvt_pk_bf16_f32 v49, v50, v51
 v_mfma_f32_16x16x32_bf16 a[160:163], v[116:119], a[140:143], a[160:163]
 ds_read_b128 v[68:71], v0 offset:40960
 v_add_f32 v7, v51, v7
 v_mfma_f32_16x16x32_bf16 a[192:195], v[124:127], a[140:143], a[192:195]
 v_exp_f32 v56, v56
 v_mfma_f32_16x16x32_bf16 a[192:195], v[120:123], a[136:139], a[192:195]
 v_exp_f32 v57, v57
 v_mfma_f32_16x16x32_bf16 a[224:227], v[128:131], a[136:139], a[224:227]
 v_add_f32 v8, v56, v8
 v_cvt_pk_bf16_f32 v56, v56, v57
 v_mfma_f32_16x16x32_bf16 a[224:227], v[132:135], a[140:143], a[224:227]
 v_exp_f32 v58, v58
 v_mfma_f32_16x16x32_bf16 v[140:143], v[84:87], a[148:151], v[140:143]
 ds_read_b64_tr_b16 a[136:137], v1 offset:16896
 v_add_f32 v8, v57, v8
 v_mfma_f32_16x16x32_bf16 v[140:143], v[80:83], a[144:147], v[140:143]
 v_exp_f32 v59, v59
 v_mfma_f32_16x16x32_bf16 v[172:175], v[88:91], a[144:147], v[172:175]
 v_add_f32 v8, v58, v8
 v_cvt_pk_bf16_f32 v57, v58, v59
 v_mfma_f32_16x16x32_bf16 v[172:175], v[92:95], a[148:151], v[172:175]
 ds_read_b64_tr_b16 a[138:139], v1 offset:20992
 v_add_f32 v8, v59, v8
 v_mfma_f32_16x16x32_bf16 v[204:207], v[100:103], a[148:151], v[204:207]
 v_exp_f32 v64, v64
 v_mfma_f32_16x16x32_bf16 v[204:207], v[96:99], a[144:147], v[204:207]
 v_exp_f32 v65, v65
 v_mfma_f32_16x16x32_bf16 v[236:239], v[104:107], a[144:147], v[236:239]
 v_exp_f32 v66, v66
 v_mfma_f32_16x16x32_bf16 v[236:239], v[108:111], a[148:151], v[236:239]
 v_add_f32 v9, v64, v9
 v_cvt_pk_bf16_f32 v64, v64, v65
 v_mfma_f32_16x16x32_bf16 a[164:167], v[116:119], a[148:151], a[164:167]
 v_exp_f32 v67, v67
 v_mfma_f32_16x16x32_bf16 a[164:167], v[112:115], a[144:147], a[164:167]
 v_add_f32 v9, v65, v9
 v_add_f32 v9, v66, v9
 v_mfma_f32_16x16x32_bf16 a[196:199], v[120:123], a[144:147], a[196:199]
 v_exp_f32 v20, v20
 v_mfma_f32_16x16x32_bf16 a[196:199], v[124:127], a[148:151], a[196:199]
 v_add_f32 v9, v67, v9
 v_cvt_pk_bf16_f32 v65, v66, v67
 v_mfma_f32_16x16x32_bf16 a[228:231], v[132:135], a[148:151], a[228:231]
 v_exp_f32 v21, v21
 v_mfma_f32_16x16x32_bf16 a[228:231], v[128:131], a[144:147], a[228:231]
 s_waitcnt lgkmcnt(0)
 ds_read_b64_tr_b16 a[140:141], v1 offset:25088
 v_add_f32 v3, v20, v21
 v_mfma_f32_16x16x32_bf16 v[16:19], a[112:115], a[0:3], v[12:15]
 v_exp_f32 v22, v22
 v_mfma_f32_16x16x32_bf16 v[16:19], a[116:119], a[4:7], v[16:19]
 ds_read_b64_tr_b16 a[142:143], v1 offset:29184
 v_cvt_pk_bf16_f32 v72, v20, v21
 v_mfma_f32_16x16x32_bf16 v[16:19], a[120:123], a[8:11], v[16:19]
 v_exp_f32 v23, v23
 v_mfma_f32_16x16x32_bf16 v[16:19], a[124:127], a[12:15], v[16:19]
 v_add_f32 v11, v22, v23
 v_cvt_pk_bf16_f32 v73, v22, v23
 v_mfma_f32_16x16x32_bf16 v[60:63], a[124:127], a[28:31], v[12:15]
 ds_read_b64_tr_b16 a[148:149], v2 offset:25088
 v_add_f32 v10, v3, v10
 v_mfma_f32_16x16x32_bf16 v[60:63], a[120:123], a[24:27], v[60:63]
 ds_read_b64_tr_b16 a[150:151], v2 offset:29184
 v_add_f32 v10, v11, v10
 v_mfma_f32_16x16x32_bf16 v[60:63], a[116:119], a[20:23], v[60:63]
 v_exp_f32 v16, v16
 v_mfma_f32_16x16x32_bf16 v[60:63], a[112:115], a[16:19], v[60:63]
 v_exp_f32 v17, v17
 v_mfma_f32_16x16x32_bf16 v[52:55], a[112:115], a[32:35], v[12:15]
 v_add_f32 v4, v16, v4
 v_cvt_pk_bf16_f32 v26, v16, v17
 v_mfma_f32_16x16x32_bf16 v[52:55], a[116:119], a[36:39], v[52:55]
 v_exp_f32 v18, v18
 v_mfma_f32_16x16x32_bf16 v[52:55], a[120:123], a[40:43], v[52:55]
 ds_read_b64_tr_b16 a[144:145], v2 offset:16896
 v_add_f32 v4, v17, v4
 v_mfma_f32_16x16x32_bf16 v[52:55], a[124:127], a[44:47], v[52:55]
 v_exp_f32 v19, v19
 v_mfma_f32_16x16x32_bf16 v[44:47], a[124:127], a[60:63], v[12:15]
 v_add_f32 v4, v18, v4
 v_cvt_pk_bf16_f32 v27, v18, v19
 v_mfma_f32_16x16x32_bf16 v[44:47], a[120:123], a[56:59], v[44:47]
 ds_read_b64_tr_b16 a[146:147], v2 offset:20992
 v_add_f32 v4, v19, v4
 v_mfma_f32_16x16x32_bf16 v[44:47], a[116:119], a[52:55], v[44:47]
 v_exp_f32 v60, v60
 v_mfma_f32_16x16x32_bf16 v[44:47], a[112:115], a[48:51], v[44:47]
 v_exp_f32 v61, v61
 v_mfma_f32_16x16x32_bf16 v[36:39], a[112:115], a[64:67], v[12:15]
 v_add_f32 v5, v60, v5
 v_cvt_pk_bf16_f32 v34, v60, v61
 v_mfma_f32_16x16x32_bf16 v[36:39], a[116:119], a[68:71], v[36:39]
 v_exp_f32 v62, v62
 v_mfma_f32_16x16x32_bf16 v[36:39], a[120:123], a[72:75], v[36:39]
 ds_read_b128 v[76:79], v0 offset:41472
 v_add_f32 v5, v61, v5
 v_mfma_f32_16x16x32_bf16 v[36:39], a[124:127], a[76:79], v[36:39]
 v_exp_f32 v63, v63
 v_mfma_f32_16x16x32_bf16 v[28:31], a[124:127], a[92:95], v[12:15]
 v_add_f32 v5, v62, v5
 v_cvt_pk_bf16_f32 v35, v62, v63
 v_mfma_f32_16x16x32_bf16 v[28:31], a[120:123], a[88:91], v[28:31]
 ds_read_b128 a[128:131], v0 offset:41984
 v_add_f32 v5, v63, v5
 v_mfma_f32_16x16x32_bf16 v[28:31], a[116:119], a[84:87], v[28:31]
 v_exp_f32 v52, v52
 v_mfma_f32_16x16x32_bf16 v[28:31], a[112:115], a[80:83], v[28:31]
 v_exp_f32 v53, v53
 v_mfma_f32_16x16x32_bf16 v[20:23], a[112:115], a[96:99], v[12:15]
 v_add_f32 v6, v52, v6
 v_cvt_pk_bf16_f32 v42, v52, v53
 v_mfma_f32_16x16x32_bf16 v[20:23], a[116:119], a[100:103], v[20:23]
 v_exp_f32 v54, v54
 v_mfma_f32_16x16x32_bf16 v[20:23], a[120:123], a[104:107], v[20:23]
 ds_read_b128 a[132:135], v0 offset:42496
 v_add_f32 v6, v53, v6
 v_mfma_f32_16x16x32_bf16 v[20:23], a[124:127], a[108:111], v[20:23]
 v_exp_f32 v55, v55
 v_mfma_f32_16x16x32_bf16 v[144:147], v[80:83], a[136:139], v[144:147]
 s_waitcnt lgkmcnt(1)
 v_add_f32 v6, v54, v6
 v_cvt_pk_bf16_f32 v43, v54, v55
 v_mfma_f32_16x16x32_bf16 v[144:147], v[84:87], a[140:143], v[144:147]
 v_add_f32 v6, v55, v6
 v_mfma_f32_16x16x32_bf16 v[176:179], v[92:95], a[140:143], v[176:179]
 v_exp_f32 v44, v44
 v_mfma_f32_16x16x32_bf16 v[176:179], v[88:91], a[136:139], v[176:179]
 v_exp_f32 v45, v45
 v_mfma_f32_16x16x32_bf16 v[208:211], v[96:99], a[136:139], v[208:211]
 v_add_f32 v7, v44, v7
 v_cvt_pk_bf16_f32 v50, v44, v45
 v_mfma_f32_16x16x32_bf16 v[208:211], v[100:103], a[140:143], v[208:211]
 v_exp_f32 v46, v46
 v_mfma_f32_16x16x32_bf16 v[240:243], v[108:111], a[140:143], v[240:243]
 ds_read_b128 a[124:127], v0 offset:46592
 v_add_f32 v7, v45, v7
 v_mfma_f32_16x16x32_bf16 v[240:243], v[104:107], a[136:139], v[240:243]
 v_exp_f32 v47, v47
 v_mfma_f32_16x16x32_bf16 a[168:171], v[112:115], a[136:139], a[168:171]
 v_add_f32 v7, v46, v7
 v_cvt_pk_bf16_f32 v51, v46, v47
 v_mfma_f32_16x16x32_bf16 a[168:171], v[116:119], a[140:143], a[168:171]
 ds_read_b128 a[120:123], v0 offset:46080
 v_add_f32 v7, v47, v7
 v_mfma_f32_16x16x32_bf16 a[200:203], v[124:127], a[140:143], a[200:203]
 v_exp_f32 v36, v36
 v_mfma_f32_16x16x32_bf16 a[200:203], v[120:123], a[136:139], a[200:203]
 v_exp_f32 v37, v37
 v_mfma_f32_16x16x32_bf16 a[232:235], v[128:131], a[136:139], a[232:235]
 v_add_f32 v8, v36, v8
 v_cvt_pk_bf16_f32 v58, v36, v37
 v_mfma_f32_16x16x32_bf16 a[232:235], v[132:135], a[140:143], a[232:235]
 v_exp_f32 v38, v38
 v_mfma_f32_16x16x32_bf16 v[148:151], v[84:87], a[148:151], v[148:151]
 ds_read_b64_tr_b16 a[136:137], v1 offset:17408
 v_add_f32 v8, v37, v8
 v_mfma_f32_16x16x32_bf16 v[148:151], v[80:83], a[144:147], v[148:151]
 v_exp_f32 v39, v39
 v_mfma_f32_16x16x32_bf16 v[180:183], v[88:91], a[144:147], v[180:183]
 v_add_f32 v8, v38, v8
 v_cvt_pk_bf16_f32 v59, v38, v39
 v_mfma_f32_16x16x32_bf16 v[180:183], v[92:95], a[148:151], v[180:183]
 ds_read_b64_tr_b16 a[138:139], v1 offset:21504
 v_add_f32 v8, v39, v8
 v_mfma_f32_16x16x32_bf16 v[212:215], v[100:103], a[148:151], v[212:215]
 v_exp_f32 v28, v28
 v_mfma_f32_16x16x32_bf16 v[212:215], v[96:99], a[144:147], v[212:215]
 v_exp_f32 v29, v29
 v_mfma_f32_16x16x32_bf16 v[244:247], v[104:107], a[144:147], v[244:247]
 v_exp_f32 v30, v30
 v_mfma_f32_16x16x32_bf16 v[244:247], v[108:111], a[148:151], v[244:247]
 v_add_f32 v9, v28, v9
 v_cvt_pk_bf16_f32 v66, v28, v29
 v_mfma_f32_16x16x32_bf16 a[172:175], v[116:119], a[148:151], a[172:175]
 v_exp_f32 v31, v31
 v_mfma_f32_16x16x32_bf16 a[172:175], v[112:115], a[144:147], a[172:175]
 v_add_f32 v9, v29, v9
 v_add_f32 v9, v30, v9
 v_mfma_f32_16x16x32_bf16 a[204:207], v[120:123], a[144:147], a[204:207]
 v_exp_f32 v20, v20
 v_mfma_f32_16x16x32_bf16 a[204:207], v[124:127], a[148:151], a[204:207]
 v_add_f32 v9, v31, v9
 v_cvt_pk_bf16_f32 v67, v30, v31
 v_mfma_f32_16x16x32_bf16 a[236:239], v[132:135], a[148:151], a[236:239]
 v_exp_f32 v21, v21
 v_mfma_f32_16x16x32_bf16 a[236:239], v[128:131], a[144:147], a[236:239]
 ds_read_b64_tr_b16 a[140:141], v1 offset:25600
 v_add_f32 v3, v20, v21
 v_mfma_f32_16x16x32_bf16 v[16:19], v[68:71], a[0:3], v[12:15]
 v_exp_f32 v22, v22
 v_mfma_f32_16x16x32_bf16 v[16:19], v[76:79], a[4:7], v[16:19]
 ds_read_b64_tr_b16 a[142:143], v1 offset:29696
 v_cvt_pk_bf16_f32 v74, v20, v21
 v_mfma_f32_16x16x32_bf16 v[16:19], a[128:131], a[8:11], v[16:19]
 s_waitcnt lgkmcnt(2)
 v_exp_f32 v23, v23
 v_mfma_f32_16x16x32_bf16 v[16:19], a[132:135], a[12:15], v[16:19]
 v_add_f32 v11, v22, v23
 v_cvt_pk_bf16_f32 v75, v22, v23
 v_mfma_f32_16x16x32_bf16 v[36:39], a[132:135], a[28:31], v[12:15]
 ds_read_b64_tr_b16 a[148:149], v2 offset:25600
 v_add_f32 v10, v3, v10
 v_mfma_f32_16x16x32_bf16 v[36:39], a[128:131], a[24:27], v[36:39]
 ds_read_b64_tr_b16 a[150:151], v2 offset:29696
 v_add_f32 v10, v11, v10
 v_mfma_f32_16x16x32_bf16 v[36:39], v[76:79], a[20:23], v[36:39]
 v_exp_f32 v16, v16
 v_mfma_f32_16x16x32_bf16 v[36:39], v[68:71], a[16:19], v[36:39]
 v_exp_f32 v17, v17
 v_mfma_f32_16x16x32_bf16 v[44:47], v[68:71], a[32:35], v[12:15]
 v_add_f32 v4, v16, v4
 v_cvt_pk_bf16_f32 v28, v16, v17
 v_mfma_f32_16x16x32_bf16 v[44:47], v[76:79], a[36:39], v[44:47]
 v_exp_f32 v18, v18
 v_mfma_f32_16x16x32_bf16 v[44:47], a[128:131], a[40:43], v[44:47]
 ds_read_b64_tr_b16 a[144:145], v2 offset:17408
 v_add_f32 v4, v17, v4
 v_mfma_f32_16x16x32_bf16 v[44:47], a[132:135], a[44:47], v[44:47]
 v_exp_f32 v19, v19
 v_mfma_f32_16x16x32_bf16 v[52:55], a[132:135], a[60:63], v[12:15]
 v_add_f32 v4, v18, v4
 v_cvt_pk_bf16_f32 v29, v18, v19
 v_mfma_f32_16x16x32_bf16 v[52:55], a[128:131], a[56:59], v[52:55]
 ds_read_b64_tr_b16 a[146:147], v2 offset:21504
 v_add_f32 v4, v19, v4
 v_mfma_f32_16x16x32_bf16 v[52:55], v[76:79], a[52:55], v[52:55]
 v_exp_f32 v36, v36
 v_mfma_f32_16x16x32_bf16 v[52:55], v[68:71], a[48:51], v[52:55]
 v_exp_f32 v37, v37
 v_mfma_f32_16x16x32_bf16 v[60:63], v[68:71], a[64:67], v[12:15]
 v_add_f32 v5, v36, v5
 v_cvt_pk_bf16_f32 v36, v36, v37
 v_mfma_f32_16x16x32_bf16 v[60:63], v[76:79], a[68:71], v[60:63]
 v_exp_f32 v38, v38
 v_mfma_f32_16x16x32_bf16 v[60:63], a[128:131], a[72:75], v[60:63]
 ds_read_b128 a[116:119], v0 offset:45568
 v_add_f32 v5, v37, v5
 v_mfma_f32_16x16x32_bf16 v[60:63], a[132:135], a[76:79], v[60:63]
 v_exp_f32 v39, v39
 v_mfma_f32_16x16x32_bf16 v[20:23], a[132:135], a[92:95], v[12:15]
 v_add_f32 v5, v38, v5
 v_cvt_pk_bf16_f32 v37, v38, v39
 v_mfma_f32_16x16x32_bf16 v[20:23], a[128:131], a[88:91], v[20:23]
 ds_read_b128 a[112:115], v0 offset:45056
 v_add_f32 v5, v39, v5
 v_mfma_f32_16x16x32_bf16 v[20:23], v[76:79], a[84:87], v[20:23]
 v_exp_f32 v44, v44
 v_mfma_f32_16x16x32_bf16 v[20:23], v[68:71], a[80:83], v[20:23]
 v_exp_f32 v45, v45
 v_mfma_f32_16x16x32_bf16 v[152:155], v[80:83], a[136:139], v[152:155]
 s_waitcnt lgkmcnt(2)
 v_add_f32 v6, v44, v6
 v_cvt_pk_bf16_f32 v44, v44, v45
 v_mfma_f32_16x16x32_bf16 v[152:155], v[84:87], a[140:143], v[152:155]
 v_exp_f32 v46, v46
 v_mfma_f32_16x16x32_bf16 v[184:187], v[92:95], a[140:143], v[184:187]
 v_add_f32 v6, v45, v6
 v_mfma_f32_16x16x32_bf16 v[184:187], v[88:91], a[136:139], v[184:187]
 v_exp_f32 v47, v47
 v_mfma_f32_16x16x32_bf16 v[216:219], v[96:99], a[136:139], v[216:219]
 v_add_f32 v6, v46, v6
 v_cvt_pk_bf16_f32 v45, v46, v47
 v_mfma_f32_16x16x32_bf16 v[216:219], v[100:103], a[140:143], v[216:219]
 v_add_f32 v6, v47, v6
 v_mfma_f32_16x16x32_bf16 v[248:251], v[108:111], a[140:143], v[248:251]
 v_exp_f32 v52, v52
 v_mfma_f32_16x16x32_bf16 v[248:251], v[104:107], a[136:139], v[248:251]
 v_exp_f32 v53, v53
 v_mfma_f32_16x16x32_bf16 a[176:179], v[112:115], a[136:139], a[176:179]
 v_add_f32 v7, v52, v7
 v_cvt_pk_bf16_f32 v52, v52, v53
 v_mfma_f32_16x16x32_bf16 a[176:179], v[116:119], a[140:143], a[176:179]
 v_exp_f32 v54, v54
 v_mfma_f32_16x16x32_bf16 a[208:211], v[124:127], a[140:143], a[208:211]
 v_add_f32 v7, v53, v7
 v_mfma_f32_16x16x32_bf16 a[208:211], v[120:123], a[136:139], a[208:211]
 v_exp_f32 v55, v55
 v_mfma_f32_16x16x32_bf16 a[240:243], v[128:131], a[136:139], a[240:243]
 v_add_f32 v7, v54, v7
 v_cvt_pk_bf16_f32 v53, v54, v55
 v_mfma_f32_16x16x32_bf16 a[240:243], v[132:135], a[140:143], a[240:243]
 ds_read_b64_tr_b16 a[136:137], v1 offset:17920
 v_add_f32 v7, v55, v7
 v_mfma_f32_16x16x32_bf16 v[156:159], v[84:87], a[148:151], v[156:159]
 v_exp_f32 v60, v60
 v_mfma_f32_16x16x32_bf16 v[156:159], v[80:83], a[144:147], v[156:159]
 v_exp_f32 v61, v61
 v_mfma_f32_16x16x32_bf16 v[188:191], v[88:91], a[144:147], v[188:191]
 v_exp_f32 v62, v62
 v_mfma_f32_16x16x32_bf16 v[188:191], v[92:95], a[148:151], v[188:191]
 v_add_f32 v8, v60, v8
 v_cvt_pk_bf16_f32 v60, v60, v61
 v_mfma_f32_16x16x32_bf16 v[220:223], v[100:103], a[148:151], v[220:223]
 v_exp_f32 v63, v63
 v_mfma_f32_16x16x32_bf16 v[220:223], v[96:99], a[144:147], v[220:223]
 v_add_f32 v8, v61, v8
 v_add_f32 v8, v62, v8
 v_mfma_f32_16x16x32_bf16 v[252:255], v[104:107], a[144:147], v[252:255]
 v_exp_f32 v20, v20
 v_mfma_f32_16x16x32_bf16 v[252:255], v[108:111], a[148:151], v[252:255]
 v_add_f32 v8, v63, v8
 v_cvt_pk_bf16_f32 v61, v62, v63
 v_mfma_f32_16x16x32_bf16 a[180:183], v[116:119], a[148:151], a[180:183]
 v_exp_f32 v21, v21
 v_mfma_f32_16x16x32_bf16 a[180:183], v[112:115], a[144:147], a[180:183]
 ds_read_b64_tr_b16 a[138:139], v1 offset:22016
 v_add_f32 v3, v20, v21
 v_mfma_f32_16x16x32_bf16 v[16:19], v[68:71], a[96:99], v[12:15]
 v_exp_f32 v22, v22
 v_mfma_f32_16x16x32_bf16 v[16:19], v[76:79], a[100:103], v[16:19]
 ds_read_b64_tr_b16 a[140:141], v1 offset:26112
 v_cvt_pk_bf16_f32 v68, v20, v21
 v_mfma_f32_16x16x32_bf16 v[16:19], a[128:131], a[104:107], v[16:19]
 v_exp_f32 v23, v23
 v_mfma_f32_16x16x32_bf16 v[16:19], a[132:135], a[108:111], v[16:19]
 v_add_f32 v11, v22, v23
 v_cvt_pk_bf16_f32 v69, v22, v23
 v_mfma_f32_16x16x32_bf16 v[20:23], a[124:127], a[12:15], v[12:15]
 ds_read_b64_tr_b16 a[142:143], v1 offset:30208
 v_add_f32 v9, v3, v9
 v_mfma_f32_16x16x32_bf16 v[20:23], a[120:123], a[8:11], v[20:23]
 s_waitcnt lgkmcnt(3)
 v_add_f32 v9, v11, v9
 v_mfma_f32_16x16x32_bf16 v[20:23], a[116:119], a[4:7], v[20:23]
 v_exp_f32 v16, v16
 v_mfma_f32_16x16x32_bf16 v[20:23], a[112:115], a[0:3], v[20:23]
 v_exp_f32 v17, v17
 v_mfma_f32_16x16x32_bf16 a[212:215], v[120:123], a[144:147], a[212:215]
 v_exp_f32 v18, v18
 v_mfma_f32_16x16x32_bf16 a[212:215], v[124:127], a[148:151], a[212:215]
 v_add_f32 v10, v16, v10
 v_cvt_pk_bf16_f32 v76, v16, v17
 v_mfma_f32_16x16x32_bf16 a[244:247], v[132:135], a[148:151], a[244:247]
 v_exp_f32 v19, v19
 v_mfma_f32_16x16x32_bf16 a[244:247], v[128:131], a[144:147], a[244:247]
 s_waitcnt lgkmcnt(0)
 v_add_f32 v10, v17, v10
 v_add_f32 v10, v18, v10
 v_mfma_f32_16x16x32_bf16 v[160:163], v[80:83], a[136:139], v[160:163]
 v_exp_f32 v20, v20
 v_mfma_f32_16x16x32_bf16 v[160:163], v[84:87], a[140:143], v[160:163]
 v_add_f32 v10, v19, v10
 v_cvt_pk_bf16_f32 v77, v18, v19
 v_mfma_f32_16x16x32_bf16 v[192:195], v[92:95], a[140:143], v[192:195]
 v_exp_f32 v21, v21
 v_mfma_f32_16x16x32_bf16 v[192:195], v[88:91], a[136:139], v[192:195]
 ds_read_b64_tr_b16 a[148:149], v2 offset:26112
 v_add_f32 v3, v20, v21
 v_mfma_f32_16x16x32_bf16 v[16:19], a[112:115], a[16:19], v[12:15]
 v_exp_f32 v22, v22
 v_mfma_f32_16x16x32_bf16 v[16:19], a[116:119], a[20:23], v[16:19]
 ds_read_b64_tr_b16 a[150:151], v2 offset:30208
 v_cvt_pk_bf16_f32 v30, v20, v21
 v_mfma_f32_16x16x32_bf16 v[16:19], a[120:123], a[24:27], v[16:19]
 v_exp_f32 v23, v23
 v_mfma_f32_16x16x32_bf16 v[16:19], a[124:127], a[28:31], v[16:19]
 v_add_f32 v11, v22, v23
 v_cvt_pk_bf16_f32 v31, v22, v23
 v_mfma_f32_16x16x32_bf16 v[20:23], a[124:127], a[44:47], v[12:15]
 s_waitcnt vmcnt(0)
 v_add_f32 v4, v3, v4
 v_add_f32 v4, v11, v4
 v_mfma_f32_16x16x32_bf16 v[20:23], a[120:123], a[40:43], v[20:23]
 s_barrier
 v_mfma_f32_16x16x32_bf16 v[20:23], a[116:119], a[36:39], v[20:23]
 v_exp_f32 v16, v16
 v_mfma_f32_16x16x32_bf16 v[20:23], a[112:115], a[32:35], v[20:23]
 v_exp_f32 v17, v17
 v_mfma_f32_16x16x32_bf16 v[224:227], v[96:99], a[136:139], v[224:227]
 v_exp_f32 v18, v18
 v_mfma_f32_16x16x32_bf16 v[224:227], v[100:103], a[140:143], v[224:227]
 v_add_f32 v5, v16, v5
 v_cvt_pk_bf16_f32 v38, v16, v17
 v_mfma_f32_16x16x32_bf16 a[152:155], v[108:111], a[140:143], a[152:155]
 v_exp_f32 v19, v19
 v_mfma_f32_16x16x32_bf16 a[152:155], v[104:107], a[136:139], a[152:155]
 v_add_f32 v5, v17, v5
 v_add_f32 v5, v18, v5
 v_mfma_f32_16x16x32_bf16 a[184:187], v[112:115], a[136:139], a[184:187]
 v_exp_f32 v20, v20
 v_mfma_f32_16x16x32_bf16 a[184:187], v[116:119], a[140:143], a[184:187]
 v_add_f32 v5, v19, v5
 v_cvt_pk_bf16_f32 v39, v18, v19
 v_mfma_f32_16x16x32_bf16 a[216:219], v[124:127], a[140:143], a[216:219]
 v_exp_f32 v21, v21
 v_mfma_f32_16x16x32_bf16 a[216:219], v[120:123], a[136:139], a[216:219]
 ds_read_b64_tr_b16 a[144:145], v2 offset:17920
 v_add_f32 v3, v20, v21
 v_mfma_f32_16x16x32_bf16 v[16:19], a[112:115], a[48:51], v[12:15]
 v_exp_f32 v22, v22
 v_mfma_f32_16x16x32_bf16 v[16:19], a[116:119], a[52:55], v[16:19]
 ds_read_b64_tr_b16 a[146:147], v2 offset:22016
 v_cvt_pk_bf16_f32 v46, v20, v21
 v_mfma_f32_16x16x32_bf16 v[16:19], a[120:123], a[56:59], v[16:19]
 v_exp_f32 v23, v23
 v_mfma_f32_16x16x32_bf16 v[16:19], a[124:127], a[60:63], v[16:19]
 v_add_f32 v11, v22, v23
 v_cvt_pk_bf16_f32 v47, v22, v23
 v_mfma_f32_16x16x32_bf16 v[20:23], a[124:127], a[76:79], v[12:15]
 ds_read_b128 a[128:131], v0 offset:49152
 v_add_f32 v6, v3, v6
 v_mfma_f32_16x16x32_bf16 v[20:23], a[120:123], a[72:75], v[20:23]
 ds_read_b128 a[132:135], v0 offset:49664
 v_add_f32 v6, v11, v6
 v_mfma_f32_16x16x32_bf16 v[20:23], a[116:119], a[68:71], v[20:23]
 v_exp_f32 v16, v16
 v_mfma_f32_16x16x32_bf16 v[20:23], a[112:115], a[64:67], v[20:23]
 v_exp_f32 v17, v17
 v_mfma_f32_16x16x32_bf16 a[248:251], v[128:131], a[136:139], a[248:251]
 v_exp_f32 v18, v18
 v_mfma_f32_16x16x32_bf16 a[248:251], v[132:135], a[140:143], a[248:251]
 s_waitcnt lgkmcnt(2)
 v_add_f32 v7, v16, v7
 v_cvt_pk_bf16_f32 v54, v16, v17
 v_mfma_f32_16x16x32_bf16 v[164:167], v[84:87], a[148:151], v[164:167]
 v_exp_f32 v19, v19
 v_mfma_f32_16x16x32_bf16 v[164:167], v[80:83], a[144:147], v[164:167]
 v_add_f32 v7, v17, v7
 v_add_f32 v7, v18, v7
 v_mfma_f32_16x16x32_bf16 v[196:199], v[88:91], a[144:147], v[196:199]
 v_exp_f32 v20, v20
 v_mfma_f32_16x16x32_bf16 v[196:199], v[92:95], a[148:151], v[196:199]
 v_add_f32 v7, v19, v7
 v_cvt_pk_bf16_f32 v55, v18, v19
 v_mfma_f32_16x16x32_bf16 v[228:231], v[100:103], a[148:151], v[228:231]
 v_exp_f32 v21, v21
 v_mfma_f32_16x16x32_bf16 v[228:231], v[96:99], a[144:147], v[228:231]
 ds_read_b128 v[84:87], v0 offset:50176
 v_add_f32 v3, v20, v21
 v_mfma_f32_16x16x32_bf16 v[16:19], a[112:115], a[80:83], v[12:15]
 v_exp_f32 v22, v22
 v_mfma_f32_16x16x32_bf16 v[16:19], a[116:119], a[84:87], v[16:19]
 ds_read_b128 v[92:95], v0 offset:50688
 v_cvt_pk_bf16_f32 v62, v20, v21
 v_mfma_f32_16x16x32_bf16 v[16:19], a[120:123], a[88:91], v[16:19]
 v_exp_f32 v23, v23
 v_mfma_f32_16x16x32_bf16 v[16:19], a[124:127], a[92:95], v[16:19]
 v_add_f32 v11, v22, v23
 v_cvt_pk_bf16_f32 v63, v22, v23
 v_mfma_f32_16x16x32_bf16 v[20:23], a[124:127], a[108:111], v[12:15]
 ds_read_b64_tr_b16 a[136:137], v1 offset:32768
 v_add_f32 v8, v3, v8
 v_mfma_f32_16x16x32_bf16 v[20:23], a[120:123], a[104:107], v[20:23]
 ds_read_b64_tr_b16 a[138:139], v1 offset:36864
 v_add_f32 v8, v11, v8
 v_mfma_f32_16x16x32_bf16 v[20:23], a[116:119], a[100:103], v[20:23]
 v_exp_f32 v16, v16
 v_mfma_f32_16x16x32_bf16 v[20:23], a[112:115], a[96:99], v[20:23]
 v_exp_f32 v17, v17
 v_mfma_f32_16x16x32_bf16 a[156:159], v[104:107], a[144:147], a[156:159]
 v_exp_f32 v18, v18
 v_mfma_f32_16x16x32_bf16 a[156:159], v[108:111], a[148:151], a[156:159]
 v_add_f32 v9, v16, v9
 v_cvt_pk_bf16_f32 v70, v16, v17
 v_mfma_f32_16x16x32_bf16 a[188:191], v[116:119], a[148:151], a[188:191]
 v_exp_f32 v19, v19
 v_mfma_f32_16x16x32_bf16 a[188:191], v[112:115], a[144:147], a[188:191]
 v_add_f32 v9, v17, v9
 v_add_f32 v9, v18, v9
 v_mfma_f32_16x16x32_bf16 a[220:223], v[120:123], a[144:147], a[220:223]
 v_exp_f32 v20, v20
 v_mfma_f32_16x16x32_bf16 a[220:223], v[124:127], a[148:151], a[220:223]
 s_sub_u32 s27, s27, 1
 v_add_f32 v9, v19, v9
 v_cvt_pk_bf16_f32 v71, v18, v19
 v_mfma_f32_16x16x32_bf16 a[252:255], v[132:135], a[148:151], a[252:255]
 s_cmp_eq_u32 s27, 0
 v_exp_f32 v21, v21
 v_mfma_f32_16x16x32_bf16 a[252:255], v[128:131], a[144:147], a[252:255]
 s_waitcnt lgkmcnt(0)
 v_add_f32 v3, v20, v21
 s_cbranch_scc0 L_loop_7
 v_mfma_f32_16x16x32_bf16 v[16:19], a[128:131], a[0:3], v[12:15]
 v_exp_f32 v22, v22
 v_mfma_f32_16x16x32_bf16 v[16:19], a[132:135], a[4:7], v[16:19]
 ds_read_b64_tr_b16 a[140:141], v1 offset:40960
 v_cvt_pk_bf16_f32 v78, v20, v21
 v_mfma_f32_16x16x32_bf16 v[16:19], v[84:87], a[8:11], v[16:19]
 v_exp_f32 v23, v23
 v_mfma_f32_16x16x32_bf16 v[16:19], v[92:95], a[12:15], v[16:19]
 v_add_f32 v11, v22, v23
 v_cvt_pk_bf16_f32 v79, v22, v23
 v_mfma_f32_16x16x32_bf16 v[104:107], v[92:95], a[28:31], v[12:15]
 ds_read_b64_tr_b16 a[142:143], v1 offset:45056
 v_add_f32 v10, v3, v10
 v_mfma_f32_16x16x32_bf16 v[104:107], v[84:87], a[24:27], v[104:107]
 ds_read_b64_tr_b16 a[148:149], v2 offset:40960
 v_add_f32 v10, v11, v10
 v_mfma_f32_16x16x32_bf16 v[104:107], a[132:135], a[20:23], v[104:107]
 v_exp_f32 v16, v16
 v_mfma_f32_16x16x32_bf16 v[104:107], a[128:131], a[16:19], v[104:107]
 v_exp_f32 v17, v17
 v_mfma_f32_16x16x32_bf16 v[20:23], a[128:131], a[32:35], v[12:15]
 v_add_f32 v4, v16, v4
 v_cvt_pk_bf16_f32 v80, v16, v17
 v_mfma_f32_16x16x32_bf16 v[20:23], a[132:135], a[36:39], v[20:23]
 v_exp_f32 v18, v18
 v_mfma_f32_16x16x32_bf16 v[20:23], v[84:87], a[40:43], v[20:23]
 ds_read_b64_tr_b16 a[150:151], v2 offset:45056
 v_add_f32 v4, v17, v4
 v_mfma_f32_16x16x32_bf16 v[20:23], v[92:95], a[44:47], v[20:23]
 v_exp_f32 v19, v19
 v_mfma_f32_16x16x32_bf16 v[136:139], v[24:27], a[136:139], v[136:139]
 s_waitcnt lgkmcnt(1)
 v_add_f32 v4, v18, v4
 v_cvt_pk_bf16_f32 v81, v18, v19
 v_mfma_f32_16x16x32_bf16 v[136:139], v[28:31], a[140:143], v[136:139]
 ds_read_b64_tr_b16 a[144:145], v2 offset:32768
 v_add_f32 v4, v19, v4
 v_mfma_f32_16x16x32_bf16 v[168:171], v[36:39], a[140:143], v[168:171]
 v_exp_f32 v104, v104
 v_mfma_f32_16x16x32_bf16 v[168:171], v[32:35], a[136:139], v[168:171]
 v_exp_f32 v105, v105
 v_mfma_f32_16x16x32_bf16 v[200:203], v[40:43], a[136:139], v[200:203]
 ds_read_b64_tr_b16 a[146:147], v2 offset:36864
 v_add_f32 v5, v104, v5
 v_cvt_pk_bf16_f32 v88, v104, v105
 v_mfma_f32_16x16x32_bf16 v[200:203], v[44:47], a[140:143], v[200:203]
 v_exp_f32 v106, v106
 v_mfma_f32_16x16x32_bf16 v[232:235], v[52:55], a[140:143], v[232:235]
 ds_read_b128 a[112:115], v0 offset:53248
 v_add_f32 v5, v105, v5
 v_mfma_f32_16x16x32_bf16 v[232:235], v[48:51], a[136:139], v[232:235]
 v_exp_f32 v107, v107
 v_mfma_f32_16x16x32_bf16 a[160:163], v[56:59], a[136:139], a[160:163]
 ds_read_b128 a[116:119], v0 offset:53760
 v_add_f32 v5, v106, v5
 v_cvt_pk_bf16_f32 v89, v106, v107
 v_mfma_f32_16x16x32_bf16 a[160:163], v[60:63], a[140:143], a[160:163]
 ds_read_b128 a[120:123], v0 offset:54272
 v_add_f32 v5, v107, v5
 v_mfma_f32_16x16x32_bf16 a[192:195], v[68:71], a[140:143], a[192:195]
 v_exp_f32 v20, v20
 v_mfma_f32_16x16x32_bf16 a[192:195], v[64:67], a[136:139], a[192:195]
 v_exp_f32 v21, v21
 v_mfma_f32_16x16x32_bf16 a[224:227], v[72:75], a[136:139], a[224:227]
 ds_read_b128 a[124:127], v0 offset:54784
 v_add_f32 v6, v20, v6
 v_cvt_pk_bf16_f32 v96, v20, v21
 v_mfma_f32_16x16x32_bf16 a[224:227], v[76:79], a[140:143], a[224:227]
 s_waitcnt lgkmcnt(3)
 v_exp_f32 v22, v22
 v_mfma_f32_16x16x32_bf16 v[140:143], v[28:31], a[148:151], v[140:143]
 ds_read_b64_tr_b16 a[136:137], v1 offset:33280
 v_add_f32 v6, v21, v6
 v_mfma_f32_16x16x32_bf16 v[140:143], v[24:27], a[144:147], v[140:143]
 v_exp_f32 v23, v23
 v_mfma_f32_16x16x32_bf16 v[172:175], v[32:35], a[144:147], v[172:175]
 v_add_f32 v6, v22, v6
 v_cvt_pk_bf16_f32 v97, v22, v23
 v_mfma_f32_16x16x32_bf16 v[172:175], v[36:39], a[148:151], v[172:175]
 ds_read_b64_tr_b16 a[138:139], v1 offset:37376
 v_add_f32 v6, v23, v6
 v_mfma_f32_16x16x32_bf16 v[16:19], a[112:115], a[0:3], v[12:15]
 s_waitcnt lgkmcnt(3)
 ds_read_b64_tr_b16 a[140:141], v1 offset:41472
 ds_read_b64_tr_b16 a[142:143], v1 offset:45568
 v_mfma_f32_16x16x32_bf16 v[16:19], a[116:119], a[4:7], v[16:19]
 ds_read_b128 v[124:127], v0 offset:57344
 ds_read_b128 v[132:135], v0 offset:57856
 v_mfma_f32_16x16x32_bf16 v[16:19], a[120:123], a[8:11], v[16:19]
 s_waitcnt lgkmcnt(6)
 ds_read_b128 a[128:131], v0 offset:58368
 ds_read_b128 a[132:135], v0 offset:58880
 v_mfma_f32_16x16x32_bf16 v[16:19], a[124:127], a[12:15], v[16:19]
 s_nop 0
 v_mfma_f32_16x16x32_bf16 v[104:107], a[124:127], a[28:31], v[12:15]
 s_nop 0
 v_mfma_f32_16x16x32_bf16 v[104:107], a[120:123], a[24:27], v[104:107]
 s_nop 0
 s_nop 0
 v_mfma_f32_16x16x32_bf16 v[104:107], a[116:119], a[20:23], v[104:107]
 s_nop 0
 v_exp_f32 v16, v16
 v_mfma_f32_16x16x32_bf16 v[104:107], a[112:115], a[16:19], v[104:107]
 v_exp_f32 v17, v17
 v_mfma_f32_16x16x32_bf16 v[20:23], a[112:115], a[32:35], v[12:15]
 v_add_f32 v4, v16, v4
 v_cvt_pk_bf16_f32 v82, v16, v17
 v_mfma_f32_16x16x32_bf16 v[20:23], a[116:119], a[36:39], v[20:23]
 v_exp_f32 v18, v18
 v_mfma_f32_16x16x32_bf16 v[20:23], a[120:123], a[40:43], v[20:23]
 ds_read_b128 a[112:115], v0 offset:61440
 v_add_f32 v4, v17, v4
 v_mfma_f32_16x16x32_bf16 v[20:23], a[124:127], a[44:47], v[20:23]
 v_exp_f32 v19, v19
 v_mfma_f32_16x16x32_bf16 v[204:207], v[44:47], a[148:151], v[204:207]
 v_add_f32 v4, v18, v4
 v_cvt_pk_bf16_f32 v83, v18, v19
 v_mfma_f32_16x16x32_bf16 v[204:207], v[40:43], a[144:147], v[204:207]
 ds_read_b128 a[116:119], v0 offset:61952
 v_add_f32 v4, v19, v4
 v_mfma_f32_16x16x32_bf16 v[236:239], v[48:51], a[144:147], v[236:239]
 v_exp_f32 v104, v104
 v_mfma_f32_16x16x32_bf16 v[236:239], v[52:55], a[148:151], v[236:239]
 v_exp_f32 v105, v105
 v_mfma_f32_16x16x32_bf16 a[164:167], v[60:63], a[148:151], a[164:167]
 v_add_f32 v5, v104, v5
 v_cvt_pk_bf16_f32 v90, v104, v105
 v_mfma_f32_16x16x32_bf16 a[164:167], v[56:59], a[144:147], a[164:167]
 v_exp_f32 v106, v106
 v_mfma_f32_16x16x32_bf16 a[196:199], v[64:67], a[144:147], a[196:199]
 ds_read_b128 a[120:123], v0 offset:62464
 v_add_f32 v5, v105, v5
 v_mfma_f32_16x16x32_bf16 a[196:199], v[68:71], a[148:151], a[196:199]
 v_exp_f32 v107, v107
 v_mfma_f32_16x16x32_bf16 a[228:231], v[76:79], a[148:151], a[228:231]
 v_add_f32 v5, v106, v5
 v_cvt_pk_bf16_f32 v91, v106, v107
 v_mfma_f32_16x16x32_bf16 a[228:231], v[72:75], a[144:147], a[228:231]
 s_waitcnt lgkmcnt(1)
 ds_read_b64_tr_b16 a[148:149], v2 offset:41472
 v_add_f32 v5, v107, v5
 v_mfma_f32_16x16x32_bf16 v[144:147], v[24:27], a[136:139], v[144:147]
 v_exp_f32 v20, v20
 v_mfma_f32_16x16x32_bf16 v[144:147], v[28:31], a[140:143], v[144:147]
 v_exp_f32 v21, v21
 v_mfma_f32_16x16x32_bf16 v[176:179], v[36:39], a[140:143], v[176:179]
 v_add_f32 v6, v20, v6
 v_cvt_pk_bf16_f32 v98, v20, v21
 v_mfma_f32_16x16x32_bf16 v[176:179], v[32:35], a[136:139], v[176:179]
 v_exp_f32 v22, v22
 v_mfma_f32_16x16x32_bf16 v[208:211], v[40:43], a[136:139], v[208:211]
 ds_read_b64_tr_b16 a[150:151], v2 offset:45568
 v_add_f32 v6, v21, v6
 v_mfma_f32_16x16x32_bf16 v[208:211], v[44:47], a[140:143], v[208:211]
 v_exp_f32 v23, v23
 v_mfma_f32_16x16x32_bf16 v[240:243], v[52:55], a[140:143], v[240:243]
 v_add_f32 v6, v22, v6
 v_cvt_pk_bf16_f32 v99, v22, v23
 v_mfma_f32_16x16x32_bf16 v[240:243], v[48:51], a[136:139], v[240:243]
 ds_read_b64_tr_b16 a[144:145], v2 offset:33280
 v_add_f32 v6, v23, v6
 v_mfma_f32_16x16x32_bf16 v[16:19], v[124:127], a[0:3], v[12:15]
 ds_read_b64_tr_b16 a[146:147], v2 offset:37376
 ds_read_b128 a[124:127], v0 offset:62976
 v_mfma_f32_16x16x32_bf16 v[16:19], v[132:135], a[4:7], v[16:19]
 v_mfma_f32_16x16x32_bf16 v[16:19], a[128:131], a[8:11], v[16:19]
 v_mfma_f32_16x16x32_bf16 v[16:19], a[132:135], a[12:15], v[16:19]
 s_nop 0
 v_mfma_f32_16x16x32_bf16 v[104:107], a[132:135], a[28:31], v[12:15]
 s_nop 0
 v_mfma_f32_16x16x32_bf16 v[104:107], a[128:131], a[24:27], v[104:107]
 s_nop 0
 s_nop 0
 v_mfma_f32_16x16x32_bf16 v[104:107], v[132:135], a[20:23], v[104:107]
 s_nop 0
 v_exp_f32 v16, v16
 v_mfma_f32_16x16x32_bf16 v[104:107], v[124:127], a[16:19], v[104:107]
 v_exp_f32 v17, v17
 v_mfma_f32_16x16x32_bf16 v[20:23], v[124:127], a[32:35], v[12:15]
 v_add_f32 v4, v16, v4
 v_cvt_pk_bf16_f32 v84, v16, v17
 v_mfma_f32_16x16x32_bf16 v[20:23], v[132:135], a[36:39], v[20:23]
 v_exp_f32 v18, v18
 v_mfma_f32_16x16x32_bf16 v[20:23], a[128:131], a[40:43], v[20:23]
 v_add_f32 v4, v17, v4
 v_mfma_f32_16x16x32_bf16 v[20:23], a[132:135], a[44:47], v[20:23]
 v_exp_f32 v19, v19
 v_mfma_f32_16x16x32_bf16 a[168:171], v[56:59], a[136:139], a[168:171]
 v_add_f32 v4, v18, v4
 v_cvt_pk_bf16_f32 v85, v18, v19
 v_mfma_f32_16x16x32_bf16 a[168:171], v[60:63], a[140:143], a[168:171]
 v_add_f32 v4, v19, v4
 v_mfma_f32_16x16x32_bf16 a[200:203], v[68:71], a[140:143], a[200:203]
 v_exp_f32 v104, v104
 v_mfma_f32_16x16x32_bf16 a[200:203], v[64:67], a[136:139], a[200:203]
 v_exp_f32 v105, v105
 v_mfma_f32_16x16x32_bf16 a[232:235], v[72:75], a[136:139], a[232:235]
 v_add_f32 v5, v104, v5
 v_cvt_pk_bf16_f32 v92, v104, v105
 v_mfma_f32_16x16x32_bf16 a[232:235], v[76:79], a[140:143], a[232:235]
 s_waitcnt lgkmcnt(0)
 v_exp_f32 v106, v106
 v_mfma_f32_16x16x32_bf16 v[148:151], v[28:31], a[148:151], v[148:151]
 ds_read_b64_tr_b16 a[136:137], v1 offset:33792
 v_add_f32 v5, v105, v5
 v_mfma_f32_16x16x32_bf16 v[148:151], v[24:27], a[144:147], v[148:151]
 v_exp_f32 v107, v107
 v_mfma_f32_16x16x32_bf16 v[180:183], v[32:35], a[144:147], v[180:183]
 v_add_f32 v5, v106, v5
 v_cvt_pk_bf16_f32 v93, v106, v107
 v_mfma_f32_16x16x32_bf16 v[180:183], v[36:39], a[148:151], v[180:183]
 ds_read_b64_tr_b16 a[138:139], v1 offset:37888
 v_add_f32 v5, v107, v5
 v_mfma_f32_16x16x32_bf16 v[212:215], v[44:47], a[148:151], v[212:215]
 v_exp_f32 v20, v20
 v_mfma_f32_16x16x32_bf16 v[212:215], v[40:43], a[144:147], v[212:215]
 v_exp_f32 v21, v21
 v_mfma_f32_16x16x32_bf16 v[244:247], v[48:51], a[144:147], v[244:247]
 v_add_f32 v6, v20, v6
 v_cvt_pk_bf16_f32 v100, v20, v21
 v_mfma_f32_16x16x32_bf16 v[244:247], v[52:55], a[148:151], v[244:247]
 v_exp_f32 v22, v22
 v_mfma_f32_16x16x32_bf16 a[172:175], v[60:63], a[148:151], a[172:175]
 ds_read_b64_tr_b16 a[140:141], v1 offset:41984
 v_add_f32 v6, v21, v6
 v_mfma_f32_16x16x32_bf16 a[172:175], v[56:59], a[144:147], a[172:175]
 v_exp_f32 v23, v23
 v_mfma_f32_16x16x32_bf16 a[204:207], v[64:67], a[144:147], a[204:207]
 v_add_f32 v6, v22, v6
 v_cvt_pk_bf16_f32 v101, v22, v23
 v_mfma_f32_16x16x32_bf16 a[204:207], v[68:71], a[148:151], a[204:207]
 ds_read_b64_tr_b16 a[142:143], v1 offset:46080
 v_add_f32 v6, v23, v6
 v_mfma_f32_16x16x32_bf16 v[16:19], a[112:115], a[0:3], v[12:15]
 v_mfma_f32_16x16x32_bf16 v[16:19], a[116:119], a[4:7], v[16:19]
 v_mfma_f32_16x16x32_bf16 v[16:19], a[120:123], a[8:11], v[16:19]
 v_mfma_f32_16x16x32_bf16 v[16:19], a[124:127], a[12:15], v[16:19]
 s_nop 0
 v_mfma_f32_16x16x32_bf16 v[104:107], a[124:127], a[28:31], v[12:15]
 s_nop 0
 v_mfma_f32_16x16x32_bf16 v[104:107], a[120:123], a[24:27], v[104:107]
 s_nop 0
 s_nop 0
 v_mfma_f32_16x16x32_bf16 v[104:107], a[116:119], a[20:23], v[104:107]
 s_nop 0
 v_exp_f32 v16, v16
 v_mfma_f32_16x16x32_bf16 v[104:107], a[112:115], a[16:19], v[104:107]
 v_exp_f32 v17, v17
 v_mfma_f32_16x16x32_bf16 v[20:23], a[112:115], a[32:35], v[12:15]
 v_add_f32 v4, v16, v4
 v_cvt_pk_bf16_f32 v86, v16, v17
 v_mfma_f32_16x16x32_bf16 v[20:23], a[116:119], a[36:39], v[20:23]
 v_exp_f32 v18, v18
 v_mfma_f32_16x16x32_bf16 v[20:23], a[120:123], a[40:43], v[20:23]
 v_add_f32 v4, v17, v4
 v_mfma_f32_16x16x32_bf16 v[20:23], a[124:127], a[44:47], v[20:23]
 v_exp_f32 v19, v19
 v_mfma_f32_16x16x32_bf16 a[236:239], v[76:79], a[148:151], a[236:239]
 v_add_f32 v4, v18, v4
 v_cvt_pk_bf16_f32 v87, v18, v19
 v_mfma_f32_16x16x32_bf16 a[236:239], v[72:75], a[144:147], a[236:239]
 s_waitcnt lgkmcnt(0)
 ds_read_b64_tr_b16 a[148:149], v2 offset:41984
 v_add_f32 v4, v19, v4
 v_mfma_f32_16x16x32_bf16 v[152:155], v[24:27], a[136:139], v[152:155]
 v_exp_f32 v104, v104
 v_mfma_f32_16x16x32_bf16 v[152:155], v[28:31], a[140:143], v[152:155]
 v_exp_f32 v105, v105
 v_mfma_f32_16x16x32_bf16 v[184:187], v[36:39], a[140:143], v[184:187]
 v_add_f32 v5, v104, v5
 v_cvt_pk_bf16_f32 v94, v104, v105
 v_mfma_f32_16x16x32_bf16 v[184:187], v[32:35], a[136:139], v[184:187]
 v_exp_f32 v106, v106
 v_mfma_f32_16x16x32_bf16 v[216:219], v[40:43], a[136:139], v[216:219]
 ds_read_b64_tr_b16 a[150:151], v2 offset:46080
 v_add_f32 v5, v105, v5
 v_mfma_f32_16x16x32_bf16 v[216:219], v[44:47], a[140:143], v[216:219]
 v_exp_f32 v107, v107
 v_mfma_f32_16x16x32_bf16 v[248:251], v[52:55], a[140:143], v[248:251]
 ds_read_b64_tr_b16 a[144:145], v2 offset:33792
 v_add_f32 v5, v106, v5
 v_cvt_pk_bf16_f32 v95, v106, v107
 v_mfma_f32_16x16x32_bf16 v[248:251], v[48:51], a[136:139], v[248:251]
 ds_read_b64_tr_b16 a[146:147], v2 offset:37888
 v_add_f32 v5, v107, v5
 v_mfma_f32_16x16x32_bf16 a[176:179], v[56:59], a[136:139], a[176:179]
 v_exp_f32 v20, v20
 v_mfma_f32_16x16x32_bf16 a[176:179], v[60:63], a[140:143], a[176:179]
 v_exp_f32 v21, v21
 v_mfma_f32_16x16x32_bf16 a[208:211], v[68:71], a[140:143], a[208:211]
 v_add_f32 v6, v20, v6
 v_cvt_pk_bf16_f32 v102, v20, v21
 v_mfma_f32_16x16x32_bf16 a[208:211], v[64:67], a[136:139], a[208:211]
 s_waitcnt vmcnt(0)
 v_exp_f32 v22, v22
 v_mfma_f32_16x16x32_bf16 a[240:243], v[72:75], a[136:139], a[240:243]
 s_barrier
 ds_read_b64_tr_b16 a[136:137], v1 offset:34304
 v_add_f32 v6, v21, v6
 v_mfma_f32_16x16x32_bf16 a[240:243], v[76:79], a[140:143], a[240:243]
 s_waitcnt lgkmcnt(2)
 v_exp_f32 v23, v23
 v_mfma_f32_16x16x32_bf16 v[156:159], v[28:31], a[148:151], v[156:159]
 s_waitcnt lgkmcnt(1)
 v_add_f32 v6, v22, v6
 v_cvt_pk_bf16_f32 v103, v22, v23
 v_mfma_f32_16x16x32_bf16 v[156:159], v[24:27], a[144:147], v[156:159]
 ds_read_b64_tr_b16 a[138:139], v1 offset:38400
 v_add_f32 v6, v23, v6
 v_mfma_f32_16x16x32_bf16 v[188:191], v[32:35], a[144:147], v[188:191]
 ds_read_b64_tr_b16 a[140:141], v1 offset:42496
 v_mov_b32 v20, 1.0
 v_mfma_f32_16x16x32_bf16 v[188:191], v[36:39], a[148:151], v[188:191]
 ds_read_b64_tr_b16 a[142:143], v1 offset:46592
 v_mov_b32 v21, 0x7f000000
 v_mfma_f32_16x16x32_bf16 v[220:223], v[44:47], a[148:151], v[220:223]
 ds_read_b64_tr_b16 a[112:113], v1 offset:49152
 s_mul_i32 s30, s24, 4352
 v_mfma_f32_16x16x32_bf16 v[220:223], v[40:43], a[144:147], v[220:223]
 ds_read_b64_tr_b16 a[114:115], v1 offset:53248
 s_add_u32 s30, s30, 131072
 v_mfma_f32_16x16x32_bf16 v[252:255], v[48:51], a[144:147], v[252:255]
 ds_read_b64_tr_b16 a[116:117], v1 offset:57344
 v_mbcnt_lo_u32_b32 v11, -1, 0
 v_mfma_f32_16x16x32_bf16 v[252:255], v[52:55], a[148:151], v[252:255]
 ds_read_b64_tr_b16 a[118:119], v1 offset:61440
 v_mbcnt_hi_u32_b32 v11, -1, v11
 v_mfma_f32_16x16x32_bf16 a[180:183], v[60:63], a[148:151], a[180:183]
 ds_read_b64_tr_b16 a[120:121], v2 offset:49152
 v_lshrrev_b32 v23, 4, v11
 v_mfma_f32_16x16x32_bf16 a[180:183], v[56:59], a[144:147], a[180:183]
 ds_read_b64_tr_b16 a[122:123], v2 offset:53248
 v_mul_u32_u24 v17, 1088, v23
 v_mfma_f32_16x16x32_bf16 a[212:215], v[64:67], a[144:147], a[212:215]
 ds_read_b64_tr_b16 a[124:125], v2 offset:57344
 v_add_u32 v17, s30, v17
 v_mfma_f32_16x16x32_bf16 a[212:215], v[68:71], a[148:151], a[212:215]
 ds_read_b64_tr_b16 a[126:127], v2 offset:61440
 v_lshl_add_u32 v18, v23, 10, s35
 v_mfma_f32_16x16x32_bf16 a[244:247], v[76:79], a[148:151], a[244:247]
 ds_read_b64_tr_b16 a[148:149], v2 offset:42496
 v_and_b32 v19, 15, v11
 v_mfma_f32_16x16x32_bf16 a[244:247], v[72:75], a[144:147], a[244:247]
 s_waitcnt lgkmcnt(6)
 ds_read_b64_tr_b16 a[150:151], v2 offset:46592
 v_lshl_add_u32 v16, v19, 4, v17
 v_mfma_f32_16x16x32_bf16 v[160:163], v[24:27], a[136:139], v[160:163]
 ds_read_b64_tr_b16 a[144:145], v2 offset:34304
 v_and_b32 v23, 1, v11
 v_mfma_f32_16x16x32_bf16 v[160:163], v[28:31], a[140:143], v[160:163]
 ds_read_b64_tr_b16 a[146:147], v2 offset:38400
 v_lshl_add_u32 v17, v23, 7, v17
 v_mfma_f32_16x16x32_bf16 v[192:195], v[36:39], a[140:143], v[192:195]
 ds_read_b64_tr_b16 a[128:129], v1 offset:49664
 v_and_b32 v23, 14, v11
 v_mfma_f32_16x16x32_bf16 v[192:195], v[32:35], a[136:139], v[192:195]
 ds_read_b64_tr_b16 a[130:131], v1 offset:53760
 v_lshl_add_u32 v17, v23, 2, v17
 v_mfma_f32_16x16x32_bf16 v[224:227], v[40:43], a[136:139], v[224:227]
 ds_read_b64_tr_b16 a[132:133], v1 offset:57856
 v_and_b32 v23, 3, v11
 v_mfma_f32_16x16x32_bf16 v[224:227], v[44:47], a[140:143], v[224:227]
 ds_read_b64_tr_b16 a[134:135], v1 offset:61952
 v_lshl_add_u32 v18, v23, 5, v18
 v_mfma_f32_16x16x32_bf16 a[152:155], v[52:55], a[140:143], a[152:155]
 v_and_b32 v23, 4, v11
 v_mfma_f32_16x16x32_bf16 a[152:155], v[48:51], a[136:139], a[152:155]
 v_lshl_add_u32 v18, v23, 2, v18
 v_mfma_f32_16x16x32_bf16 a[184:187], v[56:59], a[136:139], a[184:187]
 v_and_b32 v23, 8, v11
 v_mfma_f32_16x16x32_bf16 a[184:187], v[60:63], a[140:143], a[184:187]
 v_lshl_add_u32 v18, v23, 4, v18
 v_mfma_f32_16x16x32_bf16 a[216:219], v[68:71], a[140:143], a[216:219]
 v_mov_b32 v23, 0
 v_mfma_f32_16x16x32_bf16 a[216:219], v[64:67], a[136:139], a[216:219]
 v_mfma_f32_16x16x32_bf16 a[248:251], v[72:75], a[136:139], a[248:251]
 ds_read_b64_tr_b16 a[136:137], v2 offset:49664
 ds_read_b64_tr_b16 a[138:139], v2 offset:53760
 v_mfma_f32_16x16x32_bf16 a[248:251], v[76:79], a[140:143], a[248:251]
 s_waitcnt lgkmcnt(2)
 ds_read_b64_tr_b16 a[140:141], v2 offset:57856
 ds_read_b64_tr_b16 a[142:143], v2 offset:61952
 v_mfma_f32_16x16x32_bf16 v[164:167], v[28:31], a[148:151], v[164:167]
 ds_read_b64_tr_b16 v[28:29], v1 offset:58368
 ds_read_b64_tr_b16 v[30:31], v1 offset:62464
 v_mfma_f32_16x16x32_bf16 v[164:167], v[24:27], a[144:147], v[164:167]
 ds_read_b64_tr_b16 v[24:25], v1 offset:50176
 ds_read_b64_tr_b16 v[26:27], v1 offset:54272
 v_mfma_f32_16x16x32_bf16 v[196:199], v[32:35], a[144:147], v[196:199]
 ds_read_b64_tr_b16 v[32:33], v2 offset:50176
 ds_read_b64_tr_b16 v[34:35], v2 offset:54272
 v_mfma_f32_16x16x32_bf16 v[196:199], v[36:39], a[148:151], v[196:199]
 ds_read_b64_tr_b16 v[36:37], v2 offset:58368
 ds_read_b64_tr_b16 v[38:39], v2 offset:62464
 v_mfma_f32_16x16x32_bf16 v[228:231], v[44:47], a[148:151], v[228:231]
 ds_read_b64_tr_b16 v[44:45], v1 offset:58880
 ds_read_b64_tr_b16 v[46:47], v1 offset:62976
 v_mfma_f32_16x16x32_bf16 v[228:231], v[40:43], a[144:147], v[228:231]
 ds_read_b64_tr_b16 v[40:41], v1 offset:50688
 ds_read_b64_tr_b16 v[42:43], v1 offset:54784
 v_mfma_f32_16x16x32_bf16 a[156:159], v[48:51], a[144:147], a[156:159]
 v_mfma_f32_16x16x32_bf16 a[156:159], v[52:55], a[148:151], a[156:159]
 v_mfma_f32_16x16x32_bf16 a[188:191], v[60:63], a[148:151], a[188:191]
 v_mfma_f32_16x16x32_bf16 a[188:191], v[56:59], a[144:147], a[188:191]
 v_mfma_f32_16x16x32_bf16 a[220:223], v[64:67], a[144:147], a[220:223]
 v_mfma_f32_16x16x32_bf16 a[220:223], v[68:71], a[148:151], a[220:223]
 v_mfma_f32_16x16x32_bf16 a[252:255], v[76:79], a[148:151], a[252:255]
 v_mfma_f32_16x16x32_bf16 a[252:255], v[72:75], a[144:147], a[252:255]
L_fin_7:
 v_mfma_f32_16x16x4_f32 v[72:75], v4, v20, 0
 ds_read_b64_tr_b16 a[144:145], v2 offset:50688
 ds_read_b64_tr_b16 a[146:147], v2 offset:54784
 ds_read_b64_tr_b16 a[148:149], v2 offset:58880
 ds_read_b64_tr_b16 a[150:151], v2 offset:62976
 v_mfma_f32_16x16x32_bf16 v[136:139], v[80:83], a[112:115], v[136:139]
 v_mfma_f32_16x16x32_bf16 v[136:139], v[84:87], a[116:119], v[136:139]
 v_mfma_f32_16x16x32_bf16 v[140:143], v[84:87], a[124:127], v[140:143]
 v_mfma_f32_16x16x32_bf16 v[140:143], v[80:83], a[120:123], v[140:143]
 v_mfma_f32_16x16x32_bf16 v[144:147], v[80:83], a[128:131], v[144:147]
 v_mfma_f32_16x16x32_bf16 v[144:147], v[84:87], a[132:135], v[144:147]
 s_waitcnt lgkmcnt(4)
 v_min3_f32 v21, v21, v72, v73
 v_min3_f32 v21, v21, v74, v75
 v_mfma_f32_16x16x32_bf16 v[148:151], v[84:87], a[140:143], v[148:151]
 v_rcp_f32 v72, v72
 v_mfma_f32_16x16x32_bf16 v[148:151], v[80:83], a[136:139], v[148:151]
 v_rcp_f32 v73, v73
 v_mfma_f32_16x16x32_bf16 v[152:155], v[80:83], v[24:27], v[152:155]
 v_rcp_f32 v74, v74
 v_mfma_f32_16x16x32_bf16 v[152:155], v[84:87], v[28:31], v[152:155]
 v_rcp_f32 v75, v75
 v_mfma_f32_16x16x32_bf16 v[156:159], v[84:87], v[36:39], v[156:159]
 v_mfma_f32_16x16x32_bf16 v[156:159], v[80:83], v[32:35], v[156:159]
 v_mfma_f32_16x16x32_bf16 v[160:163], v[80:83], v[40:43], v[160:163]
 v_mfma_f32_16x16x32_bf16 v[160:163], v[84:87], v[44:47], v[160:163]
 s_waitcnt lgkmcnt(0)
 v_mfma_f32_16x16x32_bf16 v[164:167], v[84:87], a[148:151], v[164:167]
 v_mfma_f32_16x16x32_bf16 v[164:167], v[80:83], a[144:147], v[164:167]
 v_pk_mul_f32 v[76:77], v[72:73], s[94:95] op_sel:[0,1] op_sel_hi:[1,1] neg_lo:[1,0] neg_hi:[1,0]
 v_pk_mul_f32 v[78:79], v[74:75], s[94:95] op_sel:[0,1] op_sel_hi:[1,1] neg_lo:[1,0] neg_hi:[1,0]
 v_pk_fma_f32 v[136:137], v[136:137], v[72:73], v[76:77]
 v_pk_fma_f32 v[140:141], v[140:141], v[72:73], v[76:77]
 v_pk_fma_f32 v[144:145], v[144:145], v[72:73], v[76:77]
 v_pk_fma_f32 v[148:149], v[148:149], v[72:73], v[76:77]
 v_pk_fma_f32 v[152:153], v[152:153], v[72:73], v[76:77]
 v_pk_fma_f32 v[156:157], v[156:157], v[72:73], v[76:77]
 v_pk_fma_f32 v[160:161], v[160:161], v[72:73], v[76:77]
 v_pk_fma_f32 v[164:165], v[164:165], v[72:73], v[76:77]
 v_cvt_pk_bf16_f32 v64, v136, v140
 v_cvt_pk_bf16_f32 v65, v144, v148
 v_cvt_pk_bf16_f32 v66, v152, v156
 v_cvt_pk_bf16_f32 v67, v160, v164
 ds_write_b128 v16, v[64:67] offset:0
 v_pk_fma_f32 v[138:139], v[138:139], v[74:75], v[78:79]
 v_pk_fma_f32 v[142:143], v[142:143], v[74:75], v[78:79]
 v_pk_fma_f32 v[146:147], v[146:147], v[74:75], v[78:79]
 v_pk_fma_f32 v[150:151], v[150:151], v[74:75], v[78:79]
 v_pk_fma_f32 v[154:155], v[154:155], v[74:75], v[78:79]
 v_pk_fma_f32 v[158:159], v[158:159], v[74:75], v[78:79]
 v_pk_fma_f32 v[162:163], v[162:163], v[74:75], v[78:79]
 v_pk_fma_f32 v[166:167], v[166:167], v[74:75], v[78:79]
 s_mov_b32 s30, 0
 v_mfma_f32_16x16x4_f32 v[72:75], v5, v20, 0
 v_cvt_pk_bf16_f32 v68, v137, v141
 v_cvt_pk_bf16_f32 v69, v145, v149
 v_cvt_pk_bf16_f32 v70, v153, v157
 v_cvt_pk_bf16_f32 v71, v161, v165
 v_max3_f32 v23, |v137|, |v141|, v23
 v_max3_f32 v23, |v145|, |v149|, v23
 v_mfma_f32_16x16x32_bf16 v[168:171], v[88:91], a[112:115], v[168:171]
 ds_read_b64_tr_b16 v[48:49], v17 offset:0
 ds_read_b64_tr_b16 v[50:51], v17 offset:64
 ds_write_b128 v16, v[68:71] offset:272
 v_mfma_f32_16x16x32_bf16 v[168:171], v[92:95], a[116:119], v[168:171]
 v_max3_f32 v23, |v153|, |v157|, v23
 v_max3_f32 v23, |v161|, |v165|, v23
 v_mfma_f32_16x16x32_bf16 v[80:83], v[68:71], v[64:67], 0
 v_cvt_pk_bf16_f32 v64, v138, v142
 v_mfma_f32_16x16x32_bf16 v[172:175], v[92:95], a[124:127], v[172:175]
 v_cvt_pk_bf16_f32 v65, v146, v150
 v_cvt_pk_bf16_f32 v66, v154, v158
 v_cvt_pk_bf16_f32 v67, v162, v166
 v_mfma_f32_16x16x32_bf16 v[172:175], v[88:91], a[120:123], v[172:175]
 s_waitcnt lgkmcnt(1)
 buffer_store_dwordx4 v[48:51], v18, s[16:19], s30 offen offset:0 sc0 sc1
 ds_read_b64_tr_b16 v[52:53], v17 offset:272
 ds_read_b64_tr_b16 v[54:55], v17 offset:336
 v_mfma_f32_16x16x32_bf16 v[176:179], v[88:91], a[128:131], v[176:179]
 ds_write_b128 v16, v[64:67] offset:544
 v_mfma_f32_16x16x32_bf16 v[176:179], v[92:95], a[132:135], v[176:179]
 v_cvt_pk_bf16_f32 v68, v139, v143
 v_cvt_pk_bf16_f32 v69, v147, v151
 v_cvt_pk_bf16_f32 v70, v155, v159
 v_mfma_f32_16x16x32_bf16 v[180:183], v[92:95], a[140:143], v[180:183]
 v_cvt_pk_bf16_f32 v71, v163, v167
 v_min3_f32 v21, v21, v72, v73
 v_min3_f32 v21, v21, v74, v75
 v_mfma_f32_16x16x32_bf16 v[180:183], v[88:91], a[136:139], v[180:183]
 s_waitcnt lgkmcnt(1)
 buffer_store_dwordx4 v[52:55], v18, s[16:19], s30 offen offset:256 sc0 sc1
 ds_read_b64_tr_b16 v[56:57], v17 offset:544
 ds_read_b64_tr_b16 v[58:59], v17 offset:608
 v_mfma_f32_16x16x32_bf16 v[184:187], v[88:91], v[24:27], v[184:187]
 ds_write_b128 v16, v[68:71] offset:816
 v_mfma_f32_16x16x32_bf16 v[184:187], v[92:95], v[28:31], v[184:187]
 v_mfma_f32_16x16x32_bf16 v[80:83], v[68:71], v[64:67], v[80:83]
 v_rcp_f32 v72, v72
 v_rcp_f32 v73, v73
 v_mfma_f32_16x16x32_bf16 v[188:191], v[92:95], v[36:39], v[188:191]
 v_rcp_f32 v74, v74
 v_mfma_f32_16x16x32_bf16 v[188:191], v[88:91], v[32:35], v[188:191]
 s_waitcnt lgkmcnt(1)
 buffer_store_dwordx4 v[56:59], v18, s[16:19], s30 offen offset:512 sc0 sc1
 ds_read_b64_tr_b16 v[60:61], v17 offset:816
 ds_read_b64_tr_b16 v[62:63], v17 offset:880
 v_mfma_f32_16x16x32_bf16 v[192:195], v[88:91], v[40:43], v[192:195]
 ds_read_b128 v[136:139], v0 offset:49152
 ds_read_b128 v[140:143], v0 offset:49664
 ds_read_b128 v[144:147], v0 offset:50176
 v_mfma_f32_16x16x32_bf16 v[192:195], v[92:95], v[44:47], v[192:195]
 ds_read_b128 v[148:151], v0 offset:50688
 ds_read_b128 v[152:155], v0 offset:53248
 ds_read_b128 v[156:159], v0 offset:53760
 v_mfma_f32_16x16x32_bf16 v[196:199], v[92:95], a[148:151], v[196:199]
 ds_read_b128 v[160:163], v0 offset:54272
 ds_read_b128 v[164:167], v0 offset:54784
 v_mfma_f32_16x16x32_bf16 v[196:199], v[88:91], a[144:147], v[196:199]
 v_rcp_f32 v75, v75
 s_waitcnt lgkmcnt(8)
 buffer_store_dwordx4 v[60:63], v18, s[16:19], s30 offen offset:768 sc0 sc1
 v_pk_mul_f32 v[76:77], v[72:73], s[94:95] op_sel:[0,1] op_sel_hi:[1,1] neg_lo:[1,0] neg_hi:[1,0]
 v_pk_mul_f32 v[78:79], v[74:75], s[94:95] op_sel:[0,1] op_sel_hi:[1,1] neg_lo:[1,0] neg_hi:[1,0]
 v_pk_fma_f32 v[168:169], v[168:169], v[72:73], v[76:77]
 v_pk_fma_f32 v[172:173], v[172:173], v[72:73], v[76:77]
 v_pk_fma_f32 v[176:177], v[176:177], v[72:73], v[76:77]
 v_pk_fma_f32 v[180:181], v[180:181], v[72:73], v[76:77]
 v_pk_fma_f32 v[184:185], v[184:185], v[72:73], v[76:77]
 v_pk_fma_f32 v[188:189], v[188:189], v[72:73], v[76:77]
 v_pk_fma_f32 v[192:193], v[192:193], v[72:73], v[76:77]
 v_pk_fma_f32 v[196:197], v[196:197], v[72:73], v[76:77]
 v_cvt_pk_bf16_f32 v64, v168, v172
 v_cvt_pk_bf16_f32 v65, v176, v180
 v_cvt_pk_bf16_f32 v66, v184, v188
 v_cvt_pk_bf16_f32 v67, v192, v196
 ds_write_b128 v16, v[64:67] offset:0
 v_pk_fma_f32 v[170:171], v[170:171], v[74:75], v[78:79]
 v_pk_fma_f32 v[174:175], v[174:175], v[74:75], v[78:79]
 v_pk_fma_f32 v[178:179], v[178:179], v[74:75], v[78:79]
 v_pk_fma_f32 v[182:183], v[182:183], v[74:75], v[78:79]
 v_pk_fma_f32 v[186:187], v[186:187], v[74:75], v[78:79]
 v_pk_fma_f32 v[190:191], v[190:191], v[74:75], v[78:79]
 v_pk_fma_f32 v[194:195], v[194:195], v[74:75], v[78:79]
 v_pk_fma_f32 v[198:199], v[198:199], v[74:75], v[78:79]
 s_mov_b32 s30, 4096
 v_mfma_f32_16x16x4_f32 v[72:75], v6, v20, 0
 s_waitcnt lgkmcnt(8)
 v_cvt_pk_bf16_f32 v68, v169, v173
 v_cvt_pk_bf16_f32 v69, v177, v181
 v_cvt_pk_bf16_f32 v70, v185, v189
 v_cvt_pk_bf16_f32 v71, v193, v197
 v_max3_f32 v23, |v169|, |v173|, v23
 v_max3_f32 v23, |v177|, |v181|, v23
 v_mfma_f32_16x16x32_bf16 v[104:107], v[136:139], a[48:51], v[12:15]
 s_waitcnt lgkmcnt(7)
 ds_read_b64_tr_b16 v[48:49], v17 offset:0
 ds_read_b64_tr_b16 v[50:51], v17 offset:64
 ds_write_b128 v16, v[68:71] offset:272
 v_mfma_f32_16x16x32_bf16 v[104:107], v[140:143], a[52:55], v[104:107]
 v_max3_f32 v23, |v185|, |v189|, v23
 v_max3_f32 v23, |v193|, |v197|, v23
 v_mfma_f32_16x16x32_bf16 v[80:83], v[68:71], v[64:67], v[80:83]
 s_waitcnt lgkmcnt(9)
 v_cvt_pk_bf16_f32 v64, v170, v174
 v_cvt_pk_bf16_f32 v65, v178, v182
 v_mfma_f32_16x16x32_bf16 v[104:107], v[144:147], a[56:59], v[104:107]
 s_waitcnt lgkmcnt(6)
 v_cvt_pk_bf16_f32 v66, v186, v190
 v_cvt_pk_bf16_f32 v67, v194, v198
 v_cvt_pk_bf16_f32 v68, v171, v175
 v_cvt_pk_bf16_f32 v69, v179, v183
 v_mfma_f32_16x16x32_bf16 v[104:107], v[148:151], a[60:63], v[104:107]
 s_waitcnt lgkmcnt(1)
 buffer_store_dwordx4 v[48:51], v18, s[16:19], s30 offen offset:0 sc0 sc1
 ds_read_b64_tr_b16 v[52:53], v17 offset:272
 ds_read_b64_tr_b16 v[54:55], v17 offset:336
 ds_write_b128 v16, v[64:67] offset:544
 v_mfma_f32_16x16x32_bf16 v[84:87], v[164:167], a[60:63], v[12:15]
 v_cvt_pk_bf16_f32 v70, v187, v191
 v_cvt_pk_bf16_f32 v71, v195, v199
 v_min3_f32 v21, v21, v72, v73
 v_min3_f32 v21, v21, v74, v75
 v_mfma_f32_16x16x32_bf16 v[84:87], v[160:163], a[56:59], v[84:87]
 v_mfma_f32_16x16x32_bf16 v[80:83], v[68:71], v[64:67], v[80:83]
 v_exp_f32 v104, v104
 v_exp_f32 v105, v105
 v_mfma_f32_16x16x32_bf16 v[84:87], v[156:159], a[52:55], v[84:87]
 s_waitcnt lgkmcnt(1)
 buffer_store_dwordx4 v[52:55], v18, s[16:19], s30 offen offset:256 sc0 sc1
 ds_read_b64_tr_b16 v[56:57], v17 offset:544
 ds_read_b64_tr_b16 v[58:59], v17 offset:608
 v_mfma_f32_16x16x32_bf16 v[84:87], v[152:155], a[48:51], v[84:87]
 ds_write_b128 v16, v[68:71] offset:816
 v_mfma_f32_16x16x32_bf16 v[200:203], v[96:99], a[112:115], v[200:203]
 v_add_f32 v7, v104, v7
 v_cvt_pk_bf16_f32 v104, v104, v105
 v_mfma_f32_16x16x32_bf16 v[200:203], v[100:103], a[116:119], v[200:203]
 v_exp_f32 v106, v106
 v_add_f32 v7, v105, v7
 v_mfma_f32_16x16x32_bf16 v[204:207], v[100:103], a[124:127], v[204:207]
 v_exp_f32 v107, v107
 v_add_f32 v7, v106, v7
 v_cvt_pk_bf16_f32 v105, v106, v107
 v_mfma_f32_16x16x32_bf16 v[204:207], v[96:99], a[120:123], v[204:207]
 s_waitcnt lgkmcnt(1)
 buffer_store_dwordx4 v[56:59], v18, s[16:19], s30 offen offset:512 sc0 sc1
 ds_read_b64_tr_b16 v[60:61], v17 offset:816
 ds_read_b64_tr_b16 v[62:63], v17 offset:880
 v_mfma_f32_16x16x32_bf16 v[208:211], v[96:99], a[128:131], v[208:211]
 ds_read_b128 v[168:171], v0 offset:57344
 ds_read_b128 v[172:175], v0 offset:57856
 ds_read_b128 v[176:179], v0 offset:58368
 v_mfma_f32_16x16x32_bf16 v[208:211], v[100:103], a[132:135], v[208:211]
 ds_read_b128 v[180:183], v0 offset:58880
 ds_read_b128 v[184:187], v0 offset:61440
 ds_read_b128 v[188:191], v0 offset:61952
 v_mfma_f32_16x16x32_bf16 v[212:215], v[100:103], a[140:143], v[212:215]
 ds_read_b128 v[192:195], v0 offset:62464
 ds_read_b128 v[196:199], v0 offset:62976
 v_add_f32 v7, v107, v7
 v_mfma_f32_16x16x32_bf16 v[212:215], v[96:99], a[136:139], v[212:215]
 v_exp_f32 v84, v84
 v_mfma_f32_16x16x32_bf16 v[112:115], v[136:139], a[64:67], v[12:15]
 s_waitcnt lgkmcnt(8)
 buffer_store_dwordx4 v[60:63], v18, s[16:19], s30 offen offset:768 sc0 sc1
 v_exp_f32 v85, v85
 v_add_f32 v7, v84, v7
 v_mfma_f32_16x16x32_bf16 v[112:115], v[140:143], a[68:71], v[112:115]
 v_cvt_pk_bf16_f32 v106, v84, v85
 v_exp_f32 v86, v86
 v_mfma_f32_16x16x32_bf16 v[112:115], v[144:147], a[72:75], v[112:115]
 v_add_f32 v7, v85, v7
 v_exp_f32 v87, v87
 v_mfma_f32_16x16x32_bf16 v[112:115], v[148:151], a[76:79], v[112:115]
 v_add_f32 v7, v86, v7
 v_cvt_pk_bf16_f32 v107, v86, v87
 v_add_f32 v7, v87, v7
 v_mfma_f32_16x16x32_bf16 v[88:91], v[164:167], a[76:79], v[12:15]
 v_rcp_f32 v72, v72
 v_mfma_f32_16x16x32_bf16 v[88:91], v[160:163], a[72:75], v[88:91]
 v_rcp_f32 v73, v73
 v_rcp_f32 v74, v74
 v_mfma_f32_16x16x32_bf16 v[88:91], v[156:159], a[68:71], v[88:91]
 v_exp_f32 v112, v112
 v_mfma_f32_16x16x32_bf16 v[88:91], v[152:155], a[64:67], v[88:91]
 v_exp_f32 v113, v113
 v_add_f32 v8, v112, v8
 v_cvt_pk_bf16_f32 v112, v112, v113
 v_mfma_f32_16x16x32_bf16 v[216:219], v[96:99], v[24:27], v[216:219]
 v_exp_f32 v114, v114
 v_add_f32 v8, v113, v8
 v_mfma_f32_16x16x32_bf16 v[216:219], v[100:103], v[28:31], v[216:219]
 v_exp_f32 v115, v115
 v_add_f32 v8, v114, v8
 v_mfma_f32_16x16x32_bf16 v[220:223], v[100:103], v[36:39], v[220:223]
 v_cvt_pk_bf16_f32 v113, v114, v115
 v_add_f32 v8, v115, v8
 v_mfma_f32_16x16x32_bf16 v[220:223], v[96:99], v[32:35], v[220:223]
 v_exp_f32 v88, v88
 v_exp_f32 v89, v89
 v_mfma_f32_16x16x32_bf16 v[224:227], v[96:99], v[40:43], v[224:227]
 v_add_f32 v8, v88, v8
 v_cvt_pk_bf16_f32 v114, v88, v89
 v_mfma_f32_16x16x32_bf16 v[224:227], v[100:103], v[44:47], v[224:227]
 v_exp_f32 v90, v90
 v_add_f32 v8, v89, v8
 v_mfma_f32_16x16x32_bf16 v[228:231], v[100:103], a[148:151], v[228:231]
 v_exp_f32 v91, v91
 v_add_f32 v8, v90, v8
 v_cvt_pk_bf16_f32 v115, v90, v91
 v_mfma_f32_16x16x32_bf16 v[228:231], v[96:99], a[144:147], v[228:231]
 s_waitcnt lgkmcnt(0)
 v_add_f32 v8, v91, v8
 v_rcp_f32 v75, v75
 v_pk_mul_f32 v[76:77], v[72:73], s[94:95] op_sel:[0,1] op_sel_hi:[1,1] neg_lo:[1,0] neg_hi:[1,0]
 v_pk_mul_f32 v[78:79], v[74:75], s[94:95] op_sel:[0,1] op_sel_hi:[1,1] neg_lo:[1,0] neg_hi:[1,0]
 v_pk_fma_f32 v[200:201], v[200:201], v[72:73], v[76:77]
 v_pk_fma_f32 v[204:205], v[204:205], v[72:73], v[76:77]
 v_pk_fma_f32 v[208:209], v[208:209], v[72:73], v[76:77]
 v_pk_fma_f32 v[212:213], v[212:213], v[72:73], v[76:77]
 v_pk_fma_f32 v[216:217], v[216:217], v[72:73], v[76:77]
 v_pk_fma_f32 v[220:221], v[220:221], v[72:73], v[76:77]
 v_pk_fma_f32 v[224:225], v[224:225], v[72:73], v[76:77]
 v_pk_fma_f32 v[228:229], v[228:229], v[72:73], v[76:77]
 v_cvt_pk_bf16_f32 v64, v200, v204
 v_cvt_pk_bf16_f32 v65, v208, v212
 v_cvt_pk_bf16_f32 v66, v216, v220
 v_cvt_pk_bf16_f32 v67, v224, v228
 ds_write_b128 v16, v[64:67] offset:0
 v_pk_fma_f32 v[202:203], v[202:203], v[74:75], v[78:79]
 v_pk_fma_f32 v[206:207], v[206:207], v[74:75], v[78:79]
 v_pk_fma_f32 v[210:211], v[210:211], v[74:75], v[78:79]
 v_pk_fma_f32 v[214:215], v[214:215], v[74:75], v[78:79]
 v_pk_fma_f32 v[218:219], v[218:219], v[74:75], v[78:79]
 v_pk_fma_f32 v[222:223], v[222:223], v[74:75], v[78:79]
 v_pk_fma_f32 v[226:227], v[226:227], v[74:75], v[78:79]
 v_pk_fma_f32 v[230:231], v[230:231], v[74:75], v[78:79]
 s_mov_b32 s30, 8192
 v_mfma_f32_16x16x32_bf16 v[108:111], v[168:171], a[48:51], v[12:15]
 v_cvt_pk_bf16_f32 v68, v201, v205
 v_cvt_pk_bf16_f32 v69, v209, v213
 v_cvt_pk_bf16_f32 v70, v217, v221
 v_cvt_pk_bf16_f32 v71, v225, v229
 v_mfma_f32_16x16x32_bf16 v[108:111], v[172:175], a[52:55], v[108:111]
 ds_read_b64_tr_b16 v[48:49], v17 offset:0
 ds_read_b64_tr_b16 v[50:51], v17 offset:64
 ds_write_b128 v16, v[68:71] offset:272
 v_mfma_f32_16x16x32_bf16 v[108:111], v[176:179], a[56:59], v[108:111]
 v_max3_f32 v23, |v201|, |v205|, v23
 v_max3_f32 v23, |v209|, |v213|, v23
 v_max3_f32 v23, |v217|, |v221|, v23
 v_max3_f32 v23, |v225|, |v229|, v23
 v_mfma_f32_16x16x32_bf16 v[108:111], v[180:183], a[60:63], v[108:111]
 v_mfma_f32_16x16x32_bf16 v[80:83], v[68:71], v[64:67], v[80:83]
 v_cvt_pk_bf16_f32 v64, v202, v206
 v_cvt_pk_bf16_f32 v65, v210, v214
 v_cvt_pk_bf16_f32 v66, v218, v222
 v_mfma_f32_16x16x32_bf16 v[84:87], v[196:199], a[60:63], v[12:15]
 s_waitcnt lgkmcnt(1)
 buffer_store_dwordx4 v[48:51], v18, s[16:19], s30 offen offset:0 sc0 sc1
 ds_read_b64_tr_b16 v[52:53], v17 offset:272
 ds_read_b64_tr_b16 v[54:55], v17 offset:336
 v_mfma_f32_16x16x32_bf16 v[84:87], v[192:195], a[56:59], v[84:87]
 v_cvt_pk_bf16_f32 v67, v226, v230
 v_cvt_pk_bf16_f32 v68, v203, v207
 v_cvt_pk_bf16_f32 v69, v211, v215
 v_mfma_f32_16x16x32_bf16 v[84:87], v[188:191], a[52:55], v[84:87]
 ds_write_b128 v16, v[64:67] offset:544
 v_mfma_f32_16x16x32_bf16 v[84:87], v[184:187], a[48:51], v[84:87]
 v_cvt_pk_bf16_f32 v70, v219, v223
 v_cvt_pk_bf16_f32 v71, v227, v231
 v_mfma_f32_16x16x32_bf16 v[116:119], v[168:171], a[64:67], v[12:15]
 v_exp_f32 v108, v108
 v_mfma_f32_16x16x32_bf16 v[80:83], v[68:71], v[64:67], v[80:83]
 s_waitcnt lgkmcnt(1)
 buffer_store_dwordx4 v[52:55], v18, s[16:19], s30 offen offset:256 sc0 sc1
 v_mfma_f32_16x16x32_bf16 v[116:119], v[172:175], a[68:71], v[116:119]
 ds_read_b64_tr_b16 v[56:57], v17 offset:544
 ds_read_b64_tr_b16 v[58:59], v17 offset:608
 ds_write_b128 v16, v[68:71] offset:816
 v_mfma_f32_16x16x32_bf16 v[116:119], v[176:179], a[72:75], v[116:119]
 v_exp_f32 v109, v109
 v_add_f32 v7, v108, v7
 v_mfma_f32_16x16x32_bf16 v[116:119], v[180:183], a[76:79], v[116:119]
 v_cvt_pk_bf16_f32 v108, v108, v109
 v_exp_f32 v110, v110
 v_mfma_f32_16x16x32_bf16 v[88:91], v[196:199], a[76:79], v[12:15]
 v_add_f32 v7, v109, v7
 v_exp_f32 v111, v111
 v_mfma_f32_16x16x32_bf16 v[88:91], v[192:195], a[72:75], v[88:91]
 s_waitcnt lgkmcnt(1)
 buffer_store_dwordx4 v[56:59], v18, s[16:19], s30 offen offset:512 sc0 sc1
 ds_read_b64_tr_b16 v[60:61], v17 offset:816
 ds_read_b64_tr_b16 v[62:63], v17 offset:880
 v_mfma_f32_16x16x32_bf16 v[88:91], v[188:191], a[68:71], v[88:91]
 v_add_f32 v7, v110, v7
 v_cvt_pk_bf16_f32 v109, v110, v111
 v_add_f32 v7, v111, v7
 v_mfma_f32_16x16x32_bf16 v[88:91], v[184:187], a[64:67], v[88:91]
 v_exp_f32 v84, v84
 v_mfma_f32_16x16x32_bf16 v[232:235], v[104:107], a[112:115], v[232:235]
 v_exp_f32 v85, v85
 v_add_f32 v7, v84, v7
 v_cvt_pk_bf16_f32 v110, v84, v85
 v_exp_f32 v86, v86
 v_add_f32 v7, v85, v7
 v_exp_f32 v87, v87
 s_waitcnt lgkmcnt(0)
 buffer_store_dwordx4 v[60:63], v18, s[16:19], s30 offen offset:768 sc0 sc1
 v_add_f32 v7, v86, v7
 v_cvt_pk_bf16_f32 v111, v86, v87
 v_add_f32 v7, v87, v7
 v_exp_f32 v116, v116
 v_mfma_f32_16x16x32_bf16 v[232:235], v[108:111], a[116:119], v[232:235]
 v_exp_f32 v117, v117
 v_add_f32 v8, v116, v8
 v_mfma_f32_16x16x32_bf16 v[236:239], v[108:111], a[124:127], v[236:239]
 v_cvt_pk_bf16_f32 v116, v116, v117
 v_exp_f32 v118, v118
 v_mfma_f32_16x16x32_bf16 v[236:239], v[104:107], a[120:123], v[236:239]
 v_add_f32 v8, v117, v8
 v_exp_f32 v119, v119
 v_mfma_f32_16x16x4_f32 v[72:75], v7, v20, 0
 v_add_f32 v8, v118, v8
 v_cvt_pk_bf16_f32 v117, v118, v119
 v_add_f32 v8, v119, v8
 v_exp_f32 v88, v88
 v_mfma_f32_16x16x32_bf16 v[240:243], v[104:107], a[128:131], v[240:243]
 v_exp_f32 v89, v89
 v_mfma_f32_16x16x32_bf16 v[240:243], v[108:111], a[132:135], v[240:243]
 v_add_f32 v8, v88, v8
 v_cvt_pk_bf16_f32 v118, v88, v89
 v_mfma_f32_16x16x32_bf16 v[244:247], v[108:111], a[140:143], v[244:247]
 v_exp_f32 v90, v90
 v_mfma_f32_16x16x32_bf16 v[244:247], v[104:107], a[136:139], v[244:247]
 v_add_f32 v8, v89, v8
 v_min3_f32 v21, v21, v72, v73
 v_mfma_f32_16x16x32_bf16 v[248:251], v[104:107], v[24:27], v[248:251]
 v_exp_f32 v91, v91
 v_mfma_f32_16x16x32_bf16 v[248:251], v[108:111], v[28:31], v[248:251]
 v_add_f32 v8, v90, v8
 v_cvt_pk_bf16_f32 v119, v90, v91
 v_mfma_f32_16x16x32_bf16 v[252:255], v[108:111], v[36:39], v[252:255]
 v_add_f32 v8, v91, v8
 v_min3_f32 v21, v21, v74, v75
 v_mfma_f32_16x16x32_bf16 v[252:255], v[104:107], v[32:35], v[252:255]
 v_rcp_f32 v72, v72
 v_mfma_f32_16x16x32_bf16 a[152:155], v[104:107], v[40:43], a[152:155]
 v_rcp_f32 v73, v73
 v_mfma_f32_16x16x32_bf16 a[152:155], v[108:111], v[44:47], a[152:155]
 v_rcp_f32 v74, v74
 v_mfma_f32_16x16x32_bf16 a[156:159], v[108:111], a[148:151], a[156:159]
 v_rcp_f32 v75, v75
 v_mfma_f32_16x16x32_bf16 a[156:159], v[104:107], a[144:147], a[156:159]
 s_nop 0
 s_nop 0
 s_nop 0
 s_nop 0
 v_accvgpr_read_b32 v224, a152
 v_accvgpr_read_b32 v225, a153
 v_accvgpr_read_b32 v226, a154
 v_accvgpr_read_b32 v227, a155
 v_accvgpr_read_b32 v228, a156
 v_accvgpr_read_b32 v229, a157
 v_accvgpr_read_b32 v230, a158
 v_accvgpr_read_b32 v231, a159
 v_pk_mul_f32 v[76:77], v[72:73], s[94:95] op_sel:[0,1] op_sel_hi:[1,1] neg_lo:[1,0] neg_hi:[1,0]
 v_pk_mul_f32 v[78:79], v[74:75], s[94:95] op_sel:[0,1] op_sel_hi:[1,1] neg_lo:[1,0] neg_hi:[1,0]
 v_pk_fma_f32 v[232:233], v[232:233], v[72:73], v[76:77]
 v_pk_fma_f32 v[236:237], v[236:237], v[72:73], v[76:77]
 v_pk_fma_f32 v[240:241], v[240:241], v[72:73], v[76:77]
 v_pk_fma_f32 v[244:245], v[244:245], v[72:73], v[76:77]
 v_pk_fma_f32 v[248:249], v[248:249], v[72:73], v[76:77]
 v_pk_fma_f32 v[252:253], v[252:253], v[72:73], v[76:77]
 v_pk_fma_f32 v[224:225], v[224:225], v[72:73], v[76:77]
 v_pk_fma_f32 v[228:229], v[228:229], v[72:73], v[76:77]
 v_cvt_pk_bf16_f32 v64, v232, v236
 v_cvt_pk_bf16_f32 v65, v240, v244
 v_cvt_pk_bf16_f32 v66, v248, v252
 v_cvt_pk_bf16_f32 v67, v224, v228
 ds_write_b128 v16, v[64:67] offset:0
 v_pk_fma_f32 v[234:235], v[234:235], v[74:75], v[78:79]
 v_pk_fma_f32 v[238:239], v[238:239], v[74:75], v[78:79]
 v_pk_fma_f32 v[242:243], v[242:243], v[74:75], v[78:79]
 v_pk_fma_f32 v[246:247], v[246:247], v[74:75], v[78:79]
 v_pk_fma_f32 v[250:251], v[250:251], v[74:75], v[78:79]
 v_pk_fma_f32 v[254:255], v[254:255], v[74:75], v[78:79]
 v_pk_fma_f32 v[226:227], v[226:227], v[74:75], v[78:79]
 v_pk_fma_f32 v[230:231], v[230:231], v[74:75], v[78:79]
 s_mov_b32 s30, 12288
 v_mfma_f32_16x16x4_f32 v[72:75], v8, v20, 0
 v_cvt_pk_bf16_f32 v68, v233, v237
 v_cvt_pk_bf16_f32 v69, v241, v245
 v_cvt_pk_bf16_f32 v70, v249, v253
 v_cvt_pk_bf16_f32 v71, v225, v229
 v_max3_f32 v23, |v233|, |v237|, v23
 v_max3_f32 v23, |v241|, |v245|, v23
 v_mfma_f32_16x16x32_bf16 v[120:123], v[136:139], a[80:83], v[12:15]
 ds_read_b64_tr_b16 v[48:49], v17 offset:0
 ds_read_b64_tr_b16 v[50:51], v17 offset:64
 ds_write_b128 v16, v[68:71] offset:272
 v_mfma_f32_16x16x32_bf16 v[120:123], v[140:143], a[84:87], v[120:123]
 v_max3_f32 v23, |v249|, |v253|, v23
 v_max3_f32 v23, |v225|, |v229|, v23
 v_mfma_f32_16x16x32_bf16 v[80:83], v[68:71], v[64:67], v[80:83]
 v_cvt_pk_bf16_f32 v64, v234, v238
 v_mfma_f32_16x16x32_bf16 v[120:123], v[144:147], a[88:91], v[120:123]
 v_cvt_pk_bf16_f32 v65, v242, v246
 v_cvt_pk_bf16_f32 v66, v250, v254
 v_cvt_pk_bf16_f32 v67, v226, v230
 v_mfma_f32_16x16x32_bf16 v[120:123], v[148:151], a[92:95], v[120:123]
 s_waitcnt lgkmcnt(1)
 buffer_store_dwordx4 v[48:51], v18, s[16:19], s30 offen offset:0 sc0 sc1
 ds_read_b64_tr_b16 v[52:53], v17 offset:272
 ds_read_b64_tr_b16 v[54:55], v17 offset:336
 v_mfma_f32_16x16x32_bf16 v[84:87], v[164:167], a[92:95], v[12:15]
 ds_write_b128 v16, v[64:67] offset:544
 v_mfma_f32_16x16x32_bf16 v[84:87], v[160:163], a[88:91], v[84:87]
 v_cvt_pk_bf16_f32 v68, v235, v239
 v_cvt_pk_bf16_f32 v69, v243, v247
 v_cvt_pk_bf16_f32 v70, v251, v255
 v_mfma_f32_16x16x32_bf16 v[84:87], v[156:159], a[84:87], v[84:87]
 v_cvt_pk_bf16_f32 v71, v227, v231
 v_exp_f32 v120, v120
 v_mfma_f32_16x16x32_bf16 v[84:87], v[152:155], a[80:83], v[84:87]
 s_waitcnt lgkmcnt(1)
 buffer_store_dwordx4 v[52:55], v18, s[16:19], s30 offen offset:256 sc0 sc1
 ds_read_b64_tr_b16 v[56:57], v17 offset:544
 ds_read_b64_tr_b16 v[58:59], v17 offset:608
 v_mfma_f32_16x16x32_bf16 a[160:163], v[112:115], a[112:115], a[160:163]
 ds_write_b128 v16, v[68:71] offset:816
 v_mfma_f32_16x16x32_bf16 a[160:163], v[116:119], a[116:119], a[160:163]
 v_mfma_f32_16x16x32_bf16 v[80:83], v[68:71], v[64:67], v[80:83]
 v_exp_f32 v121, v121
 v_add_f32 v9, v120, v9
 v_cvt_pk_bf16_f32 v120, v120, v121
 v_mfma_f32_16x16x32_bf16 a[164:167], v[116:119], a[124:127], a[164:167]
 v_exp_f32 v122, v122
 v_add_f32 v9, v121, v9
 v_mfma_f32_16x16x32_bf16 a[164:167], v[112:115], a[120:123], a[164:167]
 s_waitcnt lgkmcnt(1)
 buffer_store_dwordx4 v[56:59], v18, s[16:19], s30 offen offset:512 sc0 sc1
 ds_read_b64_tr_b16 v[60:61], v17 offset:816
 ds_read_b64_tr_b16 v[62:63], v17 offset:880
 v_mfma_f32_16x16x32_bf16 a[168:171], v[112:115], a[128:131], a[168:171]
 v_exp_f32 v123, v123
 v_add_f32 v9, v122, v9
 v_mfma_f32_16x16x32_bf16 a[168:171], v[116:119], a[132:135], a[168:171]
 v_cvt_pk_bf16_f32 v121, v122, v123
 v_add_f32 v9, v123, v9
 v_min3_f32 v21, v21, v72, v73
 v_mfma_f32_16x16x32_bf16 a[172:175], v[116:119], a[140:143], a[172:175]
 v_exp_f32 v84, v84
 v_min3_f32 v21, v21, v74, v75
 v_mfma_f32_16x16x32_bf16 a[172:175], v[112:115], a[136:139], a[172:175]
 v_exp_f32 v85, v85
 v_add_f32 v9, v84, v9
 v_mfma_f32_16x16x32_bf16 v[124:127], v[168:171], a[80:83], v[12:15]
 s_waitcnt lgkmcnt(0)
 buffer_store_dwordx4 v[60:63], v18, s[16:19], s30 offen offset:768 sc0 sc1
 v_cvt_pk_bf16_f32 v122, v84, v85
 v_mfma_f32_16x16x32_bf16 v[124:127], v[172:175], a[84:87], v[124:127]
 v_exp_f32 v86, v86
 v_add_f32 v9, v85, v9
 v_mfma_f32_16x16x32_bf16 v[124:127], v[176:179], a[88:91], v[124:127]
 v_exp_f32 v87, v87
 v_add_f32 v9, v86, v9
 v_mfma_f32_16x16x32_bf16 v[124:127], v[180:183], a[92:95], v[124:127]
 v_cvt_pk_bf16_f32 v123, v86, v87
 v_add_f32 v9, v87, v9
 v_mfma_f32_16x16x32_bf16 v[88:91], v[196:199], a[92:95], v[12:15]
 v_rcp_f32 v72, v72
 v_mfma_f32_16x16x32_bf16 v[88:91], v[192:195], a[88:91], v[88:91]
 v_rcp_f32 v73, v73
 v_rcp_f32 v74, v74
 v_mfma_f32_16x16x32_bf16 v[88:91], v[188:191], a[84:87], v[88:91]
 v_exp_f32 v124, v124
 v_mfma_f32_16x16x32_bf16 v[88:91], v[184:187], a[80:83], v[88:91]
 v_exp_f32 v125, v125
 v_add_f32 v9, v124, v9
 v_cvt_pk_bf16_f32 v124, v124, v125
 v_mfma_f32_16x16x32_bf16 a[176:179], v[112:115], v[24:27], a[176:179]
 v_exp_f32 v126, v126
 v_add_f32 v9, v125, v9
 v_mfma_f32_16x16x32_bf16 a[176:179], v[116:119], v[28:31], a[176:179]
 v_exp_f32 v127, v127
 v_add_f32 v9, v126, v9
 v_mfma_f32_16x16x32_bf16 a[180:183], v[116:119], v[36:39], a[180:183]
 v_cvt_pk_bf16_f32 v125, v126, v127
 v_add_f32 v9, v127, v9
 v_mfma_f32_16x16x32_bf16 a[180:183], v[112:115], v[32:35], a[180:183]
 v_exp_f32 v88, v88
 v_exp_f32 v89, v89
 v_mfma_f32_16x16x32_bf16 a[184:187], v[112:115], v[40:43], a[184:187]
 v_add_f32 v9, v88, v9
 v_cvt_pk_bf16_f32 v126, v88, v89
 v_mfma_f32_16x16x32_bf16 a[184:187], v[116:119], v[44:47], a[184:187]
 v_exp_f32 v90, v90
 v_add_f32 v9, v89, v9
 v_mfma_f32_16x16x32_bf16 a[188:191], v[116:119], a[148:151], a[188:191]
 v_exp_f32 v91, v91
 v_add_f32 v9, v90, v9
 v_cvt_pk_bf16_f32 v127, v90, v91
 v_mfma_f32_16x16x32_bf16 a[188:191], v[112:115], a[144:147], a[188:191]
 v_add_f32 v9, v91, v9
 v_rcp_f32 v75, v75
 v_accvgpr_read_b32 v200, a160
 v_accvgpr_read_b32 v201, a161
 v_accvgpr_read_b32 v202, a162
 v_accvgpr_read_b32 v203, a163
 v_accvgpr_read_b32 v204, a164
 v_accvgpr_read_b32 v205, a165
 v_accvgpr_read_b32 v206, a166
 v_accvgpr_read_b32 v207, a167
 v_accvgpr_read_b32 v208, a168
 v_accvgpr_read_b32 v209, a169
 v_accvgpr_read_b32 v210, a170
 v_accvgpr_read_b32 v211, a171
 v_accvgpr_read_b32 v212, a172
 v_accvgpr_read_b32 v213, a173
 v_accvgpr_read_b32 v214, a174
 v_accvgpr_read_b32 v215, a175
 v_accvgpr_read_b32 v216, a176
 v_accvgpr_read_b32 v217, a177
 v_accvgpr_read_b32 v218, a178
 v_accvgpr_read_b32 v219, a179
 v_accvgpr_read_b32 v220, a180
 v_accvgpr_read_b32 v221, a181
 v_accvgpr_read_b32 v222, a182
 v_accvgpr_read_b32 v223, a183
 v_accvgpr_read_b32 v224, a184
 v_accvgpr_read_b32 v225, a185
 v_accvgpr_read_b32 v226, a186
 v_accvgpr_read_b32 v227, a187
 v_accvgpr_read_b32 v228, a188
 v_accvgpr_read_b32 v229, a189
 v_accvgpr_read_b32 v230, a190
 v_accvgpr_read_b32 v231, a191
 v_pk_mul_f32 v[76:77], v[72:73], s[94:95] op_sel:[0,1] op_sel_hi:[1,1] neg_lo:[1,0] neg_hi:[1,0]
 v_pk_mul_f32 v[78:79], v[74:75], s[94:95] op_sel:[0,1] op_sel_hi:[1,1] neg_lo:[1,0] neg_hi:[1,0]
 v_pk_fma_f32 v[200:201], v[200:201], v[72:73], v[76:77]
 v_pk_fma_f32 v[204:205], v[204:205], v[72:73], v[76:77]
 v_pk_fma_f32 v[208:209], v[208:209], v[72:73], v[76:77]
 v_pk_fma_f32 v[212:213], v[212:213], v[72:73], v[76:77]
 v_pk_fma_f32 v[216:217], v[216:217], v[72:73], v[76:77]
 v_pk_fma_f32 v[220:221], v[220:221], v[72:73], v[76:77]
 v_pk_fma_f32 v[224:225], v[224:225], v[72:73], v[76:77]
 v_pk_fma_f32 v[228:229], v[228:229], v[72:73], v[76:77]
 v_cvt_pk_bf16_f32 v64, v200, v204
 v_cvt_pk_bf16_f32 v65, v208, v212
 v_cvt_pk_bf16_f32 v66, v216, v220
 v_cvt_pk_bf16_f32 v67, v224, v228
 ds_write_b128 v16, v[64:67] offset:0
 v_pk_fma_f32 v[202:203], v[202:203], v[74:75], v[78:79]
 v_pk_fma_f32 v[206:207], v[206:207], v[74:75], v[78:79]
 v_pk_fma_f32 v[210:211], v[210:211], v[74:75], v[78:79]
 v_pk_fma_f32 v[214:215], v[214:215], v[74:75], v[78:79]
 v_pk_fma_f32 v[218:219], v[218:219], v[74:75], v[78:79]
 v_pk_fma_f32 v[222:223], v[222:223], v[74:75], v[78:79]
 v_pk_fma_f32 v[226:227], v[226:227], v[74:75], v[78:79]
 v_pk_fma_f32 v[230:231], v[230:231], v[74:75], v[78:79]
 s_mov_b32 s30, 16384
 v_mfma_f32_16x16x4_f32 v[72:75], v9, v20, 0
 v_cvt_pk_bf16_f32 v68, v201, v205
 v_cvt_pk_bf16_f32 v69, v209, v213
 v_cvt_pk_bf16_f32 v70, v217, v221
 v_cvt_pk_bf16_f32 v71, v225, v229
 v_max3_f32 v23, |v201|, |v205|, v23
 v_max3_f32 v23, |v209|, |v213|, v23
 v_mfma_f32_16x16x32_bf16 v[128:131], v[136:139], a[96:99], v[12:15]
 ds_read_b64_tr_b16 v[48:49], v17 offset:0
 ds_read_b64_tr_b16 v[50:51], v17 offset:64
 ds_write_b128 v16, v[68:71] offset:272
 v_mfma_f32_16x16x32_bf16 v[128:131], v[140:143], a[100:103], v[128:131]
 v_max3_f32 v23, |v217|, |v221|, v23
 v_max3_f32 v23, |v225|, |v229|, v23
 v_mfma_f32_16x16x32_bf16 v[80:83], v[68:71], v[64:67], v[80:83]
 v_cvt_pk_bf16_f32 v64, v202, v206
 v_mfma_f32_16x16x32_bf16 v[128:131], v[144:147], a[104:107], v[128:131]
 v_cvt_pk_bf16_f32 v65, v210, v214
 v_cvt_pk_bf16_f32 v66, v218, v222
 v_cvt_pk_bf16_f32 v67, v226, v230
 v_mfma_f32_16x16x32_bf16 v[128:131], v[148:151], a[108:111], v[128:131]
 s_waitcnt lgkmcnt(1)
 buffer_store_dwordx4 v[48:51], v18, s[16:19], s30 offen offset:0 sc0 sc1
 ds_read_b64_tr_b16 v[52:53], v17 offset:272
 ds_read_b64_tr_b16 v[54:55], v17 offset:336
 v_mfma_f32_16x16x32_bf16 v[84:87], v[164:167], a[108:111], v[12:15]
 ds_write_b128 v16, v[64:67] offset:544
 v_mfma_f32_16x16x32_bf16 v[84:87], v[160:163], a[104:107], v[84:87]
 v_cvt_pk_bf16_f32 v68, v203, v207
 v_cvt_pk_bf16_f32 v69, v211, v215
 v_cvt_pk_bf16_f32 v70, v219, v223
 v_mfma_f32_16x16x32_bf16 v[84:87], v[156:159], a[100:103], v[84:87]
 v_cvt_pk_bf16_f32 v71, v227, v231
 v_exp_f32 v128, v128
 v_mfma_f32_16x16x32_bf16 v[84:87], v[152:155], a[96:99], v[84:87]
 s_waitcnt lgkmcnt(1)
 buffer_store_dwordx4 v[52:55], v18, s[16:19], s30 offen offset:256 sc0 sc1
 ds_read_b64_tr_b16 v[56:57], v17 offset:544
 ds_read_b64_tr_b16 v[58:59], v17 offset:608
 v_mfma_f32_16x16x32_bf16 a[192:195], v[120:123], a[112:115], a[192:195]
 ds_write_b128 v16, v[68:71] offset:816
 v_mfma_f32_16x16x32_bf16 a[192:195], v[124:127], a[116:119], a[192:195]
 v_mfma_f32_16x16x32_bf16 v[80:83], v[68:71], v[64:67], v[80:83]
 v_exp_f32 v129, v129
 v_add_f32 v10, v128, v10
 v_cvt_pk_bf16_f32 v128, v128, v129
 v_mfma_f32_16x16x32_bf16 a[196:199], v[124:127], a[124:127], a[196:199]
 v_exp_f32 v130, v130
 v_add_f32 v10, v129, v10
 v_mfma_f32_16x16x32_bf16 a[196:199], v[120:123], a[120:123], a[196:199]
 s_waitcnt lgkmcnt(1)
 buffer_store_dwordx4 v[56:59], v18, s[16:19], s30 offen offset:512 sc0 sc1
 ds_read_b64_tr_b16 v[60:61], v17 offset:816
 ds_read_b64_tr_b16 v[62:63], v17 offset:880
 v_mfma_f32_16x16x32_bf16 a[200:203], v[120:123], a[128:131], a[200:203]
 v_exp_f32 v131, v131
 v_add_f32 v10, v130, v10
 v_mfma_f32_16x16x32_bf16 a[200:203], v[124:127], a[132:135], a[200:203]
 v_cvt_pk_bf16_f32 v129, v130, v131
 v_add_f32 v10, v131, v10
 v_min3_f32 v21, v21, v72, v73
 v_mfma_f32_16x16x32_bf16 a[204:207], v[124:127], a[140:143], a[204:207]
 v_exp_f32 v84, v84
 v_min3_f32 v21, v21, v74, v75
 v_mfma_f32_16x16x32_bf16 a[204:207], v[120:123], a[136:139], a[204:207]
 v_exp_f32 v85, v85
 v_add_f32 v10, v84, v10
 v_mfma_f32_16x16x32_bf16 v[132:135], v[168:171], a[96:99], v[12:15]
 s_waitcnt lgkmcnt(0)
 buffer_store_dwordx4 v[60:63], v18, s[16:19], s30 offen offset:768 sc0 sc1
 v_cvt_pk_bf16_f32 v130, v84, v85
 v_mfma_f32_16x16x32_bf16 v[132:135], v[172:175], a[100:103], v[132:135]
 v_exp_f32 v86, v86
 v_add_f32 v10, v85, v10
 v_mfma_f32_16x16x32_bf16 v[132:135], v[176:179], a[104:107], v[132:135]
 v_exp_f32 v87, v87
 v_add_f32 v10, v86, v10
 v_mfma_f32_16x16x32_bf16 v[132:135], v[180:183], a[108:111], v[132:135]
 v_cvt_pk_bf16_f32 v131, v86, v87
 v_add_f32 v10, v87, v10
 v_mfma_f32_16x16x32_bf16 v[88:91], v[196:199], a[108:111], v[12:15]
 v_rcp_f32 v72, v72
 v_mfma_f32_16x16x32_bf16 v[88:91], v[192:195], a[104:107], v[88:91]
 v_rcp_f32 v73, v73
 v_rcp_f32 v74, v74
 v_mfma_f32_16x16x32_bf16 v[88:91], v[188:191], a[100:103], v[88:91]
 v_exp_f32 v132, v132
 v_mfma_f32_16x16x32_bf16 v[88:91], v[184:187], a[96:99], v[88:91]
 v_exp_f32 v133, v133
 v_add_f32 v10, v132, v10
 v_cvt_pk_bf16_f32 v132, v132, v133
 v_mfma_f32_16x16x32_bf16 a[208:211], v[120:123], v[24:27], a[208:211]
 v_exp_f32 v134, v134
 v_add_f32 v10, v133, v10
 v_mfma_f32_16x16x32_bf16 a[208:211], v[124:127], v[28:31], a[208:211]
 v_exp_f32 v135, v135
 v_add_f32 v10, v134, v10
 v_mfma_f32_16x16x32_bf16 a[212:215], v[124:127], v[36:39], a[212:215]
 v_cvt_pk_bf16_f32 v133, v134, v135
 v_add_f32 v10, v135, v10
 v_mfma_f32_16x16x32_bf16 a[212:215], v[120:123], v[32:35], a[212:215]
 v_exp_f32 v88, v88
 v_exp_f32 v89, v89
 v_mfma_f32_16x16x32_bf16 a[216:219], v[120:123], v[40:43], a[216:219]
 v_add_f32 v10, v88, v10
 v_cvt_pk_bf16_f32 v134, v88, v89
 v_mfma_f32_16x16x32_bf16 a[216:219], v[124:127], v[44:47], a[216:219]
 v_exp_f32 v90, v90
 v_add_f32 v10, v89, v10
 v_mfma_f32_16x16x32_bf16 a[220:223], v[124:127], a[148:151], a[220:223]
 v_exp_f32 v91, v91
 v_add_f32 v10, v90, v10
 v_cvt_pk_bf16_f32 v135, v90, v91
 v_mfma_f32_16x16x32_bf16 a[220:223], v[120:123], a[144:147], a[220:223]
 v_add_f32 v10, v91, v10
 v_rcp_f32 v75, v75
 v_accvgpr_read_b32 v200, a192
 v_accvgpr_read_b32 v201, a193
 v_accvgpr_read_b32 v202, a194
 v_accvgpr_read_b32 v203, a195
 v_accvgpr_read_b32 v204, a196
 v_accvgpr_read_b32 v205, a197
 v_accvgpr_read_b32 v206, a198
 v_accvgpr_read_b32 v207, a199
 v_accvgpr_read_b32 v208, a200
 v_accvgpr_read_b32 v209, a201
 v_accvgpr_read_b32 v210, a202
 v_accvgpr_read_b32 v211, a203
 v_accvgpr_read_b32 v212, a204
 v_accvgpr_read_b32 v213, a205
 v_accvgpr_read_b32 v214, a206
 v_accvgpr_read_b32 v215, a207
 v_accvgpr_read_b32 v216, a208
 v_accvgpr_read_b32 v217, a209
 v_accvgpr_read_b32 v218, a210
 v_accvgpr_read_b32 v219, a211
 v_accvgpr_read_b32 v220, a212
 v_accvgpr_read_b32 v221, a213
 v_accvgpr_read_b32 v222, a214
 v_accvgpr_read_b32 v223, a215
 v_accvgpr_read_b32 v224, a216
 v_accvgpr_read_b32 v225, a217
 v_accvgpr_read_b32 v226, a218
 v_accvgpr_read_b32 v227, a219
 v_accvgpr_read_b32 v228, a220
 v_accvgpr_read_b32 v229, a221
 v_accvgpr_read_b32 v230, a222
 v_accvgpr_read_b32 v231, a223
 v_pk_mul_f32 v[76:77], v[72:73], s[94:95] op_sel:[0,1] op_sel_hi:[1,1] neg_lo:[1,0] neg_hi:[1,0]
 v_pk_mul_f32 v[78:79], v[74:75], s[94:95] op_sel:[0,1] op_sel_hi:[1,1] neg_lo:[1,0] neg_hi:[1,0]
 v_pk_fma_f32 v[200:201], v[200:201], v[72:73], v[76:77]
 v_pk_fma_f32 v[204:205], v[204:205], v[72:73], v[76:77]
 v_pk_fma_f32 v[208:209], v[208:209], v[72:73], v[76:77]
 v_pk_fma_f32 v[212:213], v[212:213], v[72:73], v[76:77]
 v_pk_fma_f32 v[216:217], v[216:217], v[72:73], v[76:77]
 v_pk_fma_f32 v[220:221], v[220:221], v[72:73], v[76:77]
 v_pk_fma_f32 v[224:225], v[224:225], v[72:73], v[76:77]
 v_pk_fma_f32 v[228:229], v[228:229], v[72:73], v[76:77]
 v_cvt_pk_bf16_f32 v64, v200, v204
 v_cvt_pk_bf16_f32 v65, v208, v212
 v_cvt_pk_bf16_f32 v66, v216, v220
 v_cvt_pk_bf16_f32 v67, v224, v228
 ds_write_b128 v16, v[64:67] offset:0
 v_pk_fma_f32 v[202:203], v[202:203], v[74:75], v[78:79]
 v_pk_fma_f32 v[206:207], v[206:207], v[74:75], v[78:79]
 v_pk_fma_f32 v[210:211], v[210:211], v[74:75], v[78:79]
 v_pk_fma_f32 v[214:215], v[214:215], v[74:75], v[78:79]
 v_pk_fma_f32 v[218:219], v[218:219], v[74:75], v[78:79]
 v_pk_fma_f32 v[222:223], v[222:223], v[74:75], v[78:79]
 v_pk_fma_f32 v[226:227], v[226:227], v[74:75], v[78:79]
 v_pk_fma_f32 v[230:231], v[230:231], v[74:75], v[78:79]
 s_mov_b32 s30, 20480
 v_mfma_f32_16x16x4_f32 v[72:75], v10, v20, 0
 v_cvt_pk_bf16_f32 v68, v201, v205
 v_cvt_pk_bf16_f32 v69, v209, v213
 v_cvt_pk_bf16_f32 v70, v217, v221
 v_cvt_pk_bf16_f32 v71, v225, v229
 v_max3_f32 v23, |v201|, |v205|, v23
 v_max3_f32 v23, |v209|, |v213|, v23
 v_mfma_f32_16x16x32_bf16 a[224:227], v[128:131], a[112:115], a[224:227]
 ds_read_b64_tr_b16 v[48:49], v17 offset:0
 ds_read_b64_tr_b16 v[50:51], v17 offset:64
 ds_write_b128 v16, v[68:71] offset:272
 v_mfma_f32_16x16x32_bf16 a[224:227], v[132:135], a[116:119], a[224:227]
 v_max3_f32 v23, |v217|, |v221|, v23
 v_max3_f32 v23, |v225|, |v229|, v23
 v_mfma_f32_16x16x32_bf16 v[80:83], v[68:71], v[64:67], v[80:83]
 v_cvt_pk_bf16_f32 v64, v202, v206
 v_mfma_f32_16x16x32_bf16 a[228:231], v[132:135], a[124:127], a[228:231]
 v_cvt_pk_bf16_f32 v65, v210, v214
 v_cvt_pk_bf16_f32 v66, v218, v222
 v_cvt_pk_bf16_f32 v67, v226, v230
 v_mfma_f32_16x16x32_bf16 a[228:231], v[128:131], a[120:123], a[228:231]
 s_waitcnt lgkmcnt(1)
 buffer_store_dwordx4 v[48:51], v18, s[16:19], s30 offen offset:0 sc0 sc1
 ds_read_b64_tr_b16 v[52:53], v17 offset:272
 ds_read_b64_tr_b16 v[54:55], v17 offset:336
 v_mfma_f32_16x16x32_bf16 a[232:235], v[128:131], a[128:131], a[232:235]
 ds_write_b128 v16, v[64:67] offset:544
 v_mfma_f32_16x16x32_bf16 a[232:235], v[132:135], a[132:135], a[232:235]
 v_cvt_pk_bf16_f32 v68, v203, v207
 v_cvt_pk_bf16_f32 v69, v211, v215
 v_cvt_pk_bf16_f32 v70, v219, v223
 v_mfma_f32_16x16x32_bf16 a[236:239], v[132:135], a[140:143], a[236:239]
 v_cvt_pk_bf16_f32 v71, v227, v231
 v_min3_f32 v21, v21, v72, v73
 v_min3_f32 v21, v21, v74, v75
 v_mfma_f32_16x16x32_bf16 a[236:239], v[128:131], a[136:139], a[236:239]
 s_waitcnt lgkmcnt(1)
 buffer_store_dwordx4 v[52:55], v18, s[16:19], s30 offen offset:256 sc0 sc1
 ds_read_b64_tr_b16 v[56:57], v17 offset:544
 v_mfma_f32_16x16x32_bf16 a[240:243], v[128:131], v[24:27], a[240:243]
 ds_read_b64_tr_b16 v[58:59], v17 offset:608
 ds_write_b128 v16, v[68:71] offset:816
 v_mfma_f32_16x16x32_bf16 a[240:243], v[132:135], v[28:31], a[240:243]
 v_mfma_f32_16x16x32_bf16 v[80:83], v[68:71], v[64:67], v[80:83]
 v_rcp_f32 v72, v72
 v_mfma_f32_16x16x32_bf16 a[244:247], v[132:135], v[36:39], a[244:247]
 v_rcp_f32 v73, v73
 v_mfma_f32_16x16x32_bf16 a[244:247], v[128:131], v[32:35], a[244:247]
 v_rcp_f32 v74, v74
 v_mfma_f32_16x16x32_bf16 a[248:251], v[128:131], v[40:43], a[248:251]
 s_waitcnt lgkmcnt(1)
 buffer_store_dwordx4 v[56:59], v18, s[16:19], s30 offen offset:512 sc0 sc1
 ds_read_b64_tr_b16 v[60:61], v17 offset:816
 v_mfma_f32_16x16x32_bf16 a[248:251], v[132:135], v[44:47], a[248:251]
 ds_read_b64_tr_b16 v[62:63], v17 offset:880
 v_mfma_f32_16x16x32_bf16 a[252:255], v[132:135], a[148:151], a[252:255]
 v_rcp_f32 v75, v75
 v_mfma_f32_16x16x32_bf16 a[252:255], v[128:131], a[144:147], a[252:255]
 s_waitcnt lgkmcnt(0)
 buffer_store_dwordx4 v[60:63], v18, s[16:19], s30 offen offset:768 sc0 sc1
 v_accvgpr_read_b32 v200, a224
 v_accvgpr_read_b32 v201, a225
 v_accvgpr_read_b32 v202, a226
 v_accvgpr_read_b32 v203, a227
 v_accvgpr_read_b32 v204, a228
 v_accvgpr_read_b32 v205, a229
 v_accvgpr_read_b32 v206, a230
 v_accvgpr_read_b32 v207, a231
 v_accvgpr_read_b32 v208, a232
 v_accvgpr_read_b32 v209, a233
 v_accvgpr_read_b32 v210, a234
 v_accvgpr_read_b32 v211, a235
 v_accvgpr_read_b32 v212, a236
 v_accvgpr_read_b32 v213, a237
 v_accvgpr_read_b32 v214, a238
 v_accvgpr_read_b32 v215, a239
 v_accvgpr_read_b32 v216, a240
 v_accvgpr_read_b32 v217, a241
 v_accvgpr_read_b32 v218, a242
 v_accvgpr_read_b32 v219, a243
 v_accvgpr_read_b32 v220, a244
 v_accvgpr_read_b32 v221, a245
 v_accvgpr_read_b32 v222, a246
 v_accvgpr_read_b32 v223, a247
 v_accvgpr_read_b32 v224, a248
 v_accvgpr_read_b32 v225, a249
 v_accvgpr_read_b32 v226, a250
 v_accvgpr_read_b32 v227, a251
 v_accvgpr_read_b32 v228, a252
 v_accvgpr_read_b32 v229, a253
 v_accvgpr_read_b32 v230, a254
 v_accvgpr_read_b32 v231, a255
 v_pk_mul_f32 v[76:77], v[72:73], s[94:95] op_sel:[0,1] op_sel_hi:[1,1] neg_lo:[1,0] neg_hi:[1,0]
 v_pk_mul_f32 v[78:79], v[74:75], s[94:95] op_sel:[0,1] op_sel_hi:[1,1] neg_lo:[1,0] neg_hi:[1,0]
 v_pk_fma_f32 v[200:201], v[200:201], v[72:73], v[76:77]
 v_pk_fma_f32 v[204:205], v[204:205], v[72:73], v[76:77]
 v_pk_fma_f32 v[208:209], v[208:209], v[72:73], v[76:77]
 v_pk_fma_f32 v[212:213], v[212:213], v[72:73], v[76:77]
 v_pk_fma_f32 v[216:217], v[216:217], v[72:73], v[76:77]
 v_pk_fma_f32 v[220:221], v[220:221], v[72:73], v[76:77]
 v_pk_fma_f32 v[224:225], v[224:225], v[72:73], v[76:77]
 v_pk_fma_f32 v[228:229], v[228:229], v[72:73], v[76:77]
 v_cvt_pk_bf16_f32 v64, v200, v204
 v_cvt_pk_bf16_f32 v65, v208, v212
 v_cvt_pk_bf16_f32 v66, v216, v220
 v_cvt_pk_bf16_f32 v67, v224, v228
 ds_write_b128 v16, v[64:67] offset:0
 v_pk_fma_f32 v[202:203], v[202:203], v[74:75], v[78:79]
 v_pk_fma_f32 v[206:207], v[206:207], v[74:75], v[78:79]
 v_pk_fma_f32 v[210:211], v[210:211], v[74:75], v[78:79]
 v_pk_fma_f32 v[214:215], v[214:215], v[74:75], v[78:79]
 v_pk_fma_f32 v[218:219], v[218:219], v[74:75], v[78:79]
 v_pk_fma_f32 v[222:223], v[222:223], v[74:75], v[78:79]
 v_pk_fma_f32 v[226:227], v[226:227], v[74:75], v[78:79]
 v_pk_fma_f32 v[230:231], v[230:231], v[74:75], v[78:79]
 s_mov_b32 s30, 24576
 v_cvt_pk_bf16_f32 v68, v201, v205
 v_cvt_pk_bf16_f32 v69, v209, v213
 v_cvt_pk_bf16_f32 v70, v217, v221
 v_cvt_pk_bf16_f32 v71, v225, v229
 v_max3_f32 v23, |v201|, |v205|, v23
 v_max3_f32 v23, |v209|, |v213|, v23
 v_max3_f32 v23, |v217|, |v221|, v23
 v_max3_f32 v23, |v225|, |v229|, v23
 ds_read_b64_tr_b16 v[48:49], v17 offset:0
 ds_read_b64_tr_b16 v[50:51], v17 offset:64
 ds_write_b128 v16, v[68:71] offset:272
 v_mfma_f32_16x16x32_bf16 v[80:83], v[68:71], v[64:67], v[80:83]
 v_cvt_pk_bf16_f32 v64, v202, v206
 v_cvt_pk_bf16_f32 v65, v210, v214
 v_cvt_pk_bf16_f32 v66, v218, v222
 v_cvt_pk_bf16_f32 v67, v226, v230
 v_cvt_pk_bf16_f32 v68, v203, v207
 v_cvt_pk_bf16_f32 v69, v211, v215
 v_cvt_pk_bf16_f32 v70, v219, v223
 v_cvt_pk_bf16_f32 v71, v227, v231
 s_waitcnt lgkmcnt(1)
 buffer_store_dwordx4 v[48:51], v18, s[16:19], s30 offen offset:0 sc0 sc1
 ds_read_b64_tr_b16 v[52:53], v17 offset:272
 v_mfma_f32_16x16x32_bf16 v[80:83], v[68:71], v[64:67], v[80:83]
 ds_read_b64_tr_b16 v[54:55], v17 offset:336
 ds_write_b128 v16, v[64:67] offset:544
 s_waitcnt lgkmcnt(1)
 buffer_store_dwordx4 v[52:55], v18, s[16:19], s30 offen offset:256 sc0 sc1
 ds_read_b64_tr_b16 v[56:57], v17 offset:544
 ds_read_b64_tr_b16 v[58:59], v17 offset:608
 s_waitcnt lgkmcnt(0)
 buffer_store_dwordx4 v[56:59], v18, s[16:19], s30 offen offset:512 sc0 sc1
 ds_write_b128 v16, v[68:71] offset:816
 ds_read_b64_tr_b16 v[60:61], v17 offset:816
 ds_read_b64_tr_b16 v[62:63], v17 offset:880
 s_waitcnt lgkmcnt(0)
 buffer_store_dwordx4 v[60:63], v18, s[16:19], s30 offen offset:768 sc0 sc1
 v_max3_f32 v22, v4, v5, v6
 v_max3_f32 v22, v22, v7, v8
 v_max3_f32 v22, v22, v9, v10
 v_cmp_nlt_f32 vcc, s88, v21
 v_cmp_ngt_f32 s[32:33], s89, v22
 s_nop 3
 s_or_b64 s[32:33], s[32:33], vcc
 v_mul_f32 v23, 0x44000000, v23
 v_mul_f32 v23, v23, v21
 v_cmp_gt_f32 vcc, s95, v23
 s_nop 3
 s_or_b64 s[32:33], s[32:33], vcc
 v_mov_b32 v30, 0x207
 v_add_f32 v80, v80, v81
 v_add_f32 v82, v82, v83
 v_add_f32 v80, v80, v82
 v_cmp_class_f32 vcc, v80, v30
 s_nop 3
 s_or_b64 s[32:33], s[32:33], vcc
 s_or_b32 s32, s32, s33
 s_lshl_b32 s30, s24, 2
 s_add_u32 s30, s30, 148480
 v_mov_b32 v28, s30
 v_mov_b32 v29, s32
 v_mov_b32 v30, 148480
 ds_write_b32 v28, v29
 s_waitcnt lgkmcnt(0)
 s_barrier
 ds_read_b128 v[32:35], v30
 s_waitcnt lgkmcnt(0)
 v_or3_b32 v32, v32, v33, v34
 v_or_b32 v32, v32, v35
 s_nop 0
 v_readfirstlane_b32 s30, v32
 s_nop 3
 s_cmp_eq_u32 s30, 0
 s_cbranch_scc1 L_end_7
 s_branch L_slow_7
L_end_7:
 s_endpgm
L_w6:
 s_waitcnt lgkmcnt(3)
 v_mfma_f32_16x16x32_bf16 v[248:251], a[114:117], v[136:139], 0
 v_exp_f32 v223, v223
 v_mfma_f32_16x16x32_bf16 v[248:251], a[118:121], v[136:139], v[248:251]
 v_cvt_pk_bf16_f32 v88, v220, v221
 v_mov_b32 v4, v244
 v_mfma_f32_16x16x32_bf16 v[252:255], a[112:115], v[136:139], 0
 v_cvt_pk_bf16_f32 v89, v222, v223
 v_mfma_f32_16x16x32_bf16 v[252:255], a[116:119], v[136:139], v[252:255]
 s_waitcnt lgkmcnt(2)
 v_exp_f32 v224, v224
 v_mfma_f32_16x16x32_bf16 v[16:19], a[114:117], v[140:143], 0
 v_exp_f32 v225, v225
 v_mfma_f32_16x16x32_bf16 v[16:19], a[118:121], v[140:143], v[16:19]
 v_cvt_pk_bf16_f32 v192, v248, v249
 v_cvt_pk_bf16_f32 v193, v250, v251
 v_mfma_f32_16x16x32_bf16 v[20:23], a[112:115], v[140:143], 0
 v_accvgpr_write_b32 a32, v192
 v_accvgpr_write_b32 a33, v193
 v_mfma_f32_16x16x32_bf16 v[20:23], a[116:119], v[140:143], v[20:23]
 s_waitcnt lgkmcnt(0)
 v_cvt_pk_bf16_f32 v194, v252, v253
 v_cvt_pk_bf16_f32 v195, v254, v255
 v_mfma_f32_16x16x32_bf16 v[248:251], a[114:117], v[144:147], 0
 v_accvgpr_write_b32 a34, v194
 v_accvgpr_write_b32 a35, v195
 v_mfma_f32_16x16x32_bf16 v[248:251], a[118:121], v[144:147], v[248:251]
 v_cvt_pk_bf16_f32 v192, v16, v17
 v_cvt_pk_bf16_f32 v193, v18, v19
 v_mfma_f32_16x16x32_bf16 v[252:255], a[112:115], v[144:147], 0
 v_accvgpr_write_b32 a36, v192
 v_accvgpr_write_b32 a37, v193
 v_mfma_f32_16x16x32_bf16 v[252:255], a[116:119], v[144:147], v[252:255]
 v_cvt_pk_bf16_f32 v194, v20, v21
 v_cvt_pk_bf16_f32 v195, v22, v23
 v_mfma_f32_16x16x32_bf16 v[16:19], a[114:117], v[148:151], 0
 v_accvgpr_write_b32 a38, v194
 v_accvgpr_write_b32 a39, v195
 v_mfma_f32_16x16x32_bf16 v[16:19], a[118:121], v[148:151], v[16:19]
 v_cvt_pk_bf16_f32 v192, v248, v249
 v_cvt_pk_bf16_f32 v193, v250, v251
 v_mfma_f32_16x16x32_bf16 v[20:23], a[112:115], v[148:151], 0
 v_accvgpr_write_b32 a40, v192
 v_accvgpr_write_b32 a41, v193
 v_mfma_f32_16x16x32_bf16 v[20:23], a[116:119], v[148:151], v[20:23]
 v_cvt_pk_bf16_f32 v194, v252, v253
 v_cvt_pk_bf16_f32 v195, v254, v255
 v_mfma_f32_16x16x32_bf16 v[168:171], a[152:155], a[32:35], v[12:15]
 v_accvgpr_write_b32 a42, v194
 v_accvgpr_write_b32 a43, v195
 v_mfma_f32_16x16x32_bf16 v[168:171], a[156:159], a[36:39], v[168:171]
 v_cvt_pk_bf16_f32 v192, v16, v17
 v_cvt_pk_bf16_f32 v193, v18, v19
 v_mfma_f32_16x16x32_bf16 v[172:175], a[168:171], a[32:35], v[12:15]
 v_accvgpr_write_b32 a44, v192
 v_accvgpr_write_b32 a45, v193
 v_mfma_f32_16x16x32_bf16 v[172:175], a[172:175], a[36:39], v[172:175]
 v_cvt_pk_bf16_f32 v194, v20, v21
 v_cvt_pk_bf16_f32 v195, v22, v23
 v_mfma_f32_16x16x32_bf16 v[168:171], a[160:163], a[40:43], v[168:171]
 v_accvgpr_write_b32 a46, v194
 v_accvgpr_write_b32 a47, v195
 v_mfma_f32_16x16x32_bf16 v[172:175], a[176:179], a[40:43], v[172:175]
 v_exp_f32 v226, v226
 v_mfma_f32_16x16x32_bf16 v[168:171], a[164:167], a[44:47], v[168:171]
 v_exp_f32 v227, v227
 v_mfma_f32_16x16x32_bf16 v[172:175], a[180:183], a[44:47], v[172:175]
 v_cvt_pk_bf16_f32 v90, v224, v225
 v_cvt_pk_bf16_f32 v91, v226, v227
 v_mfma_f32_16x16x32_bf16 v[176:179], a[184:187], a[32:35], v[12:15]
 s_nop 0
 v_mfma_f32_16x16x32_bf16 v[176:179], a[188:191], a[36:39], v[176:179]
 s_nop 0
 v_exp_f32 v168, v168
 v_mfma_f32_16x16x32_bf16 v[176:179], a[192:195], a[40:43], v[176:179]
 v_exp_f32 v169, v169
 v_mfma_f32_16x16x32_bf16 v[176:179], a[196:199], a[44:47], v[176:179]
 v_exp_f32 v170, v170
 v_mfma_f32_16x16x32_bf16 v[180:183], a[200:203], a[32:35], v[12:15]
 v_exp_f32 v171, v171
 v_mfma_f32_16x16x32_bf16 v[180:183], a[204:207], a[36:39], v[180:183]
 v_cvt_pk_bf16_f32 v40, v168, v169
 v_cvt_pk_bf16_f32 v41, v170, v171
 v_mfma_f32_16x16x32_bf16 v[180:183], a[208:211], a[40:43], v[180:183]
 v_exp_f32 v172, v172
 v_mfma_f32_16x16x32_bf16 v[180:183], a[212:215], a[44:47], v[180:183]
 v_exp_f32 v173, v173
 v_mfma_f32_16x16x32_bf16 v[184:187], a[216:219], a[32:35], v[12:15]
 v_exp_f32 v174, v174
 v_mfma_f32_16x16x32_bf16 v[184:187], a[224:227], a[36:39], v[184:187]
 v_exp_f32 v175, v175
 v_mfma_f32_16x16x32_bf16 v[184:187], a[228:231], a[40:43], v[184:187]
 v_cvt_pk_bf16_f32 v42, v172, v173
 v_cvt_pk_bf16_f32 v43, v174, v175
 v_mfma_f32_16x16x32_bf16 v[184:187], a[232:235], a[44:47], v[184:187]
 v_exp_f32 v176, v176
 v_mfma_f32_16x16x32_bf16 v[188:191], a[236:239], a[32:35], v[12:15]
 v_exp_f32 v177, v177
 v_mfma_f32_16x16x32_bf16 v[188:191], a[240:243], a[36:39], v[188:191]
 v_exp_f32 v178, v178
 v_mfma_f32_16x16x32_bf16 v[188:191], a[244:247], a[40:43], v[188:191]
 v_exp_f32 v179, v179
 v_mfma_f32_16x16x32_bf16 v[188:191], a[248:251], a[44:47], v[188:191]
 v_cvt_pk_bf16_f32 v44, v176, v177
 v_cvt_pk_bf16_f32 v45, v178, v179
 v_mfma_f32_16x16x32_bf16 v[244:247], v[240:243], v[32:35], 0
 v_exp_f32 v180, v180
 v_mfma_f32_16x16x32_bf16 v[244:247], v[240:243], v[36:39], v[244:247]
 v_exp_f32 v181, v181
 v_mfma_f32_16x16x32_bf16 v[244:247], v[240:243], v[88:91], v[244:247]
 v_exp_f32 v182, v182
 v_exp_f32 v183, v183
 v_cvt_pk_bf16_f32 v46, v180, v181
 v_cvt_pk_bf16_f32 v47, v182, v183
 v_exp_f32 v184, v184
 v_exp_f32 v185, v185
 v_exp_f32 v186, v186
 s_waitcnt vmcnt(8)
 ds_read_b128 v[152:155], v11 offset:12288
 ds_read_b128 v[156:159], v11 offset:12800
 ds_read_b128 v[160:163], v11 offset:13312
 ds_read_b128 v[164:167], v11 offset:13824
 s_add_u32 m0, s28, 65536
 s_add_u32 s36, s28, 0
 buffer_load_dwordx4 v3, s[12:15], s36 offen offset:0 nt lds
 s_add_u32 m0, s28, 66432
 s_nop 0
 buffer_load_dwordx4 v3, s[12:15], s36 offen offset:128 nt lds
 s_add_u32 m0, s28, 24576
 s_add_u32 s36, s28, 24576
 buffer_load_dwordx4 v3, s[8:11], s36 offen offset:0 nt lds
 s_add_u32 m0, s28, 25472
 s_nop 0
 buffer_load_dwordx4 v3, s[8:11], s36 offen offset:128 nt lds
 s_waitcnt lgkmcnt(3)
 v_mfma_f32_16x16x32_bf16 v[248:251], a[114:117], v[152:155], 0
 v_exp_f32 v187, v187
 v_mfma_f32_16x16x32_bf16 v[248:251], a[118:121], v[152:155], v[248:251]
 v_cvt_pk_bf16_f32 v96, v184, v185
 v_mov_b32 v5, v244
 v_mfma_f32_16x16x32_bf16 v[252:255], a[112:115], v[152:155], 0
 v_cvt_pk_bf16_f32 v97, v186, v187
 v_mfma_f32_16x16x32_bf16 v[252:255], a[116:119], v[152:155], v[252:255]
 s_waitcnt lgkmcnt(2)
 v_exp_f32 v188, v188
 v_mfma_f32_16x16x32_bf16 v[16:19], a[114:117], v[156:159], 0
 v_exp_f32 v189, v189
 v_mfma_f32_16x16x32_bf16 v[16:19], a[118:121], v[156:159], v[16:19]
 v_cvt_pk_bf16_f32 v192, v248, v249
 v_cvt_pk_bf16_f32 v193, v250, v251
 v_mfma_f32_16x16x32_bf16 v[20:23], a[112:115], v[156:159], 0
 v_accvgpr_write_b32 a48, v192
 v_accvgpr_write_b32 a49, v193
 v_mfma_f32_16x16x32_bf16 v[20:23], a[116:119], v[156:159], v[20:23]
 s_waitcnt lgkmcnt(0)
 v_cvt_pk_bf16_f32 v194, v252, v253
 v_cvt_pk_bf16_f32 v195, v254, v255
 v_mfma_f32_16x16x32_bf16 v[248:251], a[114:117], v[160:163], 0
 v_accvgpr_write_b32 a50, v194
 v_accvgpr_write_b32 a51, v195
 v_mfma_f32_16x16x32_bf16 v[248:251], a[118:121], v[160:163], v[248:251]
 v_cvt_pk_bf16_f32 v192, v16, v17
 v_cvt_pk_bf16_f32 v193, v18, v19
 v_mfma_f32_16x16x32_bf16 v[252:255], a[112:115], v[160:163], 0
 v_accvgpr_write_b32 a52, v192
 v_accvgpr_write_b32 a53, v193
 v_mfma_f32_16x16x32_bf16 v[252:255], a[116:119], v[160:163], v[252:255]
 v_cvt_pk_bf16_f32 v194, v20, v21
 v_cvt_pk_bf16_f32 v195, v22, v23
 v_mfma_f32_16x16x32_bf16 v[16:19], a[114:117], v[164:167], 0
 v_accvgpr_write_b32 a54, v194
 v_accvgpr_write_b32 a55, v195
 v_mfma_f32_16x16x32_bf16 v[16:19], a[118:121], v[164:167], v[16:19]
 v_cvt_pk_bf16_f32 v192, v248, v249
 v_cvt_pk_bf16_f32 v193, v250, v251
 v_mfma_f32_16x16x32_bf16 v[20:23], a[112:115], v[164:167], 0
 v_accvgpr_write_b32 a56, v192
 v_accvgpr_write_b32 a57, v193
 v_mfma_f32_16x16x32_bf16 v[20:23], a[116:119], v[164:167], v[20:23]
 v_cvt_pk_bf16_f32 v194, v252, v253
 v_cvt_pk_bf16_f32 v195, v254, v255
 v_mfma_f32_16x16x32_bf16 v[204:207], a[152:155], a[48:51], v[12:15]
 v_accvgpr_write_b32 a58, v194
 v_accvgpr_write_b32 a59, v195
 v_mfma_f32_16x16x32_bf16 v[204:207], a[156:159], a[52:55], v[204:207]
 v_cvt_pk_bf16_f32 v192, v16, v17
 v_cvt_pk_bf16_f32 v193, v18, v19
 v_mfma_f32_16x16x32_bf16 v[208:211], a[168:171], a[48:51], v[12:15]
 v_accvgpr_write_b32 a60, v192
 v_accvgpr_write_b32 a61, v193
 v_mfma_f32_16x16x32_bf16 v[208:211], a[172:175], a[52:55], v[208:211]
 v_cvt_pk_bf16_f32 v194, v20, v21
 v_cvt_pk_bf16_f32 v195, v22, v23
 v_mfma_f32_16x16x32_bf16 v[204:207], a[160:163], a[56:59], v[204:207]
 v_accvgpr_write_b32 a62, v194
 v_accvgpr_write_b32 a63, v195
 v_mfma_f32_16x16x32_bf16 v[208:211], a[176:179], a[56:59], v[208:211]
 v_exp_f32 v190, v190
 v_mfma_f32_16x16x32_bf16 v[204:207], a[164:167], a[60:63], v[204:207]
 v_exp_f32 v191, v191
 v_mfma_f32_16x16x32_bf16 v[208:211], a[180:183], a[60:63], v[208:211]
 v_cvt_pk_bf16_f32 v98, v188, v189
 v_cvt_pk_bf16_f32 v99, v190, v191
 v_mfma_f32_16x16x32_bf16 v[212:215], a[184:187], a[48:51], v[12:15]
 s_nop 0
 v_mfma_f32_16x16x32_bf16 v[212:215], a[188:191], a[52:55], v[212:215]
 s_nop 0
 v_exp_f32 v204, v204
 v_mfma_f32_16x16x32_bf16 v[212:215], a[192:195], a[56:59], v[212:215]
 v_exp_f32 v205, v205
 v_mfma_f32_16x16x32_bf16 v[212:215], a[196:199], a[60:63], v[212:215]
 v_exp_f32 v206, v206
 v_mfma_f32_16x16x32_bf16 v[216:219], a[200:203], a[48:51], v[12:15]
 v_exp_f32 v207, v207
 v_mfma_f32_16x16x32_bf16 v[216:219], a[204:207], a[52:55], v[216:219]
 v_cvt_pk_bf16_f32 v48, v204, v205
 v_cvt_pk_bf16_f32 v49, v206, v207
 v_mfma_f32_16x16x32_bf16 v[216:219], a[208:211], a[56:59], v[216:219]
 v_exp_f32 v208, v208
 v_mfma_f32_16x16x32_bf16 v[216:219], a[212:215], a[60:63], v[216:219]
 v_exp_f32 v209, v209
 v_mfma_f32_16x16x32_bf16 v[220:223], a[216:219], a[48:51], v[12:15]
 v_exp_f32 v210, v210
 v_mfma_f32_16x16x32_bf16 v[220:223], a[224:227], a[52:55], v[220:223]
 v_exp_f32 v211, v211
 v_mfma_f32_16x16x32_bf16 v[220:223], a[228:231], a[56:59], v[220:223]
 v_cvt_pk_bf16_f32 v50, v208, v209
 v_cvt_pk_bf16_f32 v51, v210, v211
 v_mfma_f32_16x16x32_bf16 v[220:223], a[232:235], a[60:63], v[220:223]
 v_exp_f32 v212, v212
 v_mfma_f32_16x16x32_bf16 v[224:227], a[236:239], a[48:51], v[12:15]
 v_exp_f32 v213, v213
 v_mfma_f32_16x16x32_bf16 v[224:227], a[240:243], a[52:55], v[224:227]
 v_exp_f32 v214, v214
 v_mfma_f32_16x16x32_bf16 v[224:227], a[244:247], a[56:59], v[224:227]
 v_exp_f32 v215, v215
 v_mfma_f32_16x16x32_bf16 v[224:227], a[248:251], a[60:63], v[224:227]
 v_cvt_pk_bf16_f32 v52, v212, v213
 v_cvt_pk_bf16_f32 v53, v214, v215
 v_mfma_f32_16x16x32_bf16 v[244:247], v[240:243], v[40:43], 0
 v_exp_f32 v216, v216
 v_mfma_f32_16x16x32_bf16 v[244:247], v[240:243], v[44:47], v[244:247]
 v_exp_f32 v217, v217
 v_mfma_f32_16x16x32_bf16 v[244:247], v[240:243], v[96:99], v[244:247]
 v_exp_f32 v218, v218
 v_exp_f32 v219, v219
 v_cvt_pk_bf16_f32 v54, v216, v217
 v_cvt_pk_bf16_f32 v55, v218, v219
 v_exp_f32 v220, v220
 v_exp_f32 v221, v221
 v_exp_f32 v222, v222
 s_waitcnt vmcnt(8)
 ds_read_b128 v[136:139], v11 offset:0
 ds_read_b128 v[140:143], v11 offset:512
 ds_read_b128 v[144:147], v11 offset:1024
 ds_read_b128 v[148:151], v11 offset:1536
 s_add_u32 m0, s28, 73728
 s_add_u32 s36, s28, 8192
 buffer_load_dwordx4 v3, s[12:15], s36 offen offset:0 nt lds
 s_add_u32 m0, s28, 74624
 s_nop 0
 buffer_load_dwordx4 v3, s[12:15], s36 offen offset:128 nt lds
 s_add_u32 m0, s28, 32768
 s_add_u32 s36, s28, 32768
 buffer_load_dwordx4 v3, s[8:11], s36 offen offset:0 nt lds
 s_add_u32 m0, s28, 33664
 s_nop 0
 buffer_load_dwordx4 v3, s[8:11], s36 offen offset:128 nt lds
 s_waitcnt lgkmcnt(3)
 v_mfma_f32_16x16x32_bf16 v[248:251], a[114:117], v[136:139], 0
 v_exp_f32 v223, v223
 v_mfma_f32_16x16x32_bf16 v[248:251], a[118:121], v[136:139], v[248:251]
 v_cvt_pk_bf16_f32 v104, v220, v221
 v_mov_b32 v6, v244
 v_mfma_f32_16x16x32_bf16 v[252:255], a[112:115], v[136:139], 0
 v_cvt_pk_bf16_f32 v105, v222, v223
 v_mfma_f32_16x16x32_bf16 v[252:255], a[116:119], v[136:139], v[252:255]
 s_waitcnt lgkmcnt(2)
 v_exp_f32 v224, v224
 v_mfma_f32_16x16x32_bf16 v[16:19], a[114:117], v[140:143], 0
 v_exp_f32 v225, v225
 v_mfma_f32_16x16x32_bf16 v[16:19], a[118:121], v[140:143], v[16:19]
 v_cvt_pk_bf16_f32 v192, v248, v249
 v_cvt_pk_bf16_f32 v193, v250, v251
 v_mfma_f32_16x16x32_bf16 v[20:23], a[112:115], v[140:143], 0
 v_accvgpr_write_b32 a64, v192
 v_accvgpr_write_b32 a65, v193
 v_mfma_f32_16x16x32_bf16 v[20:23], a[116:119], v[140:143], v[20:23]
 s_waitcnt lgkmcnt(0)
 v_cvt_pk_bf16_f32 v194, v252, v253
 v_cvt_pk_bf16_f32 v195, v254, v255
 v_mfma_f32_16x16x32_bf16 v[248:251], a[114:117], v[144:147], 0
 v_accvgpr_write_b32 a66, v194
 v_accvgpr_write_b32 a67, v195
 v_mfma_f32_16x16x32_bf16 v[248:251], a[118:121], v[144:147], v[248:251]
 v_cvt_pk_bf16_f32 v192, v16, v17
 v_cvt_pk_bf16_f32 v193, v18, v19
 v_mfma_f32_16x16x32_bf16 v[252:255], a[112:115], v[144:147], 0
 v_accvgpr_write_b32 a68, v192
 v_accvgpr_write_b32 a69, v193
 v_mfma_f32_16x16x32_bf16 v[252:255], a[116:119], v[144:147], v[252:255]
 v_cvt_pk_bf16_f32 v194, v20, v21
 v_cvt_pk_bf16_f32 v195, v22, v23
 v_mfma_f32_16x16x32_bf16 v[16:19], a[114:117], v[148:151], 0
 v_accvgpr_write_b32 a70, v194
 v_accvgpr_write_b32 a71, v195
 v_mfma_f32_16x16x32_bf16 v[16:19], a[118:121], v[148:151], v[16:19]
 v_cvt_pk_bf16_f32 v192, v248, v249
 v_cvt_pk_bf16_f32 v193, v250, v251
 v_mfma_f32_16x16x32_bf16 v[20:23], a[112:115], v[148:151], 0
 v_accvgpr_write_b32 a72, v192
 v_accvgpr_write_b32 a73, v193
 v_mfma_f32_16x16x32_bf16 v[20:23], a[116:119], v[148:151], v[20:23]
 v_cvt_pk_bf16_f32 v194, v252, v253
 v_cvt_pk_bf16_f32 v195, v254, v255
 v_mfma_f32_16x16x32_bf16 v[168:171], a[152:155], a[64:67], v[12:15]
 v_accvgpr_write_b32 a74, v194
 v_accvgpr_write_b32 a75, v195
 v_mfma_f32_16x16x32_bf16 v[168:171], a[156:159], a[68:71], v[168:171]
 v_cvt_pk_bf16_f32 v192, v16, v17
 v_cvt_pk_bf16_f32 v193, v18, v19
 v_mfma_f32_16x16x32_bf16 v[172:175], a[168:171], a[64:67], v[12:15]
 v_accvgpr_write_b32 a76, v192
 v_accvgpr_write_b32 a77, v193
 v_mfma_f32_16x16x32_bf16 v[172:175], a[172:175], a[68:71], v[172:175]
 v_cvt_pk_bf16_f32 v194, v20, v21
 v_cvt_pk_bf16_f32 v195, v22, v23
 v_mfma_f32_16x16x32_bf16 v[168:171], a[160:163], a[72:75], v[168:171]
 v_accvgpr_write_b32 a78, v194
 v_accvgpr_write_b32 a79, v195
 v_mfma_f32_16x16x32_bf16 v[172:175], a[176:179], a[72:75], v[172:175]
 v_exp_f32 v226, v226
 v_mfma_f32_16x16x32_bf16 v[168:171], a[164:167], a[76:79], v[168:171]
 v_exp_f32 v227, v227
 v_mfma_f32_16x16x32_bf16 v[172:175], a[180:183], a[76:79], v[172:175]
 v_cvt_pk_bf16_f32 v106, v224, v225
 v_cvt_pk_bf16_f32 v107, v226, v227
 v_mfma_f32_16x16x32_bf16 v[176:179], a[184:187], a[64:67], v[12:15]
 s_nop 0
 v_mfma_f32_16x16x32_bf16 v[176:179], a[188:191], a[68:71], v[176:179]
 s_nop 0
 v_exp_f32 v168, v168
 v_mfma_f32_16x16x32_bf16 v[176:179], a[192:195], a[72:75], v[176:179]
 v_exp_f32 v169, v169
 v_mfma_f32_16x16x32_bf16 v[176:179], a[196:199], a[76:79], v[176:179]
 v_exp_f32 v170, v170
 v_mfma_f32_16x16x32_bf16 v[180:183], a[200:203], a[64:67], v[12:15]
 v_exp_f32 v171, v171
 v_mfma_f32_16x16x32_bf16 v[180:183], a[204:207], a[68:71], v[180:183]
 v_cvt_pk_bf16_f32 v56, v168, v169
 v_cvt_pk_bf16_f32 v57, v170, v171
 v_mfma_f32_16x16x32_bf16 v[180:183], a[208:211], a[72:75], v[180:183]
 v_exp_f32 v172, v172
 v_mfma_f32_16x16x32_bf16 v[180:183], a[212:215], a[76:79], v[180:183]
 v_exp_f32 v173, v173
 v_mfma_f32_16x16x32_bf16 v[184:187], a[216:219], a[64:67], v[12:15]
 v_exp_f32 v174, v174
 v_mfma_f32_16x16x32_bf16 v[184:187], a[224:227], a[68:71], v[184:187]
 v_exp_f32 v175, v175
 v_mfma_f32_16x16x32_bf16 v[184:187], a[228:231], a[72:75], v[184:187]
 v_cvt_pk_bf16_f32 v58, v172, v173
 v_cvt_pk_bf16_f32 v59, v174, v175
 v_mfma_f32_16x16x32_bf16 v[184:187], a[232:235], a[76:79], v[184:187]
 v_exp_f32 v176, v176
 v_mfma_f32_16x16x32_bf16 v[188:191], a[236:239], a[64:67], v[12:15]
 v_exp_f32 v177, v177
 v_mfma_f32_16x16x32_bf16 v[188:191], a[240:243], a[68:71], v[188:191]
 v_exp_f32 v178, v178
 v_mfma_f32_16x16x32_bf16 v[188:191], a[244:247], a[72:75], v[188:191]
 v_exp_f32 v179, v179
 v_mfma_f32_16x16x32_bf16 v[188:191], a[248:251], a[76:79], v[188:191]
 v_cvt_pk_bf16_f32 v60, v176, v177
 v_cvt_pk_bf16_f32 v61, v178, v179
 v_mfma_f32_16x16x32_bf16 v[244:247], v[240:243], v[48:51], 0
 v_exp_f32 v180, v180
 v_mfma_f32_16x16x32_bf16 v[244:247], v[240:243], v[52:55], v[244:247]
 v_exp_f32 v181, v181
 v_mfma_f32_16x16x32_bf16 v[244:247], v[240:243], v[104:107], v[244:247]
 v_exp_f32 v182, v182
 v_exp_f32 v183, v183
 v_cvt_pk_bf16_f32 v62, v180, v181
 v_cvt_pk_bf16_f32 v63, v182, v183
 v_exp_f32 v184, v184
 v_exp_f32 v185, v185
 v_exp_f32 v186, v186
 v_min_f32 v196, v4, v6
 v_min3_f32 v196, v196, v5, v6
 s_nop 1
 v_min_f32_dpp v196, v196, v196 row_ror:8 row_mask:0xf bank_mask:0xf
 s_nop 1
 v_min_f32_dpp v196, v196, v196 row_ror:4 row_mask:0xf bank_mask:0xf
 s_nop 1
 v_min_f32_dpp v196, v196, v196 row_ror:2 row_mask:0xf bank_mask:0xf
 s_nop 1
 v_min_f32_dpp v196, v196, v196 row_ror:1 row_mask:0xf bank_mask:0xf
 v_mul_f32 v198, v198, v196
 v_min_u32 v198, 0x7b000000, v198
 v_readfirstlane_b32 s94, v196
 v_and_b32 v198, 0x7f800000, v198
 v_mul_f32 v228, 0x3fc00000, v198
 v_mul_f32 v229, 0x3fc00000, v198
 v_mul_f32 v230, 0x3fc00000, v198
 v_mul_f32 v231, 0x3fc00000, v198
 v_accvgpr_write_b32 a220, v228
 v_accvgpr_write_b32 a221, v228
 v_accvgpr_write_b32 a222, v228
 v_accvgpr_write_b32 a223, v228
 v_readfirstlane_b32 s95, v228
 s_sub_u32 s94, s94, 0x2000000
 s_max_u32 s88, s88, s94
 s_waitcnt vmcnt(8)
 ds_read_b128 v[152:155], v11 offset:4096
 ds_read_b128 v[156:159], v11 offset:4608
 ds_read_b128 v[160:163], v11 offset:5120
 ds_read_b128 v[164:167], v11 offset:5632
 s_waitcnt lgkmcnt(3)
 v_mfma_f32_16x16x32_bf16 v[248:251], a[114:117], v[152:155], 0
 v_exp_f32 v187, v187
 v_mfma_f32_16x16x32_bf16 v[248:251], a[118:121], v[152:155], v[248:251]
 v_cvt_pk_bf16_f32 v112, v184, v185
 v_mov_b32 v7, v244
 v_mfma_f32_16x16x32_bf16 v[252:255], a[112:115], v[152:155], 0
 v_cvt_pk_bf16_f32 v113, v186, v187
 v_mfma_f32_16x16x32_bf16 v[252:255], a[116:119], v[152:155], v[252:255]
 s_waitcnt lgkmcnt(2)
 v_exp_f32 v188, v188
 v_mfma_f32_16x16x32_bf16 v[16:19], a[114:117], v[156:159], 0
 v_exp_f32 v189, v189
 v_mfma_f32_16x16x32_bf16 v[16:19], a[118:121], v[156:159], v[16:19]
 v_cvt_pk_bf16_f32 v192, v248, v249
 v_cvt_pk_bf16_f32 v193, v250, v251
 v_mfma_f32_16x16x32_bf16 v[20:23], a[112:115], v[156:159], 0
 v_accvgpr_write_b32 a80, v192
 v_accvgpr_write_b32 a81, v193
 v_mfma_f32_16x16x32_bf16 v[20:23], a[116:119], v[156:159], v[20:23]
 s_waitcnt lgkmcnt(0)
 v_cvt_pk_bf16_f32 v194, v252, v253
 v_cvt_pk_bf16_f32 v195, v254, v255
 v_mfma_f32_16x16x32_bf16 v[248:251], a[114:117], v[160:163], 0
 v_accvgpr_write_b32 a82, v194
 v_accvgpr_write_b32 a83, v195
 v_mfma_f32_16x16x32_bf16 v[248:251], a[118:121], v[160:163], v[248:251]
 v_cvt_pk_bf16_f32 v192, v16, v17
 v_cvt_pk_bf16_f32 v193, v18, v19
 v_mfma_f32_16x16x32_bf16 v[252:255], a[112:115], v[160:163], 0
 v_accvgpr_write_b32 a84, v192
 v_accvgpr_write_b32 a85, v193
 v_mfma_f32_16x16x32_bf16 v[252:255], a[116:119], v[160:163], v[252:255]
 v_cvt_pk_bf16_f32 v194, v20, v21
 v_cvt_pk_bf16_f32 v195, v22, v23
 v_mfma_f32_16x16x32_bf16 v[16:19], a[114:117], v[164:167], 0
 v_accvgpr_write_b32 a86, v194
 v_accvgpr_write_b32 a87, v195
 v_mfma_f32_16x16x32_bf16 v[16:19], a[118:121], v[164:167], v[16:19]
 v_cvt_pk_bf16_f32 v192, v248, v249
 v_cvt_pk_bf16_f32 v193, v250, v251
 v_mfma_f32_16x16x32_bf16 v[20:23], a[112:115], v[164:167], 0
 v_accvgpr_write_b32 a88, v192
 v_accvgpr_write_b32 a89, v193
 v_mfma_f32_16x16x32_bf16 v[20:23], a[116:119], v[164:167], v[20:23]
 v_cvt_pk_bf16_f32 v194, v252, v253
 v_cvt_pk_bf16_f32 v195, v254, v255
 v_mfma_f32_16x16x32_bf16 v[204:207], a[152:155], a[80:83], v[12:15]
 v_accvgpr_write_b32 a90, v194
 v_accvgpr_write_b32 a91, v195
 v_mfma_f32_16x16x32_bf16 v[204:207], a[156:159], a[84:87], v[204:207]
 v_cvt_pk_bf16_f32 v192, v16, v17
 v_cvt_pk_bf16_f32 v193, v18, v19
 v_mfma_f32_16x16x32_bf16 v[208:211], a[168:171], a[80:83], v[12:15]
 v_accvgpr_write_b32 a92, v192
 v_accvgpr_write_b32 a93, v193
 v_mfma_f32_16x16x32_bf16 v[208:211], a[172:175], a[84:87], v[208:211]
 v_cvt_pk_bf16_f32 v194, v20, v21
 v_cvt_pk_bf16_f32 v195, v22, v23
 v_mfma_f32_16x16x32_bf16 v[204:207], a[160:163], a[88:91], v[204:207]
 v_accvgpr_write_b32 a94, v194
 v_accvgpr_write_b32 a95, v195
 v_mfma_f32_16x16x32_bf16 v[208:211], a[176:179], a[88:91], v[208:211]
 v_exp_f32 v190, v190
 v_mfma_f32_16x16x32_bf16 v[204:207], a[164:167], a[92:95], v[204:207]
 v_exp_f32 v191, v191
 v_mfma_f32_16x16x32_bf16 v[208:211], a[180:183], a[92:95], v[208:211]
 v_cvt_pk_bf16_f32 v114, v188, v189
 v_cvt_pk_bf16_f32 v115, v190, v191
 v_mfma_f32_16x16x32_bf16 v[84:87], a[184:187], a[80:83], v[12:15]
 s_nop 0
 v_mfma_f32_16x16x32_bf16 v[84:87], a[188:191], a[84:87], v[84:87]
 s_nop 0
 v_exp_f32 v204, v204
 v_mfma_f32_16x16x32_bf16 v[84:87], a[192:195], a[88:91], v[84:87]
 v_exp_f32 v205, v205
 v_mfma_f32_16x16x32_bf16 v[84:87], a[196:199], a[92:95], v[84:87]
 v_exp_f32 v206, v206
 v_mfma_f32_16x16x32_bf16 v[92:95], a[200:203], a[80:83], v[12:15]
 v_exp_f32 v207, v207
 v_mfma_f32_16x16x32_bf16 v[92:95], a[204:207], a[84:87], v[92:95]
 v_cvt_pk_bf16_f32 v64, v204, v205
 v_add_f32 v9, v204, v205
 v_mfma_f32_16x16x32_bf16 v[92:95], a[208:211], a[88:91], v[92:95]
 v_cvt_pk_bf16_f32 v65, v206, v207
 v_add_f32 v9, v206, v9
 v_mfma_f32_16x16x32_bf16 v[92:95], a[212:215], a[92:95], v[92:95]
 s_waitcnt vmcnt(6)
 s_barrier
 ds_read_b64_tr_b16 a[136:137], v1 offset:0
 ds_read_b64_tr_b16 a[138:139], v1 offset:4096
 ds_read_b64_tr_b16 a[140:141], v2 offset:0
 ds_read_b64_tr_b16 a[142:143], v2 offset:4096
 ds_read_b64_tr_b16 a[144:145], v1 offset:512
 ds_read_b64_tr_b16 a[146:147], v1 offset:4608
 v_mfma_f32_16x16x32_bf16 v[100:103], a[216:219], a[80:83], v[12:15]
 v_add_f32 v9, v207, v9
 v_exp_f32 v208, v208
 v_mfma_f32_16x16x32_bf16 v[100:103], a[224:227], a[84:87], v[100:103]
 v_exp_f32 v209, v209
 v_mfma_f32_16x16x32_bf16 v[100:103], a[228:231], a[88:91], v[100:103]
 v_exp_f32 v210, v210
 v_mfma_f32_16x16x32_bf16 v[100:103], a[232:235], a[92:95], v[100:103]
 v_exp_f32 v211, v211
 v_mfma_f32_16x16x32_bf16 v[108:111], a[236:239], a[80:83], v[12:15]
 v_cvt_pk_bf16_f32 v66, v208, v209
 v_add_f32 v9, v208, v9
 v_mfma_f32_16x16x32_bf16 v[108:111], a[240:243], a[84:87], v[108:111]
 v_add_f32 v9, v209, v9
 v_cvt_pk_bf16_f32 v67, v210, v211
 v_mfma_f32_16x16x32_bf16 v[108:111], a[244:247], a[88:91], v[108:111]
 v_add_f32 v9, v210, v9
 v_add_f32 v9, v211, v9
 v_mfma_f32_16x16x32_bf16 v[108:111], a[248:251], a[92:95], v[108:111]
 v_exp_f32 v84, v84
 v_mfma_f32_16x16x32_bf16 v[244:247], v[240:243], v[56:59], 0
 v_exp_f32 v85, v85
 v_mfma_f32_16x16x32_bf16 v[244:247], v[240:243], v[60:63], v[244:247]
 v_exp_f32 v86, v86
 v_mfma_f32_16x16x32_bf16 v[244:247], v[240:243], v[112:115], v[244:247]
 s_waitcnt lgkmcnt(0)
 v_exp_f32 v87, v87
 v_cvt_pk_bf16_f32 v68, v84, v85
 v_add_f32 v9, v84, v9
 v_add_f32 v9, v85, v9
 v_cvt_pk_bf16_f32 v69, v86, v87
 v_add_f32 v9, v86, v9
 v_add_f32 v9, v87, v9
 v_exp_f32 v92, v92
 v_exp_f32 v93, v93
 v_mov_b32 v8, v244
 s_mov_b32 s25, 81920
 s_mov_b32 s26, 49152
 s_mov_b32 s27, 8
 v_mfma_f32_16x16x32_bf16 v[136:139], v[24:27], a[136:139], v[228:231]
 v_exp_f32 v94, v94
 v_mfma_f32_16x16x32_bf16 v[168:171], v[32:35], a[136:139], v[228:231]
 s_add_u32 s36, s28, 16384
 ds_read_b64_tr_b16 a[148:149], v2 offset:512
 ds_read_b64_tr_b16 a[150:151], v2 offset:4608
 v_mfma_f32_16x16x32_bf16 v[200:203], v[40:43], a[136:139], v[228:231]
 s_add_u32 m0, s28, 81920
 v_exp_f32 v95, v95
 v_mfma_f32_16x16x32_bf16 v[232:235], v[48:51], a[136:139], v[228:231]
 buffer_load_dwordx4 v3, s[12:15], s36 offen offset:0 nt lds
 v_mfma_f32_16x16x32_bf16 a[160:163], v[56:59], a[136:139], a[220:223]
 v_cvt_pk_bf16_f32 v70, v92, v93
 v_add_f32 v9, v92, v9
 v_mfma_f32_16x16x32_bf16 a[192:195], v[64:67], a[136:139], a[220:223]
 ds_read_b64_tr_b16 a[136:137], v1 offset:1024
 ds_read_b64_tr_b16 a[138:139], v1 offset:5120
 v_mfma_f32_16x16x32_bf16 v[140:143], v[24:27], a[140:143], v[228:231]
 s_add_u32 m0, s28, 82816
 v_add_f32 v9, v93, v9
 v_cvt_pk_bf16_f32 v71, v94, v95
 v_mfma_f32_16x16x32_bf16 v[172:175], v[32:35], a[140:143], v[228:231]
 buffer_load_dwordx4 v3, s[12:15], s36 offen offset:128 nt lds
 v_mfma_f32_16x16x32_bf16 v[204:207], v[40:43], a[140:143], v[228:231]
 v_add_f32 v9, v94, v9
 v_add_f32 v9, v95, v9
 v_mfma_f32_16x16x32_bf16 v[236:239], v[48:51], a[140:143], v[228:231]
 s_add_u32 s36, s28, 24576
 v_mfma_f32_16x16x32_bf16 a[164:167], v[56:59], a[140:143], a[220:223]
 s_add_u32 m0, s28, 90112
 v_exp_f32 v100, v100
 v_mfma_f32_16x16x32_bf16 a[196:199], v[64:67], a[140:143], a[220:223]
 buffer_load_dwordx4 v3, s[12:15], s36 offen offset:0 nt lds
 v_mfma_f32_16x16x32_bf16 v[144:147], v[24:27], a[144:147], v[228:231]
 v_exp_f32 v101, v101
 v_mfma_f32_16x16x32_bf16 v[176:179], v[32:35], a[144:147], v[228:231]
 ds_read_b64_tr_b16 a[140:141], v2 offset:1024
 ds_read_b64_tr_b16 a[142:143], v2 offset:5120
 v_mfma_f32_16x16x32_bf16 v[208:211], v[40:43], a[144:147], v[228:231]
 s_add_u32 m0, s28, 91008
 v_exp_f32 v102, v102
 v_mfma_f32_16x16x32_bf16 v[240:243], v[48:51], a[144:147], v[228:231]
 buffer_load_dwordx4 v3, s[12:15], s36 offen offset:128 nt lds
 v_mfma_f32_16x16x32_bf16 a[168:171], v[56:59], a[144:147], a[220:223]
 s_add_u32 s36, s28, 40960
 v_exp_f32 v103, v103
 v_mfma_f32_16x16x32_bf16 a[200:203], v[64:67], a[144:147], a[220:223]
 s_waitcnt lgkmcnt(2)
 ds_read_b64_tr_b16 a[144:145], v1 offset:1536
 ds_read_b64_tr_b16 a[146:147], v1 offset:5632
 v_mfma_f32_16x16x32_bf16 v[148:151], v[24:27], a[148:151], v[228:231]
 s_add_u32 m0, s28, 40960
 v_cvt_pk_bf16_f32 v120, v100, v101
 v_add_f32 v9, v100, v9
 v_mfma_f32_16x16x32_bf16 v[180:183], v[32:35], a[148:151], v[228:231]
 buffer_load_dwordx4 v3, s[8:11], s36 offen offset:0 nt lds
 v_mfma_f32_16x16x32_bf16 v[212:215], v[40:43], a[148:151], v[228:231]
 v_add_f32 v9, v101, v9
 v_cvt_pk_bf16_f32 v121, v102, v103
 v_mfma_f32_16x16x32_bf16 v[244:247], v[48:51], a[148:151], v[228:231]
 v_mfma_f32_16x16x32_bf16 a[172:175], v[56:59], a[148:151], a[220:223]
 s_add_u32 m0, s28, 41856
 v_add_f32 v9, v102, v9
 v_add_f32 v9, v103, v9
 v_mfma_f32_16x16x32_bf16 a[204:207], v[64:67], a[148:151], a[220:223]
 buffer_load_dwordx4 v3, s[8:11], s36 offen offset:128 nt lds
 v_mfma_f32_16x16x32_bf16 v[152:155], v[24:27], a[136:139], v[228:231]
 v_exp_f32 v108, v108
 v_mfma_f32_16x16x32_bf16 v[184:187], v[32:35], a[136:139], v[228:231]
 s_add_u32 s36, s28, 32768
 ds_read_b64_tr_b16 a[148:149], v2 offset:1536
 ds_read_b64_tr_b16 a[150:151], v2 offset:5632
 v_mfma_f32_16x16x32_bf16 v[216:219], v[40:43], a[136:139], v[228:231]
 s_add_u32 m0, s28, 98304
 v_exp_f32 v109, v109
 v_mfma_f32_16x16x32_bf16 v[248:251], v[48:51], a[136:139], v[228:231]
 buffer_load_dwordx4 v3, s[12:15], s36 offen offset:0 nt lds
 v_mfma_f32_16x16x32_bf16 a[176:179], v[56:59], a[136:139], a[220:223]
 v_exp_f32 v110, v110
 v_mfma_f32_16x16x32_bf16 a[208:211], v[64:67], a[136:139], a[220:223]
 s_waitcnt lgkmcnt(2)
 v_mfma_f32_16x16x32_bf16 v[156:159], v[24:27], a[140:143], v[228:231]
 s_add_u32 m0, s28, 99200
 v_exp_f32 v111, v111
 v_mfma_f32_16x16x32_bf16 v[188:191], v[32:35], a[140:143], v[228:231]
 buffer_load_dwordx4 v3, s[12:15], s36 offen offset:128 nt lds
 v_mfma_f32_16x16x32_bf16 v[220:223], v[40:43], a[140:143], v[228:231]
 s_mov_b32 m0, 106496
 v_cvt_pk_bf16_f32 v122, v108, v109
 v_add_f32 v9, v108, v9
 v_mfma_f32_16x16x32_bf16 v[252:255], v[48:51], a[140:143], v[228:231]
 s_waitcnt vmcnt(10)
 s_mov_b32 s36, 40960
 v_mfma_f32_16x16x32_bf16 a[180:183], v[56:59], a[140:143], a[220:223]
 s_barrier
 buffer_load_dwordx4 v3, s[12:15], s36 offen offset:0 nt lds
 v_add_f32 v9, v109, v9
 v_cvt_pk_bf16_f32 v123, v110, v111
 v_mfma_f32_16x16x32_bf16 a[212:215], v[64:67], a[140:143], a[220:223]
 ds_read_b128 v[116:119], v0 offset:24576
 ds_read_b128 v[124:127], v0 offset:25088
 v_mfma_f32_16x16x32_bf16 v[160:163], v[24:27], a[144:147], v[228:231]
 buffer_load_dwordx4 v3, s[12:15], s36 offen offset:2048 nt lds
 v_add_f32 v9, v110, v9
 v_add_f32 v9, v111, v9
 v_mfma_f32_16x16x32_bf16 v[192:195], v[32:35], a[144:147], v[228:231]
 s_mov_b32 m0, 107392
 ds_read_b128 a[128:131], v0 offset:25600
 ds_read_b128 a[132:135], v0 offset:26112
 v_mfma_f32_16x16x32_bf16 v[224:227], v[40:43], a[144:147], v[228:231]
 buffer_load_dwordx4 v3, s[12:15], s36 offen offset:128 nt lds
 v_mfma_f32_16x16x32_bf16 a[152:155], v[48:51], a[144:147], a[220:223]
 ds_read_b64_tr_b16 a[136:137], v1 offset:8192
 ds_read_b64_tr_b16 a[138:139], v1 offset:12288
 v_mfma_f32_16x16x32_bf16 a[184:187], v[56:59], a[144:147], a[220:223]
 buffer_load_dwordx4 v3, s[12:15], s36 offen offset:2176 nt lds
 v_mfma_f32_16x16x32_bf16 a[216:219], v[64:67], a[144:147], a[220:223]
 s_waitcnt lgkmcnt(6)
 ds_read_b64_tr_b16 a[140:141], v2 offset:8192
 ds_read_b64_tr_b16 a[142:143], v2 offset:12288
 v_mfma_f32_16x16x32_bf16 v[164:167], v[24:27], a[148:151], v[228:231]
 s_mov_b32 s36, 45056
 ds_read_b64_tr_b16 a[144:145], v1 offset:8704
 ds_read_b64_tr_b16 a[146:147], v1 offset:12800
 v_mfma_f32_16x16x32_bf16 v[196:199], v[32:35], a[148:151], v[228:231]
 s_mov_b32 m0, 110592
 ds_read_b128 a[112:115], v0 offset:28672
 ds_read_b128 a[116:119], v0 offset:29184
 v_mfma_f32_16x16x32_bf16 v[228:231], v[40:43], a[148:151], v[228:231]
 buffer_load_dwordx4 v3, s[12:15], s36 offen offset:0 nt lds
 v_mfma_f32_16x16x32_bf16 a[156:159], v[48:51], a[148:151], a[220:223]
 ds_read_b128 a[120:123], v0 offset:29696
 ds_read_b128 a[124:127], v0 offset:30208
 v_mfma_f32_16x16x32_bf16 a[188:191], v[56:59], a[148:151], a[220:223]
 buffer_load_dwordx4 v3, s[12:15], s36 offen offset:2048 nt lds
 v_mfma_f32_16x16x32_bf16 a[220:223], v[64:67], a[148:151], a[220:223]
 s_waitcnt lgkmcnt(8)
 s_mov_b32 m0, 111488
 ds_read_b64_tr_b16 a[148:149], v2 offset:8704
 ds_read_b64_tr_b16 a[150:151], v2 offset:12800
 v_mfma_f32_16x16x32_bf16 v[16:19], v[116:119], a[0:3], v[12:15]
 buffer_load_dwordx4 v3, s[12:15], s36 offen offset:128 nt lds
 v_mfma_f32_16x16x32_bf16 v[16:19], v[124:127], a[4:7], v[16:19]
 v_mfma_f32_16x16x32_bf16 v[16:19], a[128:131], a[8:11], v[16:19]
 v_mfma_f32_16x16x32_bf16 v[16:19], a[132:135], a[12:15], v[16:19]
 v_mfma_f32_16x16x32_bf16 v[20:23], a[132:135], a[28:31], v[12:15]
 s_nop 0
 buffer_load_dwordx4 v3, s[12:15], s36 offen offset:2176 nt lds
 v_mfma_f32_16x16x32_bf16 v[20:23], a[128:131], a[24:27], v[20:23]
 s_mov_b32 m0, 49152
 s_mov_b32 s36, 49152
 v_mfma_f32_16x16x32_bf16 v[20:23], v[124:127], a[20:23], v[20:23]
 buffer_load_dwordx4 v3, s[8:11], s36 offen offset:0 nt lds
 v_exp_f32 v16, v16
 v_mfma_f32_16x16x32_bf16 v[20:23], v[116:119], a[16:19], v[20:23]
 v_exp_f32 v17, v17
 v_mfma_f32_16x16x32_bf16 v[136:139], v[28:31], a[136:139], v[136:139]
 buffer_load_dwordx4 v3, s[8:11], s36 offen offset:2048 nt lds
 v_exp_f32 v18, v18
 v_mfma_f32_16x16x32_bf16 v[168:171], v[36:39], a[136:139], v[168:171]
 v_add_f32 v4, v16, v4
 v_cvt_pk_bf16_f32 v84, v16, v17
 v_mfma_f32_16x16x32_bf16 v[200:203], v[44:47], a[136:139], v[200:203]
 v_exp_f32 v19, v19
 v_mfma_f32_16x16x32_bf16 v[232:235], v[52:55], a[136:139], v[232:235]
 s_mov_b32 m0, 50048
 v_add_f32 v4, v17, v4
 v_add_f32 v4, v18, v4
 v_mfma_f32_16x16x32_bf16 a[160:163], v[60:63], a[136:139], a[160:163]
 buffer_load_dwordx4 v3, s[8:11], s36 offen offset:128 nt lds
 v_exp_f32 v20, v20
 v_mfma_f32_16x16x32_bf16 a[192:195], v[68:71], a[136:139], a[192:195]
 s_waitcnt lgkmcnt(0)
 v_add_f32 v4, v19, v4
 v_cvt_pk_bf16_f32 v85, v18, v19
 v_mfma_f32_16x16x32_bf16 v[140:143], v[28:31], a[140:143], v[140:143]
 buffer_load_dwordx4 v3, s[8:11], s36 offen offset:2176 nt lds
 v_exp_f32 v21, v21
 v_mfma_f32_16x16x32_bf16 v[172:175], v[36:39], a[140:143], v[172:175]
 s_mov_b32 m0, 53248
 s_mov_b32 s36, 53248
 ds_read_b64_tr_b16 a[136:137], v1 offset:9216
 v_add_f32 v10, v20, v21
 v_mfma_f32_16x16x32_bf16 v[16:19], v[116:119], a[32:35], v[12:15]
 buffer_load_dwordx4 v3, s[8:11], s36 offen offset:0 nt lds
 v_exp_f32 v22, v22
 v_mfma_f32_16x16x32_bf16 v[16:19], v[124:127], a[36:39], v[16:19]
 ds_read_b64_tr_b16 a[138:139], v1 offset:13312
 v_cvt_pk_bf16_f32 v92, v20, v21
 v_mfma_f32_16x16x32_bf16 v[16:19], a[128:131], a[40:43], v[16:19]
 buffer_load_dwordx4 v3, s[8:11], s36 offen offset:2048 nt lds
 v_exp_f32 v23, v23
 v_mfma_f32_16x16x32_bf16 v[16:19], a[132:135], a[44:47], v[16:19]
 v_add_f32 v11, v22, v23
 v_cvt_pk_bf16_f32 v93, v22, v23
 v_mfma_f32_16x16x32_bf16 v[20:23], a[132:135], a[60:63], v[12:15]
 v_add_f32 v5, v10, v5
 v_mfma_f32_16x16x32_bf16 v[20:23], a[128:131], a[56:59], v[20:23]
 s_mov_b32 m0, 54144
 v_add_f32 v5, v11, v5
 v_mfma_f32_16x16x32_bf16 v[20:23], v[124:127], a[52:55], v[20:23]
 buffer_load_dwordx4 v3, s[8:11], s36 offen offset:128 nt lds
 v_exp_f32 v16, v16
 v_mfma_f32_16x16x32_bf16 v[20:23], v[116:119], a[48:51], v[20:23]
 v_exp_f32 v17, v17
 v_mfma_f32_16x16x32_bf16 v[204:207], v[44:47], a[140:143], v[204:207]
 buffer_load_dwordx4 v3, s[8:11], s36 offen offset:2176 nt lds
 v_exp_f32 v18, v18
 v_mfma_f32_16x16x32_bf16 v[236:239], v[52:55], a[140:143], v[236:239]
 s_mov_b32 m0, 57344
 s_mov_b32 s36, 57344
 v_add_f32 v6, v16, v6
 v_cvt_pk_bf16_f32 v100, v16, v17
 v_mfma_f32_16x16x32_bf16 a[164:167], v[60:63], a[140:143], a[164:167]
 buffer_load_dwordx4 v3, s[8:11], s36 offen offset:0 nt lds
 v_exp_f32 v19, v19
 v_mfma_f32_16x16x32_bf16 a[196:199], v[68:71], a[140:143], a[196:199]
 v_add_f32 v6, v17, v6
 v_add_f32 v6, v18, v6
 v_mfma_f32_16x16x32_bf16 v[144:147], v[28:31], a[144:147], v[144:147]
 v_exp_f32 v20, v20
 v_mfma_f32_16x16x32_bf16 v[176:179], v[36:39], a[144:147], v[176:179]
 v_add_f32 v6, v19, v6
 v_cvt_pk_bf16_f32 v101, v18, v19
 v_mfma_f32_16x16x32_bf16 v[208:211], v[44:47], a[144:147], v[208:211]
 buffer_load_dwordx4 v3, s[8:11], s36 offen offset:2048 nt lds
 v_exp_f32 v21, v21
 v_mfma_f32_16x16x32_bf16 v[240:243], v[52:55], a[144:147], v[240:243]
 s_mov_b32 m0, 58240
 ds_read_b64_tr_b16 a[140:141], v2 offset:9216
 v_add_f32 v10, v20, v21
 v_mfma_f32_16x16x32_bf16 v[16:19], v[116:119], a[64:67], v[12:15]
 buffer_load_dwordx4 v3, s[8:11], s36 offen offset:128 nt lds
 v_exp_f32 v22, v22
 v_mfma_f32_16x16x32_bf16 v[16:19], v[124:127], a[68:71], v[16:19]
 ds_read_b64_tr_b16 a[142:143], v2 offset:13312
 v_cvt_pk_bf16_f32 v108, v20, v21
 v_mfma_f32_16x16x32_bf16 v[16:19], a[128:131], a[72:75], v[16:19]
 buffer_load_dwordx4 v3, s[8:11], s36 offen offset:2176 nt lds
 v_exp_f32 v23, v23
 v_mfma_f32_16x16x32_bf16 v[16:19], a[132:135], a[76:79], v[16:19]
 v_add_f32 v11, v22, v23
 v_cvt_pk_bf16_f32 v109, v22, v23
 v_mfma_f32_16x16x32_bf16 v[20:23], a[132:135], a[92:95], v[12:15]
 s_mov_b32 s36, 61440
 v_add_f32 v7, v10, v7
 v_mfma_f32_16x16x32_bf16 v[20:23], a[128:131], a[88:91], v[20:23]
 s_mov_b32 m0, 61440
 v_add_f32 v7, v11, v7
 v_mfma_f32_16x16x32_bf16 v[20:23], v[124:127], a[84:87], v[20:23]
 buffer_load_dwordx4 v3, s[8:11], s36 offen offset:0 nt lds
 v_exp_f32 v16, v16
 v_mfma_f32_16x16x32_bf16 v[20:23], v[116:119], a[80:83], v[20:23]
 v_exp_f32 v17, v17
 v_mfma_f32_16x16x32_bf16 a[168:171], v[60:63], a[144:147], a[168:171]
 buffer_load_dwordx4 v3, s[8:11], s36 offen offset:2048 nt lds
 v_exp_f32 v18, v18
 v_mfma_f32_16x16x32_bf16 a[200:203], v[68:71], a[144:147], a[200:203]
 s_mov_b32 m0, 62336
 v_add_f32 v8, v16, v8
 v_cvt_pk_bf16_f32 v116, v16, v17
 v_mfma_f32_16x16x32_bf16 v[148:151], v[28:31], a[148:151], v[148:151]
 buffer_load_dwordx4 v3, s[8:11], s36 offen offset:128 nt lds
 v_exp_f32 v19, v19
 v_mfma_f32_16x16x32_bf16 v[180:183], v[36:39], a[148:151], v[180:183]
 v_add_f32 v8, v17, v8
 v_add_f32 v8, v18, v8
 v_mfma_f32_16x16x32_bf16 v[212:215], v[44:47], a[148:151], v[212:215]
 buffer_load_dwordx4 v3, s[8:11], s36 offen offset:2176 nt lds
 v_exp_f32 v20, v20
 v_mfma_f32_16x16x32_bf16 v[244:247], v[52:55], a[148:151], v[244:247]
 v_add_f32 v8, v19, v8
 v_cvt_pk_bf16_f32 v117, v18, v19
 v_mfma_f32_16x16x32_bf16 a[172:175], v[60:63], a[148:151], a[172:175]
 s_mov_b32 s36, 65536
 v_exp_f32 v21, v21
 v_mfma_f32_16x16x32_bf16 a[204:207], v[68:71], a[148:151], a[204:207]
 s_mov_b32 m0, 0
 ds_read_b64_tr_b16 a[144:145], v1 offset:9728
 v_add_f32 v10, v20, v21
 v_mfma_f32_16x16x32_bf16 v[16:19], a[112:115], a[0:3], v[12:15]
 buffer_load_dwordx4 v3, s[8:11], s36 offen offset:0 nt lds
 v_exp_f32 v22, v22
 v_mfma_f32_16x16x32_bf16 v[16:19], a[116:119], a[4:7], v[16:19]
 ds_read_b64_tr_b16 a[146:147], v1 offset:13824
 v_cvt_pk_bf16_f32 v124, v20, v21
 v_mfma_f32_16x16x32_bf16 v[16:19], a[120:123], a[8:11], v[16:19]
 buffer_load_dwordx4 v3, s[8:11], s36 offen offset:2048 nt lds
 v_exp_f32 v23, v23
 v_mfma_f32_16x16x32_bf16 v[16:19], a[124:127], a[12:15], v[16:19]
 s_mov_b32 m0, 896
 v_add_f32 v11, v22, v23
 v_cvt_pk_bf16_f32 v125, v22, v23
 v_mfma_f32_16x16x32_bf16 v[20:23], a[124:127], a[28:31], v[12:15]
 buffer_load_dwordx4 v3, s[8:11], s36 offen offset:128 nt lds
 v_add_f32 v9, v10, v9
 v_mfma_f32_16x16x32_bf16 v[20:23], a[120:123], a[24:27], v[20:23]
 ds_read_b64_tr_b16 a[148:149], v2 offset:9728
 v_add_f32 v9, v11, v9
 v_mfma_f32_16x16x32_bf16 v[20:23], a[116:119], a[20:23], v[20:23]
 v_exp_f32 v16, v16
 v_mfma_f32_16x16x32_bf16 v[20:23], a[112:115], a[16:19], v[20:23]
 s_waitcnt lgkmcnt(2)
 v_exp_f32 v17, v17
 v_mfma_f32_16x16x32_bf16 v[152:155], v[28:31], a[136:139], v[152:155]
 buffer_load_dwordx4 v3, s[8:11], s36 offen offset:2176 nt lds
 v_exp_f32 v18, v18
 v_mfma_f32_16x16x32_bf16 v[184:187], v[36:39], a[136:139], v[184:187]
 s_mov_b32 m0, 4096
 s_mov_b32 s36, 69632
 v_add_f32 v4, v16, v4
 v_cvt_pk_bf16_f32 v86, v16, v17
 v_mfma_f32_16x16x32_bf16 v[216:219], v[44:47], a[136:139], v[216:219]
 buffer_load_dwordx4 v3, s[8:11], s36 offen offset:0 nt lds
 v_exp_f32 v19, v19
 v_mfma_f32_16x16x32_bf16 v[248:251], v[52:55], a[136:139], v[248:251]
 v_add_f32 v4, v17, v4
 v_add_f32 v4, v18, v4
 v_mfma_f32_16x16x32_bf16 a[176:179], v[60:63], a[136:139], a[176:179]
 buffer_load_dwordx4 v3, s[8:11], s36 offen offset:2048 nt lds
 v_exp_f32 v20, v20
 v_mfma_f32_16x16x32_bf16 a[208:211], v[68:71], a[136:139], a[208:211]
 v_add_f32 v4, v19, v4
 v_cvt_pk_bf16_f32 v87, v18, v19
 v_mfma_f32_16x16x32_bf16 v[156:159], v[28:31], a[140:143], v[156:159]
 v_exp_f32 v21, v21
 v_mfma_f32_16x16x32_bf16 v[188:191], v[36:39], a[140:143], v[188:191]
 s_mov_b32 m0, 4992
 ds_read_b64_tr_b16 a[150:151], v2 offset:13824
 v_add_f32 v10, v20, v21
 v_mfma_f32_16x16x32_bf16 v[16:19], a[112:115], a[32:35], v[12:15]
 buffer_load_dwordx4 v3, s[8:11], s36 offen offset:128 nt lds
 v_exp_f32 v22, v22
 v_mfma_f32_16x16x32_bf16 v[16:19], a[116:119], a[36:39], v[16:19]
 v_cvt_pk_bf16_f32 v94, v20, v21
 v_mfma_f32_16x16x32_bf16 v[16:19], a[120:123], a[40:43], v[16:19]
 buffer_load_dwordx4 v3, s[8:11], s36 offen offset:2176 nt lds
 v_exp_f32 v23, v23
 v_mfma_f32_16x16x32_bf16 v[16:19], a[124:127], a[44:47], v[16:19]
 s_mov_b32 m0, 8192
 s_mov_b32 s36, 73728
 v_add_f32 v11, v22, v23
 v_cvt_pk_bf16_f32 v95, v22, v23
 v_mfma_f32_16x16x32_bf16 v[20:23], a[124:127], a[60:63], v[12:15]
 s_waitcnt vmcnt(34)
 buffer_load_dwordx4 v3, s[8:11], s36 offen offset:0 nt lds
 v_add_f32 v5, v10, v5
 v_mfma_f32_16x16x32_bf16 v[20:23], a[120:123], a[56:59], v[20:23]
 s_barrier
 ds_read_b128 a[128:131], v0 offset:32768
 v_add_f32 v5, v11, v5
 v_mfma_f32_16x16x32_bf16 v[20:23], a[116:119], a[52:55], v[20:23]
 buffer_load_dwordx4 v3, s[8:11], s36 offen offset:2048 nt lds
 v_exp_f32 v16, v16
 v_mfma_f32_16x16x32_bf16 v[20:23], a[112:115], a[48:51], v[20:23]
 v_exp_f32 v17, v17
 v_mfma_f32_16x16x32_bf16 v[220:223], v[44:47], a[140:143], v[220:223]
 v_exp_f32 v18, v18
 v_mfma_f32_16x16x32_bf16 v[252:255], v[52:55], a[140:143], v[252:255]
 s_mov_b32 m0, 9088
 v_add_f32 v6, v16, v6
 v_cvt_pk_bf16_f32 v102, v16, v17
 v_mfma_f32_16x16x32_bf16 a[180:183], v[60:63], a[140:143], a[180:183]
 buffer_load_dwordx4 v3, s[8:11], s36 offen offset:128 nt lds
 v_exp_f32 v19, v19
 v_mfma_f32_16x16x32_bf16 a[212:215], v[68:71], a[140:143], a[212:215]
 s_waitcnt lgkmcnt(1)
 v_add_f32 v6, v17, v6
 v_add_f32 v6, v18, v6
 v_mfma_f32_16x16x32_bf16 v[160:163], v[28:31], a[144:147], v[160:163]
 buffer_load_dwordx4 v3, s[8:11], s36 offen offset:2176 nt lds
 v_exp_f32 v20, v20
 v_mfma_f32_16x16x32_bf16 v[192:195], v[36:39], a[144:147], v[192:195]
 s_mov_b32 m0, 12288
 s_mov_b32 s36, 77824
 v_add_f32 v6, v19, v6
 v_cvt_pk_bf16_f32 v103, v18, v19
 v_mfma_f32_16x16x32_bf16 v[164:167], v[28:31], a[148:151], v[164:167]
 buffer_load_dwordx4 v3, s[8:11], s36 offen offset:0 nt lds
 v_exp_f32 v21, v21
 v_mfma_f32_16x16x32_bf16 v[196:199], v[36:39], a[148:151], v[196:199]
 ds_read_b128 a[132:135], v0 offset:33280
 v_add_f32 v10, v20, v21
 v_mfma_f32_16x16x32_bf16 v[16:19], a[112:115], a[64:67], v[12:15]
 v_exp_f32 v22, v22
 v_mfma_f32_16x16x32_bf16 v[16:19], a[116:119], a[68:71], v[16:19]
 ds_read_b128 v[28:31], v0 offset:33792
 v_cvt_pk_bf16_f32 v110, v20, v21
 v_mfma_f32_16x16x32_bf16 v[16:19], a[120:123], a[72:75], v[16:19]
 buffer_load_dwordx4 v3, s[8:11], s36 offen offset:2048 nt lds
 v_exp_f32 v23, v23
 v_mfma_f32_16x16x32_bf16 v[16:19], a[124:127], a[76:79], v[16:19]
 s_mov_b32 m0, 13184
 v_add_f32 v11, v22, v23
 v_cvt_pk_bf16_f32 v111, v22, v23
 v_mfma_f32_16x16x32_bf16 v[20:23], a[124:127], a[92:95], v[12:15]
 buffer_load_dwordx4 v3, s[8:11], s36 offen offset:128 nt lds
 v_add_f32 v7, v10, v7
 v_mfma_f32_16x16x32_bf16 v[20:23], a[120:123], a[88:91], v[20:23]
 ds_read_b128 v[36:39], v0 offset:34304
 v_add_f32 v7, v11, v7
 v_mfma_f32_16x16x32_bf16 v[20:23], a[116:119], a[84:87], v[20:23]
 buffer_load_dwordx4 v3, s[8:11], s36 offen offset:2176 nt lds
 v_exp_f32 v16, v16
 v_mfma_f32_16x16x32_bf16 v[20:23], a[112:115], a[80:83], v[20:23]
 v_exp_f32 v17, v17
 v_mfma_f32_16x16x32_bf16 v[224:227], v[44:47], a[144:147], v[224:227]
 v_exp_f32 v18, v18
 v_mfma_f32_16x16x32_bf16 a[152:155], v[52:55], a[144:147], a[152:155]
 v_add_f32 v8, v16, v8
 v_cvt_pk_bf16_f32 v118, v16, v17
 v_mfma_f32_16x16x32_bf16 a[184:187], v[60:63], a[144:147], a[184:187]
 v_exp_f32 v19, v19
 v_mfma_f32_16x16x32_bf16 a[216:219], v[68:71], a[144:147], a[216:219]
 v_add_f32 v8, v17, v8
 v_add_f32 v8, v18, v8
 v_mfma_f32_16x16x32_bf16 v[228:231], v[44:47], a[148:151], v[228:231]
 v_exp_f32 v20, v20
 v_mfma_f32_16x16x32_bf16 a[156:159], v[52:55], a[148:151], a[156:159]
 ds_read_b64_tr_b16 a[136:137], v1 offset:16384
 v_add_f32 v8, v19, v8
 v_cvt_pk_bf16_f32 v119, v18, v19
 v_mfma_f32_16x16x32_bf16 a[188:191], v[60:63], a[148:151], a[188:191]
 v_exp_f32 v21, v21
 v_mfma_f32_16x16x32_bf16 a[220:223], v[68:71], a[148:151], a[220:223]
 s_waitcnt lgkmcnt(1)
 ds_read_b64_tr_b16 a[138:139], v1 offset:20480
 v_add_f32 v10, v20, v21
 s_branch L_sub1_6
.p2align 6
L_loop_6:
 v_mfma_f32_16x16x32_bf16 v[16:19], a[128:131], a[0:3], v[12:15]
 v_exp_f32 v22, v22
 v_mfma_f32_16x16x32_bf16 v[16:19], a[132:135], a[4:7], v[16:19]
 ds_read_b64_tr_b16 a[140:141], v1 offset:40960
 v_cvt_pk_bf16_f32 v70, v20, v21
 v_mfma_f32_16x16x32_bf16 v[16:19], v[84:87], a[8:11], v[16:19]
 v_exp_f32 v23, v23
 v_mfma_f32_16x16x32_bf16 v[16:19], v[92:95], a[12:15], v[16:19]
 v_add_f32 v11, v22, v23
 v_cvt_pk_bf16_f32 v71, v22, v23
 v_mfma_f32_16x16x32_bf16 v[76:79], v[92:95], a[28:31], v[12:15]
 s_mov_b32 m0, 65536
 ds_read_b64_tr_b16 a[142:143], v1 offset:45056
 v_add_f32 v9, v10, v9
 v_mfma_f32_16x16x32_bf16 v[76:79], v[84:87], a[24:27], v[76:79]
 ds_read_b64_tr_b16 a[144:145], v2 offset:32768
 buffer_load_dwordx4 v3, s[12:15], s26 offen offset:0 nt lds
 buffer_load_dwordx4 v3, s[12:15], s26 offen offset:2048 nt lds
 v_add_f32 v9, v11, v9
 v_mfma_f32_16x16x32_bf16 v[76:79], a[132:135], a[20:23], v[76:79]
 v_exp_f32 v16, v16
 v_mfma_f32_16x16x32_bf16 v[76:79], a[128:131], a[16:19], v[76:79]
 v_exp_f32 v17, v17
 v_mfma_f32_16x16x32_bf16 v[128:131], a[128:131], a[32:35], v[12:15]
 v_add_f32 v4, v16, v4
 v_cvt_pk_bf16_f32 v80, v16, v17
 v_mfma_f32_16x16x32_bf16 v[128:131], a[132:135], a[36:39], v[128:131]
 v_exp_f32 v18, v18
 v_mfma_f32_16x16x32_bf16 v[128:131], v[84:87], a[40:43], v[128:131]
 ds_read_b64_tr_b16 a[146:147], v2 offset:36864
 v_add_f32 v4, v17, v4
 v_mfma_f32_16x16x32_bf16 v[128:131], v[92:95], a[44:47], v[128:131]
 v_exp_f32 v19, v19
 v_mfma_f32_16x16x32_bf16 v[132:135], v[92:95], a[60:63], v[12:15]
 v_add_f32 v4, v18, v4
 v_cvt_pk_bf16_f32 v81, v18, v19
 v_mfma_f32_16x16x32_bf16 v[132:135], v[84:87], a[56:59], v[132:135]
 ds_read_b64_tr_b16 a[148:149], v2 offset:40960
 v_add_f32 v4, v19, v4
 v_mfma_f32_16x16x32_bf16 v[132:135], a[132:135], a[52:55], v[132:135]
 v_exp_f32 v76, v76
 v_mfma_f32_16x16x32_bf16 v[132:135], a[128:131], a[48:51], v[132:135]
 v_exp_f32 v77, v77
 v_mfma_f32_16x16x32_bf16 v[72:75], a[128:131], a[64:67], v[12:15]
 s_mov_b32 m0, 66432
 v_add_f32 v5, v76, v5
 v_cvt_pk_bf16_f32 v88, v76, v77
 v_mfma_f32_16x16x32_bf16 v[72:75], a[132:135], a[68:71], v[72:75]
 buffer_load_dwordx4 v3, s[12:15], s26 offen offset:128 nt lds
 buffer_load_dwordx4 v3, s[12:15], s26 offen offset:2176 nt lds
 v_exp_f32 v78, v78
 v_mfma_f32_16x16x32_bf16 v[72:75], v[84:87], a[72:75], v[72:75]
 s_add_u32 s26, s26, 4096
 ds_read_b64_tr_b16 a[150:151], v2 offset:45056
 v_add_f32 v5, v77, v5
 v_mfma_f32_16x16x32_bf16 v[72:75], v[92:95], a[76:79], v[72:75]
 v_exp_f32 v79, v79
 v_mfma_f32_16x16x32_bf16 v[20:23], v[92:95], a[92:95], v[12:15]
 v_add_f32 v5, v78, v5
 v_cvt_pk_bf16_f32 v89, v78, v79
 v_mfma_f32_16x16x32_bf16 v[20:23], v[84:87], a[88:91], v[20:23]
 ds_read_b128 a[112:115], v0 offset:53248
 v_add_f32 v5, v79, v5
 v_mfma_f32_16x16x32_bf16 v[20:23], a[132:135], a[84:87], v[20:23]
 v_exp_f32 v128, v128
 v_mfma_f32_16x16x32_bf16 v[20:23], a[128:131], a[80:83], v[20:23]
 s_waitcnt lgkmcnt(2)
 v_exp_f32 v129, v129
 v_mfma_f32_16x16x32_bf16 v[136:139], v[24:27], a[136:139], v[136:139]
 v_add_f32 v6, v128, v6
 v_cvt_pk_bf16_f32 v96, v128, v129
 v_mfma_f32_16x16x32_bf16 v[136:139], v[28:31], a[140:143], v[136:139]
 v_exp_f32 v130, v130
 v_mfma_f32_16x16x32_bf16 v[168:171], v[36:39], a[140:143], v[168:171]
 ds_read_b128 a[116:119], v0 offset:53760
 v_add_f32 v6, v129, v6
 v_mfma_f32_16x16x32_bf16 v[168:171], v[32:35], a[136:139], v[168:171]
 v_exp_f32 v131, v131
 v_mfma_f32_16x16x32_bf16 v[200:203], v[40:43], a[136:139], v[200:203]
 s_mov_b32 m0, 69632
 v_add_f32 v6, v130, v6
 v_cvt_pk_bf16_f32 v97, v130, v131
 v_mfma_f32_16x16x32_bf16 v[200:203], v[44:47], a[140:143], v[200:203]
 ds_read_b128 a[120:123], v0 offset:54272
 buffer_load_dwordx4 v3, s[12:15], s26 offen offset:0 nt lds
 buffer_load_dwordx4 v3, s[12:15], s26 offen offset:2048 nt lds
 v_add_f32 v6, v131, v6
 v_mfma_f32_16x16x32_bf16 v[232:235], v[52:55], a[140:143], v[232:235]
 v_exp_f32 v132, v132
 v_mfma_f32_16x16x32_bf16 v[232:235], v[48:51], a[136:139], v[232:235]
 v_exp_f32 v133, v133
 v_mfma_f32_16x16x32_bf16 a[160:163], v[56:59], a[136:139], a[160:163]
 v_add_f32 v7, v132, v7
 v_cvt_pk_bf16_f32 v104, v132, v133
 v_mfma_f32_16x16x32_bf16 a[160:163], v[60:63], a[140:143], a[160:163]
 v_exp_f32 v134, v134
 v_mfma_f32_16x16x32_bf16 a[192:195], v[68:71], a[140:143], a[192:195]
 ds_read_b128 a[124:127], v0 offset:54784
 v_add_f32 v7, v133, v7
 v_mfma_f32_16x16x32_bf16 a[192:195], v[64:67], a[136:139], a[192:195]
 v_exp_f32 v135, v135
 v_mfma_f32_16x16x32_bf16 v[140:143], v[24:27], a[144:147], v[140:143]
 s_waitcnt lgkmcnt(1)
 v_add_f32 v7, v134, v7
 v_cvt_pk_bf16_f32 v105, v134, v135
 v_mfma_f32_16x16x32_bf16 v[140:143], v[28:31], a[148:151], v[140:143]
 ds_read_b64_tr_b16 a[136:137], v1 offset:33280
 v_add_f32 v7, v135, v7
 v_mfma_f32_16x16x32_bf16 v[172:175], v[36:39], a[148:151], v[172:175]
 v_exp_f32 v72, v72
 v_mfma_f32_16x16x32_bf16 v[172:175], v[32:35], a[144:147], v[172:175]
 v_exp_f32 v73, v73
 v_mfma_f32_16x16x32_bf16 v[204:207], v[40:43], a[144:147], v[204:207]
 s_mov_b32 m0, 70528
 v_exp_f32 v74, v74
 v_mfma_f32_16x16x32_bf16 v[204:207], v[44:47], a[148:151], v[204:207]
 buffer_load_dwordx4 v3, s[12:15], s26 offen offset:128 nt lds
 buffer_load_dwordx4 v3, s[12:15], s26 offen offset:2176 nt lds
 v_add_f32 v8, v72, v8
 v_cvt_pk_bf16_f32 v112, v72, v73
 v_mfma_f32_16x16x32_bf16 v[236:239], v[52:55], a[148:151], v[236:239]
 s_add_u32 s26, s26, 4096
 v_exp_f32 v75, v75
 v_mfma_f32_16x16x32_bf16 v[236:239], v[48:51], a[144:147], v[236:239]
 v_add_f32 v8, v73, v8
 v_add_f32 v8, v74, v8
 v_mfma_f32_16x16x32_bf16 a[164:167], v[56:59], a[144:147], a[164:167]
 v_exp_f32 v20, v20
 v_mfma_f32_16x16x32_bf16 a[164:167], v[60:63], a[148:151], a[164:167]
 v_add_f32 v8, v75, v8
 v_cvt_pk_bf16_f32 v113, v74, v75
 v_mfma_f32_16x16x32_bf16 a[196:199], v[68:71], a[148:151], a[196:199]
 v_exp_f32 v21, v21
 v_mfma_f32_16x16x32_bf16 a[196:199], v[64:67], a[144:147], a[196:199]
 ds_read_b64_tr_b16 a[138:139], v1 offset:37376
 v_add_f32 v10, v20, v21
 v_mfma_f32_16x16x32_bf16 v[16:19], a[112:115], a[0:3], v[12:15]
 v_exp_f32 v22, v22
 v_mfma_f32_16x16x32_bf16 v[16:19], a[116:119], a[4:7], v[16:19]
 ds_read_b64_tr_b16 a[140:141], v1 offset:41472
 v_cvt_pk_bf16_f32 v120, v20, v21
 v_mfma_f32_16x16x32_bf16 v[16:19], a[120:123], a[8:11], v[16:19]
 s_waitcnt lgkmcnt(2)
 v_exp_f32 v23, v23
 v_mfma_f32_16x16x32_bf16 v[16:19], a[124:127], a[12:15], v[16:19]
 v_add_f32 v11, v22, v23
 v_cvt_pk_bf16_f32 v121, v22, v23
 v_mfma_f32_16x16x32_bf16 v[76:79], a[124:127], a[28:31], v[12:15]
 s_mov_b32 m0, 73728
 ds_read_b64_tr_b16 a[142:143], v1 offset:45568
 v_add_f32 v9, v10, v9
 v_mfma_f32_16x16x32_bf16 v[76:79], a[120:123], a[24:27], v[76:79]
 ds_read_b64_tr_b16 a[144:145], v2 offset:33280
 buffer_load_dwordx4 v3, s[12:15], s26 offen offset:0 nt lds
 buffer_load_dwordx4 v3, s[12:15], s26 offen offset:2048 nt lds
 v_add_f32 v9, v11, v9
 v_mfma_f32_16x16x32_bf16 v[76:79], a[116:119], a[20:23], v[76:79]
 v_exp_f32 v16, v16
 v_mfma_f32_16x16x32_bf16 v[76:79], a[112:115], a[16:19], v[76:79]
 v_exp_f32 v17, v17
 v_mfma_f32_16x16x32_bf16 v[128:131], a[112:115], a[32:35], v[12:15]
 v_add_f32 v4, v16, v4
 v_cvt_pk_bf16_f32 v82, v16, v17
 v_mfma_f32_16x16x32_bf16 v[128:131], a[116:119], a[36:39], v[128:131]
 v_exp_f32 v18, v18
 v_mfma_f32_16x16x32_bf16 v[128:131], a[120:123], a[40:43], v[128:131]
 ds_read_b64_tr_b16 a[146:147], v2 offset:37376
 v_add_f32 v4, v17, v4
 v_mfma_f32_16x16x32_bf16 v[128:131], a[124:127], a[44:47], v[128:131]
 v_exp_f32 v19, v19
 v_mfma_f32_16x16x32_bf16 v[132:135], a[124:127], a[60:63], v[12:15]
 v_add_f32 v4, v18, v4
 v_cvt_pk_bf16_f32 v83, v18, v19
 v_mfma_f32_16x16x32_bf16 v[132:135], a[120:123], a[56:59], v[132:135]
 ds_read_b64_tr_b16 a[148:149], v2 offset:41472
 v_add_f32 v4, v19, v4
 v_mfma_f32_16x16x32_bf16 v[132:135], a[116:119], a[52:55], v[132:135]
 v_exp_f32 v76, v76
 v_mfma_f32_16x16x32_bf16 v[132:135], a[112:115], a[48:51], v[132:135]
 v_exp_f32 v77, v77
 v_mfma_f32_16x16x32_bf16 v[72:75], a[112:115], a[64:67], v[12:15]
 s_mov_b32 m0, 74624
 v_add_f32 v5, v76, v5
 v_cvt_pk_bf16_f32 v90, v76, v77
 v_mfma_f32_16x16x32_bf16 v[72:75], a[116:119], a[68:71], v[72:75]
 buffer_load_dwordx4 v3, s[12:15], s26 offen offset:128 nt lds
 buffer_load_dwordx4 v3, s[12:15], s26 offen offset:2176 nt lds
 v_exp_f32 v78, v78
 v_mfma_f32_16x16x32_bf16 v[72:75], a[120:123], a[72:75], v[72:75]
 s_add_u32 s26, s26, 4096
 ds_read_b64_tr_b16 a[150:151], v2 offset:45568
 v_add_f32 v5, v77, v5
 v_mfma_f32_16x16x32_bf16 v[72:75], a[124:127], a[76:79], v[72:75]
 v_exp_f32 v79, v79
 v_mfma_f32_16x16x32_bf16 v[20:23], a[124:127], a[92:95], v[12:15]
 v_add_f32 v5, v78, v5
 v_cvt_pk_bf16_f32 v91, v78, v79
 v_mfma_f32_16x16x32_bf16 v[20:23], a[120:123], a[88:91], v[20:23]
 ds_read_b128 v[116:119], v0 offset:57344
 v_add_f32 v5, v79, v5
 v_mfma_f32_16x16x32_bf16 v[20:23], a[116:119], a[84:87], v[20:23]
 v_exp_f32 v128, v128
 v_mfma_f32_16x16x32_bf16 v[20:23], a[112:115], a[80:83], v[20:23]
 s_waitcnt lgkmcnt(2)
 v_exp_f32 v129, v129
 v_mfma_f32_16x16x32_bf16 v[144:147], v[24:27], a[136:139], v[144:147]
 v_add_f32 v6, v128, v6
 v_cvt_pk_bf16_f32 v98, v128, v129
 v_mfma_f32_16x16x32_bf16 v[144:147], v[28:31], a[140:143], v[144:147]
 v_exp_f32 v130, v130
 v_mfma_f32_16x16x32_bf16 v[176:179], v[36:39], a[140:143], v[176:179]
 ds_read_b128 v[124:127], v0 offset:57856
 v_add_f32 v6, v129, v6
 v_mfma_f32_16x16x32_bf16 v[176:179], v[32:35], a[136:139], v[176:179]
 v_exp_f32 v131, v131
 v_mfma_f32_16x16x32_bf16 v[208:211], v[40:43], a[136:139], v[208:211]
 s_mov_b32 m0, 77824
 v_add_f32 v6, v130, v6
 v_cvt_pk_bf16_f32 v99, v130, v131
 v_mfma_f32_16x16x32_bf16 v[208:211], v[44:47], a[140:143], v[208:211]
 ds_read_b128 a[128:131], v0 offset:58368
 buffer_load_dwordx4 v3, s[12:15], s26 offen offset:0 nt lds
 buffer_load_dwordx4 v3, s[12:15], s26 offen offset:2048 nt lds
 v_add_f32 v6, v131, v6
 v_mfma_f32_16x16x32_bf16 v[240:243], v[52:55], a[140:143], v[240:243]
 v_exp_f32 v132, v132
 v_mfma_f32_16x16x32_bf16 v[240:243], v[48:51], a[136:139], v[240:243]
 v_exp_f32 v133, v133
 v_mfma_f32_16x16x32_bf16 a[168:171], v[56:59], a[136:139], a[168:171]
 v_add_f32 v7, v132, v7
 v_cvt_pk_bf16_f32 v106, v132, v133
 v_mfma_f32_16x16x32_bf16 a[168:171], v[60:63], a[140:143], a[168:171]
 v_exp_f32 v134, v134
 v_mfma_f32_16x16x32_bf16 a[200:203], v[68:71], a[140:143], a[200:203]
 ds_read_b128 a[132:135], v0 offset:58880
 v_add_f32 v7, v133, v7
 v_mfma_f32_16x16x32_bf16 a[200:203], v[64:67], a[136:139], a[200:203]
 v_exp_f32 v135, v135
 v_mfma_f32_16x16x32_bf16 v[148:151], v[24:27], a[144:147], v[148:151]
 s_waitcnt lgkmcnt(1)
 v_add_f32 v7, v134, v7
 v_cvt_pk_bf16_f32 v107, v134, v135
 v_mfma_f32_16x16x32_bf16 v[148:151], v[28:31], a[148:151], v[148:151]
 ds_read_b64_tr_b16 a[136:137], v1 offset:33792
 v_add_f32 v7, v135, v7
 v_mfma_f32_16x16x32_bf16 v[180:183], v[36:39], a[148:151], v[180:183]
 v_exp_f32 v72, v72
 v_mfma_f32_16x16x32_bf16 v[180:183], v[32:35], a[144:147], v[180:183]
 v_exp_f32 v73, v73
 v_mfma_f32_16x16x32_bf16 v[212:215], v[40:43], a[144:147], v[212:215]
 s_mov_b32 m0, 78720
 v_exp_f32 v74, v74
 v_mfma_f32_16x16x32_bf16 v[212:215], v[44:47], a[148:151], v[212:215]
 buffer_load_dwordx4 v3, s[12:15], s26 offen offset:128 nt lds
 buffer_load_dwordx4 v3, s[12:15], s26 offen offset:2176 nt lds
 v_add_f32 v8, v72, v8
 v_cvt_pk_bf16_f32 v114, v72, v73
 v_mfma_f32_16x16x32_bf16 v[244:247], v[52:55], a[148:151], v[244:247]
 s_add_u32 s26, s26, 4096
 v_exp_f32 v75, v75
 v_mfma_f32_16x16x32_bf16 v[244:247], v[48:51], a[144:147], v[244:247]
 v_add_f32 v8, v73, v8
 v_add_f32 v8, v74, v8
 v_mfma_f32_16x16x32_bf16 a[172:175], v[56:59], a[144:147], a[172:175]
 v_exp_f32 v20, v20
 v_mfma_f32_16x16x32_bf16 a[172:175], v[60:63], a[148:151], a[172:175]
 v_add_f32 v8, v75, v8
 v_cvt_pk_bf16_f32 v115, v74, v75
 v_mfma_f32_16x16x32_bf16 a[204:207], v[68:71], a[148:151], a[204:207]
 v_exp_f32 v21, v21
 v_mfma_f32_16x16x32_bf16 a[204:207], v[64:67], a[144:147], a[204:207]
 ds_read_b64_tr_b16 a[138:139], v1 offset:37888
 v_add_f32 v10, v20, v21
 v_mfma_f32_16x16x32_bf16 v[16:19], v[116:119], a[0:3], v[12:15]
 v_exp_f32 v22, v22
 v_mfma_f32_16x16x32_bf16 v[16:19], v[124:127], a[4:7], v[16:19]
 ds_read_b64_tr_b16 a[140:141], v1 offset:41984
 v_cvt_pk_bf16_f32 v122, v20, v21
 v_mfma_f32_16x16x32_bf16 v[16:19], a[128:131], a[8:11], v[16:19]
 s_waitcnt lgkmcnt(2)
 v_exp_f32 v23, v23
 v_mfma_f32_16x16x32_bf16 v[16:19], a[132:135], a[12:15], v[16:19]
 v_add_f32 v11, v22, v23
 v_cvt_pk_bf16_f32 v123, v22, v23
 v_mfma_f32_16x16x32_bf16 v[76:79], a[132:135], a[28:31], v[12:15]
 s_mov_b32 m0, 32768
 ds_read_b64_tr_b16 a[142:143], v1 offset:46080
 v_add_f32 v9, v10, v9
 v_mfma_f32_16x16x32_bf16 v[76:79], a[128:131], a[24:27], v[76:79]
 ds_read_b64_tr_b16 a[144:145], v2 offset:33792
 buffer_load_dwordx4 v3, s[8:11], s25 offen offset:0 nt lds
 buffer_load_dwordx4 v3, s[8:11], s25 offen offset:2048 nt lds
 v_add_f32 v9, v11, v9
 v_mfma_f32_16x16x32_bf16 v[76:79], v[124:127], a[20:23], v[76:79]
 v_exp_f32 v16, v16
 v_mfma_f32_16x16x32_bf16 v[76:79], v[116:119], a[16:19], v[76:79]
 v_exp_f32 v17, v17
 v_mfma_f32_16x16x32_bf16 v[128:131], v[116:119], a[32:35], v[12:15]
 v_add_f32 v4, v16, v4
 v_cvt_pk_bf16_f32 v84, v16, v17
 v_mfma_f32_16x16x32_bf16 v[128:131], v[124:127], a[36:39], v[128:131]
 v_exp_f32 v18, v18
 v_mfma_f32_16x16x32_bf16 v[128:131], a[128:131], a[40:43], v[128:131]
 ds_read_b64_tr_b16 a[146:147], v2 offset:37888
 v_add_f32 v4, v17, v4
 v_mfma_f32_16x16x32_bf16 v[128:131], a[132:135], a[44:47], v[128:131]
 v_exp_f32 v19, v19
 v_mfma_f32_16x16x32_bf16 v[132:135], a[132:135], a[60:63], v[12:15]
 v_add_f32 v4, v18, v4
 v_cvt_pk_bf16_f32 v85, v18, v19
 v_mfma_f32_16x16x32_bf16 v[132:135], a[128:131], a[56:59], v[132:135]
 ds_read_b64_tr_b16 a[148:149], v2 offset:41984
 v_add_f32 v4, v19, v4
 v_mfma_f32_16x16x32_bf16 v[132:135], v[124:127], a[52:55], v[132:135]
 v_exp_f32 v76, v76
 v_mfma_f32_16x16x32_bf16 v[132:135], v[116:119], a[48:51], v[132:135]
 v_exp_f32 v77, v77
 v_mfma_f32_16x16x32_bf16 v[72:75], v[116:119], a[64:67], v[12:15]
 s_mov_b32 m0, 33664
 v_add_f32 v5, v76, v5
 v_cvt_pk_bf16_f32 v92, v76, v77
 v_mfma_f32_16x16x32_bf16 v[72:75], v[124:127], a[68:71], v[72:75]
 buffer_load_dwordx4 v3, s[8:11], s25 offen offset:128 nt lds
 buffer_load_dwordx4 v3, s[8:11], s25 offen offset:2176 nt lds
 v_exp_f32 v78, v78
 v_mfma_f32_16x16x32_bf16 v[72:75], a[128:131], a[72:75], v[72:75]
 s_add_u32 s25, s25, 4096
 ds_read_b64_tr_b16 a[150:151], v2 offset:46080
 v_add_f32 v5, v77, v5
 v_mfma_f32_16x16x32_bf16 v[72:75], a[132:135], a[76:79], v[72:75]
 v_exp_f32 v79, v79
 v_mfma_f32_16x16x32_bf16 v[20:23], a[132:135], a[92:95], v[12:15]
 v_add_f32 v5, v78, v5
 v_cvt_pk_bf16_f32 v93, v78, v79
 v_mfma_f32_16x16x32_bf16 v[20:23], a[128:131], a[88:91], v[20:23]
 ds_read_b128 a[112:115], v0 offset:61440
 v_add_f32 v5, v79, v5
 v_mfma_f32_16x16x32_bf16 v[20:23], v[124:127], a[84:87], v[20:23]
 v_exp_f32 v128, v128
 v_mfma_f32_16x16x32_bf16 v[20:23], v[116:119], a[80:83], v[20:23]
 s_waitcnt lgkmcnt(2)
 v_exp_f32 v129, v129
 v_mfma_f32_16x16x32_bf16 v[152:155], v[24:27], a[136:139], v[152:155]
 v_add_f32 v6, v128, v6
 v_cvt_pk_bf16_f32 v100, v128, v129
 v_mfma_f32_16x16x32_bf16 v[152:155], v[28:31], a[140:143], v[152:155]
 v_exp_f32 v130, v130
 v_mfma_f32_16x16x32_bf16 v[184:187], v[36:39], a[140:143], v[184:187]
 ds_read_b128 a[116:119], v0 offset:61952
 v_add_f32 v6, v129, v6
 v_mfma_f32_16x16x32_bf16 v[184:187], v[32:35], a[136:139], v[184:187]
 v_exp_f32 v131, v131
 v_mfma_f32_16x16x32_bf16 v[216:219], v[40:43], a[136:139], v[216:219]
 s_mov_b32 m0, 36864
 v_add_f32 v6, v130, v6
 v_cvt_pk_bf16_f32 v101, v130, v131
 v_mfma_f32_16x16x32_bf16 v[216:219], v[44:47], a[140:143], v[216:219]
 ds_read_b128 a[120:123], v0 offset:62464
 buffer_load_dwordx4 v3, s[8:11], s25 offen offset:0 nt lds
 buffer_load_dwordx4 v3, s[8:11], s25 offen offset:2048 nt lds
 v_add_f32 v6, v131, v6
 v_mfma_f32_16x16x32_bf16 v[248:251], v[52:55], a[140:143], v[248:251]
 v_exp_f32 v132, v132
 v_mfma_f32_16x16x32_bf16 v[248:251], v[48:51], a[136:139], v[248:251]
 v_exp_f32 v133, v133
 v_mfma_f32_16x16x32_bf16 a[176:179], v[56:59], a[136:139], a[176:179]
 v_add_f32 v7, v132, v7
 v_cvt_pk_bf16_f32 v108, v132, v133
 v_mfma_f32_16x16x32_bf16 a[176:179], v[60:63], a[140:143], a[176:179]
 v_exp_f32 v134, v134
 v_mfma_f32_16x16x32_bf16 a[208:211], v[68:71], a[140:143], a[208:211]
 ds_read_b128 a[124:127], v0 offset:62976
 v_add_f32 v7, v133, v7
 v_mfma_f32_16x16x32_bf16 a[208:211], v[64:67], a[136:139], a[208:211]
 v_exp_f32 v135, v135
 v_mfma_f32_16x16x32_bf16 v[156:159], v[24:27], a[144:147], v[156:159]
 s_waitcnt lgkmcnt(1)
 v_add_f32 v7, v134, v7
 v_cvt_pk_bf16_f32 v109, v134, v135
 v_mfma_f32_16x16x32_bf16 v[156:159], v[28:31], a[148:151], v[156:159]
 ds_read_b64_tr_b16 a[136:137], v1 offset:34304
 v_add_f32 v7, v135, v7
 v_mfma_f32_16x16x32_bf16 v[188:191], v[36:39], a[148:151], v[188:191]
 v_exp_f32 v72, v72
 v_mfma_f32_16x16x32_bf16 v[188:191], v[32:35], a[144:147], v[188:191]
 v_exp_f32 v73, v73
 v_mfma_f32_16x16x32_bf16 v[220:223], v[40:43], a[144:147], v[220:223]
 s_mov_b32 m0, 37760
 v_exp_f32 v74, v74
 v_mfma_f32_16x16x32_bf16 v[220:223], v[44:47], a[148:151], v[220:223]
 buffer_load_dwordx4 v3, s[8:11], s25 offen offset:128 nt lds
 buffer_load_dwordx4 v3, s[8:11], s25 offen offset:2176 nt lds
 v_add_f32 v8, v72, v8
 v_cvt_pk_bf16_f32 v116, v72, v73
 v_mfma_f32_16x16x32_bf16 v[252:255], v[52:55], a[148:151], v[252:255]
 s_add_u32 s25, s25, 4096
 v_exp_f32 v75, v75
 v_mfma_f32_16x16x32_bf16 v[252:255], v[48:51], a[144:147], v[252:255]
 v_add_f32 v8, v73, v8
 v_add_f32 v8, v74, v8
 v_mfma_f32_16x16x32_bf16 a[180:183], v[56:59], a[144:147], a[180:183]
 v_exp_f32 v20, v20
 v_mfma_f32_16x16x32_bf16 a[180:183], v[60:63], a[148:151], a[180:183]
 v_add_f32 v8, v75, v8
 v_cvt_pk_bf16_f32 v117, v74, v75
 v_mfma_f32_16x16x32_bf16 a[212:215], v[68:71], a[148:151], a[212:215]
 v_exp_f32 v21, v21
 v_mfma_f32_16x16x32_bf16 a[212:215], v[64:67], a[144:147], a[212:215]
 ds_read_b64_tr_b16 a[138:139], v1 offset:38400
 v_add_f32 v10, v20, v21
 v_mfma_f32_16x16x32_bf16 v[16:19], a[112:115], a[0:3], v[12:15]
 v_exp_f32 v22, v22
 v_mfma_f32_16x16x32_bf16 v[16:19], a[116:119], a[4:7], v[16:19]
 ds_read_b64_tr_b16 a[140:141], v1 offset:42496
 v_cvt_pk_bf16_f32 v124, v20, v21
 v_mfma_f32_16x16x32_bf16 v[16:19], a[120:123], a[8:11], v[16:19]
 s_waitcnt lgkmcnt(2)
 v_exp_f32 v23, v23
 v_mfma_f32_16x16x32_bf16 v[16:19], a[124:127], a[12:15], v[16:19]
 s_mov_b32 m0, 40960
 v_add_f32 v11, v22, v23
 v_cvt_pk_bf16_f32 v125, v22, v23
 v_mfma_f32_16x16x32_bf16 v[76:79], a[124:127], a[28:31], v[12:15]
 s_waitcnt vmcnt(40)
 ds_read_b64_tr_b16 a[142:143], v1 offset:46592
 v_add_f32 v9, v10, v9
 v_mfma_f32_16x16x32_bf16 v[76:79], a[120:123], a[24:27], v[76:79]
 s_barrier
 ds_read_b64_tr_b16 a[144:145], v2 offset:34304
 buffer_load_dwordx4 v3, s[8:11], s25 offen offset:0 nt lds
 buffer_load_dwordx4 v3, s[8:11], s25 offen offset:2048 nt lds
 v_add_f32 v9, v11, v9
 v_mfma_f32_16x16x32_bf16 v[76:79], a[116:119], a[20:23], v[76:79]
 v_exp_f32 v16, v16
 v_mfma_f32_16x16x32_bf16 v[76:79], a[112:115], a[16:19], v[76:79]
 v_exp_f32 v17, v17
 v_mfma_f32_16x16x32_bf16 v[128:131], a[112:115], a[32:35], v[12:15]
 v_add_f32 v4, v16, v4
 v_cvt_pk_bf16_f32 v86, v16, v17
 v_mfma_f32_16x16x32_bf16 v[128:131], a[116:119], a[36:39], v[128:131]
 v_exp_f32 v18, v18
 v_mfma_f32_16x16x32_bf16 v[128:131], a[120:123], a[40:43], v[128:131]
 ds_read_b64_tr_b16 a[146:147], v2 offset:38400
 v_add_f32 v4, v17, v4
 v_mfma_f32_16x16x32_bf16 v[128:131], a[124:127], a[44:47], v[128:131]
 v_exp_f32 v19, v19
 v_mfma_f32_16x16x32_bf16 v[20:23], a[124:127], a[60:63], v[12:15]
 v_add_f32 v4, v18, v4
 v_cvt_pk_bf16_f32 v87, v18, v19
 v_mfma_f32_16x16x32_bf16 v[20:23], a[120:123], a[56:59], v[20:23]
 ds_read_b64_tr_b16 a[148:149], v2 offset:42496
 v_add_f32 v4, v19, v4
 v_mfma_f32_16x16x32_bf16 v[20:23], a[116:119], a[52:55], v[20:23]
 v_exp_f32 v76, v76
 v_mfma_f32_16x16x32_bf16 v[20:23], a[112:115], a[48:51], v[20:23]
 s_waitcnt lgkmcnt(2)
 v_exp_f32 v77, v77
 v_mfma_f32_16x16x32_bf16 v[160:163], v[24:27], a[136:139], v[160:163]
 s_mov_b32 m0, 41856
 v_add_f32 v5, v76, v5
 v_cvt_pk_bf16_f32 v94, v76, v77
 v_mfma_f32_16x16x32_bf16 v[160:163], v[28:31], a[140:143], v[160:163]
 buffer_load_dwordx4 v3, s[8:11], s25 offen offset:128 nt lds
 buffer_load_dwordx4 v3, s[8:11], s25 offen offset:2176 nt lds
 v_exp_f32 v78, v78
 v_mfma_f32_16x16x32_bf16 v[192:195], v[36:39], a[140:143], v[192:195]
 s_add_u32 s25, s25, 4096
 ds_read_b64_tr_b16 a[150:151], v2 offset:46592
 v_add_f32 v5, v77, v5
 v_mfma_f32_16x16x32_bf16 v[192:195], v[32:35], a[136:139], v[192:195]
 v_exp_f32 v79, v79
 v_mfma_f32_16x16x32_bf16 v[224:227], v[40:43], a[136:139], v[224:227]
 v_add_f32 v5, v78, v5
 v_cvt_pk_bf16_f32 v95, v78, v79
 v_mfma_f32_16x16x32_bf16 v[224:227], v[44:47], a[140:143], v[224:227]
 ds_read_b128 a[128:131], v0 offset:0
 v_add_f32 v5, v79, v5
 v_mfma_f32_16x16x32_bf16 a[152:155], v[52:55], a[140:143], a[152:155]
 v_exp_f32 v128, v128
 v_mfma_f32_16x16x32_bf16 a[152:155], v[48:51], a[136:139], a[152:155]
 v_exp_f32 v129, v129
 v_mfma_f32_16x16x32_bf16 a[184:187], v[56:59], a[136:139], a[184:187]
 v_exp_f32 v130, v130
 v_mfma_f32_16x16x32_bf16 a[184:187], v[60:63], a[140:143], a[184:187]
 v_add_f32 v6, v128, v6
 v_cvt_pk_bf16_f32 v102, v128, v129
 v_mfma_f32_16x16x32_bf16 a[216:219], v[68:71], a[140:143], a[216:219]
 v_exp_f32 v131, v131
 v_mfma_f32_16x16x32_bf16 a[216:219], v[64:67], a[136:139], a[216:219]
 s_waitcnt lgkmcnt(1)
 v_add_f32 v6, v129, v6
 v_add_f32 v6, v130, v6
 v_mfma_f32_16x16x32_bf16 v[164:167], v[24:27], a[144:147], v[164:167]
 s_mov_b32 m0, 45056
 v_exp_f32 v20, v20
 v_mfma_f32_16x16x32_bf16 v[164:167], v[28:31], a[148:151], v[164:167]
 buffer_load_dwordx4 v3, s[8:11], s25 offen offset:0 nt lds
 buffer_load_dwordx4 v3, s[8:11], s25 offen offset:2048 nt lds
 v_add_f32 v6, v131, v6
 v_cvt_pk_bf16_f32 v103, v130, v131
 v_mfma_f32_16x16x32_bf16 v[196:199], v[36:39], a[148:151], v[196:199]
 v_exp_f32 v21, v21
 v_mfma_f32_16x16x32_bf16 v[196:199], v[32:35], a[144:147], v[196:199]
 ds_read_b128 a[132:135], v0 offset:512
 v_add_f32 v10, v20, v21
 v_mfma_f32_16x16x32_bf16 v[16:19], a[112:115], a[64:67], v[12:15]
 v_exp_f32 v22, v22
 v_mfma_f32_16x16x32_bf16 v[16:19], a[116:119], a[68:71], v[16:19]
 ds_read_b128 v[28:31], v0 offset:1024
 v_cvt_pk_bf16_f32 v110, v20, v21
 v_mfma_f32_16x16x32_bf16 v[16:19], a[120:123], a[72:75], v[16:19]
 v_exp_f32 v23, v23
 v_mfma_f32_16x16x32_bf16 v[16:19], a[124:127], a[76:79], v[16:19]
 v_add_f32 v11, v22, v23
 v_cvt_pk_bf16_f32 v111, v22, v23
 v_mfma_f32_16x16x32_bf16 v[20:23], a[124:127], a[92:95], v[12:15]
 ds_read_b128 v[36:39], v0 offset:1536
 v_add_f32 v7, v10, v7
 v_mfma_f32_16x16x32_bf16 v[20:23], a[120:123], a[88:91], v[20:23]
 ds_read_b64_tr_b16 a[136:137], v1 offset:49152
 v_add_f32 v7, v11, v7
 v_mfma_f32_16x16x32_bf16 v[20:23], a[116:119], a[84:87], v[20:23]
 v_exp_f32 v16, v16
 v_mfma_f32_16x16x32_bf16 v[20:23], a[112:115], a[80:83], v[20:23]
 v_exp_f32 v17, v17
 v_mfma_f32_16x16x32_bf16 v[228:231], v[40:43], a[144:147], v[228:231]
 s_mov_b32 m0, 45952
 v_exp_f32 v18, v18
 v_mfma_f32_16x16x32_bf16 v[228:231], v[44:47], a[148:151], v[228:231]
 buffer_load_dwordx4 v3, s[8:11], s25 offen offset:128 nt lds
 buffer_load_dwordx4 v3, s[8:11], s25 offen offset:2176 nt lds
 v_add_f32 v8, v16, v8
 v_cvt_pk_bf16_f32 v118, v16, v17
 v_mfma_f32_16x16x32_bf16 a[156:159], v[52:55], a[148:151], a[156:159]
 s_add_u32 s25, s25, 4096
 v_exp_f32 v19, v19
 v_mfma_f32_16x16x32_bf16 a[156:159], v[48:51], a[144:147], a[156:159]
 v_add_f32 v8, v17, v8
 v_add_f32 v8, v18, v8
 v_mfma_f32_16x16x32_bf16 a[188:191], v[56:59], a[144:147], a[188:191]
 v_exp_f32 v20, v20
 v_mfma_f32_16x16x32_bf16 a[188:191], v[60:63], a[148:151], a[188:191]
 v_add_f32 v8, v19, v8
 v_cvt_pk_bf16_f32 v119, v18, v19
 v_mfma_f32_16x16x32_bf16 a[220:223], v[68:71], a[148:151], a[220:223]
 v_exp_f32 v21, v21
 v_mfma_f32_16x16x32_bf16 a[220:223], v[64:67], a[144:147], a[220:223]
 s_waitcnt lgkmcnt(0)
 ds_read_b64_tr_b16 a[138:139], v1 offset:53248
 v_add_f32 v10, v20, v21
 v_mfma_f32_16x16x32_bf16 v[16:19], a[128:131], a[0:3], v[12:15]
 v_exp_f32 v22, v22
 v_mfma_f32_16x16x32_bf16 v[16:19], a[132:135], a[4:7], v[16:19]
 ds_read_b64_tr_b16 a[140:141], v1 offset:57344
 v_cvt_pk_bf16_f32 v126, v20, v21
 v_mfma_f32_16x16x32_bf16 v[16:19], v[28:31], a[8:11], v[16:19]
 v_exp_f32 v23, v23
 v_mfma_f32_16x16x32_bf16 v[16:19], v[36:39], a[12:15], v[16:19]
 v_add_f32 v11, v22, v23
 v_cvt_pk_bf16_f32 v127, v22, v23
 v_mfma_f32_16x16x32_bf16 v[76:79], v[36:39], a[28:31], v[12:15]
 s_mov_b32 m0, 81920
 ds_read_b64_tr_b16 a[142:143], v1 offset:61440
 v_add_f32 v9, v10, v9
 v_mfma_f32_16x16x32_bf16 v[76:79], v[28:31], a[24:27], v[76:79]
 ds_read_b64_tr_b16 a[144:145], v2 offset:49152
 buffer_load_dwordx4 v3, s[12:15], s26 offen offset:0 nt lds
 buffer_load_dwordx4 v3, s[12:15], s26 offen offset:2048 nt lds
 v_add_f32 v9, v11, v9
 v_mfma_f32_16x16x32_bf16 v[76:79], a[132:135], a[20:23], v[76:79]
 v_exp_f32 v16, v16
 v_mfma_f32_16x16x32_bf16 v[76:79], a[128:131], a[16:19], v[76:79]
 v_exp_f32 v17, v17
 v_mfma_f32_16x16x32_bf16 v[128:131], a[128:131], a[32:35], v[12:15]
 v_add_f32 v4, v16, v4
 v_cvt_pk_bf16_f32 v24, v16, v17
 v_mfma_f32_16x16x32_bf16 v[128:131], a[132:135], a[36:39], v[128:131]
 v_exp_f32 v18, v18
 v_mfma_f32_16x16x32_bf16 v[128:131], v[28:31], a[40:43], v[128:131]
 ds_read_b64_tr_b16 a[146:147], v2 offset:53248
 v_add_f32 v4, v17, v4
 v_mfma_f32_16x16x32_bf16 v[128:131], v[36:39], a[44:47], v[128:131]
 v_exp_f32 v19, v19
 v_mfma_f32_16x16x32_bf16 v[132:135], v[36:39], a[60:63], v[12:15]
 v_add_f32 v4, v18, v4
 v_cvt_pk_bf16_f32 v25, v18, v19
 v_mfma_f32_16x16x32_bf16 v[132:135], v[28:31], a[56:59], v[132:135]
 ds_read_b64_tr_b16 a[148:149], v2 offset:57344
 v_add_f32 v4, v19, v4
 v_mfma_f32_16x16x32_bf16 v[132:135], a[132:135], a[52:55], v[132:135]
 v_exp_f32 v76, v76
 v_mfma_f32_16x16x32_bf16 v[132:135], a[128:131], a[48:51], v[132:135]
 v_exp_f32 v77, v77
 v_mfma_f32_16x16x32_bf16 v[72:75], a[128:131], a[64:67], v[12:15]
 s_mov_b32 m0, 82816
 v_add_f32 v5, v76, v5
 v_cvt_pk_bf16_f32 v32, v76, v77
 v_mfma_f32_16x16x32_bf16 v[72:75], a[132:135], a[68:71], v[72:75]
 buffer_load_dwordx4 v3, s[12:15], s26 offen offset:128 nt lds
 buffer_load_dwordx4 v3, s[12:15], s26 offen offset:2176 nt lds
 v_exp_f32 v78, v78
 v_mfma_f32_16x16x32_bf16 v[72:75], v[28:31], a[72:75], v[72:75]
 s_add_u32 s26, s26, 4096
 ds_read_b64_tr_b16 a[150:151], v2 offset:61440
 v_add_f32 v5, v77, v5
 v_mfma_f32_16x16x32_bf16 v[72:75], v[36:39], a[76:79], v[72:75]
 v_exp_f32 v79, v79
 v_mfma_f32_16x16x32_bf16 v[20:23], v[36:39], a[92:95], v[12:15]
 v_add_f32 v5, v78, v5
 v_cvt_pk_bf16_f32 v33, v78, v79
 v_mfma_f32_16x16x32_bf16 v[20:23], v[28:31], a[88:91], v[20:23]
 ds_read_b128 a[112:115], v0 offset:4096
 v_add_f32 v5, v79, v5
 v_mfma_f32_16x16x32_bf16 v[20:23], a[132:135], a[84:87], v[20:23]
 v_exp_f32 v128, v128
 v_mfma_f32_16x16x32_bf16 v[20:23], a[128:131], a[80:83], v[20:23]
 s_waitcnt lgkmcnt(2)
 v_exp_f32 v129, v129
 v_mfma_f32_16x16x32_bf16 v[136:139], v[80:83], a[136:139], v[136:139]
 v_add_f32 v6, v128, v6
 v_cvt_pk_bf16_f32 v40, v128, v129
 v_mfma_f32_16x16x32_bf16 v[136:139], v[84:87], a[140:143], v[136:139]
 v_exp_f32 v130, v130
 v_mfma_f32_16x16x32_bf16 v[168:171], v[92:95], a[140:143], v[168:171]
 ds_read_b128 a[116:119], v0 offset:4608
 v_add_f32 v6, v129, v6
 v_mfma_f32_16x16x32_bf16 v[168:171], v[88:91], a[136:139], v[168:171]
 v_exp_f32 v131, v131
 v_mfma_f32_16x16x32_bf16 v[200:203], v[96:99], a[136:139], v[200:203]
 s_mov_b32 m0, 86016
 v_add_f32 v6, v130, v6
 v_cvt_pk_bf16_f32 v41, v130, v131
 v_mfma_f32_16x16x32_bf16 v[200:203], v[100:103], a[140:143], v[200:203]
 ds_read_b128 a[120:123], v0 offset:5120
 buffer_load_dwordx4 v3, s[12:15], s26 offen offset:0 nt lds
 buffer_load_dwordx4 v3, s[12:15], s26 offen offset:2048 nt lds
 v_add_f32 v6, v131, v6
 v_mfma_f32_16x16x32_bf16 v[232:235], v[108:111], a[140:143], v[232:235]
 v_exp_f32 v132, v132
 v_mfma_f32_16x16x32_bf16 v[232:235], v[104:107], a[136:139], v[232:235]
 v_exp_f32 v133, v133
 v_mfma_f32_16x16x32_bf16 a[160:163], v[112:115], a[136:139], a[160:163]
 v_add_f32 v7, v132, v7
 v_cvt_pk_bf16_f32 v48, v132, v133
 v_mfma_f32_16x16x32_bf16 a[160:163], v[116:119], a[140:143], a[160:163]
 v_exp_f32 v134, v134
 v_mfma_f32_16x16x32_bf16 a[192:195], v[124:127], a[140:143], a[192:195]
 ds_read_b128 a[124:127], v0 offset:5632
 v_add_f32 v7, v133, v7
 v_mfma_f32_16x16x32_bf16 a[192:195], v[120:123], a[136:139], a[192:195]
 v_exp_f32 v135, v135
 v_mfma_f32_16x16x32_bf16 v[140:143], v[80:83], a[144:147], v[140:143]
 s_waitcnt lgkmcnt(1)
 v_add_f32 v7, v134, v7
 v_cvt_pk_bf16_f32 v49, v134, v135
 v_mfma_f32_16x16x32_bf16 v[140:143], v[84:87], a[148:151], v[140:143]
 ds_read_b64_tr_b16 a[136:137], v1 offset:49664
 v_add_f32 v7, v135, v7
 v_mfma_f32_16x16x32_bf16 v[172:175], v[92:95], a[148:151], v[172:175]
 v_exp_f32 v72, v72
 v_mfma_f32_16x16x32_bf16 v[172:175], v[88:91], a[144:147], v[172:175]
 v_exp_f32 v73, v73
 v_mfma_f32_16x16x32_bf16 v[204:207], v[96:99], a[144:147], v[204:207]
 s_mov_b32 m0, 86912
 v_exp_f32 v74, v74
 v_mfma_f32_16x16x32_bf16 v[204:207], v[100:103], a[148:151], v[204:207]
 buffer_load_dwordx4 v3, s[12:15], s26 offen offset:128 nt lds
 buffer_load_dwordx4 v3, s[12:15], s26 offen offset:2176 nt lds
 v_add_f32 v8, v72, v8
 v_cvt_pk_bf16_f32 v56, v72, v73
 v_mfma_f32_16x16x32_bf16 v[236:239], v[108:111], a[148:151], v[236:239]
 s_add_u32 s26, s26, 4096
 v_exp_f32 v75, v75
 v_mfma_f32_16x16x32_bf16 v[236:239], v[104:107], a[144:147], v[236:239]
 v_add_f32 v8, v73, v8
 v_add_f32 v8, v74, v8
 v_mfma_f32_16x16x32_bf16 a[164:167], v[112:115], a[144:147], a[164:167]
 v_exp_f32 v20, v20
 v_mfma_f32_16x16x32_bf16 a[164:167], v[116:119], a[148:151], a[164:167]
 v_add_f32 v8, v75, v8
 v_cvt_pk_bf16_f32 v57, v74, v75
 v_mfma_f32_16x16x32_bf16 a[196:199], v[124:127], a[148:151], a[196:199]
 v_exp_f32 v21, v21
 v_mfma_f32_16x16x32_bf16 a[196:199], v[120:123], a[144:147], a[196:199]
 ds_read_b64_tr_b16 a[138:139], v1 offset:53760
 v_add_f32 v10, v20, v21
 v_mfma_f32_16x16x32_bf16 v[16:19], a[112:115], a[0:3], v[12:15]
 v_exp_f32 v22, v22
 v_mfma_f32_16x16x32_bf16 v[16:19], a[116:119], a[4:7], v[16:19]
 ds_read_b64_tr_b16 a[140:141], v1 offset:57856
 v_cvt_pk_bf16_f32 v64, v20, v21
 v_mfma_f32_16x16x32_bf16 v[16:19], a[120:123], a[8:11], v[16:19]
 s_waitcnt lgkmcnt(2)
 v_exp_f32 v23, v23
 v_mfma_f32_16x16x32_bf16 v[16:19], a[124:127], a[12:15], v[16:19]
 v_add_f32 v11, v22, v23
 v_cvt_pk_bf16_f32 v65, v22, v23
 v_mfma_f32_16x16x32_bf16 v[76:79], a[124:127], a[28:31], v[12:15]
 s_mov_b32 m0, 90112
 ds_read_b64_tr_b16 a[142:143], v1 offset:61952
 v_add_f32 v9, v10, v9
 v_mfma_f32_16x16x32_bf16 v[76:79], a[120:123], a[24:27], v[76:79]
 ds_read_b64_tr_b16 a[144:145], v2 offset:49664
 buffer_load_dwordx4 v3, s[12:15], s26 offen offset:0 nt lds
 buffer_load_dwordx4 v3, s[12:15], s26 offen offset:2048 nt lds
 v_add_f32 v9, v11, v9
 v_mfma_f32_16x16x32_bf16 v[76:79], a[116:119], a[20:23], v[76:79]
 v_exp_f32 v16, v16
 v_mfma_f32_16x16x32_bf16 v[76:79], a[112:115], a[16:19], v[76:79]
 v_exp_f32 v17, v17
 v_mfma_f32_16x16x32_bf16 v[128:131], a[112:115], a[32:35], v[12:15]
 v_add_f32 v4, v16, v4
 v_cvt_pk_bf16_f32 v26, v16, v17
 v_mfma_f32_16x16x32_bf16 v[128:131], a[116:119], a[36:39], v[128:131]
 v_exp_f32 v18, v18
 v_mfma_f32_16x16x32_bf16 v[128:131], a[120:123], a[40:43], v[128:131]
 ds_read_b64_tr_b16 a[146:147], v2 offset:53760
 v_add_f32 v4, v17, v4
 v_mfma_f32_16x16x32_bf16 v[128:131], a[124:127], a[44:47], v[128:131]
 v_exp_f32 v19, v19
 v_mfma_f32_16x16x32_bf16 v[132:135], a[124:127], a[60:63], v[12:15]
 v_add_f32 v4, v18, v4
 v_cvt_pk_bf16_f32 v27, v18, v19
 v_mfma_f32_16x16x32_bf16 v[132:135], a[120:123], a[56:59], v[132:135]
 ds_read_b64_tr_b16 a[148:149], v2 offset:57856
 v_add_f32 v4, v19, v4
 v_mfma_f32_16x16x32_bf16 v[132:135], a[116:119], a[52:55], v[132:135]
 v_exp_f32 v76, v76
 v_mfma_f32_16x16x32_bf16 v[132:135], a[112:115], a[48:51], v[132:135]
 v_exp_f32 v77, v77
 v_mfma_f32_16x16x32_bf16 v[72:75], a[112:115], a[64:67], v[12:15]
 s_mov_b32 m0, 91008
 v_add_f32 v5, v76, v5
 v_cvt_pk_bf16_f32 v34, v76, v77
 v_mfma_f32_16x16x32_bf16 v[72:75], a[116:119], a[68:71], v[72:75]
 buffer_load_dwordx4 v3, s[12:15], s26 offen offset:128 nt lds
 buffer_load_dwordx4 v3, s[12:15], s26 offen offset:2176 nt lds
 v_exp_f32 v78, v78
 v_mfma_f32_16x16x32_bf16 v[72:75], a[120:123], a[72:75], v[72:75]
 s_add_u32 s26, s26, 4096
 ds_read_b64_tr_b16 a[150:151], v2 offset:61952
 v_add_f32 v5, v77, v5
 v_mfma_f32_16x16x32_bf16 v[72:75], a[124:127], a[76:79], v[72:75]
 v_exp_f32 v79, v79
 v_mfma_f32_16x16x32_bf16 v[20:23], a[124:127], a[92:95], v[12:15]
 v_add_f32 v5, v78, v5
 v_cvt_pk_bf16_f32 v35, v78, v79
 v_mfma_f32_16x16x32_bf16 v[20:23], a[120:123], a[88:91], v[20:23]
 ds_read_b128 v[60:63], v0 offset:8192
 v_add_f32 v5, v79, v5
 v_mfma_f32_16x16x32_bf16 v[20:23], a[116:119], a[84:87], v[20:23]
 v_exp_f32 v128, v128
 v_mfma_f32_16x16x32_bf16 v[20:23], a[112:115], a[80:83], v[20:23]
 s_waitcnt lgkmcnt(2)
 v_exp_f32 v129, v129
 v_mfma_f32_16x16x32_bf16 v[144:147], v[80:83], a[136:139], v[144:147]
 v_add_f32 v6, v128, v6
 v_cvt_pk_bf16_f32 v42, v128, v129
 v_mfma_f32_16x16x32_bf16 v[144:147], v[84:87], a[140:143], v[144:147]
 v_exp_f32 v130, v130
 v_mfma_f32_16x16x32_bf16 v[176:179], v[92:95], a[140:143], v[176:179]
 ds_read_b128 v[68:71], v0 offset:8704
 v_add_f32 v6, v129, v6
 v_mfma_f32_16x16x32_bf16 v[176:179], v[88:91], a[136:139], v[176:179]
 v_exp_f32 v131, v131
 v_mfma_f32_16x16x32_bf16 v[208:211], v[96:99], a[136:139], v[208:211]
 s_mov_b32 m0, 94208
 v_add_f32 v6, v130, v6
 v_cvt_pk_bf16_f32 v43, v130, v131
 v_mfma_f32_16x16x32_bf16 v[208:211], v[100:103], a[140:143], v[208:211]
 ds_read_b128 a[128:131], v0 offset:9216
 buffer_load_dwordx4 v3, s[12:15], s26 offen offset:0 nt lds
 buffer_load_dwordx4 v3, s[12:15], s26 offen offset:2048 nt lds
 v_add_f32 v6, v131, v6
 v_mfma_f32_16x16x32_bf16 v[240:243], v[108:111], a[140:143], v[240:243]
 v_exp_f32 v132, v132
 v_mfma_f32_16x16x32_bf16 v[240:243], v[104:107], a[136:139], v[240:243]
 v_exp_f32 v133, v133
 v_mfma_f32_16x16x32_bf16 a[168:171], v[112:115], a[136:139], a[168:171]
 v_add_f32 v7, v132, v7
 v_cvt_pk_bf16_f32 v50, v132, v133
 v_mfma_f32_16x16x32_bf16 a[168:171], v[116:119], a[140:143], a[168:171]
 v_exp_f32 v134, v134
 v_mfma_f32_16x16x32_bf16 a[200:203], v[124:127], a[140:143], a[200:203]
 ds_read_b128 a[132:135], v0 offset:9728
 v_add_f32 v7, v133, v7
 v_mfma_f32_16x16x32_bf16 a[200:203], v[120:123], a[136:139], a[200:203]
 v_exp_f32 v135, v135
 v_mfma_f32_16x16x32_bf16 v[148:151], v[80:83], a[144:147], v[148:151]
 s_waitcnt lgkmcnt(1)
 v_add_f32 v7, v134, v7
 v_cvt_pk_bf16_f32 v51, v134, v135
 v_mfma_f32_16x16x32_bf16 v[148:151], v[84:87], a[148:151], v[148:151]
 ds_read_b64_tr_b16 a[136:137], v1 offset:50176
 v_add_f32 v7, v135, v7
 v_mfma_f32_16x16x32_bf16 v[180:183], v[92:95], a[148:151], v[180:183]
 v_exp_f32 v72, v72
 v_mfma_f32_16x16x32_bf16 v[180:183], v[88:91], a[144:147], v[180:183]
 v_exp_f32 v73, v73
 v_mfma_f32_16x16x32_bf16 v[212:215], v[96:99], a[144:147], v[212:215]
 s_mov_b32 m0, 95104
 v_exp_f32 v74, v74
 v_mfma_f32_16x16x32_bf16 v[212:215], v[100:103], a[148:151], v[212:215]
 buffer_load_dwordx4 v3, s[12:15], s26 offen offset:128 nt lds
 buffer_load_dwordx4 v3, s[12:15], s26 offen offset:2176 nt lds
 v_add_f32 v8, v72, v8
 v_cvt_pk_bf16_f32 v58, v72, v73
 v_mfma_f32_16x16x32_bf16 v[244:247], v[108:111], a[148:151], v[244:247]
 s_add_u32 s26, s26, 4096
 v_exp_f32 v75, v75
 v_mfma_f32_16x16x32_bf16 v[244:247], v[104:107], a[144:147], v[244:247]
 v_add_f32 v8, v73, v8
 v_add_f32 v8, v74, v8
 v_mfma_f32_16x16x32_bf16 a[172:175], v[112:115], a[144:147], a[172:175]
 v_exp_f32 v20, v20
 v_mfma_f32_16x16x32_bf16 a[172:175], v[116:119], a[148:151], a[172:175]
 v_add_f32 v8, v75, v8
 v_cvt_pk_bf16_f32 v59, v74, v75
 v_mfma_f32_16x16x32_bf16 a[204:207], v[124:127], a[148:151], a[204:207]
 v_exp_f32 v21, v21
 v_mfma_f32_16x16x32_bf16 a[204:207], v[120:123], a[144:147], a[204:207]
 ds_read_b64_tr_b16 a[138:139], v1 offset:54272
 v_add_f32 v10, v20, v21
 v_mfma_f32_16x16x32_bf16 v[16:19], v[60:63], a[0:3], v[12:15]
 v_exp_f32 v22, v22
 v_mfma_f32_16x16x32_bf16 v[16:19], v[68:71], a[4:7], v[16:19]
 ds_read_b64_tr_b16 a[140:141], v1 offset:58368
 v_cvt_pk_bf16_f32 v66, v20, v21
 v_mfma_f32_16x16x32_bf16 v[16:19], a[128:131], a[8:11], v[16:19]
 s_waitcnt lgkmcnt(2)
 v_exp_f32 v23, v23
 v_mfma_f32_16x16x32_bf16 v[16:19], a[132:135], a[12:15], v[16:19]
 v_add_f32 v11, v22, v23
 v_cvt_pk_bf16_f32 v67, v22, v23
 v_mfma_f32_16x16x32_bf16 v[76:79], a[132:135], a[28:31], v[12:15]
 s_mov_b32 m0, 49152
 ds_read_b64_tr_b16 a[142:143], v1 offset:62464
 v_add_f32 v9, v10, v9
 v_mfma_f32_16x16x32_bf16 v[76:79], a[128:131], a[24:27], v[76:79]
 ds_read_b64_tr_b16 a[144:145], v2 offset:50176
 buffer_load_dwordx4 v3, s[8:11], s25 offen offset:0 nt lds
 buffer_load_dwordx4 v3, s[8:11], s25 offen offset:2048 nt lds
 v_add_f32 v9, v11, v9
 v_mfma_f32_16x16x32_bf16 v[76:79], v[68:71], a[20:23], v[76:79]
 v_exp_f32 v16, v16
 v_mfma_f32_16x16x32_bf16 v[76:79], v[60:63], a[16:19], v[76:79]
 v_exp_f32 v17, v17
 v_mfma_f32_16x16x32_bf16 v[128:131], v[60:63], a[32:35], v[12:15]
 v_add_f32 v4, v16, v4
 v_cvt_pk_bf16_f32 v28, v16, v17
 v_mfma_f32_16x16x32_bf16 v[128:131], v[68:71], a[36:39], v[128:131]
 v_exp_f32 v18, v18
 v_mfma_f32_16x16x32_bf16 v[128:131], a[128:131], a[40:43], v[128:131]
 ds_read_b64_tr_b16 a[146:147], v2 offset:54272
 v_add_f32 v4, v17, v4
 v_mfma_f32_16x16x32_bf16 v[128:131], a[132:135], a[44:47], v[128:131]
 v_exp_f32 v19, v19
 v_mfma_f32_16x16x32_bf16 v[132:135], a[132:135], a[60:63], v[12:15]
 v_add_f32 v4, v18, v4
 v_cvt_pk_bf16_f32 v29, v18, v19
 v_mfma_f32_16x16x32_bf16 v[132:135], a[128:131], a[56:59], v[132:135]
 ds_read_b64_tr_b16 a[148:149], v2 offset:58368
 v_add_f32 v4, v19, v4
 v_mfma_f32_16x16x32_bf16 v[132:135], v[68:71], a[52:55], v[132:135]
 v_exp_f32 v76, v76
 v_mfma_f32_16x16x32_bf16 v[132:135], v[60:63], a[48:51], v[132:135]
 v_exp_f32 v77, v77
 v_mfma_f32_16x16x32_bf16 v[72:75], v[60:63], a[64:67], v[12:15]
 s_mov_b32 m0, 50048
 v_add_f32 v5, v76, v5
 v_cvt_pk_bf16_f32 v36, v76, v77
 v_mfma_f32_16x16x32_bf16 v[72:75], v[68:71], a[68:71], v[72:75]
 buffer_load_dwordx4 v3, s[8:11], s25 offen offset:128 nt lds
 buffer_load_dwordx4 v3, s[8:11], s25 offen offset:2176 nt lds
 v_exp_f32 v78, v78
 v_mfma_f32_16x16x32_bf16 v[72:75], a[128:131], a[72:75], v[72:75]
 s_add_u32 s25, s25, 4096
 ds_read_b64_tr_b16 a[150:151], v2 offset:62464
 v_add_f32 v5, v77, v5
 v_mfma_f32_16x16x32_bf16 v[72:75], a[132:135], a[76:79], v[72:75]
 v_exp_f32 v79, v79
 v_mfma_f32_16x16x32_bf16 v[20:23], a[132:135], a[92:95], v[12:15]
 v_add_f32 v5, v78, v5
 v_cvt_pk_bf16_f32 v37, v78, v79
 v_mfma_f32_16x16x32_bf16 v[20:23], a[128:131], a[88:91], v[20:23]
 ds_read_b128 a[112:115], v0 offset:12288
 v_add_f32 v5, v79, v5
 v_mfma_f32_16x16x32_bf16 v[20:23], v[68:71], a[84:87], v[20:23]
 v_exp_f32 v128, v128
 v_mfma_f32_16x16x32_bf16 v[20:23], v[60:63], a[80:83], v[20:23]
 s_waitcnt lgkmcnt(2)
 v_exp_f32 v129, v129
 v_mfma_f32_16x16x32_bf16 v[152:155], v[80:83], a[136:139], v[152:155]
 v_add_f32 v6, v128, v6
 v_cvt_pk_bf16_f32 v44, v128, v129
 v_mfma_f32_16x16x32_bf16 v[152:155], v[84:87], a[140:143], v[152:155]
 v_exp_f32 v130, v130
 v_mfma_f32_16x16x32_bf16 v[184:187], v[92:95], a[140:143], v[184:187]
 ds_read_b128 a[116:119], v0 offset:12800
 v_add_f32 v6, v129, v6
 v_mfma_f32_16x16x32_bf16 v[184:187], v[88:91], a[136:139], v[184:187]
 v_exp_f32 v131, v131
 v_mfma_f32_16x16x32_bf16 v[216:219], v[96:99], a[136:139], v[216:219]
 s_mov_b32 m0, 53248
 v_add_f32 v6, v130, v6
 v_cvt_pk_bf16_f32 v45, v130, v131
 v_mfma_f32_16x16x32_bf16 v[216:219], v[100:103], a[140:143], v[216:219]
 ds_read_b128 a[120:123], v0 offset:13312
 buffer_load_dwordx4 v3, s[8:11], s25 offen offset:0 nt lds
 buffer_load_dwordx4 v3, s[8:11], s25 offen offset:2048 nt lds
 v_add_f32 v6, v131, v6
 v_mfma_f32_16x16x32_bf16 v[248:251], v[108:111], a[140:143], v[248:251]
 v_exp_f32 v132, v132
 v_mfma_f32_16x16x32_bf16 v[248:251], v[104:107], a[136:139], v[248:251]
 v_exp_f32 v133, v133
 v_mfma_f32_16x16x32_bf16 a[176:179], v[112:115], a[136:139], a[176:179]
 v_add_f32 v7, v132, v7
 v_cvt_pk_bf16_f32 v52, v132, v133
 v_mfma_f32_16x16x32_bf16 a[176:179], v[116:119], a[140:143], a[176:179]
 v_exp_f32 v134, v134
 v_mfma_f32_16x16x32_bf16 a[208:211], v[124:127], a[140:143], a[208:211]
 ds_read_b128 a[124:127], v0 offset:13824
 v_add_f32 v7, v133, v7
 v_mfma_f32_16x16x32_bf16 a[208:211], v[120:123], a[136:139], a[208:211]
 v_exp_f32 v135, v135
 v_mfma_f32_16x16x32_bf16 v[156:159], v[80:83], a[144:147], v[156:159]
 s_waitcnt lgkmcnt(1)
 v_add_f32 v7, v134, v7
 v_cvt_pk_bf16_f32 v53, v134, v135
 v_mfma_f32_16x16x32_bf16 v[156:159], v[84:87], a[148:151], v[156:159]
 ds_read_b64_tr_b16 a[136:137], v1 offset:50688
 v_add_f32 v7, v135, v7
 v_mfma_f32_16x16x32_bf16 v[188:191], v[92:95], a[148:151], v[188:191]
 v_exp_f32 v72, v72
 v_mfma_f32_16x16x32_bf16 v[188:191], v[88:91], a[144:147], v[188:191]
 v_exp_f32 v73, v73
 v_mfma_f32_16x16x32_bf16 v[220:223], v[96:99], a[144:147], v[220:223]
 s_mov_b32 m0, 54144
 v_exp_f32 v74, v74
 v_mfma_f32_16x16x32_bf16 v[220:223], v[100:103], a[148:151], v[220:223]
 buffer_load_dwordx4 v3, s[8:11], s25 offen offset:128 nt lds
 buffer_load_dwordx4 v3, s[8:11], s25 offen offset:2176 nt lds
 v_add_f32 v8, v72, v8
 v_cvt_pk_bf16_f32 v60, v72, v73
 v_mfma_f32_16x16x32_bf16 v[252:255], v[108:111], a[148:151], v[252:255]
 s_add_u32 s25, s25, 4096
 v_exp_f32 v75, v75
 v_mfma_f32_16x16x32_bf16 v[252:255], v[104:107], a[144:147], v[252:255]
 v_add_f32 v8, v73, v8
 v_add_f32 v8, v74, v8
 v_mfma_f32_16x16x32_bf16 a[180:183], v[112:115], a[144:147], a[180:183]
 v_exp_f32 v20, v20
 v_mfma_f32_16x16x32_bf16 a[180:183], v[116:119], a[148:151], a[180:183]
 v_add_f32 v8, v75, v8
 v_cvt_pk_bf16_f32 v61, v74, v75
 v_mfma_f32_16x16x32_bf16 a[212:215], v[124:127], a[148:151], a[212:215]
 v_exp_f32 v21, v21
 v_mfma_f32_16x16x32_bf16 a[212:215], v[120:123], a[144:147], a[212:215]
 ds_read_b64_tr_b16 a[138:139], v1 offset:54784
 v_add_f32 v10, v20, v21
 v_mfma_f32_16x16x32_bf16 v[16:19], a[112:115], a[0:3], v[12:15]
 v_exp_f32 v22, v22
 v_mfma_f32_16x16x32_bf16 v[16:19], a[116:119], a[4:7], v[16:19]
 ds_read_b64_tr_b16 a[140:141], v1 offset:58880
 v_cvt_pk_bf16_f32 v68, v20, v21
 v_mfma_f32_16x16x32_bf16 v[16:19], a[120:123], a[8:11], v[16:19]
 s_waitcnt lgkmcnt(2)
 v_exp_f32 v23, v23
 v_mfma_f32_16x16x32_bf16 v[16:19], a[124:127], a[12:15], v[16:19]
 s_mov_b32 m0, 57344
 v_add_f32 v11, v22, v23
 v_cvt_pk_bf16_f32 v69, v22, v23
 v_mfma_f32_16x16x32_bf16 v[76:79], a[124:127], a[28:31], v[12:15]
 s_waitcnt vmcnt(40)
 ds_read_b64_tr_b16 a[142:143], v1 offset:62976
 v_add_f32 v9, v10, v9
 v_mfma_f32_16x16x32_bf16 v[76:79], a[120:123], a[24:27], v[76:79]
 s_barrier
 ds_read_b64_tr_b16 a[144:145], v2 offset:50688
 buffer_load_dwordx4 v3, s[8:11], s25 offen offset:0 nt lds
 buffer_load_dwordx4 v3, s[8:11], s25 offen offset:2048 nt lds
 v_add_f32 v9, v11, v9
 v_mfma_f32_16x16x32_bf16 v[76:79], a[116:119], a[20:23], v[76:79]
 v_exp_f32 v16, v16
 v_mfma_f32_16x16x32_bf16 v[76:79], a[112:115], a[16:19], v[76:79]
 v_exp_f32 v17, v17
 v_mfma_f32_16x16x32_bf16 v[128:131], a[112:115], a[32:35], v[12:15]
 v_add_f32 v4, v16, v4
 v_cvt_pk_bf16_f32 v30, v16, v17
 v_mfma_f32_16x16x32_bf16 v[128:131], a[116:119], a[36:39], v[128:131]
 v_exp_f32 v18, v18
 v_mfma_f32_16x16x32_bf16 v[128:131], a[120:123], a[40:43], v[128:131]
 ds_read_b64_tr_b16 a[146:147], v2 offset:54784
 v_add_f32 v4, v17, v4
 v_mfma_f32_16x16x32_bf16 v[128:131], a[124:127], a[44:47], v[128:131]
 v_exp_f32 v19, v19
 v_mfma_f32_16x16x32_bf16 v[20:23], a[124:127], a[60:63], v[12:15]
 v_add_f32 v4, v18, v4
 v_cvt_pk_bf16_f32 v31, v18, v19
 v_mfma_f32_16x16x32_bf16 v[20:23], a[120:123], a[56:59], v[20:23]
 ds_read_b64_tr_b16 a[148:149], v2 offset:58880
 v_add_f32 v4, v19, v4
 v_mfma_f32_16x16x32_bf16 v[20:23], a[116:119], a[52:55], v[20:23]
 v_exp_f32 v76, v76
 v_mfma_f32_16x16x32_bf16 v[20:23], a[112:115], a[48:51], v[20:23]
 s_waitcnt lgkmcnt(2)
 v_exp_f32 v77, v77
 v_mfma_f32_16x16x32_bf16 v[160:163], v[80:83], a[136:139], v[160:163]
 s_mov_b32 m0, 58240
 v_add_f32 v5, v76, v5
 v_cvt_pk_bf16_f32 v38, v76, v77
 v_mfma_f32_16x16x32_bf16 v[160:163], v[84:87], a[140:143], v[160:163]
 buffer_load_dwordx4 v3, s[8:11], s25 offen offset:128 nt lds
 buffer_load_dwordx4 v3, s[8:11], s25 offen offset:2176 nt lds
 v_exp_f32 v78, v78
 v_mfma_f32_16x16x32_bf16 v[192:195], v[92:95], a[140:143], v[192:195]
 s_add_u32 s25, s25, 4096
 ds_read_b64_tr_b16 a[150:151], v2 offset:62976
 v_add_f32 v5, v77, v5
 v_mfma_f32_16x16x32_bf16 v[192:195], v[88:91], a[136:139], v[192:195]
 v_exp_f32 v79, v79
 v_mfma_f32_16x16x32_bf16 v[224:227], v[96:99], a[136:139], v[224:227]
 v_add_f32 v5, v78, v5
 v_cvt_pk_bf16_f32 v39, v78, v79
 v_mfma_f32_16x16x32_bf16 v[224:227], v[100:103], a[140:143], v[224:227]
 ds_read_b128 a[128:131], v0 offset:16384
 v_add_f32 v5, v79, v5
 v_mfma_f32_16x16x32_bf16 a[152:155], v[108:111], a[140:143], a[152:155]
 v_exp_f32 v128, v128
 v_mfma_f32_16x16x32_bf16 a[152:155], v[104:107], a[136:139], a[152:155]
 v_exp_f32 v129, v129
 v_mfma_f32_16x16x32_bf16 a[184:187], v[112:115], a[136:139], a[184:187]
 v_exp_f32 v130, v130
 v_mfma_f32_16x16x32_bf16 a[184:187], v[116:119], a[140:143], a[184:187]
 v_add_f32 v6, v128, v6
 v_cvt_pk_bf16_f32 v46, v128, v129
 v_mfma_f32_16x16x32_bf16 a[216:219], v[124:127], a[140:143], a[216:219]
 v_exp_f32 v131, v131
 v_mfma_f32_16x16x32_bf16 a[216:219], v[120:123], a[136:139], a[216:219]
 s_waitcnt lgkmcnt(1)
 v_add_f32 v6, v129, v6
 v_add_f32 v6, v130, v6
 v_mfma_f32_16x16x32_bf16 v[164:167], v[80:83], a[144:147], v[164:167]
 s_mov_b32 m0, 61440
 v_exp_f32 v20, v20
 v_mfma_f32_16x16x32_bf16 v[164:167], v[84:87], a[148:151], v[164:167]
 buffer_load_dwordx4 v3, s[8:11], s25 offen offset:0 nt lds
 buffer_load_dwordx4 v3, s[8:11], s25 offen offset:2048 nt lds
 v_add_f32 v6, v131, v6
 v_cvt_pk_bf16_f32 v47, v130, v131
 v_mfma_f32_16x16x32_bf16 v[196:199], v[92:95], a[148:151], v[196:199]
 v_exp_f32 v21, v21
 v_mfma_f32_16x16x32_bf16 v[196:199], v[88:91], a[144:147], v[196:199]
 ds_read_b128 a[132:135], v0 offset:16896
 v_add_f32 v10, v20, v21
 v_mfma_f32_16x16x32_bf16 v[16:19], a[112:115], a[64:67], v[12:15]
 v_exp_f32 v22, v22
 v_mfma_f32_16x16x32_bf16 v[16:19], a[116:119], a[68:71], v[16:19]
 ds_read_b128 v[84:87], v0 offset:17408
 v_cvt_pk_bf16_f32 v54, v20, v21
 v_mfma_f32_16x16x32_bf16 v[16:19], a[120:123], a[72:75], v[16:19]
 v_exp_f32 v23, v23
 v_mfma_f32_16x16x32_bf16 v[16:19], a[124:127], a[76:79], v[16:19]
 v_add_f32 v11, v22, v23
 v_cvt_pk_bf16_f32 v55, v22, v23
 v_mfma_f32_16x16x32_bf16 v[20:23], a[124:127], a[92:95], v[12:15]
 ds_read_b128 v[92:95], v0 offset:17920
 v_add_f32 v7, v10, v7
 v_mfma_f32_16x16x32_bf16 v[20:23], a[120:123], a[88:91], v[20:23]
 ds_read_b64_tr_b16 a[136:137], v1 offset:0
 v_add_f32 v7, v11, v7
 v_mfma_f32_16x16x32_bf16 v[20:23], a[116:119], a[84:87], v[20:23]
 v_exp_f32 v16, v16
 v_mfma_f32_16x16x32_bf16 v[20:23], a[112:115], a[80:83], v[20:23]
 v_exp_f32 v17, v17
 v_mfma_f32_16x16x32_bf16 v[228:231], v[96:99], a[144:147], v[228:231]
 s_mov_b32 m0, 62336
 v_exp_f32 v18, v18
 v_mfma_f32_16x16x32_bf16 v[228:231], v[100:103], a[148:151], v[228:231]
 buffer_load_dwordx4 v3, s[8:11], s25 offen offset:128 nt lds
 buffer_load_dwordx4 v3, s[8:11], s25 offen offset:2176 nt lds
 v_add_f32 v8, v16, v8
 v_cvt_pk_bf16_f32 v62, v16, v17
 v_mfma_f32_16x16x32_bf16 a[156:159], v[108:111], a[148:151], a[156:159]
 s_add_u32 s25, s25, 4096
 v_exp_f32 v19, v19
 v_mfma_f32_16x16x32_bf16 a[156:159], v[104:107], a[144:147], a[156:159]
 v_add_f32 v8, v17, v8
 v_add_f32 v8, v18, v8
 v_mfma_f32_16x16x32_bf16 a[188:191], v[112:115], a[144:147], a[188:191]
 v_exp_f32 v20, v20
 v_mfma_f32_16x16x32_bf16 a[188:191], v[116:119], a[148:151], a[188:191]
 v_add_f32 v8, v19, v8
 v_cvt_pk_bf16_f32 v63, v18, v19
 v_mfma_f32_16x16x32_bf16 a[220:223], v[124:127], a[148:151], a[220:223]
 v_exp_f32 v21, v21
 v_mfma_f32_16x16x32_bf16 a[220:223], v[120:123], a[144:147], a[220:223]
 s_waitcnt lgkmcnt(0)
 ds_read_b64_tr_b16 a[138:139], v1 offset:4096
 v_add_f32 v10, v20, v21
 v_mfma_f32_16x16x32_bf16 v[16:19], a[128:131], a[0:3], v[12:15]
 v_exp_f32 v22, v22
 v_mfma_f32_16x16x32_bf16 v[16:19], a[132:135], a[4:7], v[16:19]
 ds_read_b64_tr_b16 a[140:141], v1 offset:8192
 v_cvt_pk_bf16_f32 v70, v20, v21
 v_mfma_f32_16x16x32_bf16 v[16:19], v[84:87], a[8:11], v[16:19]
 v_exp_f32 v23, v23
 v_mfma_f32_16x16x32_bf16 v[16:19], v[92:95], a[12:15], v[16:19]
 v_add_f32 v11, v22, v23
 v_cvt_pk_bf16_f32 v71, v22, v23
 v_mfma_f32_16x16x32_bf16 v[76:79], v[92:95], a[28:31], v[12:15]
 s_mov_b32 m0, 98304
 ds_read_b64_tr_b16 a[142:143], v1 offset:12288
 v_add_f32 v9, v10, v9
 v_mfma_f32_16x16x32_bf16 v[76:79], v[84:87], a[24:27], v[76:79]
 ds_read_b64_tr_b16 a[144:145], v2 offset:0
 buffer_load_dwordx4 v3, s[12:15], s26 offen offset:0 nt lds
 buffer_load_dwordx4 v3, s[12:15], s26 offen offset:2048 nt lds
 v_add_f32 v9, v11, v9
 v_mfma_f32_16x16x32_bf16 v[76:79], a[132:135], a[20:23], v[76:79]
 v_exp_f32 v16, v16
 v_mfma_f32_16x16x32_bf16 v[76:79], a[128:131], a[16:19], v[76:79]
 v_exp_f32 v17, v17
 v_mfma_f32_16x16x32_bf16 v[128:131], a[128:131], a[32:35], v[12:15]
 v_add_f32 v4, v16, v4
 v_cvt_pk_bf16_f32 v80, v16, v17
 v_mfma_f32_16x16x32_bf16 v[128:131], a[132:135], a[36:39], v[128:131]
 v_exp_f32 v18, v18
 v_mfma_f32_16x16x32_bf16 v[128:131], v[84:87], a[40:43], v[128:131]
 ds_read_b64_tr_b16 a[146:147], v2 offset:4096
 v_add_f32 v4, v17, v4
 v_mfma_f32_16x16x32_bf16 v[128:131], v[92:95], a[44:47], v[128:131]
 v_exp_f32 v19, v19
 v_mfma_f32_16x16x32_bf16 v[132:135], v[92:95], a[60:63], v[12:15]
 v_add_f32 v4, v18, v4
 v_cvt_pk_bf16_f32 v81, v18, v19
 v_mfma_f32_16x16x32_bf16 v[132:135], v[84:87], a[56:59], v[132:135]
 ds_read_b64_tr_b16 a[148:149], v2 offset:8192
 v_add_f32 v4, v19, v4
 v_mfma_f32_16x16x32_bf16 v[132:135], a[132:135], a[52:55], v[132:135]
 v_exp_f32 v76, v76
 v_mfma_f32_16x16x32_bf16 v[132:135], a[128:131], a[48:51], v[132:135]
 v_exp_f32 v77, v77
 v_mfma_f32_16x16x32_bf16 v[72:75], a[128:131], a[64:67], v[12:15]
 s_mov_b32 m0, 99200
 v_add_f32 v5, v76, v5
 v_cvt_pk_bf16_f32 v88, v76, v77
 v_mfma_f32_16x16x32_bf16 v[72:75], a[132:135], a[68:71], v[72:75]
 buffer_load_dwordx4 v3, s[12:15], s26 offen offset:128 nt lds
 buffer_load_dwordx4 v3, s[12:15], s26 offen offset:2176 nt lds
 v_exp_f32 v78, v78
 v_mfma_f32_16x16x32_bf16 v[72:75], v[84:87], a[72:75], v[72:75]
 s_add_u32 s26, s26, 4096
 ds_read_b64_tr_b16 a[150:151], v2 offset:12288
 v_add_f32 v5, v77, v5
 v_mfma_f32_16x16x32_bf16 v[72:75], v[92:95], a[76:79], v[72:75]
 v_exp_f32 v79, v79
 v_mfma_f32_16x16x32_bf16 v[20:23], v[92:95], a[92:95], v[12:15]
 v_add_f32 v5, v78, v5
 v_cvt_pk_bf16_f32 v89, v78, v79
 v_mfma_f32_16x16x32_bf16 v[20:23], v[84:87], a[88:91], v[20:23]
 ds_read_b128 a[112:115], v0 offset:20480
 v_add_f32 v5, v79, v5
 v_mfma_f32_16x16x32_bf16 v[20:23], a[132:135], a[84:87], v[20:23]
 v_exp_f32 v128, v128
 v_mfma_f32_16x16x32_bf16 v[20:23], a[128:131], a[80:83], v[20:23]
 s_waitcnt lgkmcnt(2)
 v_exp_f32 v129, v129
 v_mfma_f32_16x16x32_bf16 v[136:139], v[24:27], a[136:139], v[136:139]
 v_add_f32 v6, v128, v6
 v_cvt_pk_bf16_f32 v96, v128, v129
 v_mfma_f32_16x16x32_bf16 v[136:139], v[28:31], a[140:143], v[136:139]
 v_exp_f32 v130, v130
 v_mfma_f32_16x16x32_bf16 v[168:171], v[36:39], a[140:143], v[168:171]
 ds_read_b128 a[116:119], v0 offset:20992
 v_add_f32 v6, v129, v6
 v_mfma_f32_16x16x32_bf16 v[168:171], v[32:35], a[136:139], v[168:171]
 v_exp_f32 v131, v131
 v_mfma_f32_16x16x32_bf16 v[200:203], v[40:43], a[136:139], v[200:203]
 s_mov_b32 m0, 102400
 v_add_f32 v6, v130, v6
 v_cvt_pk_bf16_f32 v97, v130, v131
 v_mfma_f32_16x16x32_bf16 v[200:203], v[44:47], a[140:143], v[200:203]
 ds_read_b128 a[120:123], v0 offset:21504
 buffer_load_dwordx4 v3, s[12:15], s26 offen offset:0 nt lds
 buffer_load_dwordx4 v3, s[12:15], s26 offen offset:2048 nt lds
 v_add_f32 v6, v131, v6
 v_mfma_f32_16x16x32_bf16 v[232:235], v[52:55], a[140:143], v[232:235]
 v_exp_f32 v132, v132
 v_mfma_f32_16x16x32_bf16 v[232:235], v[48:51], a[136:139], v[232:235]
 v_exp_f32 v133, v133
 v_mfma_f32_16x16x32_bf16 a[160:163], v[56:59], a[136:139], a[160:163]
 v_add_f32 v7, v132, v7
 v_cvt_pk_bf16_f32 v104, v132, v133
 v_mfma_f32_16x16x32_bf16 a[160:163], v[60:63], a[140:143], a[160:163]
 v_exp_f32 v134, v134
 v_mfma_f32_16x16x32_bf16 a[192:195], v[68:71], a[140:143], a[192:195]
 ds_read_b128 a[124:127], v0 offset:22016
 v_add_f32 v7, v133, v7
 v_mfma_f32_16x16x32_bf16 a[192:195], v[64:67], a[136:139], a[192:195]
 v_exp_f32 v135, v135
 v_mfma_f32_16x16x32_bf16 v[140:143], v[24:27], a[144:147], v[140:143]
 s_waitcnt lgkmcnt(1)
 v_add_f32 v7, v134, v7
 v_cvt_pk_bf16_f32 v105, v134, v135
 v_mfma_f32_16x16x32_bf16 v[140:143], v[28:31], a[148:151], v[140:143]
 ds_read_b64_tr_b16 a[136:137], v1 offset:512
 v_add_f32 v7, v135, v7
 v_mfma_f32_16x16x32_bf16 v[172:175], v[36:39], a[148:151], v[172:175]
 v_exp_f32 v72, v72
 v_mfma_f32_16x16x32_bf16 v[172:175], v[32:35], a[144:147], v[172:175]
 v_exp_f32 v73, v73
 v_mfma_f32_16x16x32_bf16 v[204:207], v[40:43], a[144:147], v[204:207]
 s_mov_b32 m0, 103296
 v_exp_f32 v74, v74
 v_mfma_f32_16x16x32_bf16 v[204:207], v[44:47], a[148:151], v[204:207]
 buffer_load_dwordx4 v3, s[12:15], s26 offen offset:128 nt lds
 buffer_load_dwordx4 v3, s[12:15], s26 offen offset:2176 nt lds
 v_add_f32 v8, v72, v8
 v_cvt_pk_bf16_f32 v112, v72, v73
 v_mfma_f32_16x16x32_bf16 v[236:239], v[52:55], a[148:151], v[236:239]
 s_add_u32 s26, s26, 4096
 v_exp_f32 v75, v75
 v_mfma_f32_16x16x32_bf16 v[236:239], v[48:51], a[144:147], v[236:239]
 v_add_f32 v8, v73, v8
 v_add_f32 v8, v74, v8
 v_mfma_f32_16x16x32_bf16 a[164:167], v[56:59], a[144:147], a[164:167]
 v_exp_f32 v20, v20
 v_mfma_f32_16x16x32_bf16 a[164:167], v[60:63], a[148:151], a[164:167]
 v_add_f32 v8, v75, v8
 v_cvt_pk_bf16_f32 v113, v74, v75
 v_mfma_f32_16x16x32_bf16 a[196:199], v[68:71], a[148:151], a[196:199]
 v_exp_f32 v21, v21
 v_mfma_f32_16x16x32_bf16 a[196:199], v[64:67], a[144:147], a[196:199]
 ds_read_b64_tr_b16 a[138:139], v1 offset:4608
 v_add_f32 v10, v20, v21
 v_mfma_f32_16x16x32_bf16 v[16:19], a[112:115], a[0:3], v[12:15]
 v_exp_f32 v22, v22
 v_mfma_f32_16x16x32_bf16 v[16:19], a[116:119], a[4:7], v[16:19]
 ds_read_b64_tr_b16 a[140:141], v1 offset:8704
 v_cvt_pk_bf16_f32 v120, v20, v21
 v_mfma_f32_16x16x32_bf16 v[16:19], a[120:123], a[8:11], v[16:19]
 s_waitcnt lgkmcnt(2)
 v_exp_f32 v23, v23
 v_mfma_f32_16x16x32_bf16 v[16:19], a[124:127], a[12:15], v[16:19]
 v_add_f32 v11, v22, v23
 v_cvt_pk_bf16_f32 v121, v22, v23
 v_mfma_f32_16x16x32_bf16 v[76:79], a[124:127], a[28:31], v[12:15]
 s_mov_b32 m0, 106496
 ds_read_b64_tr_b16 a[142:143], v1 offset:12800
 v_add_f32 v9, v10, v9
 v_mfma_f32_16x16x32_bf16 v[76:79], a[120:123], a[24:27], v[76:79]
 ds_read_b64_tr_b16 a[144:145], v2 offset:512
 buffer_load_dwordx4 v3, s[12:15], s26 offen offset:0 nt lds
 buffer_load_dwordx4 v3, s[12:15], s26 offen offset:2048 nt lds
 v_add_f32 v9, v11, v9
 v_mfma_f32_16x16x32_bf16 v[76:79], a[116:119], a[20:23], v[76:79]
 v_exp_f32 v16, v16
 v_mfma_f32_16x16x32_bf16 v[76:79], a[112:115], a[16:19], v[76:79]
 v_exp_f32 v17, v17
 v_mfma_f32_16x16x32_bf16 v[128:131], a[112:115], a[32:35], v[12:15]
 v_add_f32 v4, v16, v4
 v_cvt_pk_bf16_f32 v82, v16, v17
 v_mfma_f32_16x16x32_bf16 v[128:131], a[116:119], a[36:39], v[128:131]
 v_exp_f32 v18, v18
 v_mfma_f32_16x16x32_bf16 v[128:131], a[120:123], a[40:43], v[128:131]
 ds_read_b64_tr_b16 a[146:147], v2 offset:4608
 v_add_f32 v4, v17, v4
 v_mfma_f32_16x16x32_bf16 v[128:131], a[124:127], a[44:47], v[128:131]
 v_exp_f32 v19, v19
 v_mfma_f32_16x16x32_bf16 v[132:135], a[124:127], a[60:63], v[12:15]
 v_add_f32 v4, v18, v4
 v_cvt_pk_bf16_f32 v83, v18, v19
 v_mfma_f32_16x16x32_bf16 v[132:135], a[120:123], a[56:59], v[132:135]
 ds_read_b64_tr_b16 a[148:149], v2 offset:8704
 v_add_f32 v4, v19, v4
 v_mfma_f32_16x16x32_bf16 v[132:135], a[116:119], a[52:55], v[132:135]
 v_exp_f32 v76, v76
 v_mfma_f32_16x16x32_bf16 v[132:135], a[112:115], a[48:51], v[132:135]
 v_exp_f32 v77, v77
 v_mfma_f32_16x16x32_bf16 v[72:75], a[112:115], a[64:67], v[12:15]
 s_mov_b32 m0, 107392
 v_add_f32 v5, v76, v5
 v_cvt_pk_bf16_f32 v90, v76, v77
 v_mfma_f32_16x16x32_bf16 v[72:75], a[116:119], a[68:71], v[72:75]
 buffer_load_dwordx4 v3, s[12:15], s26 offen offset:128 nt lds
 buffer_load_dwordx4 v3, s[12:15], s26 offen offset:2176 nt lds
 v_exp_f32 v78, v78
 v_mfma_f32_16x16x32_bf16 v[72:75], a[120:123], a[72:75], v[72:75]
 s_add_u32 s26, s26, 4096
 ds_read_b64_tr_b16 a[150:151], v2 offset:12800
 v_add_f32 v5, v77, v5
 v_mfma_f32_16x16x32_bf16 v[72:75], a[124:127], a[76:79], v[72:75]
 v_exp_f32 v79, v79
 v_mfma_f32_16x16x32_bf16 v[20:23], a[124:127], a[92:95], v[12:15]
 v_add_f32 v5, v78, v5
 v_cvt_pk_bf16_f32 v91, v78, v79
 v_mfma_f32_16x16x32_bf16 v[20:23], a[120:123], a[88:91], v[20:23]
 ds_read_b128 v[116:119], v0 offset:24576
 v_add_f32 v5, v79, v5
 v_mfma_f32_16x16x32_bf16 v[20:23], a[116:119], a[84:87], v[20:23]
 v_exp_f32 v128, v128
 v_mfma_f32_16x16x32_bf16 v[20:23], a[112:115], a[80:83], v[20:23]
 s_waitcnt lgkmcnt(2)
 v_exp_f32 v129, v129
 v_mfma_f32_16x16x32_bf16 v[144:147], v[24:27], a[136:139], v[144:147]
 v_add_f32 v6, v128, v6
 v_cvt_pk_bf16_f32 v98, v128, v129
 v_mfma_f32_16x16x32_bf16 v[144:147], v[28:31], a[140:143], v[144:147]
 v_exp_f32 v130, v130
 v_mfma_f32_16x16x32_bf16 v[176:179], v[36:39], a[140:143], v[176:179]
 ds_read_b128 v[124:127], v0 offset:25088
 v_add_f32 v6, v129, v6
 v_mfma_f32_16x16x32_bf16 v[176:179], v[32:35], a[136:139], v[176:179]
 v_exp_f32 v131, v131
 v_mfma_f32_16x16x32_bf16 v[208:211], v[40:43], a[136:139], v[208:211]
 s_mov_b32 m0, 110592
 v_add_f32 v6, v130, v6
 v_cvt_pk_bf16_f32 v99, v130, v131
 v_mfma_f32_16x16x32_bf16 v[208:211], v[44:47], a[140:143], v[208:211]
 ds_read_b128 a[128:131], v0 offset:25600
 buffer_load_dwordx4 v3, s[12:15], s26 offen offset:0 nt lds
 buffer_load_dwordx4 v3, s[12:15], s26 offen offset:2048 nt lds
 v_add_f32 v6, v131, v6
 v_mfma_f32_16x16x32_bf16 v[240:243], v[52:55], a[140:143], v[240:243]
 v_exp_f32 v132, v132
 v_mfma_f32_16x16x32_bf16 v[240:243], v[48:51], a[136:139], v[240:243]
 v_exp_f32 v133, v133
 v_mfma_f32_16x16x32_bf16 a[168:171], v[56:59], a[136:139], a[168:171]
 v_add_f32 v7, v132, v7
 v_cvt_pk_bf16_f32 v106, v132, v133
 v_mfma_f32_16x16x32_bf16 a[168:171], v[60:63], a[140:143], a[168:171]
 v_exp_f32 v134, v134
 v_mfma_f32_16x16x32_bf16 a[200:203], v[68:71], a[140:143], a[200:203]
 ds_read_b128 a[132:135], v0 offset:26112
 v_add_f32 v7, v133, v7
 v_mfma_f32_16x16x32_bf16 a[200:203], v[64:67], a[136:139], a[200:203]
 v_exp_f32 v135, v135
 v_mfma_f32_16x16x32_bf16 v[148:151], v[24:27], a[144:147], v[148:151]
 s_waitcnt lgkmcnt(1)
 v_add_f32 v7, v134, v7
 v_cvt_pk_bf16_f32 v107, v134, v135
 v_mfma_f32_16x16x32_bf16 v[148:151], v[28:31], a[148:151], v[148:151]
 ds_read_b64_tr_b16 a[136:137], v1 offset:1024
 v_add_f32 v7, v135, v7
 v_mfma_f32_16x16x32_bf16 v[180:183], v[36:39], a[148:151], v[180:183]
 v_exp_f32 v72, v72
 v_mfma_f32_16x16x32_bf16 v[180:183], v[32:35], a[144:147], v[180:183]
 v_exp_f32 v73, v73
 v_mfma_f32_16x16x32_bf16 v[212:215], v[40:43], a[144:147], v[212:215]
 s_mov_b32 m0, 111488
 v_exp_f32 v74, v74
 v_mfma_f32_16x16x32_bf16 v[212:215], v[44:47], a[148:151], v[212:215]
 buffer_load_dwordx4 v3, s[12:15], s26 offen offset:128 nt lds
 buffer_load_dwordx4 v3, s[12:15], s26 offen offset:2176 nt lds
 v_add_f32 v8, v72, v8
 v_cvt_pk_bf16_f32 v114, v72, v73
 v_mfma_f32_16x16x32_bf16 v[244:247], v[52:55], a[148:151], v[244:247]
 s_add_u32 s26, s26, 4096
 v_exp_f32 v75, v75
 v_mfma_f32_16x16x32_bf16 v[244:247], v[48:51], a[144:147], v[244:247]
 v_add_f32 v8, v73, v8
 v_add_f32 v8, v74, v8
 v_mfma_f32_16x16x32_bf16 a[172:175], v[56:59], a[144:147], a[172:175]
 v_exp_f32 v20, v20
 v_mfma_f32_16x16x32_bf16 a[172:175], v[60:63], a[148:151], a[172:175]
 v_add_f32 v8, v75, v8
 v_cvt_pk_bf16_f32 v115, v74, v75
 v_mfma_f32_16x16x32_bf16 a[204:207], v[68:71], a[148:151], a[204:207]
 v_exp_f32 v21, v21
 v_mfma_f32_16x16x32_bf16 a[204:207], v[64:67], a[144:147], a[204:207]
 ds_read_b64_tr_b16 a[138:139], v1 offset:5120
 v_add_f32 v10, v20, v21
 v_mfma_f32_16x16x32_bf16 v[16:19], v[116:119], a[0:3], v[12:15]
 v_exp_f32 v22, v22
 v_mfma_f32_16x16x32_bf16 v[16:19], v[124:127], a[4:7], v[16:19]
 ds_read_b64_tr_b16 a[140:141], v1 offset:9216
 v_cvt_pk_bf16_f32 v122, v20, v21
 v_mfma_f32_16x16x32_bf16 v[16:19], a[128:131], a[8:11], v[16:19]
 s_waitcnt lgkmcnt(2)
 v_exp_f32 v23, v23
 v_mfma_f32_16x16x32_bf16 v[16:19], a[132:135], a[12:15], v[16:19]
 v_add_f32 v11, v22, v23
 v_cvt_pk_bf16_f32 v123, v22, v23
 v_mfma_f32_16x16x32_bf16 v[76:79], a[132:135], a[28:31], v[12:15]
 s_mov_b32 m0, 0
 ds_read_b64_tr_b16 a[142:143], v1 offset:13312
 v_add_f32 v9, v10, v9
 v_mfma_f32_16x16x32_bf16 v[76:79], a[128:131], a[24:27], v[76:79]
 ds_read_b64_tr_b16 a[144:145], v2 offset:1024
 buffer_load_dwordx4 v3, s[8:11], s25 offen offset:0 nt lds
 buffer_load_dwordx4 v3, s[8:11], s25 offen offset:2048 nt lds
 v_add_f32 v9, v11, v9
 v_mfma_f32_16x16x32_bf16 v[76:79], v[124:127], a[20:23], v[76:79]
 v_exp_f32 v16, v16
 v_mfma_f32_16x16x32_bf16 v[76:79], v[116:119], a[16:19], v[76:79]
 v_exp_f32 v17, v17
 v_mfma_f32_16x16x32_bf16 v[128:131], v[116:119], a[32:35], v[12:15]
 v_add_f32 v4, v16, v4
 v_cvt_pk_bf16_f32 v84, v16, v17
 v_mfma_f32_16x16x32_bf16 v[128:131], v[124:127], a[36:39], v[128:131]
 v_exp_f32 v18, v18
 v_mfma_f32_16x16x32_bf16 v[128:131], a[128:131], a[40:43], v[128:131]
 ds_read_b64_tr_b16 a[146:147], v2 offset:5120
 v_add_f32 v4, v17, v4
 v_mfma_f32_16x16x32_bf16 v[128:131], a[132:135], a[44:47], v[128:131]
 v_exp_f32 v19, v19
 v_mfma_f32_16x16x32_bf16 v[132:135], a[132:135], a[60:63], v[12:15]
 v_add_f32 v4, v18, v4
 v_cvt_pk_bf16_f32 v85, v18, v19
 v_mfma_f32_16x16x32_bf16 v[132:135], a[128:131], a[56:59], v[132:135]
 ds_read_b64_tr_b16 a[148:149], v2 offset:9216
 v_add_f32 v4, v19, v4
 v_mfma_f32_16x16x32_bf16 v[132:135], v[124:127], a[52:55], v[132:135]
 v_exp_f32 v76, v76
 v_mfma_f32_16x16x32_bf16 v[132:135], v[116:119], a[48:51], v[132:135]
 v_exp_f32 v77, v77
 v_mfma_f32_16x16x32_bf16 v[72:75], v[116:119], a[64:67], v[12:15]
 s_mov_b32 m0, 896
 v_add_f32 v5, v76, v5
 v_cvt_pk_bf16_f32 v92, v76, v77
 v_mfma_f32_16x16x32_bf16 v[72:75], v[124:127], a[68:71], v[72:75]
 buffer_load_dwordx4 v3, s[8:11], s25 offen offset:128 nt lds
 buffer_load_dwordx4 v3, s[8:11], s25 offen offset:2176 nt lds
 v_exp_f32 v78, v78
 v_mfma_f32_16x16x32_bf16 v[72:75], a[128:131], a[72:75], v[72:75]
 s_add_u32 s25, s25, 4096
 ds_read_b64_tr_b16 a[150:151], v2 offset:13312
 v_add_f32 v5, v77, v5
 v_mfma_f32_16x16x32_bf16 v[72:75], a[132:135], a[76:79], v[72:75]
 v_exp_f32 v79, v79
 v_mfma_f32_16x16x32_bf16 v[20:23], a[132:135], a[92:95], v[12:15]
 v_add_f32 v5, v78, v5
 v_cvt_pk_bf16_f32 v93, v78, v79
 v_mfma_f32_16x16x32_bf16 v[20:23], a[128:131], a[88:91], v[20:23]
 ds_read_b128 a[112:115], v0 offset:28672
 v_add_f32 v5, v79, v5
 v_mfma_f32_16x16x32_bf16 v[20:23], v[124:127], a[84:87], v[20:23]
 v_exp_f32 v128, v128
 v_mfma_f32_16x16x32_bf16 v[20:23], v[116:119], a[80:83], v[20:23]
 s_waitcnt lgkmcnt(2)
 v_exp_f32 v129, v129
 v_mfma_f32_16x16x32_bf16 v[152:155], v[24:27], a[136:139], v[152:155]
 v_add_f32 v6, v128, v6
 v_cvt_pk_bf16_f32 v100, v128, v129
 v_mfma_f32_16x16x32_bf16 v[152:155], v[28:31], a[140:143], v[152:155]
 v_exp_f32 v130, v130
 v_mfma_f32_16x16x32_bf16 v[184:187], v[36:39], a[140:143], v[184:187]
 ds_read_b128 a[116:119], v0 offset:29184
 v_add_f32 v6, v129, v6
 v_mfma_f32_16x16x32_bf16 v[184:187], v[32:35], a[136:139], v[184:187]
 v_exp_f32 v131, v131
 v_mfma_f32_16x16x32_bf16 v[216:219], v[40:43], a[136:139], v[216:219]
 s_mov_b32 m0, 4096
 v_add_f32 v6, v130, v6
 v_cvt_pk_bf16_f32 v101, v130, v131
 v_mfma_f32_16x16x32_bf16 v[216:219], v[44:47], a[140:143], v[216:219]
 ds_read_b128 a[120:123], v0 offset:29696
 buffer_load_dwordx4 v3, s[8:11], s25 offen offset:0 nt lds
 buffer_load_dwordx4 v3, s[8:11], s25 offen offset:2048 nt lds
 v_add_f32 v6, v131, v6
 v_mfma_f32_16x16x32_bf16 v[248:251], v[52:55], a[140:143], v[248:251]
 v_exp_f32 v132, v132
 v_mfma_f32_16x16x32_bf16 v[248:251], v[48:51], a[136:139], v[248:251]
 v_exp_f32 v133, v133
 v_mfma_f32_16x16x32_bf16 a[176:179], v[56:59], a[136:139], a[176:179]
 v_add_f32 v7, v132, v7
 v_cvt_pk_bf16_f32 v108, v132, v133
 v_mfma_f32_16x16x32_bf16 a[176:179], v[60:63], a[140:143], a[176:179]
 v_exp_f32 v134, v134
 v_mfma_f32_16x16x32_bf16 a[208:211], v[68:71], a[140:143], a[208:211]
 ds_read_b128 a[124:127], v0 offset:30208
 v_add_f32 v7, v133, v7
 v_mfma_f32_16x16x32_bf16 a[208:211], v[64:67], a[136:139], a[208:211]
 v_exp_f32 v135, v135
 v_mfma_f32_16x16x32_bf16 v[156:159], v[24:27], a[144:147], v[156:159]
 s_waitcnt lgkmcnt(1)
 v_add_f32 v7, v134, v7
 v_cvt_pk_bf16_f32 v109, v134, v135
 v_mfma_f32_16x16x32_bf16 v[156:159], v[28:31], a[148:151], v[156:159]
 ds_read_b64_tr_b16 a[136:137], v1 offset:1536
 v_add_f32 v7, v135, v7
 v_mfma_f32_16x16x32_bf16 v[188:191], v[36:39], a[148:151], v[188:191]
 v_exp_f32 v72, v72
 v_mfma_f32_16x16x32_bf16 v[188:191], v[32:35], a[144:147], v[188:191]
 v_exp_f32 v73, v73
 v_mfma_f32_16x16x32_bf16 v[220:223], v[40:43], a[144:147], v[220:223]
 s_mov_b32 m0, 4992
 v_exp_f32 v74, v74
 v_mfma_f32_16x16x32_bf16 v[220:223], v[44:47], a[148:151], v[220:223]
 buffer_load_dwordx4 v3, s[8:11], s25 offen offset:128 nt lds
 buffer_load_dwordx4 v3, s[8:11], s25 offen offset:2176 nt lds
 v_add_f32 v8, v72, v8
 v_cvt_pk_bf16_f32 v116, v72, v73
 v_mfma_f32_16x16x32_bf16 v[252:255], v[52:55], a[148:151], v[252:255]
 s_add_u32 s25, s25, 4096
 v_exp_f32 v75, v75
 v_mfma_f32_16x16x32_bf16 v[252:255], v[48:51], a[144:147], v[252:255]
 v_add_f32 v8, v73, v8
 v_add_f32 v8, v74, v8
 v_mfma_f32_16x16x32_bf16 a[180:183], v[56:59], a[144:147], a[180:183]
 v_exp_f32 v20, v20
 v_mfma_f32_16x16x32_bf16 a[180:183], v[60:63], a[148:151], a[180:183]
 v_add_f32 v8, v75, v8
 v_cvt_pk_bf16_f32 v117, v74, v75
 v_mfma_f32_16x16x32_bf16 a[212:215], v[68:71], a[148:151], a[212:215]
 v_exp_f32 v21, v21
 v_mfma_f32_16x16x32_bf16 a[212:215], v[64:67], a[144:147], a[212:215]
 ds_read_b64_tr_b16 a[138:139], v1 offset:5632
 v_add_f32 v10, v20, v21
 v_mfma_f32_16x16x32_bf16 v[16:19], a[112:115], a[0:3], v[12:15]
 v_exp_f32 v22, v22
 v_mfma_f32_16x16x32_bf16 v[16:19], a[116:119], a[4:7], v[16:19]
 ds_read_b64_tr_b16 a[140:141], v1 offset:9728
 v_cvt_pk_bf16_f32 v124, v20, v21
 v_mfma_f32_16x16x32_bf16 v[16:19], a[120:123], a[8:11], v[16:19]
 s_waitcnt lgkmcnt(2)
 v_exp_f32 v23, v23
 v_mfma_f32_16x16x32_bf16 v[16:19], a[124:127], a[12:15], v[16:19]
 s_mov_b32 m0, 8192
 v_add_f32 v11, v22, v23
 v_cvt_pk_bf16_f32 v125, v22, v23
 v_mfma_f32_16x16x32_bf16 v[76:79], a[124:127], a[28:31], v[12:15]
 s_waitcnt vmcnt(40)
 ds_read_b64_tr_b16 a[142:143], v1 offset:13824
 v_add_f32 v9, v10, v9
 v_mfma_f32_16x16x32_bf16 v[76:79], a[120:123], a[24:27], v[76:79]
 s_barrier
 ds_read_b64_tr_b16 a[144:145], v2 offset:1536
 buffer_load_dwordx4 v3, s[8:11], s25 offen offset:0 nt lds
 buffer_load_dwordx4 v3, s[8:11], s25 offen offset:2048 nt lds
 v_add_f32 v9, v11, v9
 v_mfma_f32_16x16x32_bf16 v[76:79], a[116:119], a[20:23], v[76:79]
 v_exp_f32 v16, v16
 v_mfma_f32_16x16x32_bf16 v[76:79], a[112:115], a[16:19], v[76:79]
 v_exp_f32 v17, v17
 v_mfma_f32_16x16x32_bf16 v[128:131], a[112:115], a[32:35], v[12:15]
 v_add_f32 v4, v16, v4
 v_cvt_pk_bf16_f32 v86, v16, v17
 v_mfma_f32_16x16x32_bf16 v[128:131], a[116:119], a[36:39], v[128:131]
 v_exp_f32 v18, v18
 v_mfma_f32_16x16x32_bf16 v[128:131], a[120:123], a[40:43], v[128:131]
 ds_read_b64_tr_b16 a[146:147], v2 offset:5632
 v_add_f32 v4, v17, v4
 v_mfma_f32_16x16x32_bf16 v[128:131], a[124:127], a[44:47], v[128:131]
 v_exp_f32 v19, v19
 v_mfma_f32_16x16x32_bf16 v[20:23], a[124:127], a[60:63], v[12:15]
 v_add_f32 v4, v18, v4
 v_cvt_pk_bf16_f32 v87, v18, v19
 v_mfma_f32_16x16x32_bf16 v[20:23], a[120:123], a[56:59], v[20:23]
 ds_read_b64_tr_b16 a[148:149], v2 offset:9728
 v_add_f32 v4, v19, v4
 v_mfma_f32_16x16x32_bf16 v[20:23], a[116:119], a[52:55], v[20:23]
 v_exp_f32 v76, v76
 v_mfma_f32_16x16x32_bf16 v[20:23], a[112:115], a[48:51], v[20:23]
 s_waitcnt lgkmcnt(2)
 v_exp_f32 v77, v77
 v_mfma_f32_16x16x32_bf16 v[160:163], v[24:27], a[136:139], v[160:163]
 s_mov_b32 m0, 9088
 v_add_f32 v5, v76, v5
 v_cvt_pk_bf16_f32 v94, v76, v77
 v_mfma_f32_16x16x32_bf16 v[160:163], v[28:31], a[140:143], v[160:163]
 buffer_load_dwordx4 v3, s[8:11], s25 offen offset:128 nt lds
 buffer_load_dwordx4 v3, s[8:11], s25 offen offset:2176 nt lds
 v_exp_f32 v78, v78
 v_mfma_f32_16x16x32_bf16 v[192:195], v[36:39], a[140:143], v[192:195]
 s_add_u32 s25, s25, 4096
 ds_read_b64_tr_b16 a[150:151], v2 offset:13824
 v_add_f32 v5, v77, v5
 v_mfma_f32_16x16x32_bf16 v[192:195], v[32:35], a[136:139], v[192:195]
 v_exp_f32 v79, v79
 v_mfma_f32_16x16x32_bf16 v[224:227], v[40:43], a[136:139], v[224:227]
 v_add_f32 v5, v78, v5
 v_cvt_pk_bf16_f32 v95, v78, v79
 v_mfma_f32_16x16x32_bf16 v[224:227], v[44:47], a[140:143], v[224:227]
 ds_read_b128 a[128:131], v0 offset:32768
 v_add_f32 v5, v79, v5
 v_mfma_f32_16x16x32_bf16 a[152:155], v[52:55], a[140:143], a[152:155]
 v_exp_f32 v128, v128
 v_mfma_f32_16x16x32_bf16 a[152:155], v[48:51], a[136:139], a[152:155]
 v_exp_f32 v129, v129
 v_mfma_f32_16x16x32_bf16 a[184:187], v[56:59], a[136:139], a[184:187]
 v_exp_f32 v130, v130
 v_mfma_f32_16x16x32_bf16 a[184:187], v[60:63], a[140:143], a[184:187]
 v_add_f32 v6, v128, v6
 v_cvt_pk_bf16_f32 v102, v128, v129
 v_mfma_f32_16x16x32_bf16 a[216:219], v[68:71], a[140:143], a[216:219]
 v_exp_f32 v131, v131
 v_mfma_f32_16x16x32_bf16 a[216:219], v[64:67], a[136:139], a[216:219]
 s_waitcnt lgkmcnt(1)
 v_add_f32 v6, v129, v6
 v_add_f32 v6, v130, v6
 v_mfma_f32_16x16x32_bf16 v[164:167], v[24:27], a[144:147], v[164:167]
 s_mov_b32 m0, 12288
 v_exp_f32 v20, v20
 v_mfma_f32_16x16x32_bf16 v[164:167], v[28:31], a[148:151], v[164:167]
 buffer_load_dwordx4 v3, s[8:11], s25 offen offset:0 nt lds
 buffer_load_dwordx4 v3, s[8:11], s25 offen offset:2048 nt lds
 v_add_f32 v6, v131, v6
 v_cvt_pk_bf16_f32 v103, v130, v131
 v_mfma_f32_16x16x32_bf16 v[196:199], v[36:39], a[148:151], v[196:199]
 v_exp_f32 v21, v21
 v_mfma_f32_16x16x32_bf16 v[196:199], v[32:35], a[144:147], v[196:199]
 ds_read_b128 a[132:135], v0 offset:33280
 v_add_f32 v10, v20, v21
 v_mfma_f32_16x16x32_bf16 v[16:19], a[112:115], a[64:67], v[12:15]
 v_exp_f32 v22, v22
 v_mfma_f32_16x16x32_bf16 v[16:19], a[116:119], a[68:71], v[16:19]
 ds_read_b128 v[28:31], v0 offset:33792
 v_cvt_pk_bf16_f32 v110, v20, v21
 v_mfma_f32_16x16x32_bf16 v[16:19], a[120:123], a[72:75], v[16:19]
 v_exp_f32 v23, v23
 v_mfma_f32_16x16x32_bf16 v[16:19], a[124:127], a[76:79], v[16:19]
 v_add_f32 v11, v22, v23
 v_cvt_pk_bf16_f32 v111, v22, v23
 v_mfma_f32_16x16x32_bf16 v[20:23], a[124:127], a[92:95], v[12:15]
 ds_read_b128 v[36:39], v0 offset:34304
 v_add_f32 v7, v10, v7
 v_mfma_f32_16x16x32_bf16 v[20:23], a[120:123], a[88:91], v[20:23]
 ds_read_b64_tr_b16 a[136:137], v1 offset:16384
 v_add_f32 v7, v11, v7
 v_mfma_f32_16x16x32_bf16 v[20:23], a[116:119], a[84:87], v[20:23]
 v_exp_f32 v16, v16
 v_mfma_f32_16x16x32_bf16 v[20:23], a[112:115], a[80:83], v[20:23]
 v_exp_f32 v17, v17
 v_mfma_f32_16x16x32_bf16 v[228:231], v[40:43], a[144:147], v[228:231]
 s_mov_b32 m0, 13184
 v_exp_f32 v18, v18
 v_mfma_f32_16x16x32_bf16 v[228:231], v[44:47], a[148:151], v[228:231]
 buffer_load_dwordx4 v3, s[8:11], s25 offen offset:128 nt lds
 buffer_load_dwordx4 v3, s[8:11], s25 offen offset:2176 nt lds
 v_add_f32 v8, v16, v8
 v_cvt_pk_bf16_f32 v118, v16, v17
 v_mfma_f32_16x16x32_bf16 a[156:159], v[52:55], a[148:151], a[156:159]
 s_add_u32 s25, s25, 4096
 v_exp_f32 v19, v19
 v_mfma_f32_16x16x32_bf16 a[156:159], v[48:51], a[144:147], a[156:159]
 v_add_f32 v8, v17, v8
 v_add_f32 v8, v18, v8
 v_mfma_f32_16x16x32_bf16 a[188:191], v[56:59], a[144:147], a[188:191]
 v_exp_f32 v20, v20
 v_mfma_f32_16x16x32_bf16 a[188:191], v[60:63], a[148:151], a[188:191]
 v_add_f32 v8, v19, v8
 v_cvt_pk_bf16_f32 v119, v18, v19
 v_mfma_f32_16x16x32_bf16 a[220:223], v[68:71], a[148:151], a[220:223]
 v_exp_f32 v21, v21
 v_mfma_f32_16x16x32_bf16 a[220:223], v[64:67], a[144:147], a[220:223]
 s_waitcnt lgkmcnt(0)
 ds_read_b64_tr_b16 a[138:139], v1 offset:20480
 v_add_f32 v10, v20, v21
L_sub1_6:
 v_mfma_f32_16x16x32_bf16 v[16:19], a[128:131], a[0:3], v[12:15]
 v_exp_f32 v22, v22
 v_mfma_f32_16x16x32_bf16 v[16:19], a[132:135], a[4:7], v[16:19]
 ds_read_b64_tr_b16 a[140:141], v1 offset:24576
 v_cvt_pk_bf16_f32 v126, v20, v21
 v_mfma_f32_16x16x32_bf16 v[16:19], v[28:31], a[8:11], v[16:19]
 v_exp_f32 v23, v23
 v_mfma_f32_16x16x32_bf16 v[16:19], v[36:39], a[12:15], v[16:19]
 v_add_f32 v11, v22, v23
 v_cvt_pk_bf16_f32 v127, v22, v23
 v_mfma_f32_16x16x32_bf16 v[76:79], v[36:39], a[28:31], v[12:15]
 s_mov_b32 m0, 114688
 ds_read_b64_tr_b16 a[142:143], v1 offset:28672
 v_add_f32 v9, v10, v9
 v_mfma_f32_16x16x32_bf16 v[76:79], v[28:31], a[24:27], v[76:79]
 ds_read_b64_tr_b16 a[144:145], v2 offset:16384
 buffer_load_dwordx4 v3, s[12:15], s26 offen offset:0 nt lds
 buffer_load_dwordx4 v3, s[12:15], s26 offen offset:2048 nt lds
 v_add_f32 v9, v11, v9
 v_mfma_f32_16x16x32_bf16 v[76:79], a[132:135], a[20:23], v[76:79]
 v_exp_f32 v16, v16
 v_mfma_f32_16x16x32_bf16 v[76:79], a[128:131], a[16:19], v[76:79]
 v_exp_f32 v17, v17
 v_mfma_f32_16x16x32_bf16 v[128:131], a[128:131], a[32:35], v[12:15]
 v_add_f32 v4, v16, v4
 v_cvt_pk_bf16_f32 v24, v16, v17
 v_mfma_f32_16x16x32_bf16 v[128:131], a[132:135], a[36:39], v[128:131]
 v_exp_f32 v18, v18
 v_mfma_f32_16x16x32_bf16 v[128:131], v[28:31], a[40:43], v[128:131]
 ds_read_b64_tr_b16 a[146:147], v2 offset:20480
 v_add_f32 v4, v17, v4
 v_mfma_f32_16x16x32_bf16 v[128:131], v[36:39], a[44:47], v[128:131]
 v_exp_f32 v19, v19
 v_mfma_f32_16x16x32_bf16 v[132:135], v[36:39], a[60:63], v[12:15]
 v_add_f32 v4, v18, v4
 v_cvt_pk_bf16_f32 v25, v18, v19
 v_mfma_f32_16x16x32_bf16 v[132:135], v[28:31], a[56:59], v[132:135]
 ds_read_b64_tr_b16 a[148:149], v2 offset:24576
 v_add_f32 v4, v19, v4
 v_mfma_f32_16x16x32_bf16 v[132:135], a[132:135], a[52:55], v[132:135]
 v_exp_f32 v76, v76
 v_mfma_f32_16x16x32_bf16 v[132:135], a[128:131], a[48:51], v[132:135]
 v_exp_f32 v77, v77
 v_mfma_f32_16x16x32_bf16 v[72:75], a[128:131], a[64:67], v[12:15]
 s_mov_b32 m0, 115584
 v_add_f32 v5, v76, v5
 v_cvt_pk_bf16_f32 v32, v76, v77
 v_mfma_f32_16x16x32_bf16 v[72:75], a[132:135], a[68:71], v[72:75]
 buffer_load_dwordx4 v3, s[12:15], s26 offen offset:128 nt lds
 buffer_load_dwordx4 v3, s[12:15], s26 offen offset:2176 nt lds
 v_exp_f32 v78, v78
 v_mfma_f32_16x16x32_bf16 v[72:75], v[28:31], a[72:75], v[72:75]
 s_add_u32 s26, s26, 4096
 ds_read_b64_tr_b16 a[150:151], v2 offset:28672
 v_add_f32 v5, v77, v5
 v_mfma_f32_16x16x32_bf16 v[72:75], v[36:39], a[76:79], v[72:75]
 v_exp_f32 v79, v79
 v_mfma_f32_16x16x32_bf16 v[20:23], v[36:39], a[92:95], v[12:15]
 v_add_f32 v5, v78, v5
 v_cvt_pk_bf16_f32 v33, v78, v79
 v_mfma_f32_16x16x32_bf16 v[20:23], v[28:31], a[88:91], v[20:23]
 ds_read_b128 a[112:115], v0 offset:36864
 v_add_f32 v5, v79, v5
 v_mfma_f32_16x16x32_bf16 v[20:23], a[132:135], a[84:87], v[20:23]
 v_exp_f32 v128, v128
 v_mfma_f32_16x16x32_bf16 v[20:23], a[128:131], a[80:83], v[20:23]
 s_waitcnt lgkmcnt(2)
 v_exp_f32 v129, v129
 v_mfma_f32_16x16x32_bf16 v[136:139], v[80:83], a[136:139], v[136:139]
 v_add_f32 v6, v128, v6
 v_cvt_pk_bf16_f32 v40, v128, v129
 v_mfma_f32_16x16x32_bf16 v[136:139], v[84:87], a[140:143], v[136:139]
 v_exp_f32 v130, v130
 v_mfma_f32_16x16x32_bf16 v[168:171], v[92:95], a[140:143], v[168:171]
 ds_read_b128 a[116:119], v0 offset:37376
 v_add_f32 v6, v129, v6
 v_mfma_f32_16x16x32_bf16 v[168:171], v[88:91], a[136:139], v[168:171]
 v_exp_f32 v131, v131
 v_mfma_f32_16x16x32_bf16 v[200:203], v[96:99], a[136:139], v[200:203]
 s_mov_b32 m0, 118784
 v_add_f32 v6, v130, v6
 v_cvt_pk_bf16_f32 v41, v130, v131
 v_mfma_f32_16x16x32_bf16 v[200:203], v[100:103], a[140:143], v[200:203]
 ds_read_b128 a[120:123], v0 offset:37888
 buffer_load_dwordx4 v3, s[12:15], s26 offen offset:0 nt lds
 buffer_load_dwordx4 v3, s[12:15], s26 offen offset:2048 nt lds
 v_add_f32 v6, v131, v6
 v_mfma_f32_16x16x32_bf16 v[232:235], v[108:111], a[140:143], v[232:235]
 v_exp_f32 v132, v132
 v_mfma_f32_16x16x32_bf16 v[232:235], v[104:107], a[136:139], v[232:235]
 v_exp_f32 v133, v133
 v_mfma_f32_16x16x32_bf16 a[160:163], v[112:115], a[136:139], a[160:163]
 v_add_f32 v7, v132, v7
 v_cvt_pk_bf16_f32 v48, v132, v133
 v_mfma_f32_16x16x32_bf16 a[160:163], v[116:119], a[140:143], a[160:163]
 v_exp_f32 v134, v134
 v_mfma_f32_16x16x32_bf16 a[192:195], v[124:127], a[140:143], a[192:195]
 ds_read_b128 a[124:127], v0 offset:38400
 v_add_f32 v7, v133, v7
 v_mfma_f32_16x16x32_bf16 a[192:195], v[120:123], a[136:139], a[192:195]
 v_exp_f32 v135, v135
 v_mfma_f32_16x16x32_bf16 v[140:143], v[80:83], a[144:147], v[140:143]
 s_waitcnt lgkmcnt(1)
 v_add_f32 v7, v134, v7
 v_cvt_pk_bf16_f32 v49, v134, v135
 v_mfma_f32_16x16x32_bf16 v[140:143], v[84:87], a[148:151], v[140:143]
 ds_read_b64_tr_b16 a[136:137], v1 offset:16896
 v_add_f32 v7, v135, v7
 v_mfma_f32_16x16x32_bf16 v[172:175], v[92:95], a[148:151], v[172:175]
 v_exp_f32 v72, v72
 v_mfma_f32_16x16x32_bf16 v[172:175], v[88:91], a[144:147], v[172:175]
 v_exp_f32 v73, v73
 v_mfma_f32_16x16x32_bf16 v[204:207], v[96:99], a[144:147], v[204:207]
 s_mov_b32 m0, 119680
 v_exp_f32 v74, v74
 v_mfma_f32_16x16x32_bf16 v[204:207], v[100:103], a[148:151], v[204:207]
 buffer_load_dwordx4 v3, s[12:15], s26 offen offset:128 nt lds
 buffer_load_dwordx4 v3, s[12:15], s26 offen offset:2176 nt lds
 v_add_f32 v8, v72, v8
 v_cvt_pk_bf16_f32 v56, v72, v73
 v_mfma_f32_16x16x32_bf16 v[236:239], v[108:111], a[148:151], v[236:239]
 s_add_u32 s26, s26, 4096
 v_exp_f32 v75, v75
 v_mfma_f32_16x16x32_bf16 v[236:239], v[104:107], a[144:147], v[236:239]
 v_add_f32 v8, v73, v8
 v_add_f32 v8, v74, v8
 v_mfma_f32_16x16x32_bf16 a[164:167], v[112:115], a[144:147], a[164:167]
 v_exp_f32 v20, v20
 v_mfma_f32_16x16x32_bf16 a[164:167], v[116:119], a[148:151], a[164:167]
 v_add_f32 v8, v75, v8
 v_cvt_pk_bf16_f32 v57, v74, v75
 v_mfma_f32_16x16x32_bf16 a[196:199], v[124:127], a[148:151], a[196:199]
 v_exp_f32 v21, v21
 v_mfma_f32_16x16x32_bf16 a[196:199], v[120:123], a[144:147], a[196:199]
 ds_read_b64_tr_b16 a[138:139], v1 offset:20992
 v_add_f32 v10, v20, v21
 v_mfma_f32_16x16x32_bf16 v[16:19], a[112:115], a[0:3], v[12:15]
 v_exp_f32 v22, v22
 v_mfma_f32_16x16x32_bf16 v[16:19], a[116:119], a[4:7], v[16:19]
 ds_read_b64_tr_b16 a[140:141], v1 offset:25088
 v_cvt_pk_bf16_f32 v64, v20, v21
 v_mfma_f32_16x16x32_bf16 v[16:19], a[120:123], a[8:11], v[16:19]
 s_waitcnt lgkmcnt(2)
 v_exp_f32 v23, v23
 v_mfma_f32_16x16x32_bf16 v[16:19], a[124:127], a[12:15], v[16:19]
 v_add_f32 v11, v22, v23
 v_cvt_pk_bf16_f32 v65, v22, v23
 v_mfma_f32_16x16x32_bf16 v[76:79], a[124:127], a[28:31], v[12:15]
 s_mov_b32 m0, 122880
 ds_read_b64_tr_b16 a[142:143], v1 offset:29184
 v_add_f32 v9, v10, v9
 v_mfma_f32_16x16x32_bf16 v[76:79], a[120:123], a[24:27], v[76:79]
 ds_read_b64_tr_b16 a[144:145], v2 offset:16896
 buffer_load_dwordx4 v3, s[12:15], s26 offen offset:0 nt lds
 buffer_load_dwordx4 v3, s[12:15], s26 offen offset:2048 nt lds
 v_add_f32 v9, v11, v9
 v_mfma_f32_16x16x32_bf16 v[76:79], a[116:119], a[20:23], v[76:79]
 v_exp_f32 v16, v16
 v_mfma_f32_16x16x32_bf16 v[76:79], a[112:115], a[16:19], v[76:79]
 v_exp_f32 v17, v17
 v_mfma_f32_16x16x32_bf16 v[128:131], a[112:115], a[32:35], v[12:15]
 v_add_f32 v4, v16, v4
 v_cvt_pk_bf16_f32 v26, v16, v17
 v_mfma_f32_16x16x32_bf16 v[128:131], a[116:119], a[36:39], v[128:131]
 v_exp_f32 v18, v18
 v_mfma_f32_16x16x32_bf16 v[128:131], a[120:123], a[40:43], v[128:131]
 ds_read_b64_tr_b16 a[146:147], v2 offset:20992
 v_add_f32 v4, v17, v4
 v_mfma_f32_16x16x32_bf16 v[128:131], a[124:127], a[44:47], v[128:131]
 v_exp_f32 v19, v19
 v_mfma_f32_16x16x32_bf16 v[132:135], a[124:127], a[60:63], v[12:15]
 v_add_f32 v4, v18, v4
 v_cvt_pk_bf16_f32 v27, v18, v19
 v_mfma_f32_16x16x32_bf16 v[132:135], a[120:123], a[56:59], v[132:135]
 ds_read_b64_tr_b16 a[148:149], v2 offset:25088
 v_add_f32 v4, v19, v4
 v_mfma_f32_16x16x32_bf16 v[132:135], a[116:119], a[52:55], v[132:135]
 v_exp_f32 v76, v76
 v_mfma_f32_16x16x32_bf16 v[132:135], a[112:115], a[48:51], v[132:135]
 v_exp_f32 v77, v77
 v_mfma_f32_16x16x32_bf16 v[72:75], a[112:115], a[64:67], v[12:15]
 s_mov_b32 m0, 123776
 v_add_f32 v5, v76, v5
 v_cvt_pk_bf16_f32 v34, v76, v77
 v_mfma_f32_16x16x32_bf16 v[72:75], a[116:119], a[68:71], v[72:75]
 buffer_load_dwordx4 v3, s[12:15], s26 offen offset:128 nt lds
 buffer_load_dwordx4 v3, s[12:15], s26 offen offset:2176 nt lds
 v_exp_f32 v78, v78
 v_mfma_f32_16x16x32_bf16 v[72:75], a[120:123], a[72:75], v[72:75]
 s_add_u32 s26, s26, 4096
 ds_read_b64_tr_b16 a[150:151], v2 offset:29184
 v_add_f32 v5, v77, v5
 v_mfma_f32_16x16x32_bf16 v[72:75], a[124:127], a[76:79], v[72:75]
 v_exp_f32 v79, v79
 v_mfma_f32_16x16x32_bf16 v[20:23], a[124:127], a[92:95], v[12:15]
 v_add_f32 v5, v78, v5
 v_cvt_pk_bf16_f32 v35, v78, v79
 v_mfma_f32_16x16x32_bf16 v[20:23], a[120:123], a[88:91], v[20:23]
 ds_read_b128 v[60:63], v0 offset:40960
 v_add_f32 v5, v79, v5
 v_mfma_f32_16x16x32_bf16 v[20:23], a[116:119], a[84:87], v[20:23]
 v_exp_f32 v128, v128
 v_mfma_f32_16x16x32_bf16 v[20:23], a[112:115], a[80:83], v[20:23]
 s_waitcnt lgkmcnt(2)
 v_exp_f32 v129, v129
 v_mfma_f32_16x16x32_bf16 v[144:147], v[80:83], a[136:139], v[144:147]
 v_add_f32 v6, v128, v6
 v_cvt_pk_bf16_f32 v42, v128, v129
 v_mfma_f32_16x16x32_bf16 v[144:147], v[84:87], a[140:143], v[144:147]
 v_exp_f32 v130, v130
 v_mfma_f32_16x16x32_bf16 v[176:179], v[92:95], a[140:143], v[176:179]
 ds_read_b128 v[68:71], v0 offset:41472
 v_add_f32 v6, v129, v6
 v_mfma_f32_16x16x32_bf16 v[176:179], v[88:91], a[136:139], v[176:179]
 v_exp_f32 v131, v131
 v_mfma_f32_16x16x32_bf16 v[208:211], v[96:99], a[136:139], v[208:211]
 s_mov_b32 m0, 126976
 v_add_f32 v6, v130, v6
 v_cvt_pk_bf16_f32 v43, v130, v131
 v_mfma_f32_16x16x32_bf16 v[208:211], v[100:103], a[140:143], v[208:211]
 ds_read_b128 a[128:131], v0 offset:41984
 buffer_load_dwordx4 v3, s[12:15], s26 offen offset:0 nt lds
 buffer_load_dwordx4 v3, s[12:15], s26 offen offset:2048 nt lds
 v_add_f32 v6, v131, v6
 v_mfma_f32_16x16x32_bf16 v[240:243], v[108:111], a[140:143], v[240:243]
 v_exp_f32 v132, v132
 v_mfma_f32_16x16x32_bf16 v[240:243], v[104:107], a[136:139], v[240:243]
 v_exp_f32 v133, v133
 v_mfma_f32_16x16x32_bf16 a[168:171], v[112:115], a[136:139], a[168:171]
 v_add_f32 v7, v132, v7
 v_cvt_pk_bf16_f32 v50, v132, v133
 v_mfma_f32_16x16x32_bf16 a[168:171], v[116:119], a[140:143], a[168:171]
 v_exp_f32 v134, v134
 v_mfma_f32_16x16x32_bf16 a[200:203], v[124:127], a[140:143], a[200:203]
 ds_read_b128 a[132:135], v0 offset:42496
 v_add_f32 v7, v133, v7
 v_mfma_f32_16x16x32_bf16 a[200:203], v[120:123], a[136:139], a[200:203]
 v_exp_f32 v135, v135
 v_mfma_f32_16x16x32_bf16 v[148:151], v[80:83], a[144:147], v[148:151]
 s_waitcnt lgkmcnt(1)
 v_add_f32 v7, v134, v7
 v_cvt_pk_bf16_f32 v51, v134, v135
 v_mfma_f32_16x16x32_bf16 v[148:151], v[84:87], a[148:151], v[148:151]
 ds_read_b64_tr_b16 a[136:137], v1 offset:17408
 v_add_f32 v7, v135, v7
 v_mfma_f32_16x16x32_bf16 v[180:183], v[92:95], a[148:151], v[180:183]
 v_exp_f32 v72, v72
 v_mfma_f32_16x16x32_bf16 v[180:183], v[88:91], a[144:147], v[180:183]
 v_exp_f32 v73, v73
 v_mfma_f32_16x16x32_bf16 v[212:215], v[96:99], a[144:147], v[212:215]
 s_mov_b32 m0, 127872
 v_exp_f32 v74, v74
 v_mfma_f32_16x16x32_bf16 v[212:215], v[100:103], a[148:151], v[212:215]
 buffer_load_dwordx4 v3, s[12:15], s26 offen offset:128 nt lds
 buffer_load_dwordx4 v3, s[12:15], s26 offen offset:2176 nt lds
 v_add_f32 v8, v72, v8
 v_cvt_pk_bf16_f32 v58, v72, v73
 v_mfma_f32_16x16x32_bf16 v[244:247], v[108:111], a[148:151], v[244:247]
 s_add_u32 s26, s26, 4096
 v_exp_f32 v75, v75
 v_mfma_f32_16x16x32_bf16 v[244:247], v[104:107], a[144:147], v[244:247]
 v_add_f32 v8, v73, v8
 v_add_f32 v8, v74, v8
 v_mfma_f32_16x16x32_bf16 a[172:175], v[112:115], a[144:147], a[172:175]
 v_exp_f32 v20, v20
 v_mfma_f32_16x16x32_bf16 a[172:175], v[116:119], a[148:151], a[172:175]
 v_add_f32 v8, v75, v8
 v_cvt_pk_bf16_f32 v59, v74, v75
 v_mfma_f32_16x16x32_bf16 a[204:207], v[124:127], a[148:151], a[204:207]
 v_exp_f32 v21, v21
 v_mfma_f32_16x16x32_bf16 a[204:207], v[120:123], a[144:147], a[204:207]
 ds_read_b64_tr_b16 a[138:139], v1 offset:21504
 v_add_f32 v10, v20, v21
 v_mfma_f32_16x16x32_bf16 v[16:19], v[60:63], a[0:3], v[12:15]
 v_exp_f32 v22, v22
 v_mfma_f32_16x16x32_bf16 v[16:19], v[68:71], a[4:7], v[16:19]
 ds_read_b64_tr_b16 a[140:141], v1 offset:25600
 v_cvt_pk_bf16_f32 v66, v20, v21
 v_mfma_f32_16x16x32_bf16 v[16:19], a[128:131], a[8:11], v[16:19]
 s_waitcnt lgkmcnt(2)
 v_exp_f32 v23, v23
 v_mfma_f32_16x16x32_bf16 v[16:19], a[132:135], a[12:15], v[16:19]
 v_add_f32 v11, v22, v23
 v_cvt_pk_bf16_f32 v67, v22, v23
 v_mfma_f32_16x16x32_bf16 v[76:79], a[132:135], a[28:31], v[12:15]
 s_mov_b32 m0, 16384
 ds_read_b64_tr_b16 a[142:143], v1 offset:29696
 v_add_f32 v9, v10, v9
 v_mfma_f32_16x16x32_bf16 v[76:79], a[128:131], a[24:27], v[76:79]
 ds_read_b64_tr_b16 a[144:145], v2 offset:17408
 buffer_load_dwordx4 v3, s[8:11], s25 offen offset:0 nt lds
 buffer_load_dwordx4 v3, s[8:11], s25 offen offset:2048 nt lds
 v_add_f32 v9, v11, v9
 v_mfma_f32_16x16x32_bf16 v[76:79], v[68:71], a[20:23], v[76:79]
 v_exp_f32 v16, v16
 v_mfma_f32_16x16x32_bf16 v[76:79], v[60:63], a[16:19], v[76:79]
 v_exp_f32 v17, v17
 v_mfma_f32_16x16x32_bf16 v[128:131], v[60:63], a[32:35], v[12:15]
 v_add_f32 v4, v16, v4
 v_cvt_pk_bf16_f32 v28, v16, v17
 v_mfma_f32_16x16x32_bf16 v[128:131], v[68:71], a[36:39], v[128:131]
 v_exp_f32 v18, v18
 v_mfma_f32_16x16x32_bf16 v[128:131], a[128:131], a[40:43], v[128:131]
 ds_read_b64_tr_b16 a[146:147], v2 offset:21504
 v_add_f32 v4, v17, v4
 v_mfma_f32_16x16x32_bf16 v[128:131], a[132:135], a[44:47], v[128:131]
 v_exp_f32 v19, v19
 v_mfma_f32_16x16x32_bf16 v[132:135], a[132:135], a[60:63], v[12:15]
 v_add_f32 v4, v18, v4
 v_cvt_pk_bf16_f32 v29, v18, v19
 v_mfma_f32_16x16x32_bf16 v[132:135], a[128:131], a[56:59], v[132:135]
 ds_read_b64_tr_b16 a[148:149], v2 offset:25600
 v_add_f32 v4, v19, v4
 v_mfma_f32_16x16x32_bf16 v[132:135], v[68:71], a[52:55], v[132:135]
 v_exp_f32 v76, v76
 v_mfma_f32_16x16x32_bf16 v[132:135], v[60:63], a[48:51], v[132:135]
 v_exp_f32 v77, v77
 v_mfma_f32_16x16x32_bf16 v[72:75], v[60:63], a[64:67], v[12:15]
 s_mov_b32 m0, 17280
 v_add_f32 v5, v76, v5
 v_cvt_pk_bf16_f32 v36, v76, v77
 v_mfma_f32_16x16x32_bf16 v[72:75], v[68:71], a[68:71], v[72:75]
 buffer_load_dwordx4 v3, s[8:11], s25 offen offset:128 nt lds
 buffer_load_dwordx4 v3, s[8:11], s25 offen offset:2176 nt lds
 v_exp_f32 v78, v78
 v_mfma_f32_16x16x32_bf16 v[72:75], a[128:131], a[72:75], v[72:75]
 s_add_u32 s25, s25, 4096
 ds_read_b64_tr_b16 a[150:151], v2 offset:29696
 v_add_f32 v5, v77, v5
 v_mfma_f32_16x16x32_bf16 v[72:75], a[132:135], a[76:79], v[72:75]
 v_exp_f32 v79, v79
 v_mfma_f32_16x16x32_bf16 v[20:23], a[132:135], a[92:95], v[12:15]
 v_add_f32 v5, v78, v5
 v_cvt_pk_bf16_f32 v37, v78, v79
 v_mfma_f32_16x16x32_bf16 v[20:23], a[128:131], a[88:91], v[20:23]
 ds_read_b128 a[112:115], v0 offset:45056
 v_add_f32 v5, v79, v5
 v_mfma_f32_16x16x32_bf16 v[20:23], v[68:71], a[84:87], v[20:23]
 v_exp_f32 v128, v128
 v_mfma_f32_16x16x32_bf16 v[20:23], v[60:63], a[80:83], v[20:23]
 s_waitcnt lgkmcnt(2)
 v_exp_f32 v129, v129
 v_mfma_f32_16x16x32_bf16 v[152:155], v[80:83], a[136:139], v[152:155]
 v_add_f32 v6, v128, v6
 v_cvt_pk_bf16_f32 v44, v128, v129
 v_mfma_f32_16x16x32_bf16 v[152:155], v[84:87], a[140:143], v[152:155]
 v_exp_f32 v130, v130
 v_mfma_f32_16x16x32_bf16 v[184:187], v[92:95], a[140:143], v[184:187]
 ds_read_b128 a[116:119], v0 offset:45568
 v_add_f32 v6, v129, v6
 v_mfma_f32_16x16x32_bf16 v[184:187], v[88:91], a[136:139], v[184:187]
 v_exp_f32 v131, v131
 v_mfma_f32_16x16x32_bf16 v[216:219], v[96:99], a[136:139], v[216:219]
 s_mov_b32 m0, 20480
 v_add_f32 v6, v130, v6
 v_cvt_pk_bf16_f32 v45, v130, v131
 v_mfma_f32_16x16x32_bf16 v[216:219], v[100:103], a[140:143], v[216:219]
 ds_read_b128 a[120:123], v0 offset:46080
 buffer_load_dwordx4 v3, s[8:11], s25 offen offset:0 nt lds
 buffer_load_dwordx4 v3, s[8:11], s25 offen offset:2048 nt lds
 v_add_f32 v6, v131, v6
 v_mfma_f32_16x16x32_bf16 v[248:251], v[108:111], a[140:143], v[248:251]
 v_exp_f32 v132, v132
 v_mfma_f32_16x16x32_bf16 v[248:251], v[104:107], a[136:139], v[248:251]
 v_exp_f32 v133, v133
 v_mfma_f32_16x16x32_bf16 a[176:179], v[112:115], a[136:139], a[176:179]
 v_add_f32 v7, v132, v7
 v_cvt_pk_bf16_f32 v52, v132, v133
 v_mfma_f32_16x16x32_bf16 a[176:179], v[116:119], a[140:143], a[176:179]
 v_exp_f32 v134, v134
 v_mfma_f32_16x16x32_bf16 a[208:211], v[124:127], a[140:143], a[208:211]
 ds_read_b128 a[124:127], v0 offset:46592
 v_add_f32 v7, v133, v7
 v_mfma_f32_16x16x32_bf16 a[208:211], v[120:123], a[136:139], a[208:211]
 v_exp_f32 v135, v135
 v_mfma_f32_16x16x32_bf16 v[156:159], v[80:83], a[144:147], v[156:159]
 s_waitcnt lgkmcnt(1)
 v_add_f32 v7, v134, v7
 v_cvt_pk_bf16_f32 v53, v134, v135
 v_mfma_f32_16x16x32_bf16 v[156:159], v[84:87], a[148:151], v[156:159]
 ds_read_b64_tr_b16 a[136:137], v1 offset:17920
 v_add_f32 v7, v135, v7
 v_mfma_f32_16x16x32_bf16 v[188:191], v[92:95], a[148:151], v[188:191]
 v_exp_f32 v72, v72
 v_mfma_f32_16x16x32_bf16 v[188:191], v[88:91], a[144:147], v[188:191]
 v_exp_f32 v73, v73
 v_mfma_f32_16x16x32_bf16 v[220:223], v[96:99], a[144:147], v[220:223]
 s_mov_b32 m0, 21376
 v_exp_f32 v74, v74
 v_mfma_f32_16x16x32_bf16 v[220:223], v[100:103], a[148:151], v[220:223]
 buffer_load_dwordx4 v3, s[8:11], s25 offen offset:128 nt lds
 buffer_load_dwordx4 v3, s[8:11], s25 offen offset:2176 nt lds
 v_add_f32 v8, v72, v8
 v_cvt_pk_bf16_f32 v60, v72, v73
 v_mfma_f32_16x16x32_bf16 v[252:255], v[108:111], a[148:151], v[252:255]
 s_add_u32 s25, s25, 4096
 v_exp_f32 v75, v75
 v_mfma_f32_16x16x32_bf16 v[252:255], v[104:107], a[144:147], v[252:255]
 v_add_f32 v8, v73, v8
 v_add_f32 v8, v74, v8
 v_mfma_f32_16x16x32_bf16 a[180:183], v[112:115], a[144:147], a[180:183]
 v_exp_f32 v20, v20
 v_mfma_f32_16x16x32_bf16 a[180:183], v[116:119], a[148:151], a[180:183]
 v_add_f32 v8, v75, v8
 v_cvt_pk_bf16_f32 v61, v74, v75
 v_mfma_f32_16x16x32_bf16 a[212:215], v[124:127], a[148:151], a[212:215]
 v_exp_f32 v21, v21
 v_mfma_f32_16x16x32_bf16 a[212:215], v[120:123], a[144:147], a[212:215]
 ds_read_b64_tr_b16 a[138:139], v1 offset:22016
 v_add_f32 v10, v20, v21
 v_mfma_f32_16x16x32_bf16 v[16:19], a[112:115], a[0:3], v[12:15]
 v_exp_f32 v22, v22
 v_mfma_f32_16x16x32_bf16 v[16:19], a[116:119], a[4:7], v[16:19]
 ds_read_b64_tr_b16 a[140:141], v1 offset:26112
 v_cvt_pk_bf16_f32 v68, v20, v21
 v_mfma_f32_16x16x32_bf16 v[16:19], a[120:123], a[8:11], v[16:19]
 s_waitcnt lgkmcnt(2)
 v_exp_f32 v23, v23
 v_mfma_f32_16x16x32_bf16 v[16:19], a[124:127], a[12:15], v[16:19]
 s_mov_b32 m0, 24576
 v_add_f32 v11, v22, v23
 v_cvt_pk_bf16_f32 v69, v22, v23
 v_mfma_f32_16x16x32_bf16 v[76:79], a[124:127], a[28:31], v[12:15]
 s_waitcnt vmcnt(40)
 ds_read_b64_tr_b16 a[142:143], v1 offset:30208
 v_add_f32 v9, v10, v9
 v_mfma_f32_16x16x32_bf16 v[76:79], a[120:123], a[24:27], v[76:79]
 s_barrier
 ds_read_b64_tr_b16 a[144:145], v2 offset:17920
 buffer_load_dwordx4 v3, s[8:11], s25 offen offset:0 nt lds
 buffer_load_dwordx4 v3, s[8:11], s25 offen offset:2048 nt lds
 v_add_f32 v9, v11, v9
 v_mfma_f32_16x16x32_bf16 v[76:79], a[116:119], a[20:23], v[76:79]
 v_exp_f32 v16, v16
 v_mfma_f32_16x16x32_bf16 v[76:79], a[112:115], a[16:19], v[76:79]
 v_exp_f32 v17, v17
 v_mfma_f32_16x16x32_bf16 v[128:131], a[112:115], a[32:35], v[12:15]
 v_add_f32 v4, v16, v4
 v_cvt_pk_bf16_f32 v30, v16, v17
 v_mfma_f32_16x16x32_bf16 v[128:131], a[116:119], a[36:39], v[128:131]
 v_exp_f32 v18, v18
 v_mfma_f32_16x16x32_bf16 v[128:131], a[120:123], a[40:43], v[128:131]
 ds_read_b64_tr_b16 a[146:147], v2 offset:22016
 v_add_f32 v4, v17, v4
 v_mfma_f32_16x16x32_bf16 v[128:131], a[124:127], a[44:47], v[128:131]
 v_exp_f32 v19, v19
 v_mfma_f32_16x16x32_bf16 v[20:23], a[124:127], a[60:63], v[12:15]
 v_add_f32 v4, v18, v4
 v_cvt_pk_bf16_f32 v31, v18, v19
 v_mfma_f32_16x16x32_bf16 v[20:23], a[120:123], a[56:59], v[20:23]
 ds_read_b64_tr_b16 a[148:149], v2 offset:26112
 v_add_f32 v4, v19, v4
 v_mfma_f32_16x16x32_bf16 v[20:23], a[116:119], a[52:55], v[20:23]
 v_exp_f32 v76, v76
 v_mfma_f32_16x16x32_bf16 v[20:23], a[112:115], a[48:51], v[20:23]
 s_waitcnt lgkmcnt(2)
 v_exp_f32 v77, v77
 v_mfma_f32_16x16x32_bf16 v[160:163], v[80:83], a[136:139], v[160:163]
 s_mov_b32 m0, 25472
 v_add_f32 v5, v76, v5
 v_cvt_pk_bf16_f32 v38, v76, v77
 v_mfma_f32_16x16x32_bf16 v[160:163], v[84:87], a[140:143], v[160:163]
 buffer_load_dwordx4 v3, s[8:11], s25 offen offset:128 nt lds
 buffer_load_dwordx4 v3, s[8:11], s25 offen offset:2176 nt lds
 v_exp_f32 v78, v78
 v_mfma_f32_16x16x32_bf16 v[192:195], v[92:95], a[140:143], v[192:195]
 s_add_u32 s25, s25, 4096
 ds_read_b64_tr_b16 a[150:151], v2 offset:30208
 v_add_f32 v5, v77, v5
 v_mfma_f32_16x16x32_bf16 v[192:195], v[88:91], a[136:139], v[192:195]
 v_exp_f32 v79, v79
 v_mfma_f32_16x16x32_bf16 v[224:227], v[96:99], a[136:139], v[224:227]
 v_add_f32 v5, v78, v5
 v_cvt_pk_bf16_f32 v39, v78, v79
 v_mfma_f32_16x16x32_bf16 v[224:227], v[100:103], a[140:143], v[224:227]
 ds_read_b128 a[128:131], v0 offset:49152
 v_add_f32 v5, v79, v5
 v_mfma_f32_16x16x32_bf16 a[152:155], v[108:111], a[140:143], a[152:155]
 v_exp_f32 v128, v128
 v_mfma_f32_16x16x32_bf16 a[152:155], v[104:107], a[136:139], a[152:155]
 v_exp_f32 v129, v129
 v_mfma_f32_16x16x32_bf16 a[184:187], v[112:115], a[136:139], a[184:187]
 v_exp_f32 v130, v130
 v_mfma_f32_16x16x32_bf16 a[184:187], v[116:119], a[140:143], a[184:187]
 v_add_f32 v6, v128, v6
 v_cvt_pk_bf16_f32 v46, v128, v129
 v_mfma_f32_16x16x32_bf16 a[216:219], v[124:127], a[140:143], a[216:219]
 v_exp_f32 v131, v131
 v_mfma_f32_16x16x32_bf16 a[216:219], v[120:123], a[136:139], a[216:219]
 s_waitcnt lgkmcnt(1)
 v_add_f32 v6, v129, v6
 v_add_f32 v6, v130, v6
 v_mfma_f32_16x16x32_bf16 v[164:167], v[80:83], a[144:147], v[164:167]
 s_mov_b32 m0, 28672
 v_exp_f32 v20, v20
 v_mfma_f32_16x16x32_bf16 v[164:167], v[84:87], a[148:151], v[164:167]
 buffer_load_dwordx4 v3, s[8:11], s25 offen offset:0 nt lds
 buffer_load_dwordx4 v3, s[8:11], s25 offen offset:2048 nt lds
 v_add_f32 v6, v131, v6
 v_cvt_pk_bf16_f32 v47, v130, v131
 v_mfma_f32_16x16x32_bf16 v[196:199], v[92:95], a[148:151], v[196:199]
 v_exp_f32 v21, v21
 v_mfma_f32_16x16x32_bf16 v[196:199], v[88:91], a[144:147], v[196:199]
 ds_read_b128 a[132:135], v0 offset:49664
 v_add_f32 v10, v20, v21
 v_mfma_f32_16x16x32_bf16 v[16:19], a[112:115], a[64:67], v[12:15]
 v_exp_f32 v22, v22
 v_mfma_f32_16x16x32_bf16 v[16:19], a[116:119], a[68:71], v[16:19]
 ds_read_b128 v[84:87], v0 offset:50176
 v_cvt_pk_bf16_f32 v54, v20, v21
 v_mfma_f32_16x16x32_bf16 v[16:19], a[120:123], a[72:75], v[16:19]
 v_exp_f32 v23, v23
 v_mfma_f32_16x16x32_bf16 v[16:19], a[124:127], a[76:79], v[16:19]
 v_add_f32 v11, v22, v23
 v_cvt_pk_bf16_f32 v55, v22, v23
 v_mfma_f32_16x16x32_bf16 v[20:23], a[124:127], a[92:95], v[12:15]
 ds_read_b128 v[92:95], v0 offset:50688
 v_add_f32 v7, v10, v7
 v_mfma_f32_16x16x32_bf16 v[20:23], a[120:123], a[88:91], v[20:23]
 ds_read_b64_tr_b16 a[136:137], v1 offset:32768
 v_add_f32 v7, v11, v7
 v_mfma_f32_16x16x32_bf16 v[20:23], a[116:119], a[84:87], v[20:23]
 v_exp_f32 v16, v16
 v_mfma_f32_16x16x32_bf16 v[20:23], a[112:115], a[80:83], v[20:23]
 v_exp_f32 v17, v17
 v_mfma_f32_16x16x32_bf16 v[228:231], v[96:99], a[144:147], v[228:231]
 s_mov_b32 m0, 29568
 v_exp_f32 v18, v18
 v_mfma_f32_16x16x32_bf16 v[228:231], v[100:103], a[148:151], v[228:231]
 buffer_load_dwordx4 v3, s[8:11], s25 offen offset:128 nt lds
 buffer_load_dwordx4 v3, s[8:11], s25 offen offset:2176 nt lds
 v_add_f32 v8, v16, v8
 v_cvt_pk_bf16_f32 v62, v16, v17
 v_mfma_f32_16x16x32_bf16 a[156:159], v[108:111], a[148:151], a[156:159]
 s_add_u32 s25, s25, 4096
 v_exp_f32 v19, v19
 v_mfma_f32_16x16x32_bf16 a[156:159], v[104:107], a[144:147], a[156:159]
 v_add_f32 v8, v17, v8
 v_add_f32 v8, v18, v8
 v_mfma_f32_16x16x32_bf16 a[188:191], v[112:115], a[144:147], a[188:191]
 v_exp_f32 v20, v20
 v_mfma_f32_16x16x32_bf16 a[188:191], v[116:119], a[148:151], a[188:191]
 s_sub_u32 s27, s27, 1
 v_add_f32 v8, v19, v8
 v_cvt_pk_bf16_f32 v63, v18, v19
 v_mfma_f32_16x16x32_bf16 a[220:223], v[124:127], a[148:151], a[220:223]
 s_cmp_eq_u32 s27, 0
 v_exp_f32 v21, v21
 v_mfma_f32_16x16x32_bf16 a[220:223], v[120:123], a[144:147], a[220:223]
 s_waitcnt lgkmcnt(0)
 ds_read_b64_tr_b16 a[138:139], v1 offset:36864
 v_add_f32 v10, v20, v21
 s_cbranch_scc0 L_loop_6
 v_mfma_f32_16x16x32_bf16 v[16:19], a[128:131], a[0:3], v[12:15]
 v_exp_f32 v22, v22
 v_mfma_f32_16x16x32_bf16 v[16:19], a[132:135], a[4:7], v[16:19]
 ds_read_b64_tr_b16 a[140:141], v1 offset:40960
 v_cvt_pk_bf16_f32 v70, v20, v21
 v_mfma_f32_16x16x32_bf16 v[16:19], v[84:87], a[8:11], v[16:19]
 v_exp_f32 v23, v23
 v_mfma_f32_16x16x32_bf16 v[16:19], v[92:95], a[12:15], v[16:19]
 v_add_f32 v11, v22, v23
 v_cvt_pk_bf16_f32 v71, v22, v23
 v_mfma_f32_16x16x32_bf16 v[104:107], v[92:95], a[28:31], v[12:15]
 ds_read_b64_tr_b16 a[142:143], v1 offset:45056
 v_add_f32 v9, v10, v9
 v_mfma_f32_16x16x32_bf16 v[104:107], v[84:87], a[24:27], v[104:107]
 ds_read_b64_tr_b16 a[144:145], v2 offset:32768
 v_add_f32 v9, v11, v9
 v_mfma_f32_16x16x32_bf16 v[104:107], a[132:135], a[20:23], v[104:107]
 v_exp_f32 v16, v16
 v_mfma_f32_16x16x32_bf16 v[104:107], a[128:131], a[16:19], v[104:107]
 v_exp_f32 v17, v17
 v_mfma_f32_16x16x32_bf16 v[20:23], a[128:131], a[32:35], v[12:15]
 v_add_f32 v4, v16, v4
 v_cvt_pk_bf16_f32 v80, v16, v17
 v_mfma_f32_16x16x32_bf16 v[20:23], a[132:135], a[36:39], v[20:23]
 v_exp_f32 v18, v18
 v_mfma_f32_16x16x32_bf16 v[20:23], v[84:87], a[40:43], v[20:23]
 ds_read_b64_tr_b16 a[146:147], v2 offset:36864
 v_add_f32 v4, v17, v4
 v_mfma_f32_16x16x32_bf16 v[20:23], v[92:95], a[44:47], v[20:23]
 s_waitcnt lgkmcnt(2)
 v_exp_f32 v19, v19
 v_mfma_f32_16x16x32_bf16 v[136:139], v[24:27], a[136:139], v[136:139]
 v_add_f32 v4, v18, v4
 v_cvt_pk_bf16_f32 v81, v18, v19
 v_mfma_f32_16x16x32_bf16 v[136:139], v[28:31], a[140:143], v[136:139]
 ds_read_b64_tr_b16 a[148:149], v2 offset:40960
 v_add_f32 v4, v19, v4
 v_mfma_f32_16x16x32_bf16 v[168:171], v[36:39], a[140:143], v[168:171]
 v_exp_f32 v104, v104
 v_mfma_f32_16x16x32_bf16 v[168:171], v[32:35], a[136:139], v[168:171]
 v_exp_f32 v105, v105
 v_mfma_f32_16x16x32_bf16 v[200:203], v[40:43], a[136:139], v[200:203]
 ds_read_b64_tr_b16 a[150:151], v2 offset:45056
 v_add_f32 v5, v104, v5
 v_cvt_pk_bf16_f32 v88, v104, v105
 v_mfma_f32_16x16x32_bf16 v[200:203], v[44:47], a[140:143], v[200:203]
 v_exp_f32 v106, v106
 v_mfma_f32_16x16x32_bf16 v[232:235], v[52:55], a[140:143], v[232:235]
 ds_read_b128 a[112:115], v0 offset:53248
 v_add_f32 v5, v105, v5
 v_mfma_f32_16x16x32_bf16 v[232:235], v[48:51], a[136:139], v[232:235]
 v_exp_f32 v107, v107
 v_mfma_f32_16x16x32_bf16 a[160:163], v[56:59], a[136:139], a[160:163]
 ds_read_b128 a[116:119], v0 offset:53760
 v_add_f32 v5, v106, v5
 v_cvt_pk_bf16_f32 v89, v106, v107
 v_mfma_f32_16x16x32_bf16 a[160:163], v[60:63], a[140:143], a[160:163]
 ds_read_b128 a[120:123], v0 offset:54272
 v_add_f32 v5, v107, v5
 v_mfma_f32_16x16x32_bf16 a[192:195], v[68:71], a[140:143], a[192:195]
 v_exp_f32 v20, v20
 v_mfma_f32_16x16x32_bf16 a[192:195], v[64:67], a[136:139], a[192:195]
 s_waitcnt lgkmcnt(3)
 v_exp_f32 v21, v21
 v_mfma_f32_16x16x32_bf16 v[140:143], v[24:27], a[144:147], v[140:143]
 ds_read_b128 a[124:127], v0 offset:54784
 v_add_f32 v6, v20, v6
 v_cvt_pk_bf16_f32 v96, v20, v21
 v_mfma_f32_16x16x32_bf16 v[140:143], v[28:31], a[148:151], v[140:143]
 v_exp_f32 v22, v22
 v_mfma_f32_16x16x32_bf16 v[172:175], v[36:39], a[148:151], v[172:175]
 ds_read_b64_tr_b16 a[136:137], v1 offset:33280
 v_add_f32 v6, v21, v6
 v_mfma_f32_16x16x32_bf16 v[172:175], v[32:35], a[144:147], v[172:175]
 v_exp_f32 v23, v23
 v_mfma_f32_16x16x32_bf16 v[204:207], v[40:43], a[144:147], v[204:207]
 v_add_f32 v6, v22, v6
 v_cvt_pk_bf16_f32 v97, v22, v23
 v_mfma_f32_16x16x32_bf16 v[204:207], v[44:47], a[148:151], v[204:207]
 s_waitcnt lgkmcnt(2)
 ds_read_b64_tr_b16 a[138:139], v1 offset:37376
 v_add_f32 v6, v23, v6
 v_mfma_f32_16x16x32_bf16 v[16:19], a[112:115], a[0:3], v[12:15]
 ds_read_b64_tr_b16 a[140:141], v1 offset:41472
 ds_read_b64_tr_b16 a[142:143], v1 offset:45568
 v_mfma_f32_16x16x32_bf16 v[16:19], a[116:119], a[4:7], v[16:19]
 ds_read_b128 v[116:119], v0 offset:57344
 ds_read_b128 v[124:127], v0 offset:57856
 v_mfma_f32_16x16x32_bf16 v[16:19], a[120:123], a[8:11], v[16:19]
 s_waitcnt lgkmcnt(6)
 ds_read_b128 a[128:131], v0 offset:58368
 ds_read_b128 a[132:135], v0 offset:58880
 v_mfma_f32_16x16x32_bf16 v[16:19], a[124:127], a[12:15], v[16:19]
 s_nop 0
 v_mfma_f32_16x16x32_bf16 v[104:107], a[124:127], a[28:31], v[12:15]
 s_nop 0
 v_mfma_f32_16x16x32_bf16 v[104:107], a[120:123], a[24:27], v[104:107]
 s_nop 0
 s_nop 0
 v_mfma_f32_16x16x32_bf16 v[104:107], a[116:119], a[20:23], v[104:107]
 s_nop 0
 v_exp_f32 v16, v16
 v_mfma_f32_16x16x32_bf16 v[104:107], a[112:115], a[16:19], v[104:107]
 v_exp_f32 v17, v17
 v_mfma_f32_16x16x32_bf16 v[20:23], a[112:115], a[32:35], v[12:15]
 v_add_f32 v4, v16, v4
 v_cvt_pk_bf16_f32 v82, v16, v17
 v_mfma_f32_16x16x32_bf16 v[20:23], a[116:119], a[36:39], v[20:23]
 v_exp_f32 v18, v18
 v_mfma_f32_16x16x32_bf16 v[20:23], a[120:123], a[40:43], v[20:23]
 ds_read_b128 a[112:115], v0 offset:61440
 v_add_f32 v4, v17, v4
 v_mfma_f32_16x16x32_bf16 v[20:23], a[124:127], a[44:47], v[20:23]
 v_exp_f32 v19, v19
 v_mfma_f32_16x16x32_bf16 v[236:239], v[52:55], a[148:151], v[236:239]
 v_add_f32 v4, v18, v4
 v_cvt_pk_bf16_f32 v83, v18, v19
 v_mfma_f32_16x16x32_bf16 v[236:239], v[48:51], a[144:147], v[236:239]
 ds_read_b128 a[116:119], v0 offset:61952
 v_add_f32 v4, v19, v4
 v_mfma_f32_16x16x32_bf16 a[164:167], v[56:59], a[144:147], a[164:167]
 v_exp_f32 v104, v104
 v_mfma_f32_16x16x32_bf16 a[164:167], v[60:63], a[148:151], a[164:167]
 v_exp_f32 v105, v105
 v_mfma_f32_16x16x32_bf16 a[196:199], v[68:71], a[148:151], a[196:199]
 v_add_f32 v5, v104, v5
 v_cvt_pk_bf16_f32 v90, v104, v105
 v_mfma_f32_16x16x32_bf16 a[196:199], v[64:67], a[144:147], a[196:199]
 s_waitcnt lgkmcnt(1)
 v_exp_f32 v106, v106
 v_mfma_f32_16x16x32_bf16 v[144:147], v[24:27], a[136:139], v[144:147]
 ds_read_b64_tr_b16 a[144:145], v2 offset:33280
 v_add_f32 v5, v105, v5
 v_mfma_f32_16x16x32_bf16 v[144:147], v[28:31], a[140:143], v[144:147]
 v_exp_f32 v107, v107
 v_mfma_f32_16x16x32_bf16 v[176:179], v[36:39], a[140:143], v[176:179]
 v_add_f32 v5, v106, v5
 v_cvt_pk_bf16_f32 v91, v106, v107
 v_mfma_f32_16x16x32_bf16 v[176:179], v[32:35], a[136:139], v[176:179]
 ds_read_b64_tr_b16 a[146:147], v2 offset:37376
 v_add_f32 v5, v107, v5
 v_mfma_f32_16x16x32_bf16 v[208:211], v[40:43], a[136:139], v[208:211]
 v_exp_f32 v20, v20
 v_mfma_f32_16x16x32_bf16 v[208:211], v[44:47], a[140:143], v[208:211]
 v_exp_f32 v21, v21
 v_mfma_f32_16x16x32_bf16 v[240:243], v[52:55], a[140:143], v[240:243]
 v_add_f32 v6, v20, v6
 v_cvt_pk_bf16_f32 v98, v20, v21
 v_mfma_f32_16x16x32_bf16 v[240:243], v[48:51], a[136:139], v[240:243]
 v_exp_f32 v22, v22
 v_mfma_f32_16x16x32_bf16 a[168:171], v[56:59], a[136:139], a[168:171]
 ds_read_b64_tr_b16 a[148:149], v2 offset:41472
 v_add_f32 v6, v21, v6
 v_mfma_f32_16x16x32_bf16 a[168:171], v[60:63], a[140:143], a[168:171]
 v_exp_f32 v23, v23
 v_mfma_f32_16x16x32_bf16 a[200:203], v[68:71], a[140:143], a[200:203]
 v_add_f32 v6, v22, v6
 v_cvt_pk_bf16_f32 v99, v22, v23
 v_mfma_f32_16x16x32_bf16 a[200:203], v[64:67], a[136:139], a[200:203]
 ds_read_b64_tr_b16 a[150:151], v2 offset:45568
 v_add_f32 v6, v23, v6
 v_mfma_f32_16x16x32_bf16 v[16:19], v[116:119], a[0:3], v[12:15]
 ds_read_b64_tr_b16 a[136:137], v1 offset:33792
 ds_read_b64_tr_b16 a[138:139], v1 offset:37888
 v_mfma_f32_16x16x32_bf16 v[16:19], v[124:127], a[4:7], v[16:19]
 ds_read_b64_tr_b16 a[140:141], v1 offset:41984
 ds_read_b64_tr_b16 a[142:143], v1 offset:46080
 v_mfma_f32_16x16x32_bf16 v[16:19], a[128:131], a[8:11], v[16:19]
 ds_read_b128 a[120:123], v0 offset:62464
 ds_read_b128 a[124:127], v0 offset:62976
 v_mfma_f32_16x16x32_bf16 v[16:19], a[132:135], a[12:15], v[16:19]
 s_nop 0
 v_mfma_f32_16x16x32_bf16 v[104:107], a[132:135], a[28:31], v[12:15]
 s_nop 0
 v_mfma_f32_16x16x32_bf16 v[104:107], a[128:131], a[24:27], v[104:107]
 s_nop 0
 s_nop 0
 v_mfma_f32_16x16x32_bf16 v[104:107], v[124:127], a[20:23], v[104:107]
 s_nop 0
 v_exp_f32 v16, v16
 v_mfma_f32_16x16x32_bf16 v[104:107], v[116:119], a[16:19], v[104:107]
 v_exp_f32 v17, v17
 v_mfma_f32_16x16x32_bf16 v[20:23], v[116:119], a[32:35], v[12:15]
 v_add_f32 v4, v16, v4
 v_cvt_pk_bf16_f32 v84, v16, v17
 v_mfma_f32_16x16x32_bf16 v[20:23], v[124:127], a[36:39], v[20:23]
 v_exp_f32 v18, v18
 v_mfma_f32_16x16x32_bf16 v[20:23], a[128:131], a[40:43], v[20:23]
 v_add_f32 v4, v17, v4
 v_mfma_f32_16x16x32_bf16 v[20:23], a[132:135], a[44:47], v[20:23]
 s_waitcnt lgkmcnt(0)
 v_exp_f32 v19, v19
 v_mfma_f32_16x16x32_bf16 v[148:151], v[24:27], a[144:147], v[148:151]
 v_add_f32 v4, v18, v4
 v_cvt_pk_bf16_f32 v85, v18, v19
 v_mfma_f32_16x16x32_bf16 v[148:151], v[28:31], a[148:151], v[148:151]
 v_add_f32 v4, v19, v4
 v_mfma_f32_16x16x32_bf16 v[180:183], v[36:39], a[148:151], v[180:183]
 v_exp_f32 v104, v104
 v_mfma_f32_16x16x32_bf16 v[180:183], v[32:35], a[144:147], v[180:183]
 v_exp_f32 v105, v105
 v_mfma_f32_16x16x32_bf16 v[212:215], v[40:43], a[144:147], v[212:215]
 v_add_f32 v5, v104, v5
 v_cvt_pk_bf16_f32 v92, v104, v105
 v_mfma_f32_16x16x32_bf16 v[212:215], v[44:47], a[148:151], v[212:215]
 v_exp_f32 v106, v106
 v_mfma_f32_16x16x32_bf16 v[244:247], v[52:55], a[148:151], v[244:247]
 v_add_f32 v5, v105, v5
 v_mfma_f32_16x16x32_bf16 v[244:247], v[48:51], a[144:147], v[244:247]
 v_exp_f32 v107, v107
 v_mfma_f32_16x16x32_bf16 a[172:175], v[56:59], a[144:147], a[172:175]
 v_add_f32 v5, v106, v5
 v_cvt_pk_bf16_f32 v93, v106, v107
 v_mfma_f32_16x16x32_bf16 a[172:175], v[60:63], a[148:151], a[172:175]
 v_add_f32 v5, v107, v5
 v_mfma_f32_16x16x32_bf16 a[204:207], v[68:71], a[148:151], a[204:207]
 v_exp_f32 v20, v20
 v_mfma_f32_16x16x32_bf16 a[204:207], v[64:67], a[144:147], a[204:207]
 v_exp_f32 v21, v21
 v_mfma_f32_16x16x32_bf16 v[152:155], v[24:27], a[136:139], v[152:155]
 v_add_f32 v6, v20, v6
 v_cvt_pk_bf16_f32 v100, v20, v21
 v_mfma_f32_16x16x32_bf16 v[152:155], v[28:31], a[140:143], v[152:155]
 v_exp_f32 v22, v22
 v_mfma_f32_16x16x32_bf16 v[184:187], v[36:39], a[140:143], v[184:187]
 ds_read_b64_tr_b16 a[144:145], v2 offset:33792
 v_add_f32 v6, v21, v6
 v_mfma_f32_16x16x32_bf16 v[184:187], v[32:35], a[136:139], v[184:187]
 v_exp_f32 v23, v23
 v_mfma_f32_16x16x32_bf16 v[216:219], v[40:43], a[136:139], v[216:219]
 v_add_f32 v6, v22, v6
 v_cvt_pk_bf16_f32 v101, v22, v23
 v_mfma_f32_16x16x32_bf16 v[216:219], v[44:47], a[140:143], v[216:219]
 ds_read_b64_tr_b16 a[146:147], v2 offset:37888
 v_add_f32 v6, v23, v6
 v_mfma_f32_16x16x32_bf16 v[16:19], a[112:115], a[0:3], v[12:15]
 ds_read_b64_tr_b16 a[148:149], v2 offset:41984
 ds_read_b64_tr_b16 a[150:151], v2 offset:46080
 v_mfma_f32_16x16x32_bf16 v[16:19], a[116:119], a[4:7], v[16:19]
 v_mfma_f32_16x16x32_bf16 v[16:19], a[120:123], a[8:11], v[16:19]
 v_mfma_f32_16x16x32_bf16 v[16:19], a[124:127], a[12:15], v[16:19]
 s_nop 0
 v_mfma_f32_16x16x32_bf16 v[104:107], a[124:127], a[28:31], v[12:15]
 s_nop 0
 v_mfma_f32_16x16x32_bf16 v[104:107], a[120:123], a[24:27], v[104:107]
 s_nop 0
 s_nop 0
 v_mfma_f32_16x16x32_bf16 v[104:107], a[116:119], a[20:23], v[104:107]
 s_nop 0
 v_exp_f32 v16, v16
 v_mfma_f32_16x16x32_bf16 v[104:107], a[112:115], a[16:19], v[104:107]
 v_exp_f32 v17, v17
 v_mfma_f32_16x16x32_bf16 v[20:23], a[112:115], a[32:35], v[12:15]
 v_add_f32 v4, v16, v4
 v_cvt_pk_bf16_f32 v86, v16, v17
 v_mfma_f32_16x16x32_bf16 v[20:23], a[116:119], a[36:39], v[20:23]
 s_waitcnt vmcnt(16)
 v_exp_f32 v18, v18
 v_mfma_f32_16x16x32_bf16 v[20:23], a[120:123], a[40:43], v[20:23]
 s_barrier
 ds_read_b64_tr_b16 a[112:113], v1 offset:49152
 v_add_f32 v4, v17, v4
 v_mfma_f32_16x16x32_bf16 v[20:23], a[124:127], a[44:47], v[20:23]
 v_exp_f32 v19, v19
 v_mfma_f32_16x16x32_bf16 v[248:251], v[52:55], a[140:143], v[248:251]
 v_add_f32 v4, v18, v4
 v_cvt_pk_bf16_f32 v87, v18, v19
 v_mfma_f32_16x16x32_bf16 v[248:251], v[48:51], a[136:139], v[248:251]
 ds_read_b64_tr_b16 a[114:115], v1 offset:53248
 v_add_f32 v4, v19, v4
 v_mfma_f32_16x16x32_bf16 a[176:179], v[56:59], a[136:139], a[176:179]
 v_exp_f32 v104, v104
 v_mfma_f32_16x16x32_bf16 a[176:179], v[60:63], a[140:143], a[176:179]
 v_exp_f32 v105, v105
 v_mfma_f32_16x16x32_bf16 a[208:211], v[68:71], a[140:143], a[208:211]
 ds_read_b64_tr_b16 a[140:141], v1 offset:42496
 v_add_f32 v5, v104, v5
 v_cvt_pk_bf16_f32 v94, v104, v105
 v_mfma_f32_16x16x32_bf16 a[208:211], v[64:67], a[136:139], a[208:211]
 s_waitcnt lgkmcnt(2)
 v_exp_f32 v106, v106
 v_mfma_f32_16x16x32_bf16 v[156:159], v[24:27], a[144:147], v[156:159]
 ds_read_b64_tr_b16 a[136:137], v1 offset:34304
 v_add_f32 v5, v105, v5
 v_mfma_f32_16x16x32_bf16 v[156:159], v[28:31], a[148:151], v[156:159]
 v_exp_f32 v107, v107
 v_mfma_f32_16x16x32_bf16 v[188:191], v[36:39], a[148:151], v[188:191]
 ds_read_b64_tr_b16 a[138:139], v1 offset:38400
 v_add_f32 v5, v106, v5
 v_cvt_pk_bf16_f32 v95, v106, v107
 v_mfma_f32_16x16x32_bf16 v[188:191], v[32:35], a[144:147], v[188:191]
 ds_read_b64_tr_b16 a[142:143], v1 offset:46592
 v_add_f32 v5, v107, v5
 v_mfma_f32_16x16x32_bf16 v[220:223], v[40:43], a[144:147], v[220:223]
 v_exp_f32 v20, v20
 v_mfma_f32_16x16x32_bf16 v[220:223], v[44:47], a[148:151], v[220:223]
 v_exp_f32 v21, v21
 v_mfma_f32_16x16x32_bf16 v[252:255], v[52:55], a[148:151], v[252:255]
 v_add_f32 v6, v20, v6
 v_cvt_pk_bf16_f32 v102, v20, v21
 v_mfma_f32_16x16x32_bf16 v[252:255], v[48:51], a[144:147], v[252:255]
 v_exp_f32 v22, v22
 v_mfma_f32_16x16x32_bf16 a[180:183], v[56:59], a[144:147], a[180:183]
 ds_read_b64_tr_b16 a[116:117], v1 offset:57344
 v_add_f32 v6, v21, v6
 v_mfma_f32_16x16x32_bf16 a[180:183], v[60:63], a[148:151], a[180:183]
 v_exp_f32 v23, v23
 v_mfma_f32_16x16x32_bf16 a[212:215], v[68:71], a[148:151], a[212:215]
 v_add_f32 v6, v22, v6
 v_cvt_pk_bf16_f32 v103, v22, v23
 v_mfma_f32_16x16x32_bf16 a[212:215], v[64:67], a[144:147], a[212:215]
 s_waitcnt lgkmcnt(1)
 ds_read_b64_tr_b16 a[144:145], v2 offset:34304
 v_add_f32 v6, v23, v6
 v_mfma_f32_16x16x32_bf16 v[160:163], v[24:27], a[136:139], v[160:163]
 ds_read_b64_tr_b16 a[146:147], v2 offset:38400
 v_mov_b32 v20, 1.0
 v_mfma_f32_16x16x32_bf16 v[160:163], v[28:31], a[140:143], v[160:163]
 ds_read_b64_tr_b16 a[148:149], v2 offset:42496
 v_mov_b32 v21, 0x7f000000
 v_mfma_f32_16x16x32_bf16 v[192:195], v[36:39], a[140:143], v[192:195]
 ds_read_b64_tr_b16 a[150:151], v2 offset:46592
 s_mul_i32 s30, s24, 4352
 v_mfma_f32_16x16x32_bf16 v[192:195], v[32:35], a[136:139], v[192:195]
 ds_read_b64_tr_b16 a[118:119], v1 offset:61440
 s_add_u32 s30, s30, 131072
 v_mfma_f32_16x16x32_bf16 v[224:227], v[40:43], a[136:139], v[224:227]
 ds_read_b64_tr_b16 a[120:121], v2 offset:49152
 v_mbcnt_lo_u32_b32 v11, -1, 0
 v_mfma_f32_16x16x32_bf16 v[224:227], v[44:47], a[140:143], v[224:227]
 ds_read_b64_tr_b16 a[122:123], v2 offset:53248
 v_mbcnt_hi_u32_b32 v11, -1, v11
 v_mfma_f32_16x16x32_bf16 a[152:155], v[52:55], a[140:143], a[152:155]
 ds_read_b64_tr_b16 a[124:125], v2 offset:57344
 v_lshrrev_b32 v23, 4, v11
 v_mfma_f32_16x16x32_bf16 a[152:155], v[48:51], a[136:139], a[152:155]
 ds_read_b64_tr_b16 a[126:127], v2 offset:61440
 v_mul_u32_u24 v17, 1088, v23
 v_mfma_f32_16x16x32_bf16 a[184:187], v[56:59], a[136:139], a[184:187]
 ds_read_b64_tr_b16 a[128:129], v1 offset:49664
 v_add_u32 v17, s30, v17
 v_mfma_f32_16x16x32_bf16 a[184:187], v[60:63], a[140:143], a[184:187]
 ds_read_b64_tr_b16 a[130:131], v1 offset:53760
 v_lshl_add_u32 v18, v23, 10, s35
 v_mfma_f32_16x16x32_bf16 a[216:219], v[68:71], a[140:143], a[216:219]
 ds_read_b64_tr_b16 a[132:133], v1 offset:57856
 v_and_b32 v19, 15, v11
 v_mfma_f32_16x16x32_bf16 a[216:219], v[64:67], a[136:139], a[216:219]
 s_waitcnt lgkmcnt(6)
 ds_read_b64_tr_b16 a[134:135], v1 offset:61952
 v_lshl_add_u32 v16, v19, 4, v17
 v_mfma_f32_16x16x32_bf16 v[164:167], v[24:27], a[144:147], v[164:167]
 ds_read_b64_tr_b16 a[136:137], v2 offset:49664
 v_and_b32 v23, 1, v11
 v_mfma_f32_16x16x32_bf16 v[164:167], v[28:31], a[148:151], v[164:167]
 ds_read_b64_tr_b16 a[138:139], v2 offset:53760
 v_lshl_add_u32 v17, v23, 7, v17
 v_mfma_f32_16x16x32_bf16 v[196:199], v[36:39], a[148:151], v[196:199]
 ds_read_b64_tr_b16 a[140:141], v2 offset:57856
 v_and_b32 v23, 14, v11
 v_mfma_f32_16x16x32_bf16 v[196:199], v[32:35], a[144:147], v[196:199]
 ds_read_b64_tr_b16 a[142:143], v2 offset:61952
 v_lshl_add_u32 v17, v23, 2, v17
 v_mfma_f32_16x16x32_bf16 v[228:231], v[40:43], a[144:147], v[228:231]
 ds_read_b64_tr_b16 v[24:25], v1 offset:50176
 v_and_b32 v23, 3, v11
 v_mfma_f32_16x16x32_bf16 v[228:231], v[44:47], a[148:151], v[228:231]
 ds_read_b64_tr_b16 v[26:27], v1 offset:54272
 v_lshl_add_u32 v18, v23, 5, v18
 v_mfma_f32_16x16x32_bf16 a[156:159], v[52:55], a[148:151], a[156:159]
 ds_read_b64_tr_b16 v[28:29], v1 offset:58368
 v_and_b32 v23, 4, v11
 v_mfma_f32_16x16x32_bf16 a[156:159], v[48:51], a[144:147], a[156:159]
 ds_read_b64_tr_b16 v[30:31], v1 offset:62464
 v_lshl_add_u32 v18, v23, 2, v18
 v_mfma_f32_16x16x32_bf16 a[188:191], v[56:59], a[144:147], a[188:191]
 ds_read_b64_tr_b16 v[32:33], v2 offset:50176
 v_and_b32 v23, 8, v11
 v_mfma_f32_16x16x32_bf16 a[188:191], v[60:63], a[148:151], a[188:191]
 ds_read_b64_tr_b16 v[34:35], v2 offset:54272
 ds_read_b64_tr_b16 v[36:37], v2 offset:58368
 v_lshl_add_u32 v18, v23, 4, v18
 v_mfma_f32_16x16x32_bf16 a[220:223], v[68:71], a[148:151], a[220:223]
 ds_read_b64_tr_b16 v[38:39], v2 offset:62464
 ds_read_b64_tr_b16 v[40:41], v1 offset:50688
 v_mov_b32 v23, 0
 v_mfma_f32_16x16x32_bf16 a[220:223], v[64:67], a[144:147], a[220:223]
 ds_read_b64_tr_b16 v[42:43], v1 offset:54784
 ds_read_b64_tr_b16 v[44:45], v1 offset:58880
 ds_read_b64_tr_b16 v[46:47], v1 offset:62976
L_fin_6:
 v_mfma_f32_16x16x4_f32 v[72:75], v4, v20, 0
 ds_read_b64_tr_b16 a[144:145], v2 offset:50688
 ds_read_b64_tr_b16 a[146:147], v2 offset:54784
 ds_read_b64_tr_b16 a[148:149], v2 offset:58880
 ds_read_b64_tr_b16 a[150:151], v2 offset:62976
 v_mfma_f32_16x16x32_bf16 v[136:139], v[80:83], a[112:115], v[136:139]
 v_mfma_f32_16x16x32_bf16 v[136:139], v[84:87], a[116:119], v[136:139]
 s_waitcnt lgkmcnt(12)
 v_mfma_f32_16x16x32_bf16 v[140:143], v[84:87], a[124:127], v[140:143]
 v_mfma_f32_16x16x32_bf16 v[140:143], v[80:83], a[120:123], v[140:143]
 v_mfma_f32_16x16x32_bf16 v[144:147], v[80:83], a[128:131], v[144:147]
 v_mfma_f32_16x16x32_bf16 v[144:147], v[84:87], a[132:135], v[144:147]
 v_min3_f32 v21, v21, v72, v73
 v_min3_f32 v21, v21, v74, v75
 v_mfma_f32_16x16x32_bf16 v[148:151], v[84:87], a[140:143], v[148:151]
 v_rcp_f32 v72, v72
 v_mfma_f32_16x16x32_bf16 v[148:151], v[80:83], a[136:139], v[148:151]
 v_rcp_f32 v73, v73
 v_mfma_f32_16x16x32_bf16 v[152:155], v[80:83], v[24:27], v[152:155]
 v_rcp_f32 v74, v74
 v_mfma_f32_16x16x32_bf16 v[152:155], v[84:87], v[28:31], v[152:155]
 s_waitcnt lgkmcnt(0)
 v_rcp_f32 v75, v75
 v_mfma_f32_16x16x32_bf16 v[156:159], v[84:87], v[36:39], v[156:159]
 v_mfma_f32_16x16x32_bf16 v[156:159], v[80:83], v[32:35], v[156:159]
 v_mfma_f32_16x16x32_bf16 v[160:163], v[80:83], v[40:43], v[160:163]
 v_mfma_f32_16x16x32_bf16 v[160:163], v[84:87], v[44:47], v[160:163]
 v_mfma_f32_16x16x32_bf16 v[164:167], v[84:87], a[148:151], v[164:167]
 v_mfma_f32_16x16x32_bf16 v[164:167], v[80:83], a[144:147], v[164:167]
 v_pk_mul_f32 v[76:77], v[72:73], s[94:95] op_sel:[0,1] op_sel_hi:[1,1] neg_lo:[1,0] neg_hi:[1,0]
 v_pk_mul_f32 v[78:79], v[74:75], s[94:95] op_sel:[0,1] op_sel_hi:[1,1] neg_lo:[1,0] neg_hi:[1,0]
 v_pk_fma_f32 v[136:137], v[136:137], v[72:73], v[76:77]
 v_pk_fma_f32 v[140:141], v[140:141], v[72:73], v[76:77]
 v_pk_fma_f32 v[144:145], v[144:145], v[72:73], v[76:77]
 v_pk_fma_f32 v[148:149], v[148:149], v[72:73], v[76:77]
 v_pk_fma_f32 v[152:153], v[152:153], v[72:73], v[76:77]
 v_pk_fma_f32 v[156:157], v[156:157], v[72:73], v[76:77]
 v_pk_fma_f32 v[160:161], v[160:161], v[72:73], v[76:77]
 v_pk_fma_f32 v[164:165], v[164:165], v[72:73], v[76:77]
 v_cvt_pk_bf16_f32 v64, v136, v140
 v_cvt_pk_bf16_f32 v65, v144, v148
 v_cvt_pk_bf16_f32 v66, v152, v156
 v_cvt_pk_bf16_f32 v67, v160, v164
 ds_write_b128 v16, v[64:67] offset:0
 v_pk_fma_f32 v[138:139], v[138:139], v[74:75], v[78:79]
 v_pk_fma_f32 v[142:143], v[142:143], v[74:75], v[78:79]
 v_pk_fma_f32 v[146:147], v[146:147], v[74:75], v[78:79]
 v_pk_fma_f32 v[150:151], v[150:151], v[74:75], v[78:79]
 v_pk_fma_f32 v[154:155], v[154:155], v[74:75], v[78:79]
 v_pk_fma_f32 v[158:159], v[158:159], v[74:75], v[78:79]
 v_pk_fma_f32 v[162:163], v[162:163], v[74:75], v[78:79]
 v_pk_fma_f32 v[166:167], v[166:167], v[74:75], v[78:79]
 s_mov_b32 s30, 0
 v_mfma_f32_16x16x4_f32 v[72:75], v5, v20, 0
 v_cvt_pk_bf16_f32 v68, v137, v141
 v_cvt_pk_bf16_f32 v69, v145, v149
 v_cvt_pk_bf16_f32 v70, v153, v157
 v_cvt_pk_bf16_f32 v71, v161, v165
 v_max3_f32 v23, |v137|, |v141|, v23
 v_max3_f32 v23, |v145|, |v149|, v23
 v_mfma_f32_16x16x32_bf16 v[168:171], v[88:91], a[112:115], v[168:171]
 ds_read_b64_tr_b16 v[48:49], v17 offset:0
 ds_read_b64_tr_b16 v[50:51], v17 offset:64
 ds_write_b128 v16, v[68:71] offset:272
 v_mfma_f32_16x16x32_bf16 v[168:171], v[92:95], a[116:119], v[168:171]
 v_max3_f32 v23, |v153|, |v157|, v23
 v_max3_f32 v23, |v161|, |v165|, v23
 v_mfma_f32_16x16x32_bf16 v[80:83], v[68:71], v[64:67], 0
 v_cvt_pk_bf16_f32 v64, v138, v142
 v_mfma_f32_16x16x32_bf16 v[172:175], v[92:95], a[124:127], v[172:175]
 v_cvt_pk_bf16_f32 v65, v146, v150
 v_cvt_pk_bf16_f32 v66, v154, v158
 v_cvt_pk_bf16_f32 v67, v162, v166
 v_mfma_f32_16x16x32_bf16 v[172:175], v[88:91], a[120:123], v[172:175]
 s_waitcnt lgkmcnt(1)
 buffer_store_dwordx4 v[48:51], v18, s[16:19], s30 offen offset:0 sc0 sc1
 ds_read_b64_tr_b16 v[52:53], v17 offset:272
 ds_read_b64_tr_b16 v[54:55], v17 offset:336
 v_mfma_f32_16x16x32_bf16 v[176:179], v[88:91], a[128:131], v[176:179]
 ds_write_b128 v16, v[64:67] offset:544
 v_mfma_f32_16x16x32_bf16 v[176:179], v[92:95], a[132:135], v[176:179]
 v_cvt_pk_bf16_f32 v68, v139, v143
 v_cvt_pk_bf16_f32 v69, v147, v151
 v_cvt_pk_bf16_f32 v70, v155, v159
 v_mfma_f32_16x16x32_bf16 v[180:183], v[92:95], a[140:143], v[180:183]
 v_cvt_pk_bf16_f32 v71, v163, v167
 v_min3_f32 v21, v21, v72, v73
 v_min3_f32 v21, v21, v74, v75
 v_mfma_f32_16x16x32_bf16 v[180:183], v[88:91], a[136:139], v[180:183]
 s_waitcnt lgkmcnt(1)
 buffer_store_dwordx4 v[52:55], v18, s[16:19], s30 offen offset:256 sc0 sc1
 ds_read_b64_tr_b16 v[56:57], v17 offset:544
 ds_read_b64_tr_b16 v[58:59], v17 offset:608
 v_mfma_f32_16x16x32_bf16 v[184:187], v[88:91], v[24:27], v[184:187]
 ds_write_b128 v16, v[68:71] offset:816
 v_mfma_f32_16x16x32_bf16 v[184:187], v[92:95], v[28:31], v[184:187]
 v_mfma_f32_16x16x32_bf16 v[80:83], v[68:71], v[64:67], v[80:83]
 v_rcp_f32 v72, v72
 v_rcp_f32 v73, v73
 v_mfma_f32_16x16x32_bf16 v[188:191], v[92:95], v[36:39], v[188:191]
 v_rcp_f32 v74, v74
 v_mfma_f32_16x16x32_bf16 v[188:191], v[88:91], v[32:35], v[188:191]
 s_waitcnt lgkmcnt(1)
 buffer_store_dwordx4 v[56:59], v18, s[16:19], s30 offen offset:512 sc0 sc1
 ds_read_b64_tr_b16 v[60:61], v17 offset:816
 ds_read_b64_tr_b16 v[62:63], v17 offset:880
 v_mfma_f32_16x16x32_bf16 v[192:195], v[88:91], v[40:43], v[192:195]
 ds_read_b128 v[136:139], v0 offset:49152
 ds_read_b128 v[140:143], v0 offset:49664
 ds_read_b128 v[144:147], v0 offset:50176
 v_mfma_f32_16x16x32_bf16 v[192:195], v[92:95], v[44:47], v[192:195]
 ds_read_b128 v[148:151], v0 offset:50688
 ds_read_b128 v[152:155], v0 offset:53248
 ds_read_b128 v[156:159], v0 offset:53760
 v_mfma_f32_16x16x32_bf16 v[196:199], v[92:95], a[148:151], v[196:199]
 ds_read_b128 v[160:163], v0 offset:54272
 ds_read_b128 v[164:167], v0 offset:54784
 v_mfma_f32_16x16x32_bf16 v[196:199], v[88:91], a[144:147], v[196:199]
 v_rcp_f32 v75, v75
 s_waitcnt lgkmcnt(8)
 buffer_store_dwordx4 v[60:63], v18, s[16:19], s30 offen offset:768 sc0 sc1
 v_pk_mul_f32 v[76:77], v[72:73], s[94:95] op_sel:[0,1] op_sel_hi:[1,1] neg_lo:[1,0] neg_hi:[1,0]
 v_pk_mul_f32 v[78:79], v[74:75], s[94:95] op_sel:[0,1] op_sel_hi:[1,1] neg_lo:[1,0] neg_hi:[1,0]
 v_pk_fma_f32 v[168:169], v[168:169], v[72:73], v[76:77]
 v_pk_fma_f32 v[172:173], v[172:173], v[72:73], v[76:77]
 v_pk_fma_f32 v[176:177], v[176:177], v[72:73], v[76:77]
 v_pk_fma_f32 v[180:181], v[180:181], v[72:73], v[76:77]
 v_pk_fma_f32 v[184:185], v[184:185], v[72:73], v[76:77]
 v_pk_fma_f32 v[188:189], v[188:189], v[72:73], v[76:77]
 v_pk_fma_f32 v[192:193], v[192:193], v[72:73], v[76:77]
 v_pk_fma_f32 v[196:197], v[196:197], v[72:73], v[76:77]
 v_cvt_pk_bf16_f32 v64, v168, v172
 v_cvt_pk_bf16_f32 v65, v176, v180
 v_cvt_pk_bf16_f32 v66, v184, v188
 v_cvt_pk_bf16_f32 v67, v192, v196
 ds_write_b128 v16, v[64:67] offset:0
 v_pk_fma_f32 v[170:171], v[170:171], v[74:75], v[78:79]
 v_pk_fma_f32 v[174:175], v[174:175], v[74:75], v[78:79]
 v_pk_fma_f32 v[178:179], v[178:179], v[74:75], v[78:79]
 v_pk_fma_f32 v[182:183], v[182:183], v[74:75], v[78:79]
 v_pk_fma_f32 v[186:187], v[186:187], v[74:75], v[78:79]
 v_pk_fma_f32 v[190:191], v[190:191], v[74:75], v[78:79]
 v_pk_fma_f32 v[194:195], v[194:195], v[74:75], v[78:79]
 v_pk_fma_f32 v[198:199], v[198:199], v[74:75], v[78:79]
 s_mov_b32 s30, 4096
 v_mfma_f32_16x16x4_f32 v[72:75], v6, v20, 0
 s_waitcnt lgkmcnt(8)
 v_cvt_pk_bf16_f32 v68, v169, v173
 v_cvt_pk_bf16_f32 v69, v177, v181
 v_cvt_pk_bf16_f32 v70, v185, v189
 v_cvt_pk_bf16_f32 v71, v193, v197
 v_max3_f32 v23, |v169|, |v173|, v23
 v_max3_f32 v23, |v177|, |v181|, v23
 v_mfma_f32_16x16x32_bf16 v[104:107], v[136:139], a[48:51], v[12:15]
 s_waitcnt lgkmcnt(7)
 ds_read_b64_tr_b16 v[48:49], v17 offset:0
 ds_read_b64_tr_b16 v[50:51], v17 offset:64
 ds_write_b128 v16, v[68:71] offset:272
 v_mfma_f32_16x16x32_bf16 v[104:107], v[140:143], a[52:55], v[104:107]
 v_max3_f32 v23, |v185|, |v189|, v23
 v_max3_f32 v23, |v193|, |v197|, v23
 v_mfma_f32_16x16x32_bf16 v[80:83], v[68:71], v[64:67], v[80:83]
 s_waitcnt lgkmcnt(9)
 v_cvt_pk_bf16_f32 v64, v170, v174
 v_cvt_pk_bf16_f32 v65, v178, v182
 v_mfma_f32_16x16x32_bf16 v[104:107], v[144:147], a[56:59], v[104:107]
 s_waitcnt lgkmcnt(6)
 v_cvt_pk_bf16_f32 v66, v186, v190
 v_cvt_pk_bf16_f32 v67, v194, v198
 v_cvt_pk_bf16_f32 v68, v171, v175
 v_cvt_pk_bf16_f32 v69, v179, v183
 v_mfma_f32_16x16x32_bf16 v[104:107], v[148:151], a[60:63], v[104:107]
 s_waitcnt lgkmcnt(1)
 buffer_store_dwordx4 v[48:51], v18, s[16:19], s30 offen offset:0 sc0 sc1
 ds_read_b64_tr_b16 v[52:53], v17 offset:272
 ds_read_b64_tr_b16 v[54:55], v17 offset:336
 ds_write_b128 v16, v[64:67] offset:544
 v_mfma_f32_16x16x32_bf16 v[84:87], v[164:167], a[60:63], v[12:15]
 v_cvt_pk_bf16_f32 v70, v187, v191
 v_cvt_pk_bf16_f32 v71, v195, v199
 v_min3_f32 v21, v21, v72, v73
 v_min3_f32 v21, v21, v74, v75
 v_mfma_f32_16x16x32_bf16 v[84:87], v[160:163], a[56:59], v[84:87]
 v_mfma_f32_16x16x32_bf16 v[80:83], v[68:71], v[64:67], v[80:83]
 v_exp_f32 v104, v104
 v_exp_f32 v105, v105
 v_mfma_f32_16x16x32_bf16 v[84:87], v[156:159], a[52:55], v[84:87]
 s_waitcnt lgkmcnt(1)
 buffer_store_dwordx4 v[52:55], v18, s[16:19], s30 offen offset:256 sc0 sc1
 ds_read_b64_tr_b16 v[56:57], v17 offset:544
 ds_read_b64_tr_b16 v[58:59], v17 offset:608
 v_mfma_f32_16x16x32_bf16 v[84:87], v[152:155], a[48:51], v[84:87]
 ds_write_b128 v16, v[68:71] offset:816
 v_mfma_f32_16x16x32_bf16 v[200:203], v[96:99], a[112:115], v[200:203]
 v_add_f32 v7, v104, v7
 v_cvt_pk_bf16_f32 v104, v104, v105
 v_mfma_f32_16x16x32_bf16 v[200:203], v[100:103], a[116:119], v[200:203]
 v_exp_f32 v106, v106
 v_add_f32 v7, v105, v7
 v_mfma_f32_16x16x32_bf16 v[204:207], v[100:103], a[124:127], v[204:207]
 v_exp_f32 v107, v107
 v_add_f32 v7, v106, v7
 v_cvt_pk_bf16_f32 v105, v106, v107
 v_mfma_f32_16x16x32_bf16 v[204:207], v[96:99], a[120:123], v[204:207]
 s_waitcnt lgkmcnt(1)
 buffer_store_dwordx4 v[56:59], v18, s[16:19], s30 offen offset:512 sc0 sc1
 ds_read_b64_tr_b16 v[60:61], v17 offset:816
 ds_read_b64_tr_b16 v[62:63], v17 offset:880
 v_mfma_f32_16x16x32_bf16 v[208:211], v[96:99], a[128:131], v[208:211]
 ds_read_b128 v[168:171], v0 offset:57344
 ds_read_b128 v[172:175], v0 offset:57856
 ds_read_b128 v[176:179], v0 offset:58368
 v_mfma_f32_16x16x32_bf16 v[208:211], v[100:103], a[132:135], v[208:211]
 ds_read_b128 v[180:183], v0 offset:58880
 ds_read_b128 v[184:187], v0 offset:61440
 ds_read_b128 v[188:191], v0 offset:61952
 v_mfma_f32_16x16x32_bf16 v[212:215], v[100:103], a[140:143], v[212:215]
 ds_read_b128 v[192:195], v0 offset:62464
 ds_read_b128 v[196:199], v0 offset:62976
 v_add_f32 v7, v107, v7
 v_mfma_f32_16x16x32_bf16 v[212:215], v[96:99], a[136:139], v[212:215]
 v_exp_f32 v84, v84
 v_mfma_f32_16x16x32_bf16 v[112:115], v[136:139], a[64:67], v[12:15]
 s_waitcnt lgkmcnt(8)
 buffer_store_dwordx4 v[60:63], v18, s[16:19], s30 offen offset:768 sc0 sc1
 v_exp_f32 v85, v85
 v_add_f32 v7, v84, v7
 v_mfma_f32_16x16x32_bf16 v[112:115], v[140:143], a[68:71], v[112:115]
 v_cvt_pk_bf16_f32 v106, v84, v85
 v_exp_f32 v86, v86
 v_mfma_f32_16x16x32_bf16 v[112:115], v[144:147], a[72:75], v[112:115]
 v_add_f32 v7, v85, v7
 v_exp_f32 v87, v87
 v_mfma_f32_16x16x32_bf16 v[112:115], v[148:151], a[76:79], v[112:115]
 v_add_f32 v7, v86, v7
 v_cvt_pk_bf16_f32 v107, v86, v87
 v_add_f32 v7, v87, v7
 v_mfma_f32_16x16x32_bf16 v[88:91], v[164:167], a[76:79], v[12:15]
 v_rcp_f32 v72, v72
 v_mfma_f32_16x16x32_bf16 v[88:91], v[160:163], a[72:75], v[88:91]
 v_rcp_f32 v73, v73
 v_rcp_f32 v74, v74
 v_mfma_f32_16x16x32_bf16 v[88:91], v[156:159], a[68:71], v[88:91]
 v_exp_f32 v112, v112
 v_mfma_f32_16x16x32_bf16 v[88:91], v[152:155], a[64:67], v[88:91]
 v_exp_f32 v113, v113
 v_add_f32 v8, v112, v8
 v_cvt_pk_bf16_f32 v112, v112, v113
 v_mfma_f32_16x16x32_bf16 v[216:219], v[96:99], v[24:27], v[216:219]
 v_exp_f32 v114, v114
 v_add_f32 v8, v113, v8
 v_mfma_f32_16x16x32_bf16 v[216:219], v[100:103], v[28:31], v[216:219]
 v_exp_f32 v115, v115
 v_add_f32 v8, v114, v8
 v_mfma_f32_16x16x32_bf16 v[220:223], v[100:103], v[36:39], v[220:223]
 v_cvt_pk_bf16_f32 v113, v114, v115
 v_add_f32 v8, v115, v8
 v_mfma_f32_16x16x32_bf16 v[220:223], v[96:99], v[32:35], v[220:223]
 v_exp_f32 v88, v88
 v_exp_f32 v89, v89
 v_mfma_f32_16x16x32_bf16 v[224:227], v[96:99], v[40:43], v[224:227]
 v_add_f32 v8, v88, v8
 v_cvt_pk_bf16_f32 v114, v88, v89
 v_mfma_f32_16x16x32_bf16 v[224:227], v[100:103], v[44:47], v[224:227]
 v_exp_f32 v90, v90
 v_add_f32 v8, v89, v8
 v_mfma_f32_16x16x32_bf16 v[228:231], v[100:103], a[148:151], v[228:231]
 v_exp_f32 v91, v91
 v_add_f32 v8, v90, v8
 v_cvt_pk_bf16_f32 v115, v90, v91
 v_mfma_f32_16x16x32_bf16 v[228:231], v[96:99], a[144:147], v[228:231]
 s_waitcnt lgkmcnt(0)
 v_add_f32 v8, v91, v8
 v_rcp_f32 v75, v75
 v_pk_mul_f32 v[76:77], v[72:73], s[94:95] op_sel:[0,1] op_sel_hi:[1,1] neg_lo:[1,0] neg_hi:[1,0]
 v_pk_mul_f32 v[78:79], v[74:75], s[94:95] op_sel:[0,1] op_sel_hi:[1,1] neg_lo:[1,0] neg_hi:[1,0]
 v_pk_fma_f32 v[200:201], v[200:201], v[72:73], v[76:77]
 v_pk_fma_f32 v[204:205], v[204:205], v[72:73], v[76:77]
 v_pk_fma_f32 v[208:209], v[208:209], v[72:73], v[76:77]
 v_pk_fma_f32 v[212:213], v[212:213], v[72:73], v[76:77]
 v_pk_fma_f32 v[216:217], v[216:217], v[72:73], v[76:77]
 v_pk_fma_f32 v[220:221], v[220:221], v[72:73], v[76:77]
 v_pk_fma_f32 v[224:225], v[224:225], v[72:73], v[76:77]
 v_pk_fma_f32 v[228:229], v[228:229], v[72:73], v[76:77]
 v_cvt_pk_bf16_f32 v64, v200, v204
 v_cvt_pk_bf16_f32 v65, v208, v212
 v_cvt_pk_bf16_f32 v66, v216, v220
 v_cvt_pk_bf16_f32 v67, v224, v228
 ds_write_b128 v16, v[64:67] offset:0
 v_pk_fma_f32 v[202:203], v[202:203], v[74:75], v[78:79]
 v_pk_fma_f32 v[206:207], v[206:207], v[74:75], v[78:79]
 v_pk_fma_f32 v[210:211], v[210:211], v[74:75], v[78:79]
 v_pk_fma_f32 v[214:215], v[214:215], v[74:75], v[78:79]
 v_pk_fma_f32 v[218:219], v[218:219], v[74:75], v[78:79]
 v_pk_fma_f32 v[222:223], v[222:223], v[74:75], v[78:79]
 v_pk_fma_f32 v[226:227], v[226:227], v[74:75], v[78:79]
 v_pk_fma_f32 v[230:231], v[230:231], v[74:75], v[78:79]
 s_mov_b32 s30, 8192
 v_mfma_f32_16x16x32_bf16 v[108:111], v[168:171], a[48:51], v[12:15]
 v_cvt_pk_bf16_f32 v68, v201, v205
 v_cvt_pk_bf16_f32 v69, v209, v213
 v_cvt_pk_bf16_f32 v70, v217, v221
 v_cvt_pk_bf16_f32 v71, v225, v229
 v_mfma_f32_16x16x32_bf16 v[108:111], v[172:175], a[52:55], v[108:111]
 ds_read_b64_tr_b16 v[48:49], v17 offset:0
 ds_read_b64_tr_b16 v[50:51], v17 offset:64
 ds_write_b128 v16, v[68:71] offset:272
 v_mfma_f32_16x16x32_bf16 v[108:111], v[176:179], a[56:59], v[108:111]
 v_max3_f32 v23, |v201|, |v205|, v23
 v_max3_f32 v23, |v209|, |v213|, v23
 v_max3_f32 v23, |v217|, |v221|, v23
 v_max3_f32 v23, |v225|, |v229|, v23
 v_mfma_f32_16x16x32_bf16 v[108:111], v[180:183], a[60:63], v[108:111]
 v_mfma_f32_16x16x32_bf16 v[80:83], v[68:71], v[64:67], v[80:83]
 v_cvt_pk_bf16_f32 v64, v202, v206
 v_cvt_pk_bf16_f32 v65, v210, v214
 v_cvt_pk_bf16_f32 v66, v218, v222
 v_mfma_f32_16x16x32_bf16 v[84:87], v[196:199], a[60:63], v[12:15]
 s_waitcnt lgkmcnt(1)
 buffer_store_dwordx4 v[48:51], v18, s[16:19], s30 offen offset:0 sc0 sc1
 ds_read_b64_tr_b16 v[52:53], v17 offset:272
 ds_read_b64_tr_b16 v[54:55], v17 offset:336
 v_mfma_f32_16x16x32_bf16 v[84:87], v[192:195], a[56:59], v[84:87]
 v_cvt_pk_bf16_f32 v67, v226, v230
 v_cvt_pk_bf16_f32 v68, v203, v207
 v_cvt_pk_bf16_f32 v69, v211, v215
 v_mfma_f32_16x16x32_bf16 v[84:87], v[188:191], a[52:55], v[84:87]
 ds_write_b128 v16, v[64:67] offset:544
 v_mfma_f32_16x16x32_bf16 v[84:87], v[184:187], a[48:51], v[84:87]
 v_cvt_pk_bf16_f32 v70, v219, v223
 v_cvt_pk_bf16_f32 v71, v227, v231
 v_mfma_f32_16x16x32_bf16 v[116:119], v[168:171], a[64:67], v[12:15]
 v_exp_f32 v108, v108
 v_mfma_f32_16x16x32_bf16 v[80:83], v[68:71], v[64:67], v[80:83]
 s_waitcnt lgkmcnt(1)
 buffer_store_dwordx4 v[52:55], v18, s[16:19], s30 offen offset:256 sc0 sc1
 v_mfma_f32_16x16x32_bf16 v[116:119], v[172:175], a[68:71], v[116:119]
 ds_read_b64_tr_b16 v[56:57], v17 offset:544
 ds_read_b64_tr_b16 v[58:59], v17 offset:608
 ds_write_b128 v16, v[68:71] offset:816
 v_mfma_f32_16x16x32_bf16 v[116:119], v[176:179], a[72:75], v[116:119]
 v_exp_f32 v109, v109
 v_add_f32 v7, v108, v7
 v_mfma_f32_16x16x32_bf16 v[116:119], v[180:183], a[76:79], v[116:119]
 v_cvt_pk_bf16_f32 v108, v108, v109
 v_exp_f32 v110, v110
 v_mfma_f32_16x16x32_bf16 v[88:91], v[196:199], a[76:79], v[12:15]
 v_add_f32 v7, v109, v7
 v_exp_f32 v111, v111
 v_mfma_f32_16x16x32_bf16 v[88:91], v[192:195], a[72:75], v[88:91]
 s_waitcnt lgkmcnt(1)
 buffer_store_dwordx4 v[56:59], v18, s[16:19], s30 offen offset:512 sc0 sc1
 ds_read_b64_tr_b16 v[60:61], v17 offset:816
 ds_read_b64_tr_b16 v[62:63], v17 offset:880
 v_mfma_f32_16x16x32_bf16 v[88:91], v[188:191], a[68:71], v[88:91]
 v_add_f32 v7, v110, v7
 v_cvt_pk_bf16_f32 v109, v110, v111
 v_add_f32 v7, v111, v7
 v_mfma_f32_16x16x32_bf16 v[88:91], v[184:187], a[64:67], v[88:91]
 v_exp_f32 v84, v84
 v_mfma_f32_16x16x32_bf16 v[232:235], v[104:107], a[112:115], v[232:235]
 v_exp_f32 v85, v85
 v_add_f32 v7, v84, v7
 v_cvt_pk_bf16_f32 v110, v84, v85
 v_exp_f32 v86, v86
 v_add_f32 v7, v85, v7
 v_exp_f32 v87, v87
 s_waitcnt lgkmcnt(0)
 buffer_store_dwordx4 v[60:63], v18, s[16:19], s30 offen offset:768 sc0 sc1
 v_add_f32 v7, v86, v7
 v_cvt_pk_bf16_f32 v111, v86, v87
 v_add_f32 v7, v87, v7
 v_exp_f32 v116, v116
 v_mfma_f32_16x16x32_bf16 v[232:235], v[108:111], a[116:119], v[232:235]
 v_exp_f32 v117, v117
 v_add_f32 v8, v116, v8
 v_mfma_f32_16x16x32_bf16 v[236:239], v[108:111], a[124:127], v[236:239]
 v_cvt_pk_bf16_f32 v116, v116, v117
 v_exp_f32 v118, v118
 v_mfma_f32_16x16x32_bf16 v[236:239], v[104:107], a[120:123], v[236:239]
 v_add_f32 v8, v117, v8
 v_exp_f32 v119, v119
 v_mfma_f32_16x16x4_f32 v[72:75], v7, v20, 0
 v_add_f32 v8, v118, v8
 v_cvt_pk_bf16_f32 v117, v118, v119
 v_add_f32 v8, v119, v8
 v_exp_f32 v88, v88
 v_mfma_f32_16x16x32_bf16 v[240:243], v[104:107], a[128:131], v[240:243]
 v_exp_f32 v89, v89
 v_mfma_f32_16x16x32_bf16 v[240:243], v[108:111], a[132:135], v[240:243]
 v_add_f32 v8, v88, v8
 v_cvt_pk_bf16_f32 v118, v88, v89
 v_mfma_f32_16x16x32_bf16 v[244:247], v[108:111], a[140:143], v[244:247]
 v_exp_f32 v90, v90
 v_mfma_f32_16x16x32_bf16 v[244:247], v[104:107], a[136:139], v[244:247]
 v_add_f32 v8, v89, v8
 v_min3_f32 v21, v21, v72, v73
 v_mfma_f32_16x16x32_bf16 v[248:251], v[104:107], v[24:27], v[248:251]
 v_exp_f32 v91, v91
 v_mfma_f32_16x16x32_bf16 v[248:251], v[108:111], v[28:31], v[248:251]
 v_add_f32 v8, v90, v8
 v_cvt_pk_bf16_f32 v119, v90, v91
 v_mfma_f32_16x16x32_bf16 v[252:255], v[108:111], v[36:39], v[252:255]
 v_add_f32 v8, v91, v8
 v_min3_f32 v21, v21, v74, v75
 v_mfma_f32_16x16x32_bf16 v[252:255], v[104:107], v[32:35], v[252:255]
 v_rcp_f32 v72, v72
 v_mfma_f32_16x16x32_bf16 a[152:155], v[104:107], v[40:43], a[152:155]
 v_rcp_f32 v73, v73
 v_mfma_f32_16x16x32_bf16 a[152:155], v[108:111], v[44:47], a[152:155]
 v_rcp_f32 v74, v74
 v_mfma_f32_16x16x32_bf16 a[156:159], v[108:111], a[148:151], a[156:159]
 v_rcp_f32 v75, v75
 v_mfma_f32_16x16x32_bf16 a[156:159], v[104:107], a[144:147], a[156:159]
 s_nop 0
 s_nop 0
 s_nop 0
 s_nop 0
 v_accvgpr_read_b32 v224, a152
 v_accvgpr_read_b32 v225, a153
 v_accvgpr_read_b32 v226, a154
 v_accvgpr_read_b32 v227, a155
 v_accvgpr_read_b32 v228, a156
 v_accvgpr_read_b32 v229, a157
 v_accvgpr_read_b32 v230, a158
 v_accvgpr_read_b32 v231, a159
 v_pk_mul_f32 v[76:77], v[72:73], s[94:95] op_sel:[0,1] op_sel_hi:[1,1] neg_lo:[1,0] neg_hi:[1,0]
 v_pk_mul_f32 v[78:79], v[74:75], s[94:95] op_sel:[0,1] op_sel_hi:[1,1] neg_lo:[1,0] neg_hi:[1,0]
 v_pk_fma_f32 v[232:233], v[232:233], v[72:73], v[76:77]
 v_pk_fma_f32 v[236:237], v[236:237], v[72:73], v[76:77]
 v_pk_fma_f32 v[240:241], v[240:241], v[72:73], v[76:77]
 v_pk_fma_f32 v[244:245], v[244:245], v[72:73], v[76:77]
 v_pk_fma_f32 v[248:249], v[248:249], v[72:73], v[76:77]
 v_pk_fma_f32 v[252:253], v[252:253], v[72:73], v[76:77]
 v_pk_fma_f32 v[224:225], v[224:225], v[72:73], v[76:77]
 v_pk_fma_f32 v[228:229], v[228:229], v[72:73], v[76:77]
 v_cvt_pk_bf16_f32 v64, v232, v236
 v_cvt_pk_bf16_f32 v65, v240, v244
 v_cvt_pk_bf16_f32 v66, v248, v252
 v_cvt_pk_bf16_f32 v67, v224, v228
 ds_write_b128 v16, v[64:67] offset:0
 v_pk_fma_f32 v[234:235], v[234:235], v[74:75], v[78:79]
 v_pk_fma_f32 v[238:239], v[238:239], v[74:75], v[78:79]
 v_pk_fma_f32 v[242:243], v[242:243], v[74:75], v[78:79]
 v_pk_fma_f32 v[246:247], v[246:247], v[74:75], v[78:79]
 v_pk_fma_f32 v[250:251], v[250:251], v[74:75], v[78:79]
 v_pk_fma_f32 v[254:255], v[254:255], v[74:75], v[78:79]
 v_pk_fma_f32 v[226:227], v[226:227], v[74:75], v[78:79]
 v_pk_fma_f32 v[230:231], v[230:231], v[74:75], v[78:79]
 s_mov_b32 s30, 12288
 v_mfma_f32_16x16x4_f32 v[72:75], v8, v20, 0
 v_cvt_pk_bf16_f32 v68, v233, v237
 v_cvt_pk_bf16_f32 v69, v241, v245
 v_cvt_pk_bf16_f32 v70, v249, v253
 v_cvt_pk_bf16_f32 v71, v225, v229
 v_max3_f32 v23, |v233|, |v237|, v23
 v_max3_f32 v23, |v241|, |v245|, v23
 v_mfma_f32_16x16x32_bf16 v[120:123], v[136:139], a[80:83], v[12:15]
 ds_read_b64_tr_b16 v[48:49], v17 offset:0
 ds_read_b64_tr_b16 v[50:51], v17 offset:64
 ds_write_b128 v16, v[68:71] offset:272
 v_mfma_f32_16x16x32_bf16 v[120:123], v[140:143], a[84:87], v[120:123]
 v_max3_f32 v23, |v249|, |v253|, v23
 v_max3_f32 v23, |v225|, |v229|, v23
 v_mfma_f32_16x16x32_bf16 v[80:83], v[68:71], v[64:67], v[80:83]
 v_cvt_pk_bf16_f32 v64, v234, v238
 v_mfma_f32_16x16x32_bf16 v[120:123], v[144:147], a[88:91], v[120:123]
 v_cvt_pk_bf16_f32 v65, v242, v246
 v_cvt_pk_bf16_f32 v66, v250, v254
 v_cvt_pk_bf16_f32 v67, v226, v230
 v_mfma_f32_16x16x32_bf16 v[120:123], v[148:151], a[92:95], v[120:123]
 s_waitcnt lgkmcnt(1)
 buffer_store_dwordx4 v[48:51], v18, s[16:19], s30 offen offset:0 sc0 sc1
 ds_read_b64_tr_b16 v[52:53], v17 offset:272
 ds_read_b64_tr_b16 v[54:55], v17 offset:336
 v_mfma_f32_16x16x32_bf16 v[84:87], v[164:167], a[92:95], v[12:15]
 ds_write_b128 v16, v[64:67] offset:544
 v_mfma_f32_16x16x32_bf16 v[84:87], v[160:163], a[88:91], v[84:87]
 v_cvt_pk_bf16_f32 v68, v235, v239
 v_cvt_pk_bf16_f32 v69, v243, v247
 v_cvt_pk_bf16_f32 v70, v251, v255
 v_mfma_f32_16x16x32_bf16 v[84:87], v[156:159], a[84:87], v[84:87]
 v_cvt_pk_bf16_f32 v71, v227, v231
 v_exp_f32 v120, v120
 v_mfma_f32_16x16x32_bf16 v[84:87], v[152:155], a[80:83], v[84:87]
 s_waitcnt lgkmcnt(1)
 buffer_store_dwordx4 v[52:55], v18, s[16:19], s30 offen offset:256 sc0 sc1
 ds_read_b64_tr_b16 v[56:57], v17 offset:544
 ds_read_b64_tr_b16 v[58:59], v17 offset:608
 v_mfma_f32_16x16x32_bf16 a[160:163], v[112:115], a[112:115], a[160:163]
 ds_write_b128 v16, v[68:71] offset:816
 v_mfma_f32_16x16x32_bf16 a[160:163], v[116:119], a[116:119], a[160:163]
 v_mfma_f32_16x16x32_bf16 v[80:83], v[68:71], v[64:67], v[80:83]
 v_exp_f32 v121, v121
 v_add_f32 v9, v120, v9
 v_cvt_pk_bf16_f32 v120, v120, v121
 v_mfma_f32_16x16x32_bf16 a[164:167], v[116:119], a[124:127], a[164:167]
 v_exp_f32 v122, v122
 v_add_f32 v9, v121, v9
 v_mfma_f32_16x16x32_bf16 a[164:167], v[112:115], a[120:123], a[164:167]
 s_waitcnt lgkmcnt(1)
 buffer_store_dwordx4 v[56:59], v18, s[16:19], s30 offen offset:512 sc0 sc1
 ds_read_b64_tr_b16 v[60:61], v17 offset:816
 ds_read_b64_tr_b16 v[62:63], v17 offset:880
 v_mfma_f32_16x16x32_bf16 a[168:171], v[112:115], a[128:131], a[168:171]
 v_exp_f32 v123, v123
 v_add_f32 v9, v122, v9
 v_mfma_f32_16x16x32_bf16 a[168:171], v[116:119], a[132:135], a[168:171]
 v_cvt_pk_bf16_f32 v121, v122, v123
 v_add_f32 v9, v123, v9
 v_min3_f32 v21, v21, v72, v73
 v_mfma_f32_16x16x32_bf16 a[172:175], v[116:119], a[140:143], a[172:175]
 v_exp_f32 v84, v84
 v_min3_f32 v21, v21, v74, v75
 v_mfma_f32_16x16x32_bf16 a[172:175], v[112:115], a[136:139], a[172:175]
 v_exp_f32 v85, v85
 v_add_f32 v9, v84, v9
 v_mfma_f32_16x16x32_bf16 v[124:127], v[168:171], a[80:83], v[12:15]
 s_waitcnt lgkmcnt(0)
 buffer_store_dwordx4 v[60:63], v18, s[16:19], s30 offen offset:768 sc0 sc1
 v_cvt_pk_bf16_f32 v122, v84, v85
 v_mfma_f32_16x16x32_bf16 v[124:127], v[172:175], a[84:87], v[124:127]
 v_exp_f32 v86, v86
 v_add_f32 v9, v85, v9
 v_mfma_f32_16x16x32_bf16 v[124:127], v[176:179], a[88:91], v[124:127]
 v_exp_f32 v87, v87
 v_add_f32 v9, v86, v9
 v_mfma_f32_16x16x32_bf16 v[124:127], v[180:183], a[92:95], v[124:127]
 v_cvt_pk_bf16_f32 v123, v86, v87
 v_add_f32 v9, v87, v9
 v_mfma_f32_16x16x32_bf16 v[88:91], v[196:199], a[92:95], v[12:15]
 v_rcp_f32 v72, v72
 v_mfma_f32_16x16x32_bf16 v[88:91], v[192:195], a[88:91], v[88:91]
 v_rcp_f32 v73, v73
 v_rcp_f32 v74, v74
 v_mfma_f32_16x16x32_bf16 v[88:91], v[188:191], a[84:87], v[88:91]
 v_exp_f32 v124, v124
 v_mfma_f32_16x16x32_bf16 v[88:91], v[184:187], a[80:83], v[88:91]
 v_exp_f32 v125, v125
 v_add_f32 v9, v124, v9
 v_cvt_pk_bf16_f32 v124, v124, v125
 v_mfma_f32_16x16x32_bf16 a[176:179], v[112:115], v[24:27], a[176:179]
 v_exp_f32 v126, v126
 v_add_f32 v9, v125, v9
 v_mfma_f32_16x16x32_bf16 a[176:179], v[116:119], v[28:31], a[176:179]
 v_exp_f32 v127, v127
 v_add_f32 v9, v126, v9
 v_mfma_f32_16x16x32_bf16 a[180:183], v[116:119], v[36:39], a[180:183]
 v_cvt_pk_bf16_f32 v125, v126, v127
 v_add_f32 v9, v127, v9
 v_mfma_f32_16x16x32_bf16 a[180:183], v[112:115], v[32:35], a[180:183]
 v_exp_f32 v88, v88
 v_exp_f32 v89, v89
 v_mfma_f32_16x16x32_bf16 a[184:187], v[112:115], v[40:43], a[184:187]
 v_add_f32 v9, v88, v9
 v_cvt_pk_bf16_f32 v126, v88, v89
 v_mfma_f32_16x16x32_bf16 a[184:187], v[116:119], v[44:47], a[184:187]
 v_exp_f32 v90, v90
 v_add_f32 v9, v89, v9
 v_mfma_f32_16x16x32_bf16 a[188:191], v[116:119], a[148:151], a[188:191]
 v_exp_f32 v91, v91
 v_add_f32 v9, v90, v9
 v_cvt_pk_bf16_f32 v127, v90, v91
 v_mfma_f32_16x16x32_bf16 a[188:191], v[112:115], a[144:147], a[188:191]
 v_add_f32 v9, v91, v9
 v_rcp_f32 v75, v75
 v_accvgpr_read_b32 v200, a160
 v_accvgpr_read_b32 v201, a161
 v_accvgpr_read_b32 v202, a162
 v_accvgpr_read_b32 v203, a163
 v_accvgpr_read_b32 v204, a164
 v_accvgpr_read_b32 v205, a165
 v_accvgpr_read_b32 v206, a166
 v_accvgpr_read_b32 v207, a167
 v_accvgpr_read_b32 v208, a168
 v_accvgpr_read_b32 v209, a169
 v_accvgpr_read_b32 v210, a170
 v_accvgpr_read_b32 v211, a171
 v_accvgpr_read_b32 v212, a172
 v_accvgpr_read_b32 v213, a173
 v_accvgpr_read_b32 v214, a174
 v_accvgpr_read_b32 v215, a175
 v_accvgpr_read_b32 v216, a176
 v_accvgpr_read_b32 v217, a177
 v_accvgpr_read_b32 v218, a178
 v_accvgpr_read_b32 v219, a179
 v_accvgpr_read_b32 v220, a180
 v_accvgpr_read_b32 v221, a181
 v_accvgpr_read_b32 v222, a182
 v_accvgpr_read_b32 v223, a183
 v_accvgpr_read_b32 v224, a184
 v_accvgpr_read_b32 v225, a185
 v_accvgpr_read_b32 v226, a186
 v_accvgpr_read_b32 v227, a187
 v_accvgpr_read_b32 v228, a188
 v_accvgpr_read_b32 v229, a189
 v_accvgpr_read_b32 v230, a190
 v_accvgpr_read_b32 v231, a191
 v_pk_mul_f32 v[76:77], v[72:73], s[94:95] op_sel:[0,1] op_sel_hi:[1,1] neg_lo:[1,0] neg_hi:[1,0]
 v_pk_mul_f32 v[78:79], v[74:75], s[94:95] op_sel:[0,1] op_sel_hi:[1,1] neg_lo:[1,0] neg_hi:[1,0]
 v_pk_fma_f32 v[200:201], v[200:201], v[72:73], v[76:77]
 v_pk_fma_f32 v[204:205], v[204:205], v[72:73], v[76:77]
 v_pk_fma_f32 v[208:209], v[208:209], v[72:73], v[76:77]
 v_pk_fma_f32 v[212:213], v[212:213], v[72:73], v[76:77]
 v_pk_fma_f32 v[216:217], v[216:217], v[72:73], v[76:77]
 v_pk_fma_f32 v[220:221], v[220:221], v[72:73], v[76:77]
 v_pk_fma_f32 v[224:225], v[224:225], v[72:73], v[76:77]
 v_pk_fma_f32 v[228:229], v[228:229], v[72:73], v[76:77]
 v_cvt_pk_bf16_f32 v64, v200, v204
 v_cvt_pk_bf16_f32 v65, v208, v212
 v_cvt_pk_bf16_f32 v66, v216, v220
 v_cvt_pk_bf16_f32 v67, v224, v228
 ds_write_b128 v16, v[64:67] offset:0
 v_pk_fma_f32 v[202:203], v[202:203], v[74:75], v[78:79]
 v_pk_fma_f32 v[206:207], v[206:207], v[74:75], v[78:79]
 v_pk_fma_f32 v[210:211], v[210:211], v[74:75], v[78:79]
 v_pk_fma_f32 v[214:215], v[214:215], v[74:75], v[78:79]
 v_pk_fma_f32 v[218:219], v[218:219], v[74:75], v[78:79]
 v_pk_fma_f32 v[222:223], v[222:223], v[74:75], v[78:79]
 v_pk_fma_f32 v[226:227], v[226:227], v[74:75], v[78:79]
 v_pk_fma_f32 v[230:231], v[230:231], v[74:75], v[78:79]
 s_mov_b32 s30, 16384
 v_mfma_f32_16x16x4_f32 v[72:75], v9, v20, 0
 v_cvt_pk_bf16_f32 v68, v201, v205
 v_cvt_pk_bf16_f32 v69, v209, v213
 v_cvt_pk_bf16_f32 v70, v217, v221
 v_cvt_pk_bf16_f32 v71, v225, v229
 v_max3_f32 v23, |v201|, |v205|, v23
 v_max3_f32 v23, |v209|, |v213|, v23
 v_mfma_f32_16x16x32_bf16 a[192:195], v[120:123], a[112:115], a[192:195]
 ds_read_b64_tr_b16 v[48:49], v17 offset:0
 ds_read_b64_tr_b16 v[50:51], v17 offset:64
 ds_write_b128 v16, v[68:71] offset:272
 v_mfma_f32_16x16x32_bf16 a[192:195], v[124:127], a[116:119], a[192:195]
 v_max3_f32 v23, |v217|, |v221|, v23
 v_max3_f32 v23, |v225|, |v229|, v23
 v_mfma_f32_16x16x32_bf16 v[80:83], v[68:71], v[64:67], v[80:83]
 v_cvt_pk_bf16_f32 v64, v202, v206
 v_mfma_f32_16x16x32_bf16 a[196:199], v[124:127], a[124:127], a[196:199]
 v_cvt_pk_bf16_f32 v65, v210, v214
 v_cvt_pk_bf16_f32 v66, v218, v222
 v_cvt_pk_bf16_f32 v67, v226, v230
 v_mfma_f32_16x16x32_bf16 a[196:199], v[120:123], a[120:123], a[196:199]
 s_waitcnt lgkmcnt(1)
 buffer_store_dwordx4 v[48:51], v18, s[16:19], s30 offen offset:0 sc0 sc1
 ds_read_b64_tr_b16 v[52:53], v17 offset:272
 ds_read_b64_tr_b16 v[54:55], v17 offset:336
 v_mfma_f32_16x16x32_bf16 a[200:203], v[120:123], a[128:131], a[200:203]
 ds_write_b128 v16, v[64:67] offset:544
 v_mfma_f32_16x16x32_bf16 a[200:203], v[124:127], a[132:135], a[200:203]
 v_cvt_pk_bf16_f32 v68, v203, v207
 v_cvt_pk_bf16_f32 v69, v211, v215
 v_cvt_pk_bf16_f32 v70, v219, v223
 v_mfma_f32_16x16x32_bf16 a[204:207], v[124:127], a[140:143], a[204:207]
 v_cvt_pk_bf16_f32 v71, v227, v231
 v_min3_f32 v21, v21, v72, v73
 v_min3_f32 v21, v21, v74, v75
 v_mfma_f32_16x16x32_bf16 a[204:207], v[120:123], a[136:139], a[204:207]
 s_waitcnt lgkmcnt(1)
 buffer_store_dwordx4 v[52:55], v18, s[16:19], s30 offen offset:256 sc0 sc1
 ds_read_b64_tr_b16 v[56:57], v17 offset:544
 v_mfma_f32_16x16x32_bf16 a[208:211], v[120:123], v[24:27], a[208:211]
 ds_read_b64_tr_b16 v[58:59], v17 offset:608
 ds_write_b128 v16, v[68:71] offset:816
 v_mfma_f32_16x16x32_bf16 a[208:211], v[124:127], v[28:31], a[208:211]
 v_mfma_f32_16x16x32_bf16 v[80:83], v[68:71], v[64:67], v[80:83]
 v_rcp_f32 v72, v72
 v_mfma_f32_16x16x32_bf16 a[212:215], v[124:127], v[36:39], a[212:215]
 v_rcp_f32 v73, v73
 v_mfma_f32_16x16x32_bf16 a[212:215], v[120:123], v[32:35], a[212:215]
 v_rcp_f32 v74, v74
 v_mfma_f32_16x16x32_bf16 a[216:219], v[120:123], v[40:43], a[216:219]
 s_waitcnt lgkmcnt(1)
 buffer_store_dwordx4 v[56:59], v18, s[16:19], s30 offen offset:512 sc0 sc1
 ds_read_b64_tr_b16 v[60:61], v17 offset:816
 v_mfma_f32_16x16x32_bf16 a[216:219], v[124:127], v[44:47], a[216:219]
 ds_read_b64_tr_b16 v[62:63], v17 offset:880
 v_mfma_f32_16x16x32_bf16 a[220:223], v[124:127], a[148:151], a[220:223]
 v_rcp_f32 v75, v75
 v_mfma_f32_16x16x32_bf16 a[220:223], v[120:123], a[144:147], a[220:223]
 s_waitcnt lgkmcnt(0)
 buffer_store_dwordx4 v[60:63], v18, s[16:19], s30 offen offset:768 sc0 sc1
 v_accvgpr_read_b32 v200, a192
 v_accvgpr_read_b32 v201, a193
 v_accvgpr_read_b32 v202, a194
 v_accvgpr_read_b32 v203, a195
 v_accvgpr_read_b32 v204, a196
 v_accvgpr_read_b32 v205, a197
 v_accvgpr_read_b32 v206, a198
 v_accvgpr_read_b32 v207, a199
 v_accvgpr_read_b32 v208, a200
 v_accvgpr_read_b32 v209, a201
 v_accvgpr_read_b32 v210, a202
 v_accvgpr_read_b32 v211, a203
 v_accvgpr_read_b32 v212, a204
 v_accvgpr_read_b32 v213, a205
 v_accvgpr_read_b32 v214, a206
 v_accvgpr_read_b32 v215, a207
 v_accvgpr_read_b32 v216, a208
 v_accvgpr_read_b32 v217, a209
 v_accvgpr_read_b32 v218, a210
 v_accvgpr_read_b32 v219, a211
 v_accvgpr_read_b32 v220, a212
 v_accvgpr_read_b32 v221, a213
 v_accvgpr_read_b32 v222, a214
 v_accvgpr_read_b32 v223, a215
 v_accvgpr_read_b32 v224, a216
 v_accvgpr_read_b32 v225, a217
 v_accvgpr_read_b32 v226, a218
 v_accvgpr_read_b32 v227, a219
 v_accvgpr_read_b32 v228, a220
 v_accvgpr_read_b32 v229, a221
 v_accvgpr_read_b32 v230, a222
 v_accvgpr_read_b32 v231, a223
 v_pk_mul_f32 v[76:77], v[72:73], s[94:95] op_sel:[0,1] op_sel_hi:[1,1] neg_lo:[1,0] neg_hi:[1,0]
 v_pk_mul_f32 v[78:79], v[74:75], s[94:95] op_sel:[0,1] op_sel_hi:[1,1] neg_lo:[1,0] neg_hi:[1,0]
 v_pk_fma_f32 v[200:201], v[200:201], v[72:73], v[76:77]
 v_pk_fma_f32 v[204:205], v[204:205], v[72:73], v[76:77]
 v_pk_fma_f32 v[208:209], v[208:209], v[72:73], v[76:77]
 v_pk_fma_f32 v[212:213], v[212:213], v[72:73], v[76:77]
 v_pk_fma_f32 v[216:217], v[216:217], v[72:73], v[76:77]
 v_pk_fma_f32 v[220:221], v[220:221], v[72:73], v[76:77]
 v_pk_fma_f32 v[224:225], v[224:225], v[72:73], v[76:77]
 v_pk_fma_f32 v[228:229], v[228:229], v[72:73], v[76:77]
 v_cvt_pk_bf16_f32 v64, v200, v204
 v_cvt_pk_bf16_f32 v65, v208, v212
 v_cvt_pk_bf16_f32 v66, v216, v220
 v_cvt_pk_bf16_f32 v67, v224, v228
 ds_write_b128 v16, v[64:67] offset:0
 v_pk_fma_f32 v[202:203], v[202:203], v[74:75], v[78:79]
 v_pk_fma_f32 v[206:207], v[206:207], v[74:75], v[78:79]
 v_pk_fma_f32 v[210:211], v[210:211], v[74:75], v[78:79]
 v_pk_fma_f32 v[214:215], v[214:215], v[74:75], v[78:79]
 v_pk_fma_f32 v[218:219], v[218:219], v[74:75], v[78:79]
 v_pk_fma_f32 v[222:223], v[222:223], v[74:75], v[78:79]
 v_pk_fma_f32 v[226:227], v[226:227], v[74:75], v[78:79]
 v_pk_fma_f32 v[230:231], v[230:231], v[74:75], v[78:79]
 s_mov_b32 s30, 20480
 v_cvt_pk_bf16_f32 v68, v201, v205
 v_cvt_pk_bf16_f32 v69, v209, v213
 v_cvt_pk_bf16_f32 v70, v217, v221
 v_cvt_pk_bf16_f32 v71, v225, v229
 v_max3_f32 v23, |v201|, |v205|, v23
 v_max3_f32 v23, |v209|, |v213|, v23
 v_max3_f32 v23, |v217|, |v221|, v23
 v_max3_f32 v23, |v225|, |v229|, v23
 ds_read_b64_tr_b16 v[48:49], v17 offset:0
 ds_read_b64_tr_b16 v[50:51], v17 offset:64
 ds_write_b128 v16, v[68:71] offset:272
 v_mfma_f32_16x16x32_bf16 v[80:83], v[68:71], v[64:67], v[80:83]
 v_cvt_pk_bf16_f32 v64, v202, v206
 v_cvt_pk_bf16_f32 v65, v210, v214
 v_cvt_pk_bf16_f32 v66, v218, v222
 v_cvt_pk_bf16_f32 v67, v226, v230
 v_cvt_pk_bf16_f32 v68, v203, v207
 v_cvt_pk_bf16_f32 v69, v211, v215
 v_cvt_pk_bf16_f32 v70, v219, v223
 v_cvt_pk_bf16_f32 v71, v227, v231
 s_waitcnt lgkmcnt(1)
 buffer_store_dwordx4 v[48:51], v18, s[16:19], s30 offen offset:0 sc0 sc1
 ds_read_b64_tr_b16 v[52:53], v17 offset:272
 v_mfma_f32_16x16x32_bf16 v[80:83], v[68:71], v[64:67], v[80:83]
 ds_read_b64_tr_b16 v[54:55], v17 offset:336
 ds_write_b128 v16, v[64:67] offset:544
 s_waitcnt lgkmcnt(1)
 buffer_store_dwordx4 v[52:55], v18, s[16:19], s30 offen offset:256 sc0 sc1
 ds_read_b64_tr_b16 v[56:57], v17 offset:544
 ds_read_b64_tr_b16 v[58:59], v17 offset:608
 s_waitcnt lgkmcnt(0)
 buffer_store_dwordx4 v[56:59], v18, s[16:19], s30 offen offset:512 sc0 sc1
 ds_write_b128 v16, v[68:71] offset:816
 ds_read_b64_tr_b16 v[60:61], v17 offset:816
 ds_read_b64_tr_b16 v[62:63], v17 offset:880
 s_waitcnt lgkmcnt(0)
 buffer_store_dwordx4 v[60:63], v18, s[16:19], s30 offen offset:768 sc0 sc1
 v_max3_f32 v22, v4, v5, v6
 v_max3_f32 v22, v22, v7, v8
 v_max3_f32 v22, v22, v9, v9
 v_cmp_nlt_f32 vcc, s88, v21
 v_cmp_ngt_f32 s[32:33], s89, v22
 s_nop 3
 s_or_b64 s[32:33], s[32:33], vcc
 v_mul_f32 v23, 0x44000000, v23
 v_mul_f32 v23, v23, v21
 v_cmp_gt_f32 vcc, s95, v23
 s_nop 3
 s_or_b64 s[32:33], s[32:33], vcc
 v_mov_b32 v30, 0x207
 v_add_f32 v80, v80, v81
 v_add_f32 v82, v82, v83
 v_add_f32 v80, v80, v82
 v_cmp_class_f32 vcc, v80, v30
 s_nop 3
 s_or_b64 s[32:33], s[32:33], vcc
 s_or_b32 s32, s32, s33
 s_lshl_b32 s30, s24, 2
 s_add_u32 s30, s30, 148480
 v_mov_b32 v28, s30
 v_mov_b32 v29, s32
 v_mov_b32 v30, 148480
 ds_write_b32 v28, v29
 s_waitcnt lgkmcnt(0)
 s_barrier
 ds_read_b128 v[32:35], v30
 s_waitcnt lgkmcnt(0)
 v_or3_b32 v32, v32, v33, v34
 v_or_b32 v32, v32, v35
 s_nop 0
 v_readfirstlane_b32 s30, v32
 s_nop 3
 s_cmp_eq_u32 s30, 0
 s_cbranch_scc1 L_end_6
 s_branch L_slow_6
L_end_6:
 s_endpgm
L_even:
 v_bfe_u32 v6, v5, 3, 1
 v_lshlrev_b32 v0, 11, v6
 v_lshrrev_b32 v8, 5, v5
 v_lshlrev_b32 v1, 11, v8
 v_bfe_u32 v7, v5, 4, 1
 v_lshl_add_u32 v0, v7, 4, v0
 v_and_b32 v6, 7, v5
 v_lshl_add_u32 v0, v6, 6, v0
 v_bfe_u32 v6, v5, 2, 1
 v_xor_b32 v6, v6, v8
 v_lshl_add_u32 v0, v6, 5, v0
 v_bfe_u32 v6, v5, 2, 3
 v_lshl_add_u32 v1, v6, 6, v1
 v_lshl_add_u32 v1, v7, 5, v1
 v_and_b32 v6, 3, v5
 v_lshl_add_u32 v1, v6, 3, v1
 v_add_u32 v1, 65536, v1
 v_xor_b32 v2, 32, v1
 v_add_u32 v11, s34, v0
 v_mov_b32 v240, 0x3e803e80
 v_mov_b32 v241, 0x3e803e80
 v_mov_b32 v242, 0x3e803e80
 v_mov_b32 v243, 0x3e803e80
 v_bfe_u32 v6, v5, 2, 2
 v_lshrrev_b32 v7, 4, v5
 v_and_b32 v8, 1, v5
 v_lshlrev_b32 v8, 4, v8
 v_xor_b32 v6, v6, v7
 v_bfe_u32 v7, v5, 1, 1
 v_lshl_add_u32 v6, v6, 1, v7
 v_mov_b32 v9, 0x3e03
 v_mov_b32 v10, 0xb9d8
 v_lshlrev_b32 v9, v8, v9
 v_lshlrev_b32 v10, v8, v10
 v_accvgpr_write_b32 a112, 0
 v_accvgpr_write_b32 a113, 0
 v_accvgpr_write_b32 a116, 0
 v_accvgpr_write_b32 a117, 0
 v_accvgpr_write_b32 a120, 0
 v_accvgpr_write_b32 a121, 0
 v_cmp_eq_u32 vcc, 0, v6
 s_nop 1
 v_cndmask_b32 v7, 0, v9, vcc
 v_cndmask_b32 v8, 0, v10, vcc
 v_accvgpr_write_b32 a114, v7
 v_accvgpr_write_b32 a118, v8
 v_cmp_eq_u32 vcc, 1, v6
 s_nop 1
 v_cndmask_b32 v7, 0, v9, vcc
 v_cndmask_b32 v8, 0, v10, vcc
 v_accvgpr_write_b32 a115, v7
 v_accvgpr_write_b32 a119, v8
 s_mov_b32 s38, 0x3e0293ee
 s_mov_b32 s39, 0x3e0293ee
 s_mov_b32 s88, 0x3f800000
 s_mov_b32 s89, 0x7d800000
 s_waitcnt vmcnt(5)
 v_and_b32 v232, 0x7fff7fff, v232
 v_and_b32 v233, 0x7fff7fff, v233
 v_and_b32 v234, 0x7fff7fff, v234
 v_and_b32 v235, 0x7fff7fff, v235
 v_mov_b32 v236, v232
 v_mov_b32 v237, v233
 v_mov_b32 v238, v234
 v_mov_b32 v239, v235
 v_permlane32_swap_b32 v232, v236
 v_permlane32_swap_b32 v233, v237
 v_permlane32_swap_b32 v234, v238
 v_permlane32_swap_b32 v235, v239
 v_pk_max_u16 v232, v232, v236
 v_pk_max_u16 v233, v233, v237
 v_pk_max_u16 v234, v234, v238
 v_pk_max_u16 v235, v235, v239
 v_mov_b32 v236, v232
 v_mov_b32 v237, v233
 v_mov_b32 v238, v234
 v_mov_b32 v239, v235
 v_permlane16_swap_b32 v232, v236
 v_permlane16_swap_b32 v233, v237
 v_permlane16_swap_b32 v234, v238
 v_permlane16_swap_b32 v235, v239
 v_pk_max_u16 v232, v232, v236
 v_pk_max_u16 v233, v233, v237
 v_pk_max_u16 v234, v234, v238
 v_pk_max_u16 v235, v235, v239
 v_pk_min_u16 v232, v232, v233
 v_pk_min_u16 v234, v234, v235
 v_pk_min_u16 v232, v232, v234
 v_lshlrev_b32 v198, 16, v232
 v_min_u32 v198, v198, v232
 s_nop 1
 v_min_u32_dpp v198, v198, v198 row_ror:8 row_mask:0xf bank_mask:0xf
 s_nop 1
 v_min_u32_dpp v198, v198, v198 row_ror:4 row_mask:0xf bank_mask:0xf
 s_nop 1
 v_min_u32_dpp v198, v198, v198 row_ror:2 row_mask:0xf bank_mask:0xf
 s_nop 1
 v_min_u32_dpp v198, v198, v198 row_ror:1 row_mask:0xf bank_mask:0xf
 v_mul_f32 v198, 0x41800000, v198
 s_waitcnt vmcnt(0)
 ds_read_b128 v[136:139], v11 offset:0
 ds_read_b128 v[140:143], v11 offset:512
 ds_read_b128 v[144:147], v11 offset:1024
 ds_read_b128 v[148:151], v11 offset:1536
 s_add_u32 m0, s28, 8192
 s_add_u32 s36, s28, 8192
 buffer_load_dwordx4 v3, s[8:11], s36 offen offset:0 nt lds
 s_add_u32 m0, s28, 9088
 s_nop 0
 buffer_load_dwordx4 v3, s[8:11], s36 offen offset:128 nt lds
 s_add_u32 m0, s28, 16384
 s_add_u32 s36, s28, 16384
 buffer_load_dwordx4 v3, s[8:11], s36 offen offset:0 nt lds
 s_add_u32 m0, s28, 17280
 s_nop 0
 buffer_load_dwordx4 v3, s[8:11], s36 offen offset:128 nt lds
 s_waitcnt lgkmcnt(3)
 v_mfma_f32_16x16x32_bf16 v[248:251], a[114:117], v[136:139], 0
 s_nop 0
 v_mfma_f32_16x16x32_bf16 v[248:251], a[118:121], v[136:139], v[248:251]
 s_nop 0
 v_mfma_f32_16x16x32_bf16 v[252:255], a[112:115], v[136:139], 0
 s_nop 0
 v_mfma_f32_16x16x32_bf16 v[252:255], a[116:119], v[136:139], v[252:255]
 s_waitcnt lgkmcnt(2)
 s_nop 0
 v_mfma_f32_16x16x32_bf16 v[16:19], a[114:117], v[140:143], 0
 s_nop 0
 v_mfma_f32_16x16x32_bf16 v[16:19], a[118:121], v[140:143], v[16:19]
 v_cvt_pk_bf16_f32 v192, v248, v249
 v_cvt_pk_bf16_f32 v193, v250, v251
 v_mfma_f32_16x16x32_bf16 v[20:23], a[112:115], v[140:143], 0
 v_accvgpr_write_b32 a0, v192
 v_accvgpr_write_b32 a1, v193
 v_mfma_f32_16x16x32_bf16 v[20:23], a[116:119], v[140:143], v[20:23]
 s_waitcnt lgkmcnt(0)
 v_cvt_pk_bf16_f32 v194, v252, v253
 v_cvt_pk_bf16_f32 v195, v254, v255
 s_barrier
 ds_read_b128 a[152:155], v0 offset:0
 ds_read_b128 a[156:159], v0 offset:512
 ds_read_b128 a[160:163], v0 offset:1024
 ds_read_b128 a[164:167], v0 offset:1536
 ds_read_b128 a[168:171], v0 offset:4096
 ds_read_b128 a[172:175], v0 offset:4608
 ds_read_b128 a[176:179], v0 offset:5120
 ds_read_b128 a[180:183], v0 offset:5632
 v_mfma_f32_16x16x32_bf16 v[248:251], a[114:117], v[144:147], 0
 v_accvgpr_write_b32 a2, v194
 v_accvgpr_write_b32 a3, v195
 v_mfma_f32_16x16x32_bf16 v[248:251], a[118:121], v[144:147], v[248:251]
 v_cvt_pk_bf16_f32 v192, v16, v17
 v_cvt_pk_bf16_f32 v193, v18, v19
 v_mfma_f32_16x16x32_bf16 v[252:255], a[112:115], v[144:147], 0
 v_accvgpr_write_b32 a4, v192
 v_accvgpr_write_b32 a5, v193
 v_mfma_f32_16x16x32_bf16 v[252:255], a[116:119], v[144:147], v[252:255]
 v_cvt_pk_bf16_f32 v194, v20, v21
 v_cvt_pk_bf16_f32 v195, v22, v23
 v_mfma_f32_16x16x32_bf16 v[16:19], a[114:117], v[148:151], 0
 v_accvgpr_write_b32 a6, v194
 v_accvgpr_write_b32 a7, v195
 v_mfma_f32_16x16x32_bf16 v[16:19], a[118:121], v[148:151], v[16:19]
 v_cvt_pk_bf16_f32 v192, v248, v249
 v_cvt_pk_bf16_f32 v193, v250, v251
 v_mfma_f32_16x16x32_bf16 v[20:23], a[112:115], v[148:151], 0
 v_accvgpr_write_b32 a8, v192
 v_accvgpr_write_b32 a9, v193
 v_mfma_f32_16x16x32_bf16 v[20:23], a[116:119], v[148:151], v[20:23]
 s_waitcnt lgkmcnt(0)
 v_cvt_pk_bf16_f32 v194, v252, v253
 v_cvt_pk_bf16_f32 v195, v254, v255
 v_mfma_f32_16x16x32_bf16 v[168:171], a[152:155], a[0:3], 0
 v_accvgpr_write_b32 a10, v194
 v_accvgpr_write_b32 a11, v195
 v_mfma_f32_16x16x32_bf16 v[168:171], a[156:159], a[4:7], v[168:171]
 v_cvt_pk_bf16_f32 v192, v16, v17
 v_cvt_pk_bf16_f32 v193, v18, v19
 v_mfma_f32_16x16x32_bf16 v[172:175], a[168:171], a[0:3], 0
 v_accvgpr_write_b32 a12, v192
 v_accvgpr_write_b32 a13, v193
 v_mfma_f32_16x16x32_bf16 v[172:175], a[172:175], a[4:7], v[172:175]
 v_cvt_pk_bf16_f32 v194, v20, v21
 v_cvt_pk_bf16_f32 v195, v22, v23
 v_mfma_f32_16x16x32_bf16 v[168:171], a[160:163], a[8:11], v[168:171]
 v_accvgpr_write_b32 a14, v194
 v_accvgpr_write_b32 a15, v195
 v_mfma_f32_16x16x32_bf16 v[172:175], a[176:179], a[8:11], v[172:175]
 s_nop 0
 v_mfma_f32_16x16x32_bf16 v[168:171], a[164:167], a[12:15], v[168:171]
 v_mfma_f32_16x16x32_bf16 v[172:175], a[180:183], a[12:15], v[172:175]
 s_nop 6
 v_max3_f32 v196, v168, v169, v170
 v_max_f32 v196, v196, v171
 v_mov_b32 v197, v196
 s_nop 1
 v_permlane32_swap_b32 v196, v197
 s_nop 0
 v_max_f32 v196, v196, v197
 v_mov_b32 v197, v196
 s_nop 1
 v_permlane16_swap_b32 v196, v197
 s_nop 0
 v_max_f32 v196, v196, v197
 s_nop 1
 v_max_f32_dpp v196, v196, v196 row_ror:8 row_mask:0xf bank_mask:0xf
 s_nop 1
 v_max_f32_dpp v196, v196, v196 row_ror:4 row_mask:0xf bank_mask:0xf
 s_nop 1
 v_max_f32_dpp v196, v196, v196 row_ror:2 row_mask:0xf bank_mask:0xf
 s_nop 1
 v_max_f32_dpp v196, v196, v196 row_ror:1 row_mask:0xf bank_mask:0xf
 v_sub_f32 v12, 0x428b8000, v196
 v_sub_f32 v13, 0x428b8000, v196
 v_sub_f32 v14, 0x428b8000, v196
 v_sub_f32 v15, 0x428b8000, v196
 v_add_f32 v168, v12, v168
 v_add_f32 v169, v12, v169
 v_add_f32 v170, v12, v170
 v_add_f32 v171, v12, v171
 v_exp_f32 v168, v168
 v_exp_f32 v169, v169
 v_exp_f32 v170, v170
 v_exp_f32 v171, v171
 v_cvt_pk_bf16_f32 v24, v168, v169
 v_cvt_pk_bf16_f32 v25, v170, v171
 s_waitcnt vmcnt(0)
 s_barrier
 ds_read_b128 a[184:187], v0 offset:8192
 ds_read_b128 a[188:191], v0 offset:8704
 ds_read_b128 a[192:195], v0 offset:9216
 ds_read_b128 a[196:199], v0 offset:9728
 ds_read_b128 a[200:203], v0 offset:12288
 ds_read_b128 a[204:207], v0 offset:12800
 ds_read_b128 a[208:211], v0 offset:13312
 ds_read_b128 a[212:215], v0 offset:13824
 ds_read_b128 a[216:219], v0 offset:16384
 ds_read_b128 a[224:227], v0 offset:16896
 ds_read_b128 a[228:231], v0 offset:17408
 ds_read_b128 a[232:235], v0 offset:17920
 s_add_u32 m0, s34, 4096
 s_add_u32 s36, s35, 4096
 buffer_load_dwordx4 v3, s[4:7], s36 offen offset:0 nt lds
 buffer_load_dwordx4 v3, s[4:7], s36 offen offset:2048 nt lds
 s_add_u32 m0, s34, 4992
 s_nop 0
 buffer_load_dwordx4 v3, s[4:7], s36 offen offset:128 nt lds
 buffer_load_dwordx4 v3, s[4:7], s36 offen offset:2176 nt lds
 v_add_f32 v172, v12, v172
 v_add_f32 v173, v12, v173
 v_add_f32 v174, v12, v174
 v_add_f32 v175, v12, v175
 v_exp_f32 v172, v172
 v_exp_f32 v173, v173
 v_exp_f32 v174, v174
 v_exp_f32 v175, v175
 ds_read_b128 a[236:239], v0 offset:20480
 ds_read_b128 a[240:243], v0 offset:20992
 ds_read_b128 a[244:247], v0 offset:21504
 ds_read_b128 a[248:251], v0 offset:22016
 s_waitcnt lgkmcnt(14)
 v_mfma_f32_16x16x32_bf16 v[176:179], a[184:187], a[0:3], v[12:15]
 s_waitcnt lgkmcnt(14)
 v_cvt_pk_bf16_f32 v26, v172, v173
 v_cvt_pk_bf16_f32 v27, v174, v175
 v_mfma_f32_16x16x32_bf16 v[176:179], a[188:191], a[4:7], v[176:179]
 s_waitcnt lgkmcnt(13)
 v_mfma_f32_16x16x32_bf16 v[176:179], a[192:195], a[8:11], v[176:179]
 s_waitcnt lgkmcnt(12)
 v_mfma_f32_16x16x32_bf16 v[176:179], a[196:199], a[12:15], v[176:179]
 s_waitcnt lgkmcnt(11)
 v_mfma_f32_16x16x32_bf16 v[180:183], a[200:203], a[0:3], v[12:15]
 s_waitcnt lgkmcnt(10)
 v_mfma_f32_16x16x32_bf16 v[180:183], a[204:207], a[4:7], v[180:183]
 s_waitcnt lgkmcnt(9)
 v_mfma_f32_16x16x32_bf16 v[180:183], a[208:211], a[8:11], v[180:183]
 s_waitcnt lgkmcnt(0)
 v_mfma_f32_16x16x32_bf16 v[180:183], a[212:215], a[12:15], v[180:183]
 v_mfma_f32_16x16x32_bf16 v[184:187], a[216:219], a[0:3], v[12:15]
 v_mfma_f32_16x16x32_bf16 v[184:187], a[224:227], a[4:7], v[184:187]
 v_mfma_f32_16x16x32_bf16 v[184:187], a[228:231], a[8:11], v[184:187]
 v_mfma_f32_16x16x32_bf16 v[184:187], a[232:235], a[12:15], v[184:187]
 v_exp_f32 v176, v176
 v_mfma_f32_16x16x32_bf16 v[188:191], a[236:239], a[0:3], v[12:15]
 v_exp_f32 v177, v177
 v_mfma_f32_16x16x32_bf16 v[188:191], a[240:243], a[4:7], v[188:191]
 v_exp_f32 v178, v178
 v_mfma_f32_16x16x32_bf16 v[188:191], a[244:247], a[8:11], v[188:191]
 v_exp_f32 v179, v179
 v_mfma_f32_16x16x32_bf16 v[188:191], a[248:251], a[12:15], v[188:191]
 v_cvt_pk_bf16_f32 v28, v176, v177
 v_cvt_pk_bf16_f32 v29, v178, v179
 v_exp_f32 v180, v180
 v_exp_f32 v181, v181
 v_exp_f32 v182, v182
 v_exp_f32 v183, v183
 v_cvt_pk_bf16_f32 v30, v180, v181
 v_cvt_pk_bf16_f32 v31, v182, v183
 v_exp_f32 v184, v184
 v_exp_f32 v185, v185
 s_waitcnt vmcnt(0)
 ds_read_b128 v[152:155], v11 offset:4096
 ds_read_b128 v[156:159], v11 offset:4608
 ds_read_b128 v[160:163], v11 offset:5120
 ds_read_b128 v[164:167], v11 offset:5632
 s_add_u32 m0, s34, 8192
 s_add_u32 s36, s35, 8192
 buffer_load_dwordx4 v3, s[4:7], s36 offen offset:0 nt lds
 buffer_load_dwordx4 v3, s[4:7], s36 offen offset:2048 nt lds
 s_add_u32 m0, s34, 9088
 s_nop 0
 buffer_load_dwordx4 v3, s[4:7], s36 offen offset:128 nt lds
 buffer_load_dwordx4 v3, s[4:7], s36 offen offset:2176 nt lds
 s_waitcnt lgkmcnt(3)
 v_mfma_f32_16x16x32_bf16 v[248:251], a[114:117], v[152:155], 0
 v_exp_f32 v186, v186
 v_mfma_f32_16x16x32_bf16 v[248:251], a[118:121], v[152:155], v[248:251]
 v_exp_f32 v187, v187
 v_mfma_f32_16x16x32_bf16 v[252:255], a[112:115], v[152:155], 0
 v_cvt_pk_bf16_f32 v80, v184, v185
 v_cvt_pk_bf16_f32 v81, v186, v187
 v_mfma_f32_16x16x32_bf16 v[252:255], a[116:119], v[152:155], v[252:255]
 s_waitcnt lgkmcnt(2)
 v_exp_f32 v188, v188
 v_mfma_f32_16x16x32_bf16 v[16:19], a[114:117], v[156:159], 0
 v_exp_f32 v189, v189
 v_mfma_f32_16x16x32_bf16 v[16:19], a[118:121], v[156:159], v[16:19]
 v_cvt_pk_bf16_f32 v192, v248, v249
 v_cvt_pk_bf16_f32 v193, v250, v251
 v_mfma_f32_16x16x32_bf16 v[20:23], a[112:115], v[156:159], 0
 v_accvgpr_write_b32 a16, v192
 v_accvgpr_write_b32 a17, v193
 v_mfma_f32_16x16x32_bf16 v[20:23], a[116:119], v[156:159], v[20:23]
 s_waitcnt lgkmcnt(0)
 v_cvt_pk_bf16_f32 v194, v252, v253
 v_cvt_pk_bf16_f32 v195, v254, v255
 v_mfma_f32_16x16x32_bf16 v[248:251], a[114:117], v[160:163], 0
 v_accvgpr_write_b32 a18, v194
 v_accvgpr_write_b32 a19, v195
 v_mfma_f32_16x16x32_bf16 v[248:251], a[118:121], v[160:163], v[248:251]
 v_cvt_pk_bf16_f32 v192, v16, v17
 v_cvt_pk_bf16_f32 v193, v18, v19
 v_mfma_f32_16x16x32_bf16 v[252:255], a[112:115], v[160:163], 0
 v_accvgpr_write_b32 a20, v192
 v_accvgpr_write_b32 a21, v193
 v_mfma_f32_16x16x32_bf16 v[252:255], a[116:119], v[160:163], v[252:255]
 v_cvt_pk_bf16_f32 v194, v20, v21
 v_cvt_pk_bf16_f32 v195, v22, v23
 v_mfma_f32_16x16x32_bf16 v[16:19], a[114:117], v[164:167], 0
 v_accvgpr_write_b32 a22, v194
 v_accvgpr_write_b32 a23, v195
 v_mfma_f32_16x16x32_bf16 v[16:19], a[118:121], v[164:167], v[16:19]
 v_cvt_pk_bf16_f32 v192, v248, v249
 v_cvt_pk_bf16_f32 v193, v250, v251
 v_mfma_f32_16x16x32_bf16 v[20:23], a[112:115], v[164:167], 0
 v_accvgpr_write_b32 a24, v192
 v_accvgpr_write_b32 a25, v193
 v_mfma_f32_16x16x32_bf16 v[20:23], a[116:119], v[164:167], v[20:23]
 v_cvt_pk_bf16_f32 v194, v252, v253
 v_cvt_pk_bf16_f32 v195, v254, v255
 v_mfma_f32_16x16x32_bf16 v[204:207], a[152:155], a[16:19], v[12:15]
 v_accvgpr_write_b32 a26, v194
 v_accvgpr_write_b32 a27, v195
 v_mfma_f32_16x16x32_bf16 v[204:207], a[156:159], a[20:23], v[204:207]
 v_cvt_pk_bf16_f32 v192, v16, v17
 v_cvt_pk_bf16_f32 v193, v18, v19
 v_mfma_f32_16x16x32_bf16 v[208:211], a[168:171], a[16:19], v[12:15]
 v_accvgpr_write_b32 a28, v192
 v_accvgpr_write_b32 a29, v193
 v_mfma_f32_16x16x32_bf16 v[208:211], a[172:175], a[20:23], v[208:211]
 v_cvt_pk_bf16_f32 v194, v20, v21
 v_cvt_pk_bf16_f32 v195, v22, v23
 v_mfma_f32_16x16x32_bf16 v[204:207], a[160:163], a[24:27], v[204:207]
 v_accvgpr_write_b32 a30, v194
 v_accvgpr_write_b32 a31, v195
 v_mfma_f32_16x16x32_bf16 v[208:211], a[176:179], a[24:27], v[208:211]
 v_exp_f32 v190, v190
 v_mfma_f32_16x16x32_bf16 v[204:207], a[164:167], a[28:31], v[204:207]
 v_exp_f32 v191, v191
 v_mfma_f32_16x16x32_bf16 v[208:211], a[180:183], a[28:31], v[208:211]
 v_cvt_pk_bf16_f32 v82, v188, v189
 v_cvt_pk_bf16_f32 v83, v190, v191
 v_mfma_f32_16x16x32_bf16 v[212:215], a[184:187], a[16:19], v[12:15]
 s_nop 0
 v_mfma_f32_16x16x32_bf16 v[212:215], a[188:191], a[20:23], v[212:215]
 s_nop 0
 v_exp_f32 v204, v204
 v_mfma_f32_16x16x32_bf16 v[212:215], a[192:195], a[24:27], v[212:215]
 v_exp_f32 v205, v205
 v_mfma_f32_16x16x32_bf16 v[212:215], a[196:199], a[28:31], v[212:215]
 v_exp_f32 v206, v206
 v_mfma_f32_16x16x32_bf16 v[216:219], a[200:203], a[16:19], v[12:15]
 v_exp_f32 v207, v207
 v_mfma_f32_16x16x32_bf16 v[216:219], a[204:207], a[20:23], v[216:219]
 v_cvt_pk_bf16_f32 v32, v204, v205
 v_cvt_pk_bf16_f32 v33, v206, v207
 v_mfma_f32_16x16x32_bf16 v[216:219], a[208:211], a[24:27], v[216:219]
 v_exp_f32 v208, v208
 v_mfma_f32_16x16x32_bf16 v[216:219], a[212:215], a[28:31], v[216:219]
 v_exp_f32 v209, v209
 v_mfma_f32_16x16x32_bf16 v[220:223], a[216:219], a[16:19], v[12:15]
 v_exp_f32 v210, v210
 v_mfma_f32_16x16x32_bf16 v[220:223], a[224:227], a[20:23], v[220:223]
 v_exp_f32 v211, v211
 v_mfma_f32_16x16x32_bf16 v[220:223], a[228:231], a[24:27], v[220:223]
 v_cvt_pk_bf16_f32 v34, v208, v209
 v_cvt_pk_bf16_f32 v35, v210, v211
 v_mfma_f32_16x16x32_bf16 v[220:223], a[232:235], a[28:31], v[220:223]
 v_exp_f32 v212, v212
 v_mfma_f32_16x16x32_bf16 v[224:227], a[236:239], a[16:19], v[12:15]
 v_exp_f32 v213, v213
 v_mfma_f32_16x16x32_bf16 v[224:227], a[240:243], a[20:23], v[224:227]
 v_exp_f32 v214, v214
 v_mfma_f32_16x16x32_bf16 v[224:227], a[244:247], a[24:27], v[224:227]
 v_exp_f32 v215, v215
 v_mfma_f32_16x16x32_bf16 v[224:227], a[248:251], a[28:31], v[224:227]
 v_cvt_pk_bf16_f32 v36, v212, v213
 v_cvt_pk_bf16_f32 v37, v214, v215
 v_mfma_f32_16x16x32_bf16 v[244:247], v[240:243], v[24:27], 0
 v_exp_f32 v216, v216
 v_mfma_f32_16x16x32_bf16 v[244:247], v[240:243], v[28:31], v[244:247]
 v_exp_f32 v217, v217
 v_mfma_f32_16x16x32_bf16 v[244:247], v[240:243], v[80:83], v[244:247]
 v_exp_f32 v218, v218
 v_exp_f32 v219, v219
 v_cvt_pk_bf16_f32 v38, v216, v217
 v_cvt_pk_bf16_f32 v39, v218, v219
 v_exp_f32 v220, v220
 v_exp_f32 v221, v221
 v_exp_f32 v222, v222
 s_waitcnt vmcnt(0)
 ds_read_b128 v[136:139], v11 offset:8192
 ds_read_b128 v[140:143], v11 offset:8704
 ds_read_b128 v[144:147], v11 offset:9216
 ds_read_b128 v[148:151], v11 offset:9728
 s_add_u32 m0, s34, 12288
 s_add_u32 s36, s35, 12288
 buffer_load_dwordx4 v3, s[4:7], s36 offen offset:0 nt lds
 buffer_load_dwordx4 v3, s[4:7], s36 offen offset:2048 nt lds
 s_add_u32 m0, s34, 13184
 s_nop 0
 buffer_load_dwordx4 v3, s[4:7], s36 offen offset:128 nt lds
 buffer_load_dwordx4 v3, s[4:7], s36 offen offset:2176 nt lds
 s_add_u32 m0, s34, 0
 s_add_u32 s36, s35, 16384
 buffer_load_dwordx4 v3, s[4:7], s36 offen offset:0 nt lds
 buffer_load_dwordx4 v3, s[4:7], s36 offen offset:2048 nt lds
 s_add_u32 m0, s34, 896
 s_nop 0
 buffer_load_dwordx4 v3, s[4:7], s36 offen offset:128 nt lds
 buffer_load_dwordx4 v3, s[4:7], s36 offen offset:2176 nt lds
 s_add_u32 m0, s34, 4096
 s_add_u32 s36, s35, 20480
 buffer_load_dwordx4 v3, s[4:7], s36 offen offset:0 nt lds
 buffer_load_dwordx4 v3, s[4:7], s36 offen offset:2048 nt lds
 s_add_u32 m0, s34, 4992
 s_nop 0
 buffer_load_dwordx4 v3, s[4:7], s36 offen offset:128 nt lds
 buffer_load_dwordx4 v3, s[4:7], s36 offen offset:2176 nt lds
 s_branch L_merge
L_exit:
 s_endpgm
L_slow_7:
 v_mbcnt_lo_u32_b32 v108, -1, 0
 v_mbcnt_hi_u32_b32 v108, -1, v108
 v_bfe_u32 v109, v108, 2, 3
 v_lshlrev_b32 v3, 8, v109
 v_lshrrev_b32 v109, 5, v108
 v_lshl_add_u32 v3, v109, 6, v3
 v_lshrrev_b32 v109, 3, v108
 v_and_b32 v109, 2, v109
 v_and_b32 v110, 3, v108
 v_xor_b32 v109, v109, v110
 v_lshl_add_u32 v3, v109, 4, v3
 v_and_b32 v107, 15, v108
 v_lshrrev_b32 v108, 4, v108
 v_lshlrev_b32 v107, 8, v107
 v_lshl_add_u32 v107, v108, 4, v107
 v_mov_b32 v100, 0xff800000
 v_mov_b32 v101, 0xff800000
 v_mov_b32 v102, 0xff800000
 v_mov_b32 v103, 0xff800000
 v_mov_b32 v104, 0xff800000
 v_mov_b32 v105, 0xff800000
 v_mov_b32 v106, 0xff800000
 s_mov_b32 s30, 0
 s_waitcnt vmcnt(0)
L_fa_7:
 buffer_load_dwordx4 v[24:27], v107, s[8:11], s30 offen offset:0
 buffer_load_dwordx4 v[28:31], v107, s[8:11], s30 offen offset:64
 buffer_load_dwordx4 v[32:35], v107, s[8:11], s30 offen offset:128
 buffer_load_dwordx4 v[36:39], v107, s[8:11], s30 offen offset:192
 s_waitcnt vmcnt(0)
 v_mfma_f32_16x16x32_bf16 v[56:59], v[24:27], a[0:3], 0
 v_mfma_f32_16x16x32_bf16 v[56:59], v[28:31], a[4:7], v[56:59]
 v_mfma_f32_16x16x32_bf16 v[56:59], v[32:35], a[8:11], v[56:59]
 v_mfma_f32_16x16x32_bf16 v[56:59], v[36:39], a[12:15], v[56:59]
 v_mfma_f32_16x16x32_bf16 v[60:63], v[24:27], a[16:19], 0
 v_mfma_f32_16x16x32_bf16 v[60:63], v[28:31], a[20:23], v[60:63]
 v_mfma_f32_16x16x32_bf16 v[60:63], v[32:35], a[24:27], v[60:63]
 v_mfma_f32_16x16x32_bf16 v[60:63], v[36:39], a[28:31], v[60:63]
 v_mfma_f32_16x16x32_bf16 v[64:67], v[24:27], a[32:35], 0
 v_mfma_f32_16x16x32_bf16 v[64:67], v[28:31], a[36:39], v[64:67]
 v_mfma_f32_16x16x32_bf16 v[64:67], v[32:35], a[40:43], v[64:67]
 v_mfma_f32_16x16x32_bf16 v[64:67], v[36:39], a[44:47], v[64:67]
 v_mfma_f32_16x16x32_bf16 v[68:71], v[24:27], a[48:51], 0
 v_mfma_f32_16x16x32_bf16 v[68:71], v[28:31], a[52:55], v[68:71]
 v_mfma_f32_16x16x32_bf16 v[68:71], v[32:35], a[56:59], v[68:71]
 v_mfma_f32_16x16x32_bf16 v[68:71], v[36:39], a[60:63], v[68:71]
 v_mfma_f32_16x16x32_bf16 v[72:75], v[24:27], a[64:67], 0
 v_mfma_f32_16x16x32_bf16 v[72:75], v[28:31], a[68:71], v[72:75]
 v_mfma_f32_16x16x32_bf16 v[72:75], v[32:35], a[72:75], v[72:75]
 v_mfma_f32_16x16x32_bf16 v[72:75], v[36:39], a[76:79], v[72:75]
 v_mfma_f32_16x16x32_bf16 v[76:79], v[24:27], a[80:83], 0
 v_mfma_f32_16x16x32_bf16 v[76:79], v[28:31], a[84:87], v[76:79]
 v_mfma_f32_16x16x32_bf16 v[76:79], v[32:35], a[88:91], v[76:79]
 v_mfma_f32_16x16x32_bf16 v[76:79], v[36:39], a[92:95], v[76:79]
 v_mfma_f32_16x16x32_bf16 v[80:83], v[24:27], a[96:99], 0
 v_mfma_f32_16x16x32_bf16 v[80:83], v[28:31], a[100:103], v[80:83]
 v_mfma_f32_16x16x32_bf16 v[80:83], v[32:35], a[104:107], v[80:83]
 v_mfma_f32_16x16x32_bf16 v[80:83], v[36:39], a[108:111], v[80:83]
 s_nop 7
 v_max3_f32 v100, v100, v56, v57
 v_max3_f32 v100, v100, v58, v59
 v_max3_f32 v101, v101, v60, v61
 v_max3_f32 v101, v101, v62, v63
 v_max3_f32 v102, v102, v64, v65
 v_max3_f32 v102, v102, v66, v67
 v_max3_f32 v103, v103, v68, v69
 v_max3_f32 v103, v103, v70, v71
 v_max3_f32 v104, v104, v72, v73
 v_max3_f32 v104, v104, v74, v75
 v_max3_f32 v105, v105, v76, v77
 v_max3_f32 v105, v105, v78, v79
 v_max3_f32 v106, v106, v80, v81
 v_max3_f32 v106, v106, v82, v83
 s_add_u32 s30, s30, 4096
 s_cmp_lt_u32 s30, 0x80000
 s_cbranch_scc1 L_fa_7
 v_mov_b32 v11, v100
 s_nop 1
 v_permlane32_swap_b32 v100, v11
 s_nop 0
 v_max_f32 v100, v100, v11
 v_mov_b32 v11, v100
 s_nop 1
 v_permlane16_swap_b32 v100, v11
 s_nop 0
 v_max_f32 v100, v100, v11
 v_mov_b32 v4, 0
 v_mov_b32 v136, 0
 v_mov_b32 v137, 0
 v_mov_b32 v138, 0
 v_mov_b32 v139, 0
 v_mov_b32 v140, 0
 v_mov_b32 v141, 0
 v_mov_b32 v142, 0
 v_mov_b32 v143, 0
 v_mov_b32 v144, 0
 v_mov_b32 v145, 0
 v_mov_b32 v146, 0
 v_mov_b32 v147, 0
 v_mov_b32 v148, 0
 v_mov_b32 v149, 0
 v_mov_b32 v150, 0
 v_mov_b32 v151, 0
 v_mov_b32 v152, 0
 v_mov_b32 v153, 0
 v_mov_b32 v154, 0
 v_mov_b32 v155, 0
 v_mov_b32 v156, 0
 v_mov_b32 v157, 0
 v_mov_b32 v158, 0
 v_mov_b32 v159, 0
 v_mov_b32 v160, 0
 v_mov_b32 v161, 0
 v_mov_b32 v162, 0
 v_mov_b32 v163, 0
 v_mov_b32 v164, 0
 v_mov_b32 v165, 0
 v_mov_b32 v166, 0
 v_mov_b32 v167, 0
 v_mov_b32 v11, v101
 s_nop 1
 v_permlane32_swap_b32 v101, v11
 s_nop 0
 v_max_f32 v101, v101, v11
 v_mov_b32 v11, v101
 s_nop 1
 v_permlane16_swap_b32 v101, v11
 s_nop 0
 v_max_f32 v101, v101, v11
 v_mov_b32 v5, 0
 v_mov_b32 v168, 0
 v_mov_b32 v169, 0
 v_mov_b32 v170, 0
 v_mov_b32 v171, 0
 v_mov_b32 v172, 0
 v_mov_b32 v173, 0
 v_mov_b32 v174, 0
 v_mov_b32 v175, 0
 v_mov_b32 v176, 0
 v_mov_b32 v177, 0
 v_mov_b32 v178, 0
 v_mov_b32 v179, 0
 v_mov_b32 v180, 0
 v_mov_b32 v181, 0
 v_mov_b32 v182, 0
 v_mov_b32 v183, 0
 v_mov_b32 v184, 0
 v_mov_b32 v185, 0
 v_mov_b32 v186, 0
 v_mov_b32 v187, 0
 v_mov_b32 v188, 0
 v_mov_b32 v189, 0
 v_mov_b32 v190, 0
 v_mov_b32 v191, 0
 v_mov_b32 v192, 0
 v_mov_b32 v193, 0
 v_mov_b32 v194, 0
 v_mov_b32 v195, 0
 v_mov_b32 v196, 0
 v_mov_b32 v197, 0
 v_mov_b32 v198, 0
 v_mov_b32 v199, 0
 v_mov_b32 v11, v102
 s_nop 1
 v_permlane32_swap_b32 v102, v11
 s_nop 0
 v_max_f32 v102, v102, v11
 v_mov_b32 v11, v102
 s_nop 1
 v_permlane16_swap_b32 v102, v11
 s_nop 0
 v_max_f32 v102, v102, v11
 v_mov_b32 v6, 0
 v_mov_b32 v200, 0
 v_mov_b32 v201, 0
 v_mov_b32 v202, 0
 v_mov_b32 v203, 0
 v_mov_b32 v204, 0
 v_mov_b32 v205, 0
 v_mov_b32 v206, 0
 v_mov_b32 v207, 0
 v_mov_b32 v208, 0
 v_mov_b32 v209, 0
 v_mov_b32 v210, 0
 v_mov_b32 v211, 0
 v_mov_b32 v212, 0
 v_mov_b32 v213, 0
 v_mov_b32 v214, 0
 v_mov_b32 v215, 0
 v_mov_b32 v216, 0
 v_mov_b32 v217, 0
 v_mov_b32 v218, 0
 v_mov_b32 v219, 0
 v_mov_b32 v220, 0
 v_mov_b32 v221, 0
 v_mov_b32 v222, 0
 v_mov_b32 v223, 0
 v_mov_b32 v224, 0
 v_mov_b32 v225, 0
 v_mov_b32 v226, 0
 v_mov_b32 v227, 0
 v_mov_b32 v228, 0
 v_mov_b32 v229, 0
 v_mov_b32 v230, 0
 v_mov_b32 v231, 0
 v_mov_b32 v11, v103
 s_nop 1
 v_permlane32_swap_b32 v103, v11
 s_nop 0
 v_max_f32 v103, v103, v11
 v_mov_b32 v11, v103
 s_nop 1
 v_permlane16_swap_b32 v103, v11
 s_nop 0
 v_max_f32 v103, v103, v11
 v_mov_b32 v7, 0
 v_mov_b32 v232, 0
 v_mov_b32 v233, 0
 v_mov_b32 v234, 0
 v_mov_b32 v235, 0
 v_mov_b32 v236, 0
 v_mov_b32 v237, 0
 v_mov_b32 v238, 0
 v_mov_b32 v239, 0
 v_mov_b32 v240, 0
 v_mov_b32 v241, 0
 v_mov_b32 v242, 0
 v_mov_b32 v243, 0
 v_mov_b32 v244, 0
 v_mov_b32 v245, 0
 v_mov_b32 v246, 0
 v_mov_b32 v247, 0
 v_mov_b32 v248, 0
 v_mov_b32 v249, 0
 v_mov_b32 v250, 0
 v_mov_b32 v251, 0
 v_mov_b32 v252, 0
 v_mov_b32 v253, 0
 v_mov_b32 v254, 0
 v_mov_b32 v255, 0
 v_accvgpr_write_b32 a152, 0
 v_accvgpr_write_b32 a153, 0
 v_accvgpr_write_b32 a154, 0
 v_accvgpr_write_b32 a155, 0
 v_accvgpr_write_b32 a156, 0
 v_accvgpr_write_b32 a157, 0
 v_accvgpr_write_b32 a158, 0
 v_accvgpr_write_b32 a159, 0
 v_mov_b32 v11, v104
 s_nop 1
 v_permlane32_swap_b32 v104, v11
 s_nop 0
 v_max_f32 v104, v104, v11
 v_mov_b32 v11, v104
 s_nop 1
 v_permlane16_swap_b32 v104, v11
 s_nop 0
 v_max_f32 v104, v104, v11
 v_mov_b32 v8, 0
 v_accvgpr_write_b32 a160, 0
 v_accvgpr_write_b32 a161, 0
 v_accvgpr_write_b32 a162, 0
 v_accvgpr_write_b32 a163, 0
 v_accvgpr_write_b32 a164, 0
 v_accvgpr_write_b32 a165, 0
 v_accvgpr_write_b32 a166, 0
 v_accvgpr_write_b32 a167, 0
 v_accvgpr_write_b32 a168, 0
 v_accvgpr_write_b32 a169, 0
 v_accvgpr_write_b32 a170, 0
 v_accvgpr_write_b32 a171, 0
 v_accvgpr_write_b32 a172, 0
 v_accvgpr_write_b32 a173, 0
 v_accvgpr_write_b32 a174, 0
 v_accvgpr_write_b32 a175, 0
 v_accvgpr_write_b32 a176, 0
 v_accvgpr_write_b32 a177, 0
 v_accvgpr_write_b32 a178, 0
 v_accvgpr_write_b32 a179, 0
 v_accvgpr_write_b32 a180, 0
 v_accvgpr_write_b32 a181, 0
 v_accvgpr_write_b32 a182, 0
 v_accvgpr_write_b32 a183, 0
 v_accvgpr_write_b32 a184, 0
 v_accvgpr_write_b32 a185, 0
 v_accvgpr_write_b32 a186, 0
 v_accvgpr_write_b32 a187, 0
 v_accvgpr_write_b32 a188, 0
 v_accvgpr_write_b32 a189, 0
 v_accvgpr_write_b32 a190, 0
 v_accvgpr_write_b32 a191, 0
 v_mov_b32 v11, v105
 s_nop 1
 v_permlane32_swap_b32 v105, v11
 s_nop 0
 v_max_f32 v105, v105, v11
 v_mov_b32 v11, v105
 s_nop 1
 v_permlane16_swap_b32 v105, v11
 s_nop 0
 v_max_f32 v105, v105, v11
 v_mov_b32 v9, 0
 v_accvgpr_write_b32 a192, 0
 v_accvgpr_write_b32 a193, 0
 v_accvgpr_write_b32 a194, 0
 v_accvgpr_write_b32 a195, 0
 v_accvgpr_write_b32 a196, 0
 v_accvgpr_write_b32 a197, 0
 v_accvgpr_write_b32 a198, 0
 v_accvgpr_write_b32 a199, 0
 v_accvgpr_write_b32 a200, 0
 v_accvgpr_write_b32 a201, 0
 v_accvgpr_write_b32 a202, 0
 v_accvgpr_write_b32 a203, 0
 v_accvgpr_write_b32 a204, 0
 v_accvgpr_write_b32 a205, 0
 v_accvgpr_write_b32 a206, 0
 v_accvgpr_write_b32 a207, 0
 v_accvgpr_write_b32 a208, 0
 v_accvgpr_write_b32 a209, 0
 v_accvgpr_write_b32 a210, 0
 v_accvgpr_write_b32 a211, 0
 v_accvgpr_write_b32 a212, 0
 v_accvgpr_write_b32 a213, 0
 v_accvgpr_write_b32 a214, 0
 v_accvgpr_write_b32 a215, 0
 v_accvgpr_write_b32 a216, 0
 v_accvgpr_write_b32 a217, 0
 v_accvgpr_write_b32 a218, 0
 v_accvgpr_write_b32 a219, 0
 v_accvgpr_write_b32 a220, 0
 v_accvgpr_write_b32 a221, 0
 v_accvgpr_write_b32 a222, 0
 v_accvgpr_write_b32 a223, 0
 v_mov_b32 v11, v106
 s_nop 1
 v_permlane32_swap_b32 v106, v11
 s_nop 0
 v_max_f32 v106, v106, v11
 v_mov_b32 v11, v106
 s_nop 1
 v_permlane16_swap_b32 v106, v11
 s_nop 0
 v_max_f32 v106, v106, v11
 v_mov_b32 v10, 0
 v_accvgpr_write_b32 a224, 0
 v_accvgpr_write_b32 a225, 0
 v_accvgpr_write_b32 a226, 0
 v_accvgpr_write_b32 a227, 0
 v_accvgpr_write_b32 a228, 0
 v_accvgpr_write_b32 a229, 0
 v_accvgpr_write_b32 a230, 0
 v_accvgpr_write_b32 a231, 0
 v_accvgpr_write_b32 a232, 0
 v_accvgpr_write_b32 a233, 0
 v_accvgpr_write_b32 a234, 0
 v_accvgpr_write_b32 a235, 0
 v_accvgpr_write_b32 a236, 0
 v_accvgpr_write_b32 a237, 0
 v_accvgpr_write_b32 a238, 0
 v_accvgpr_write_b32 a239, 0
 v_accvgpr_write_b32 a240, 0
 v_accvgpr_write_b32 a241, 0
 v_accvgpr_write_b32 a242, 0
 v_accvgpr_write_b32 a243, 0
 v_accvgpr_write_b32 a244, 0
 v_accvgpr_write_b32 a245, 0
 v_accvgpr_write_b32 a246, 0
 v_accvgpr_write_b32 a247, 0
 v_accvgpr_write_b32 a248, 0
 v_accvgpr_write_b32 a249, 0
 v_accvgpr_write_b32 a250, 0
 v_accvgpr_write_b32 a251, 0
 v_accvgpr_write_b32 a252, 0
 v_accvgpr_write_b32 a253, 0
 v_accvgpr_write_b32 a254, 0
 v_accvgpr_write_b32 a255, 0
 s_mov_b32 s36, s28
L_fb_7:
 s_barrier
 s_add_u32 m0, s28, 0
 s_nop 0
 buffer_load_dwordx4 v3, s[8:11], s36 offen offset:0 lds
 s_add_u32 m0, s28, 896
 s_nop 0
 buffer_load_dwordx4 v3, s[8:11], s36 offen offset:128 lds
 s_add_u32 m0, s28, 65536
 s_nop 0
 buffer_load_dwordx4 v3, s[12:15], s36 offen offset:0 lds
 s_add_u32 m0, s28, 66432
 s_nop 0
 buffer_load_dwordx4 v3, s[12:15], s36 offen offset:128 lds
 s_waitcnt vmcnt(0)
 s_barrier
 ds_read_b128 v[24:27], v0 offset:0
 ds_read_b128 v[28:31], v0 offset:512
 ds_read_b128 v[32:35], v0 offset:1024
 ds_read_b128 v[36:39], v0 offset:1536
 ds_read_b128 v[40:43], v0 offset:4096
 ds_read_b128 v[44:47], v0 offset:4608
 ds_read_b128 v[48:51], v0 offset:5120
 ds_read_b128 v[52:55], v0 offset:5632
 s_waitcnt lgkmcnt(0)
 ds_read_b64_tr_b16 v[56:57], v1 offset:0
 ds_read_b64_tr_b16 v[58:59], v1 offset:4096
 ds_read_b64_tr_b16 v[60:61], v2 offset:0
 ds_read_b64_tr_b16 v[62:63], v2 offset:4096
 ds_read_b64_tr_b16 v[64:65], v1 offset:512
 ds_read_b64_tr_b16 v[66:67], v1 offset:4608
 ds_read_b64_tr_b16 v[68:69], v2 offset:512
 ds_read_b64_tr_b16 v[70:71], v2 offset:4608
 s_waitcnt lgkmcnt(0)
 ds_read_b64_tr_b16 v[72:73], v1 offset:1024
 ds_read_b64_tr_b16 v[74:75], v1 offset:5120
 ds_read_b64_tr_b16 v[76:77], v2 offset:1024
 ds_read_b64_tr_b16 v[78:79], v2 offset:5120
 ds_read_b64_tr_b16 v[80:81], v1 offset:1536
 ds_read_b64_tr_b16 v[82:83], v1 offset:5632
 ds_read_b64_tr_b16 v[84:85], v2 offset:1536
 ds_read_b64_tr_b16 v[86:87], v2 offset:5632
 s_waitcnt lgkmcnt(0)
 v_mfma_f32_16x16x32_bf16 v[88:91], v[24:27], a[0:3], 0
 v_mfma_f32_16x16x32_bf16 v[88:91], v[28:31], a[4:7], v[88:91]
 v_mfma_f32_16x16x32_bf16 v[88:91], v[32:35], a[8:11], v[88:91]
 v_mfma_f32_16x16x32_bf16 v[88:91], v[36:39], a[12:15], v[88:91]
 v_mfma_f32_16x16x32_bf16 v[92:95], v[40:43], a[0:3], 0
 v_mfma_f32_16x16x32_bf16 v[92:95], v[44:47], a[4:7], v[92:95]
 v_mfma_f32_16x16x32_bf16 v[92:95], v[48:51], a[8:11], v[92:95]
 v_mfma_f32_16x16x32_bf16 v[92:95], v[52:55], a[12:15], v[92:95]
 s_nop 7
 v_sub_f32 v88, v88, v100
 v_sub_f32 v89, v89, v100
 v_sub_f32 v90, v90, v100
 v_sub_f32 v91, v91, v100
 v_sub_f32 v92, v92, v100
 v_sub_f32 v93, v93, v100
 v_sub_f32 v94, v94, v100
 v_sub_f32 v95, v95, v100
 v_exp_f32 v88, v88
 v_exp_f32 v89, v89
 v_exp_f32 v90, v90
 v_exp_f32 v91, v91
 v_exp_f32 v92, v92
 v_exp_f32 v93, v93
 v_exp_f32 v94, v94
 v_exp_f32 v95, v95
 s_nop 0
 v_add_f32 v4, v88, v4
 v_add_f32 v4, v89, v4
 v_add_f32 v4, v90, v4
 v_add_f32 v4, v91, v4
 v_add_f32 v4, v92, v4
 v_add_f32 v4, v93, v4
 v_add_f32 v4, v94, v4
 v_add_f32 v4, v95, v4
 v_cvt_pk_bf16_f32 v96, v88, v89
 v_cvt_pk_bf16_f32 v97, v90, v91
 v_cvt_pk_bf16_f32 v98, v92, v93
 v_cvt_pk_bf16_f32 v99, v94, v95
 s_nop 1
 v_mfma_f32_16x16x32_bf16 v[136:139], v[96:99], v[56:59], v[136:139]
 v_mfma_f32_16x16x32_bf16 v[140:143], v[96:99], v[60:63], v[140:143]
 v_mfma_f32_16x16x32_bf16 v[144:147], v[96:99], v[64:67], v[144:147]
 v_mfma_f32_16x16x32_bf16 v[148:151], v[96:99], v[68:71], v[148:151]
 v_mfma_f32_16x16x32_bf16 v[152:155], v[96:99], v[72:75], v[152:155]
 v_mfma_f32_16x16x32_bf16 v[156:159], v[96:99], v[76:79], v[156:159]
 v_mfma_f32_16x16x32_bf16 v[160:163], v[96:99], v[80:83], v[160:163]
 v_mfma_f32_16x16x32_bf16 v[164:167], v[96:99], v[84:87], v[164:167]
 v_mfma_f32_16x16x32_bf16 v[88:91], v[24:27], a[16:19], 0
 v_mfma_f32_16x16x32_bf16 v[88:91], v[28:31], a[20:23], v[88:91]
 v_mfma_f32_16x16x32_bf16 v[88:91], v[32:35], a[24:27], v[88:91]
 v_mfma_f32_16x16x32_bf16 v[88:91], v[36:39], a[28:31], v[88:91]
 v_mfma_f32_16x16x32_bf16 v[92:95], v[40:43], a[16:19], 0
 v_mfma_f32_16x16x32_bf16 v[92:95], v[44:47], a[20:23], v[92:95]
 v_mfma_f32_16x16x32_bf16 v[92:95], v[48:51], a[24:27], v[92:95]
 v_mfma_f32_16x16x32_bf16 v[92:95], v[52:55], a[28:31], v[92:95]
 s_nop 7
 v_sub_f32 v88, v88, v101
 v_sub_f32 v89, v89, v101
 v_sub_f32 v90, v90, v101
 v_sub_f32 v91, v91, v101
 v_sub_f32 v92, v92, v101
 v_sub_f32 v93, v93, v101
 v_sub_f32 v94, v94, v101
 v_sub_f32 v95, v95, v101
 v_exp_f32 v88, v88
 v_exp_f32 v89, v89
 v_exp_f32 v90, v90
 v_exp_f32 v91, v91
 v_exp_f32 v92, v92
 v_exp_f32 v93, v93
 v_exp_f32 v94, v94
 v_exp_f32 v95, v95
 s_nop 0
 v_add_f32 v5, v88, v5
 v_add_f32 v5, v89, v5
 v_add_f32 v5, v90, v5
 v_add_f32 v5, v91, v5
 v_add_f32 v5, v92, v5
 v_add_f32 v5, v93, v5
 v_add_f32 v5, v94, v5
 v_add_f32 v5, v95, v5
 v_cvt_pk_bf16_f32 v96, v88, v89
 v_cvt_pk_bf16_f32 v97, v90, v91
 v_cvt_pk_bf16_f32 v98, v92, v93
 v_cvt_pk_bf16_f32 v99, v94, v95
 s_nop 1
 v_mfma_f32_16x16x32_bf16 v[168:171], v[96:99], v[56:59], v[168:171]
 v_mfma_f32_16x16x32_bf16 v[172:175], v[96:99], v[60:63], v[172:175]
 v_mfma_f32_16x16x32_bf16 v[176:179], v[96:99], v[64:67], v[176:179]
 v_mfma_f32_16x16x32_bf16 v[180:183], v[96:99], v[68:71], v[180:183]
 v_mfma_f32_16x16x32_bf16 v[184:187], v[96:99], v[72:75], v[184:187]
 v_mfma_f32_16x16x32_bf16 v[188:191], v[96:99], v[76:79], v[188:191]
 v_mfma_f32_16x16x32_bf16 v[192:195], v[96:99], v[80:83], v[192:195]
 v_mfma_f32_16x16x32_bf16 v[196:199], v[96:99], v[84:87], v[196:199]
 v_mfma_f32_16x16x32_bf16 v[88:91], v[24:27], a[32:35], 0
 v_mfma_f32_16x16x32_bf16 v[88:91], v[28:31], a[36:39], v[88:91]
 v_mfma_f32_16x16x32_bf16 v[88:91], v[32:35], a[40:43], v[88:91]
 v_mfma_f32_16x16x32_bf16 v[88:91], v[36:39], a[44:47], v[88:91]
 v_mfma_f32_16x16x32_bf16 v[92:95], v[40:43], a[32:35], 0
 v_mfma_f32_16x16x32_bf16 v[92:95], v[44:47], a[36:39], v[92:95]
 v_mfma_f32_16x16x32_bf16 v[92:95], v[48:51], a[40:43], v[92:95]
 v_mfma_f32_16x16x32_bf16 v[92:95], v[52:55], a[44:47], v[92:95]
 s_nop 7
 v_sub_f32 v88, v88, v102
 v_sub_f32 v89, v89, v102
 v_sub_f32 v90, v90, v102
 v_sub_f32 v91, v91, v102
 v_sub_f32 v92, v92, v102
 v_sub_f32 v93, v93, v102
 v_sub_f32 v94, v94, v102
 v_sub_f32 v95, v95, v102
 v_exp_f32 v88, v88
 v_exp_f32 v89, v89
 v_exp_f32 v90, v90
 v_exp_f32 v91, v91
 v_exp_f32 v92, v92
 v_exp_f32 v93, v93
 v_exp_f32 v94, v94
 v_exp_f32 v95, v95
 s_nop 0
 v_add_f32 v6, v88, v6
 v_add_f32 v6, v89, v6
 v_add_f32 v6, v90, v6
 v_add_f32 v6, v91, v6
 v_add_f32 v6, v92, v6
 v_add_f32 v6, v93, v6
 v_add_f32 v6, v94, v6
 v_add_f32 v6, v95, v6
 v_cvt_pk_bf16_f32 v96, v88, v89
 v_cvt_pk_bf16_f32 v97, v90, v91
 v_cvt_pk_bf16_f32 v98, v92, v93
 v_cvt_pk_bf16_f32 v99, v94, v95
 s_nop 1
 v_mfma_f32_16x16x32_bf16 v[200:203], v[96:99], v[56:59], v[200:203]
 v_mfma_f32_16x16x32_bf16 v[204:207], v[96:99], v[60:63], v[204:207]
 v_mfma_f32_16x16x32_bf16 v[208:211], v[96:99], v[64:67], v[208:211]
 v_mfma_f32_16x16x32_bf16 v[212:215], v[96:99], v[68:71], v[212:215]
 v_mfma_f32_16x16x32_bf16 v[216:219], v[96:99], v[72:75], v[216:219]
 v_mfma_f32_16x16x32_bf16 v[220:223], v[96:99], v[76:79], v[220:223]
 v_mfma_f32_16x16x32_bf16 v[224:227], v[96:99], v[80:83], v[224:227]
 v_mfma_f32_16x16x32_bf16 v[228:231], v[96:99], v[84:87], v[228:231]
 v_mfma_f32_16x16x32_bf16 v[88:91], v[24:27], a[48:51], 0
 v_mfma_f32_16x16x32_bf16 v[88:91], v[28:31], a[52:55], v[88:91]
 v_mfma_f32_16x16x32_bf16 v[88:91], v[32:35], a[56:59], v[88:91]
 v_mfma_f32_16x16x32_bf16 v[88:91], v[36:39], a[60:63], v[88:91]
 v_mfma_f32_16x16x32_bf16 v[92:95], v[40:43], a[48:51], 0
 v_mfma_f32_16x16x32_bf16 v[92:95], v[44:47], a[52:55], v[92:95]
 v_mfma_f32_16x16x32_bf16 v[92:95], v[48:51], a[56:59], v[92:95]
 v_mfma_f32_16x16x32_bf16 v[92:95], v[52:55], a[60:63], v[92:95]
 s_nop 7
 v_sub_f32 v88, v88, v103
 v_sub_f32 v89, v89, v103
 v_sub_f32 v90, v90, v103
 v_sub_f32 v91, v91, v103
 v_sub_f32 v92, v92, v103
 v_sub_f32 v93, v93, v103
 v_sub_f32 v94, v94, v103
 v_sub_f32 v95, v95, v103
 v_exp_f32 v88, v88
 v_exp_f32 v89, v89
 v_exp_f32 v90, v90
 v_exp_f32 v91, v91
 v_exp_f32 v92, v92
 v_exp_f32 v93, v93
 v_exp_f32 v94, v94
 v_exp_f32 v95, v95
 s_nop 0
 v_add_f32 v7, v88, v7
 v_add_f32 v7, v89, v7
 v_add_f32 v7, v90, v7
 v_add_f32 v7, v91, v7
 v_add_f32 v7, v92, v7
 v_add_f32 v7, v93, v7
 v_add_f32 v7, v94, v7
 v_add_f32 v7, v95, v7
 v_cvt_pk_bf16_f32 v96, v88, v89
 v_cvt_pk_bf16_f32 v97, v90, v91
 v_cvt_pk_bf16_f32 v98, v92, v93
 v_cvt_pk_bf16_f32 v99, v94, v95
 s_nop 1
 v_mfma_f32_16x16x32_bf16 v[232:235], v[96:99], v[56:59], v[232:235]
 v_mfma_f32_16x16x32_bf16 v[236:239], v[96:99], v[60:63], v[236:239]
 v_mfma_f32_16x16x32_bf16 v[240:243], v[96:99], v[64:67], v[240:243]
 v_mfma_f32_16x16x32_bf16 v[244:247], v[96:99], v[68:71], v[244:247]
 v_mfma_f32_16x16x32_bf16 v[248:251], v[96:99], v[72:75], v[248:251]
 v_mfma_f32_16x16x32_bf16 v[252:255], v[96:99], v[76:79], v[252:255]
 v_mfma_f32_16x16x32_bf16 a[152:155], v[96:99], v[80:83], a[152:155]
 v_mfma_f32_16x16x32_bf16 a[156:159], v[96:99], v[84:87], a[156:159]
 v_mfma_f32_16x16x32_bf16 v[88:91], v[24:27], a[64:67], 0
 v_mfma_f32_16x16x32_bf16 v[88:91], v[28:31], a[68:71], v[88:91]
 v_mfma_f32_16x16x32_bf16 v[88:91], v[32:35], a[72:75], v[88:91]
 v_mfma_f32_16x16x32_bf16 v[88:91], v[36:39], a[76:79], v[88:91]
 v_mfma_f32_16x16x32_bf16 v[92:95], v[40:43], a[64:67], 0
 v_mfma_f32_16x16x32_bf16 v[92:95], v[44:47], a[68:71], v[92:95]
 v_mfma_f32_16x16x32_bf16 v[92:95], v[48:51], a[72:75], v[92:95]
 v_mfma_f32_16x16x32_bf16 v[92:95], v[52:55], a[76:79], v[92:95]
 s_nop 7
 v_sub_f32 v88, v88, v104
 v_sub_f32 v89, v89, v104
 v_sub_f32 v90, v90, v104
 v_sub_f32 v91, v91, v104
 v_sub_f32 v92, v92, v104
 v_sub_f32 v93, v93, v104
 v_sub_f32 v94, v94, v104
 v_sub_f32 v95, v95, v104
 v_exp_f32 v88, v88
 v_exp_f32 v89, v89
 v_exp_f32 v90, v90
 v_exp_f32 v91, v91
 v_exp_f32 v92, v92
 v_exp_f32 v93, v93
 v_exp_f32 v94, v94
 v_exp_f32 v95, v95
 s_nop 0
 v_add_f32 v8, v88, v8
 v_add_f32 v8, v89, v8
 v_add_f32 v8, v90, v8
 v_add_f32 v8, v91, v8
 v_add_f32 v8, v92, v8
 v_add_f32 v8, v93, v8
 v_add_f32 v8, v94, v8
 v_add_f32 v8, v95, v8
 v_cvt_pk_bf16_f32 v96, v88, v89
 v_cvt_pk_bf16_f32 v97, v90, v91
 v_cvt_pk_bf16_f32 v98, v92, v93
 v_cvt_pk_bf16_f32 v99, v94, v95
 s_nop 1
 v_mfma_f32_16x16x32_bf16 a[160:163], v[96:99], v[56:59], a[160:163]
 v_mfma_f32_16x16x32_bf16 a[164:167], v[96:99], v[60:63], a[164:167]
 v_mfma_f32_16x16x32_bf16 a[168:171], v[96:99], v[64:67], a[168:171]
 v_mfma_f32_16x16x32_bf16 a[172:175], v[96:99], v[68:71], a[172:175]
 v_mfma_f32_16x16x32_bf16 a[176:179], v[96:99], v[72:75], a[176:179]
 v_mfma_f32_16x16x32_bf16 a[180:183], v[96:99], v[76:79], a[180:183]
 v_mfma_f32_16x16x32_bf16 a[184:187], v[96:99], v[80:83], a[184:187]
 v_mfma_f32_16x16x32_bf16 a[188:191], v[96:99], v[84:87], a[188:191]
 v_mfma_f32_16x16x32_bf16 v[88:91], v[24:27], a[80:83], 0
 v_mfma_f32_16x16x32_bf16 v[88:91], v[28:31], a[84:87], v[88:91]
 v_mfma_f32_16x16x32_bf16 v[88:91], v[32:35], a[88:91], v[88:91]
 v_mfma_f32_16x16x32_bf16 v[88:91], v[36:39], a[92:95], v[88:91]
 v_mfma_f32_16x16x32_bf16 v[92:95], v[40:43], a[80:83], 0
 v_mfma_f32_16x16x32_bf16 v[92:95], v[44:47], a[84:87], v[92:95]
 v_mfma_f32_16x16x32_bf16 v[92:95], v[48:51], a[88:91], v[92:95]
 v_mfma_f32_16x16x32_bf16 v[92:95], v[52:55], a[92:95], v[92:95]
 s_nop 7
 v_sub_f32 v88, v88, v105
 v_sub_f32 v89, v89, v105
 v_sub_f32 v90, v90, v105
 v_sub_f32 v91, v91, v105
 v_sub_f32 v92, v92, v105
 v_sub_f32 v93, v93, v105
 v_sub_f32 v94, v94, v105
 v_sub_f32 v95, v95, v105
 v_exp_f32 v88, v88
 v_exp_f32 v89, v89
 v_exp_f32 v90, v90
 v_exp_f32 v91, v91
 v_exp_f32 v92, v92
 v_exp_f32 v93, v93
 v_exp_f32 v94, v94
 v_exp_f32 v95, v95
 s_nop 0
 v_add_f32 v9, v88, v9
 v_add_f32 v9, v89, v9
 v_add_f32 v9, v90, v9
 v_add_f32 v9, v91, v9
 v_add_f32 v9, v92, v9
 v_add_f32 v9, v93, v9
 v_add_f32 v9, v94, v9
 v_add_f32 v9, v95, v9
 v_cvt_pk_bf16_f32 v96, v88, v89
 v_cvt_pk_bf16_f32 v97, v90, v91
 v_cvt_pk_bf16_f32 v98, v92, v93
 v_cvt_pk_bf16_f32 v99, v94, v95
 s_nop 1
 v_mfma_f32_16x16x32_bf16 a[192:195], v[96:99], v[56:59], a[192:195]
 v_mfma_f32_16x16x32_bf16 a[196:199], v[96:99], v[60:63], a[196:199]
 v_mfma_f32_16x16x32_bf16 a[200:203], v[96:99], v[64:67], a[200:203]
 v_mfma_f32_16x16x32_bf16 a[204:207], v[96:99], v[68:71], a[204:207]
 v_mfma_f32_16x16x32_bf16 a[208:211], v[96:99], v[72:75], a[208:211]
 v_mfma_f32_16x16x32_bf16 a[212:215], v[96:99], v[76:79], a[212:215]
 v_mfma_f32_16x16x32_bf16 a[216:219], v[96:99], v[80:83], a[216:219]
 v_mfma_f32_16x16x32_bf16 a[220:223], v[96:99], v[84:87], a[220:223]
 v_mfma_f32_16x16x32_bf16 v[88:91], v[24:27], a[96:99], 0
 v_mfma_f32_16x16x32_bf16 v[88:91], v[28:31], a[100:103], v[88:91]
 v_mfma_f32_16x16x32_bf16 v[88:91], v[32:35], a[104:107], v[88:91]
 v_mfma_f32_16x16x32_bf16 v[88:91], v[36:39], a[108:111], v[88:91]
 v_mfma_f32_16x16x32_bf16 v[92:95], v[40:43], a[96:99], 0
 v_mfma_f32_16x16x32_bf16 v[92:95], v[44:47], a[100:103], v[92:95]
 v_mfma_f32_16x16x32_bf16 v[92:95], v[48:51], a[104:107], v[92:95]
 v_mfma_f32_16x16x32_bf16 v[92:95], v[52:55], a[108:111], v[92:95]
 s_nop 7
 v_sub_f32 v88, v88, v106
 v_sub_f32 v89, v89, v106
 v_sub_f32 v90, v90, v106
 v_sub_f32 v91, v91, v106
 v_sub_f32 v92, v92, v106
 v_sub_f32 v93, v93, v106
 v_sub_f32 v94, v94, v106
 v_sub_f32 v95, v95, v106
 v_exp_f32 v88, v88
 v_exp_f32 v89, v89
 v_exp_f32 v90, v90
 v_exp_f32 v91, v91
 v_exp_f32 v92, v92
 v_exp_f32 v93, v93
 v_exp_f32 v94, v94
 v_exp_f32 v95, v95
 s_nop 0
 v_add_f32 v10, v88, v10
 v_add_f32 v10, v89, v10
 v_add_f32 v10, v90, v10
 v_add_f32 v10, v91, v10
 v_add_f32 v10, v92, v10
 v_add_f32 v10, v93, v10
 v_add_f32 v10, v94, v10
 v_add_f32 v10, v95, v10
 v_cvt_pk_bf16_f32 v96, v88, v89
 v_cvt_pk_bf16_f32 v97, v90, v91
 v_cvt_pk_bf16_f32 v98, v92, v93
 v_cvt_pk_bf16_f32 v99, v94, v95
 s_nop 1
 v_mfma_f32_16x16x32_bf16 a[224:227], v[96:99], v[56:59], a[224:227]
 v_mfma_f32_16x16x32_bf16 a[228:231], v[96:99], v[60:63], a[228:231]
 v_mfma_f32_16x16x32_bf16 a[232:235], v[96:99], v[64:67], a[232:235]
 v_mfma_f32_16x16x32_bf16 a[236:239], v[96:99], v[68:71], a[236:239]
 v_mfma_f32_16x16x32_bf16 a[240:243], v[96:99], v[72:75], a[240:243]
 v_mfma_f32_16x16x32_bf16 a[244:247], v[96:99], v[76:79], a[244:247]
 v_mfma_f32_16x16x32_bf16 a[248:251], v[96:99], v[80:83], a[248:251]
 v_mfma_f32_16x16x32_bf16 a[252:255], v[96:99], v[84:87], a[252:255]
 s_add_u32 s36, s36, 8192
 s_cmp_lt_u32 s36, 0x80000
 s_cbranch_scc1 L_fb_7
 s_nop 7
 v_mfma_f32_16x16x4_f32 v[48:51], v4, v20, 0
 s_nop 9
 v_rcp_f32 v48, v48
 v_rcp_f32 v49, v49
 v_rcp_f32 v50, v50
 v_rcp_f32 v51, v51
 s_mov_b32 s30, 0
 v_pk_mul_f32 v[136:137], v[136:137], v[48:49]
 v_pk_mul_f32 v[140:141], v[140:141], v[48:49]
 v_pk_mul_f32 v[144:145], v[144:145], v[48:49]
 v_pk_mul_f32 v[148:149], v[148:149], v[48:49]
 v_pk_mul_f32 v[152:153], v[152:153], v[48:49]
 v_pk_mul_f32 v[156:157], v[156:157], v[48:49]
 v_pk_mul_f32 v[160:161], v[160:161], v[48:49]
 v_pk_mul_f32 v[164:165], v[164:165], v[48:49]
 v_pk_mul_f32 v[138:139], v[138:139], v[50:51]
 v_pk_mul_f32 v[142:143], v[142:143], v[50:51]
 v_pk_mul_f32 v[146:147], v[146:147], v[50:51]
 v_pk_mul_f32 v[150:151], v[150:151], v[50:51]
 v_pk_mul_f32 v[154:155], v[154:155], v[50:51]
 v_pk_mul_f32 v[158:159], v[158:159], v[50:51]
 v_pk_mul_f32 v[162:163], v[162:163], v[50:51]
 v_pk_mul_f32 v[166:167], v[166:167], v[50:51]
 v_cvt_pk_bf16_f32 v40, v136, v140
 v_cvt_pk_bf16_f32 v41, v144, v148
 v_cvt_pk_bf16_f32 v42, v152, v156
 v_cvt_pk_bf16_f32 v43, v160, v164
 ds_write_b128 v16, v[40:43] offset:0
 ds_read_b64_tr_b16 v[24:25], v17 offset:0
 ds_read_b64_tr_b16 v[26:27], v17 offset:64
 v_cvt_pk_bf16_f32 v44, v137, v141
 v_cvt_pk_bf16_f32 v45, v145, v149
 v_cvt_pk_bf16_f32 v46, v153, v157
 v_cvt_pk_bf16_f32 v47, v161, v165
 ds_write_b128 v16, v[44:47] offset:272
 ds_read_b64_tr_b16 v[28:29], v17 offset:272
 ds_read_b64_tr_b16 v[30:31], v17 offset:336
 v_cvt_pk_bf16_f32 v40, v138, v142
 v_cvt_pk_bf16_f32 v41, v146, v150
 v_cvt_pk_bf16_f32 v42, v154, v158
 v_cvt_pk_bf16_f32 v43, v162, v166
 ds_write_b128 v16, v[40:43] offset:544
 ds_read_b64_tr_b16 v[32:33], v17 offset:544
 ds_read_b64_tr_b16 v[34:35], v17 offset:608
 v_cvt_pk_bf16_f32 v44, v139, v143
 v_cvt_pk_bf16_f32 v45, v147, v151
 v_cvt_pk_bf16_f32 v46, v155, v159
 v_cvt_pk_bf16_f32 v47, v163, v167
 ds_write_b128 v16, v[44:47] offset:816
 ds_read_b64_tr_b16 v[36:37], v17 offset:816
 ds_read_b64_tr_b16 v[38:39], v17 offset:880
 s_waitcnt lgkmcnt(9)
 buffer_store_dwordx4 v[24:27], v18, s[16:19], s30 offen offset:0 sc0 sc1
 s_waitcnt lgkmcnt(6)
 buffer_store_dwordx4 v[28:31], v18, s[16:19], s30 offen offset:256 sc0 sc1
 s_waitcnt lgkmcnt(3)
 buffer_store_dwordx4 v[32:35], v18, s[16:19], s30 offen offset:512 sc0 sc1
 s_waitcnt lgkmcnt(0)
 buffer_store_dwordx4 v[36:39], v18, s[16:19], s30 offen offset:768 sc0 sc1
 v_mfma_f32_16x16x4_f32 v[48:51], v5, v20, 0
 s_nop 9
 v_rcp_f32 v48, v48
 v_rcp_f32 v49, v49
 v_rcp_f32 v50, v50
 v_rcp_f32 v51, v51
 s_mov_b32 s30, 4096
 v_pk_mul_f32 v[168:169], v[168:169], v[48:49]
 v_pk_mul_f32 v[172:173], v[172:173], v[48:49]
 v_pk_mul_f32 v[176:177], v[176:177], v[48:49]
 v_pk_mul_f32 v[180:181], v[180:181], v[48:49]
 v_pk_mul_f32 v[184:185], v[184:185], v[48:49]
 v_pk_mul_f32 v[188:189], v[188:189], v[48:49]
 v_pk_mul_f32 v[192:193], v[192:193], v[48:49]
 v_pk_mul_f32 v[196:197], v[196:197], v[48:49]
 v_pk_mul_f32 v[170:171], v[170:171], v[50:51]
 v_pk_mul_f32 v[174:175], v[174:175], v[50:51]
 v_pk_mul_f32 v[178:179], v[178:179], v[50:51]
 v_pk_mul_f32 v[182:183], v[182:183], v[50:51]
 v_pk_mul_f32 v[186:187], v[186:187], v[50:51]
 v_pk_mul_f32 v[190:191], v[190:191], v[50:51]
 v_pk_mul_f32 v[194:195], v[194:195], v[50:51]
 v_pk_mul_f32 v[198:199], v[198:199], v[50:51]
 v_cvt_pk_bf16_f32 v40, v168, v172
 v_cvt_pk_bf16_f32 v41, v176, v180
 v_cvt_pk_bf16_f32 v42, v184, v188
 v_cvt_pk_bf16_f32 v43, v192, v196
 ds_write_b128 v16, v[40:43] offset:0
 ds_read_b64_tr_b16 v[24:25], v17 offset:0
 ds_read_b64_tr_b16 v[26:27], v17 offset:64
 v_cvt_pk_bf16_f32 v44, v169, v173
 v_cvt_pk_bf16_f32 v45, v177, v181
 v_cvt_pk_bf16_f32 v46, v185, v189
 v_cvt_pk_bf16_f32 v47, v193, v197
 ds_write_b128 v16, v[44:47] offset:272
 ds_read_b64_tr_b16 v[28:29], v17 offset:272
 ds_read_b64_tr_b16 v[30:31], v17 offset:336
 v_cvt_pk_bf16_f32 v40, v170, v174
 v_cvt_pk_bf16_f32 v41, v178, v182
 v_cvt_pk_bf16_f32 v42, v186, v190
 v_cvt_pk_bf16_f32 v43, v194, v198
 ds_write_b128 v16, v[40:43] offset:544
 ds_read_b64_tr_b16 v[32:33], v17 offset:544
 ds_read_b64_tr_b16 v[34:35], v17 offset:608
 v_cvt_pk_bf16_f32 v44, v171, v175
 v_cvt_pk_bf16_f32 v45, v179, v183
 v_cvt_pk_bf16_f32 v46, v187, v191
 v_cvt_pk_bf16_f32 v47, v195, v199
 ds_write_b128 v16, v[44:47] offset:816
 ds_read_b64_tr_b16 v[36:37], v17 offset:816
 ds_read_b64_tr_b16 v[38:39], v17 offset:880
 s_waitcnt lgkmcnt(9)
 buffer_store_dwordx4 v[24:27], v18, s[16:19], s30 offen offset:0 sc0 sc1
 s_waitcnt lgkmcnt(6)
 buffer_store_dwordx4 v[28:31], v18, s[16:19], s30 offen offset:256 sc0 sc1
 s_waitcnt lgkmcnt(3)
 buffer_store_dwordx4 v[32:35], v18, s[16:19], s30 offen offset:512 sc0 sc1
 s_waitcnt lgkmcnt(0)
 buffer_store_dwordx4 v[36:39], v18, s[16:19], s30 offen offset:768 sc0 sc1
 v_mfma_f32_16x16x4_f32 v[48:51], v6, v20, 0
 s_nop 9
 v_rcp_f32 v48, v48
 v_rcp_f32 v49, v49
 v_rcp_f32 v50, v50
 v_rcp_f32 v51, v51
 s_mov_b32 s30, 8192
 v_pk_mul_f32 v[200:201], v[200:201], v[48:49]
 v_pk_mul_f32 v[204:205], v[204:205], v[48:49]
 v_pk_mul_f32 v[208:209], v[208:209], v[48:49]
 v_pk_mul_f32 v[212:213], v[212:213], v[48:49]
 v_pk_mul_f32 v[216:217], v[216:217], v[48:49]
 v_pk_mul_f32 v[220:221], v[220:221], v[48:49]
 v_pk_mul_f32 v[224:225], v[224:225], v[48:49]
 v_pk_mul_f32 v[228:229], v[228:229], v[48:49]
 v_pk_mul_f32 v[202:203], v[202:203], v[50:51]
 v_pk_mul_f32 v[206:207], v[206:207], v[50:51]
 v_pk_mul_f32 v[210:211], v[210:211], v[50:51]
 v_pk_mul_f32 v[214:215], v[214:215], v[50:51]
 v_pk_mul_f32 v[218:219], v[218:219], v[50:51]
 v_pk_mul_f32 v[222:223], v[222:223], v[50:51]
 v_pk_mul_f32 v[226:227], v[226:227], v[50:51]
 v_pk_mul_f32 v[230:231], v[230:231], v[50:51]
 v_cvt_pk_bf16_f32 v40, v200, v204
 v_cvt_pk_bf16_f32 v41, v208, v212
 v_cvt_pk_bf16_f32 v42, v216, v220
 v_cvt_pk_bf16_f32 v43, v224, v228
 ds_write_b128 v16, v[40:43] offset:0
 ds_read_b64_tr_b16 v[24:25], v17 offset:0
 ds_read_b64_tr_b16 v[26:27], v17 offset:64
 v_cvt_pk_bf16_f32 v44, v201, v205
 v_cvt_pk_bf16_f32 v45, v209, v213
 v_cvt_pk_bf16_f32 v46, v217, v221
 v_cvt_pk_bf16_f32 v47, v225, v229
 ds_write_b128 v16, v[44:47] offset:272
 ds_read_b64_tr_b16 v[28:29], v17 offset:272
 ds_read_b64_tr_b16 v[30:31], v17 offset:336
 v_cvt_pk_bf16_f32 v40, v202, v206
 v_cvt_pk_bf16_f32 v41, v210, v214
 v_cvt_pk_bf16_f32 v42, v218, v222
 v_cvt_pk_bf16_f32 v43, v226, v230
 ds_write_b128 v16, v[40:43] offset:544
 ds_read_b64_tr_b16 v[32:33], v17 offset:544
 ds_read_b64_tr_b16 v[34:35], v17 offset:608
 v_cvt_pk_bf16_f32 v44, v203, v207
 v_cvt_pk_bf16_f32 v45, v211, v215
 v_cvt_pk_bf16_f32 v46, v219, v223
 v_cvt_pk_bf16_f32 v47, v227, v231
 ds_write_b128 v16, v[44:47] offset:816
 ds_read_b64_tr_b16 v[36:37], v17 offset:816
 ds_read_b64_tr_b16 v[38:39], v17 offset:880
 s_waitcnt lgkmcnt(9)
 buffer_store_dwordx4 v[24:27], v18, s[16:19], s30 offen offset:0 sc0 sc1
 s_waitcnt lgkmcnt(6)
 buffer_store_dwordx4 v[28:31], v18, s[16:19], s30 offen offset:256 sc0 sc1
 s_waitcnt lgkmcnt(3)
 buffer_store_dwordx4 v[32:35], v18, s[16:19], s30 offen offset:512 sc0 sc1
 s_waitcnt lgkmcnt(0)
 buffer_store_dwordx4 v[36:39], v18, s[16:19], s30 offen offset:768 sc0 sc1
 v_mfma_f32_16x16x4_f32 v[48:51], v7, v20, 0
 s_nop 9
 v_rcp_f32 v48, v48
 v_rcp_f32 v49, v49
 v_rcp_f32 v50, v50
 v_rcp_f32 v51, v51
 v_accvgpr_read_b32 v224, a152
 v_accvgpr_read_b32 v225, a153
 v_accvgpr_read_b32 v226, a154
 v_accvgpr_read_b32 v227, a155
 v_accvgpr_read_b32 v228, a156
 v_accvgpr_read_b32 v229, a157
 v_accvgpr_read_b32 v230, a158
 v_accvgpr_read_b32 v231, a159
 s_mov_b32 s30, 12288
 v_pk_mul_f32 v[232:233], v[232:233], v[48:49]
 v_pk_mul_f32 v[236:237], v[236:237], v[48:49]
 v_pk_mul_f32 v[240:241], v[240:241], v[48:49]
 v_pk_mul_f32 v[244:245], v[244:245], v[48:49]
 v_pk_mul_f32 v[248:249], v[248:249], v[48:49]
 v_pk_mul_f32 v[252:253], v[252:253], v[48:49]
 v_pk_mul_f32 v[224:225], v[224:225], v[48:49]
 v_pk_mul_f32 v[228:229], v[228:229], v[48:49]
 v_pk_mul_f32 v[234:235], v[234:235], v[50:51]
 v_pk_mul_f32 v[238:239], v[238:239], v[50:51]
 v_pk_mul_f32 v[242:243], v[242:243], v[50:51]
 v_pk_mul_f32 v[246:247], v[246:247], v[50:51]
 v_pk_mul_f32 v[250:251], v[250:251], v[50:51]
 v_pk_mul_f32 v[254:255], v[254:255], v[50:51]
 v_pk_mul_f32 v[226:227], v[226:227], v[50:51]
 v_pk_mul_f32 v[230:231], v[230:231], v[50:51]
 v_cvt_pk_bf16_f32 v40, v232, v236
 v_cvt_pk_bf16_f32 v41, v240, v244
 v_cvt_pk_bf16_f32 v42, v248, v252
 v_cvt_pk_bf16_f32 v43, v224, v228
 ds_write_b128 v16, v[40:43] offset:0
 ds_read_b64_tr_b16 v[24:25], v17 offset:0
 ds_read_b64_tr_b16 v[26:27], v17 offset:64
 v_cvt_pk_bf16_f32 v44, v233, v237
 v_cvt_pk_bf16_f32 v45, v241, v245
 v_cvt_pk_bf16_f32 v46, v249, v253
 v_cvt_pk_bf16_f32 v47, v225, v229
 ds_write_b128 v16, v[44:47] offset:272
 ds_read_b64_tr_b16 v[28:29], v17 offset:272
 ds_read_b64_tr_b16 v[30:31], v17 offset:336
 v_cvt_pk_bf16_f32 v40, v234, v238
 v_cvt_pk_bf16_f32 v41, v242, v246
 v_cvt_pk_bf16_f32 v42, v250, v254
 v_cvt_pk_bf16_f32 v43, v226, v230
 ds_write_b128 v16, v[40:43] offset:544
 ds_read_b64_tr_b16 v[32:33], v17 offset:544
 ds_read_b64_tr_b16 v[34:35], v17 offset:608
 v_cvt_pk_bf16_f32 v44, v235, v239
 v_cvt_pk_bf16_f32 v45, v243, v247
 v_cvt_pk_bf16_f32 v46, v251, v255
 v_cvt_pk_bf16_f32 v47, v227, v231
 ds_write_b128 v16, v[44:47] offset:816
 ds_read_b64_tr_b16 v[36:37], v17 offset:816
 ds_read_b64_tr_b16 v[38:39], v17 offset:880
 s_waitcnt lgkmcnt(9)
 buffer_store_dwordx4 v[24:27], v18, s[16:19], s30 offen offset:0 sc0 sc1
 s_waitcnt lgkmcnt(6)
 buffer_store_dwordx4 v[28:31], v18, s[16:19], s30 offen offset:256 sc0 sc1
 s_waitcnt lgkmcnt(3)
 buffer_store_dwordx4 v[32:35], v18, s[16:19], s30 offen offset:512 sc0 sc1
 s_waitcnt lgkmcnt(0)
 buffer_store_dwordx4 v[36:39], v18, s[16:19], s30 offen offset:768 sc0 sc1
 v_mfma_f32_16x16x4_f32 v[48:51], v8, v20, 0
 s_nop 9
 v_rcp_f32 v48, v48
 v_rcp_f32 v49, v49
 v_rcp_f32 v50, v50
 v_rcp_f32 v51, v51
 v_accvgpr_read_b32 v200, a160
 v_accvgpr_read_b32 v201, a161
 v_accvgpr_read_b32 v202, a162
 v_accvgpr_read_b32 v203, a163
 v_accvgpr_read_b32 v204, a164
 v_accvgpr_read_b32 v205, a165
 v_accvgpr_read_b32 v206, a166
 v_accvgpr_read_b32 v207, a167
 v_accvgpr_read_b32 v208, a168
 v_accvgpr_read_b32 v209, a169
 v_accvgpr_read_b32 v210, a170
 v_accvgpr_read_b32 v211, a171
 v_accvgpr_read_b32 v212, a172
 v_accvgpr_read_b32 v213, a173
 v_accvgpr_read_b32 v214, a174
 v_accvgpr_read_b32 v215, a175
 v_accvgpr_read_b32 v216, a176
 v_accvgpr_read_b32 v217, a177
 v_accvgpr_read_b32 v218, a178
 v_accvgpr_read_b32 v219, a179
 v_accvgpr_read_b32 v220, a180
 v_accvgpr_read_b32 v221, a181
 v_accvgpr_read_b32 v222, a182
 v_accvgpr_read_b32 v223, a183
 v_accvgpr_read_b32 v224, a184
 v_accvgpr_read_b32 v225, a185
 v_accvgpr_read_b32 v226, a186
 v_accvgpr_read_b32 v227, a187
 v_accvgpr_read_b32 v228, a188
 v_accvgpr_read_b32 v229, a189
 v_accvgpr_read_b32 v230, a190
 v_accvgpr_read_b32 v231, a191
 s_mov_b32 s30, 16384
 v_pk_mul_f32 v[200:201], v[200:201], v[48:49]
 v_pk_mul_f32 v[204:205], v[204:205], v[48:49]
 v_pk_mul_f32 v[208:209], v[208:209], v[48:49]
 v_pk_mul_f32 v[212:213], v[212:213], v[48:49]
 v_pk_mul_f32 v[216:217], v[216:217], v[48:49]
 v_pk_mul_f32 v[220:221], v[220:221], v[48:49]
 v_pk_mul_f32 v[224:225], v[224:225], v[48:49]
 v_pk_mul_f32 v[228:229], v[228:229], v[48:49]
 v_pk_mul_f32 v[202:203], v[202:203], v[50:51]
 v_pk_mul_f32 v[206:207], v[206:207], v[50:51]
 v_pk_mul_f32 v[210:211], v[210:211], v[50:51]
 v_pk_mul_f32 v[214:215], v[214:215], v[50:51]
 v_pk_mul_f32 v[218:219], v[218:219], v[50:51]
 v_pk_mul_f32 v[222:223], v[222:223], v[50:51]
 v_pk_mul_f32 v[226:227], v[226:227], v[50:51]
 v_pk_mul_f32 v[230:231], v[230:231], v[50:51]
 v_cvt_pk_bf16_f32 v40, v200, v204
 v_cvt_pk_bf16_f32 v41, v208, v212
 v_cvt_pk_bf16_f32 v42, v216, v220
 v_cvt_pk_bf16_f32 v43, v224, v228
 ds_write_b128 v16, v[40:43] offset:0
 ds_read_b64_tr_b16 v[24:25], v17 offset:0
 ds_read_b64_tr_b16 v[26:27], v17 offset:64
 v_cvt_pk_bf16_f32 v44, v201, v205
 v_cvt_pk_bf16_f32 v45, v209, v213
 v_cvt_pk_bf16_f32 v46, v217, v221
 v_cvt_pk_bf16_f32 v47, v225, v229
 ds_write_b128 v16, v[44:47] offset:272
 ds_read_b64_tr_b16 v[28:29], v17 offset:272
 ds_read_b64_tr_b16 v[30:31], v17 offset:336
 v_cvt_pk_bf16_f32 v40, v202, v206
 v_cvt_pk_bf16_f32 v41, v210, v214
 v_cvt_pk_bf16_f32 v42, v218, v222
 v_cvt_pk_bf16_f32 v43, v226, v230
 ds_write_b128 v16, v[40:43] offset:544
 ds_read_b64_tr_b16 v[32:33], v17 offset:544
 ds_read_b64_tr_b16 v[34:35], v17 offset:608
 v_cvt_pk_bf16_f32 v44, v203, v207
 v_cvt_pk_bf16_f32 v45, v211, v215
 v_cvt_pk_bf16_f32 v46, v219, v223
 v_cvt_pk_bf16_f32 v47, v227, v231
 ds_write_b128 v16, v[44:47] offset:816
 ds_read_b64_tr_b16 v[36:37], v17 offset:816
 ds_read_b64_tr_b16 v[38:39], v17 offset:880
 s_waitcnt lgkmcnt(9)
 buffer_store_dwordx4 v[24:27], v18, s[16:19], s30 offen offset:0 sc0 sc1
 s_waitcnt lgkmcnt(6)
 buffer_store_dwordx4 v[28:31], v18, s[16:19], s30 offen offset:256 sc0 sc1
 s_waitcnt lgkmcnt(3)
 buffer_store_dwordx4 v[32:35], v18, s[16:19], s30 offen offset:512 sc0 sc1
 s_waitcnt lgkmcnt(0)
 buffer_store_dwordx4 v[36:39], v18, s[16:19], s30 offen offset:768 sc0 sc1
 v_mfma_f32_16x16x4_f32 v[48:51], v9, v20, 0
 s_nop 9
 v_rcp_f32 v48, v48
 v_rcp_f32 v49, v49
 v_rcp_f32 v50, v50
 v_rcp_f32 v51, v51
 v_accvgpr_read_b32 v200, a192
 v_accvgpr_read_b32 v201, a193
 v_accvgpr_read_b32 v202, a194
 v_accvgpr_read_b32 v203, a195
 v_accvgpr_read_b32 v204, a196
 v_accvgpr_read_b32 v205, a197
 v_accvgpr_read_b32 v206, a198
 v_accvgpr_read_b32 v207, a199
 v_accvgpr_read_b32 v208, a200
 v_accvgpr_read_b32 v209, a201
 v_accvgpr_read_b32 v210, a202
 v_accvgpr_read_b32 v211, a203
 v_accvgpr_read_b32 v212, a204
 v_accvgpr_read_b32 v213, a205
 v_accvgpr_read_b32 v214, a206
 v_accvgpr_read_b32 v215, a207
 v_accvgpr_read_b32 v216, a208
 v_accvgpr_read_b32 v217, a209
 v_accvgpr_read_b32 v218, a210
 v_accvgpr_read_b32 v219, a211
 v_accvgpr_read_b32 v220, a212
 v_accvgpr_read_b32 v221, a213
 v_accvgpr_read_b32 v222, a214
 v_accvgpr_read_b32 v223, a215
 v_accvgpr_read_b32 v224, a216
 v_accvgpr_read_b32 v225, a217
 v_accvgpr_read_b32 v226, a218
 v_accvgpr_read_b32 v227, a219
 v_accvgpr_read_b32 v228, a220
 v_accvgpr_read_b32 v229, a221
 v_accvgpr_read_b32 v230, a222
 v_accvgpr_read_b32 v231, a223
 s_mov_b32 s30, 20480
 v_pk_mul_f32 v[200:201], v[200:201], v[48:49]
 v_pk_mul_f32 v[204:205], v[204:205], v[48:49]
 v_pk_mul_f32 v[208:209], v[208:209], v[48:49]
 v_pk_mul_f32 v[212:213], v[212:213], v[48:49]
 v_pk_mul_f32 v[216:217], v[216:217], v[48:49]
 v_pk_mul_f32 v[220:221], v[220:221], v[48:49]
 v_pk_mul_f32 v[224:225], v[224:225], v[48:49]
 v_pk_mul_f32 v[228:229], v[228:229], v[48:49]
 v_pk_mul_f32 v[202:203], v[202:203], v[50:51]
 v_pk_mul_f32 v[206:207], v[206:207], v[50:51]
 v_pk_mul_f32 v[210:211], v[210:211], v[50:51]
 v_pk_mul_f32 v[214:215], v[214:215], v[50:51]
 v_pk_mul_f32 v[218:219], v[218:219], v[50:51]
 v_pk_mul_f32 v[222:223], v[222:223], v[50:51]
 v_pk_mul_f32 v[226:227], v[226:227], v[50:51]
 v_pk_mul_f32 v[230:231], v[230:231], v[50:51]
 v_cvt_pk_bf16_f32 v40, v200, v204
 v_cvt_pk_bf16_f32 v41, v208, v212
 v_cvt_pk_bf16_f32 v42, v216, v220
 v_cvt_pk_bf16_f32 v43, v224, v228
 ds_write_b128 v16, v[40:43] offset:0
 ds_read_b64_tr_b16 v[24:25], v17 offset:0
 ds_read_b64_tr_b16 v[26:27], v17 offset:64
 v_cvt_pk_bf16_f32 v44, v201, v205
 v_cvt_pk_bf16_f32 v45, v209, v213
 v_cvt_pk_bf16_f32 v46, v217, v221
 v_cvt_pk_bf16_f32 v47, v225, v229
 ds_write_b128 v16, v[44:47] offset:272
 ds_read_b64_tr_b16 v[28:29], v17 offset:272
 ds_read_b64_tr_b16 v[30:31], v17 offset:336
 v_cvt_pk_bf16_f32 v40, v202, v206
 v_cvt_pk_bf16_f32 v41, v210, v214
 v_cvt_pk_bf16_f32 v42, v218, v222
 v_cvt_pk_bf16_f32 v43, v226, v230
 ds_write_b128 v16, v[40:43] offset:544
 ds_read_b64_tr_b16 v[32:33], v17 offset:544
 ds_read_b64_tr_b16 v[34:35], v17 offset:608
 v_cvt_pk_bf16_f32 v44, v203, v207
 v_cvt_pk_bf16_f32 v45, v211, v215
 v_cvt_pk_bf16_f32 v46, v219, v223
 v_cvt_pk_bf16_f32 v47, v227, v231
 ds_write_b128 v16, v[44:47] offset:816
 ds_read_b64_tr_b16 v[36:37], v17 offset:816
 ds_read_b64_tr_b16 v[38:39], v17 offset:880
 s_waitcnt lgkmcnt(9)
 buffer_store_dwordx4 v[24:27], v18, s[16:19], s30 offen offset:0 sc0 sc1
 s_waitcnt lgkmcnt(6)
 buffer_store_dwordx4 v[28:31], v18, s[16:19], s30 offen offset:256 sc0 sc1
 s_waitcnt lgkmcnt(3)
 buffer_store_dwordx4 v[32:35], v18, s[16:19], s30 offen offset:512 sc0 sc1
 s_waitcnt lgkmcnt(0)
 buffer_store_dwordx4 v[36:39], v18, s[16:19], s30 offen offset:768 sc0 sc1
 v_mfma_f32_16x16x4_f32 v[48:51], v10, v20, 0
 s_nop 9
 v_rcp_f32 v48, v48
 v_rcp_f32 v49, v49
 v_rcp_f32 v50, v50
 v_rcp_f32 v51, v51
 v_accvgpr_read_b32 v200, a224
 v_accvgpr_read_b32 v201, a225
 v_accvgpr_read_b32 v202, a226
 v_accvgpr_read_b32 v203, a227
 v_accvgpr_read_b32 v204, a228
 v_accvgpr_read_b32 v205, a229
 v_accvgpr_read_b32 v206, a230
 v_accvgpr_read_b32 v207, a231
 v_accvgpr_read_b32 v208, a232
 v_accvgpr_read_b32 v209, a233
 v_accvgpr_read_b32 v210, a234
 v_accvgpr_read_b32 v211, a235
 v_accvgpr_read_b32 v212, a236
 v_accvgpr_read_b32 v213, a237
 v_accvgpr_read_b32 v214, a238
 v_accvgpr_read_b32 v215, a239
 v_accvgpr_read_b32 v216, a240
 v_accvgpr_read_b32 v217, a241
 v_accvgpr_read_b32 v218, a242
 v_accvgpr_read_b32 v219, a243
 v_accvgpr_read_b32 v220, a244
 v_accvgpr_read_b32 v221, a245
 v_accvgpr_read_b32 v222, a246
 v_accvgpr_read_b32 v223, a247
 v_accvgpr_read_b32 v224, a248
 v_accvgpr_read_b32 v225, a249
 v_accvgpr_read_b32 v226, a250
 v_accvgpr_read_b32 v227, a251
 v_accvgpr_read_b32 v228, a252
 v_accvgpr_read_b32 v229, a253
 v_accvgpr_read_b32 v230, a254
 v_accvgpr_read_b32 v231, a255
 s_mov_b32 s30, 24576
 v_pk_mul_f32 v[200:201], v[200:201], v[48:49]
 v_pk_mul_f32 v[204:205], v[204:205], v[48:49]
 v_pk_mul_f32 v[208:209], v[208:209], v[48:49]
 v_pk_mul_f32 v[212:213], v[212:213], v[48:49]
 v_pk_mul_f32 v[216:217], v[216:217], v[48:49]
 v_pk_mul_f32 v[220:221], v[220:221], v[48:49]
 v_pk_mul_f32 v[224:225], v[224:225], v[48:49]
 v_pk_mul_f32 v[228:229], v[228:229], v[48:49]
 v_pk_mul_f32 v[202:203], v[202:203], v[50:51]
 v_pk_mul_f32 v[206:207], v[206:207], v[50:51]
 v_pk_mul_f32 v[210:211], v[210:211], v[50:51]
 v_pk_mul_f32 v[214:215], v[214:215], v[50:51]
 v_pk_mul_f32 v[218:219], v[218:219], v[50:51]
 v_pk_mul_f32 v[222:223], v[222:223], v[50:51]
 v_pk_mul_f32 v[226:227], v[226:227], v[50:51]
 v_pk_mul_f32 v[230:231], v[230:231], v[50:51]
 v_cvt_pk_bf16_f32 v40, v200, v204
 v_cvt_pk_bf16_f32 v41, v208, v212
 v_cvt_pk_bf16_f32 v42, v216, v220
 v_cvt_pk_bf16_f32 v43, v224, v228
 ds_write_b128 v16, v[40:43] offset:0
 ds_read_b64_tr_b16 v[24:25], v17 offset:0
 ds_read_b64_tr_b16 v[26:27], v17 offset:64
 v_cvt_pk_bf16_f32 v44, v201, v205
 v_cvt_pk_bf16_f32 v45, v209, v213
 v_cvt_pk_bf16_f32 v46, v217, v221
 v_cvt_pk_bf16_f32 v47, v225, v229
 ds_write_b128 v16, v[44:47] offset:272
 ds_read_b64_tr_b16 v[28:29], v17 offset:272
 ds_read_b64_tr_b16 v[30:31], v17 offset:336
 v_cvt_pk_bf16_f32 v40, v202, v206
 v_cvt_pk_bf16_f32 v41, v210, v214
 v_cvt_pk_bf16_f32 v42, v218, v222
 v_cvt_pk_bf16_f32 v43, v226, v230
 ds_write_b128 v16, v[40:43] offset:544
 ds_read_b64_tr_b16 v[32:33], v17 offset:544
 ds_read_b64_tr_b16 v[34:35], v17 offset:608
 v_cvt_pk_bf16_f32 v44, v203, v207
 v_cvt_pk_bf16_f32 v45, v211, v215
 v_cvt_pk_bf16_f32 v46, v219, v223
 v_cvt_pk_bf16_f32 v47, v227, v231
 ds_write_b128 v16, v[44:47] offset:816
 ds_read_b64_tr_b16 v[36:37], v17 offset:816
 ds_read_b64_tr_b16 v[38:39], v17 offset:880
 s_waitcnt lgkmcnt(9)
 buffer_store_dwordx4 v[24:27], v18, s[16:19], s30 offen offset:0 sc0 sc1
 s_waitcnt lgkmcnt(6)
 buffer_store_dwordx4 v[28:31], v18, s[16:19], s30 offen offset:256 sc0 sc1
 s_waitcnt lgkmcnt(3)
 buffer_store_dwordx4 v[32:35], v18, s[16:19], s30 offen offset:512 sc0 sc1
 s_waitcnt lgkmcnt(0)
 buffer_store_dwordx4 v[36:39], v18, s[16:19], s30 offen offset:768 sc0 sc1
 s_endpgm
L_slow_6:
 v_mbcnt_lo_u32_b32 v108, -1, 0
 v_mbcnt_hi_u32_b32 v108, -1, v108
 v_bfe_u32 v109, v108, 2, 3
 v_lshlrev_b32 v3, 8, v109
 v_lshrrev_b32 v109, 5, v108
 v_lshl_add_u32 v3, v109, 6, v3
 v_lshrrev_b32 v109, 3, v108
 v_and_b32 v109, 2, v109
 v_and_b32 v110, 3, v108
 v_xor_b32 v109, v109, v110
 v_lshl_add_u32 v3, v109, 4, v3
 v_and_b32 v107, 15, v108
 v_lshrrev_b32 v108, 4, v108
 v_lshlrev_b32 v107, 8, v107
 v_lshl_add_u32 v107, v108, 4, v107
 v_mov_b32 v100, 0xff800000
 v_mov_b32 v101, 0xff800000
 v_mov_b32 v102, 0xff800000
 v_mov_b32 v103, 0xff800000
 v_mov_b32 v104, 0xff800000
 v_mov_b32 v105, 0xff800000
 s_mov_b32 s30, 0
 s_waitcnt vmcnt(0)
L_fa_6:
 buffer_load_dwordx4 v[24:27], v107, s[8:11], s30 offen offset:0
 buffer_load_dwordx4 v[28:31], v107, s[8:11], s30 offen offset:64
 buffer_load_dwordx4 v[32:35], v107, s[8:11], s30 offen offset:128
 buffer_load_dwordx4 v[36:39], v107, s[8:11], s30 offen offset:192
 s_waitcnt vmcnt(0)
 v_mfma_f32_16x16x32_bf16 v[56:59], v[24:27], a[0:3], 0
 v_mfma_f32_16x16x32_bf16 v[56:59], v[28:31], a[4:7], v[56:59]
 v_mfma_f32_16x16x32_bf16 v[56:59], v[32:35], a[8:11], v[56:59]
 v_mfma_f32_16x16x32_bf16 v[56:59], v[36:39], a[12:15], v[56:59]
 v_mfma_f32_16x16x32_bf16 v[60:63], v[24:27], a[16:19], 0
 v_mfma_f32_16x16x32_bf16 v[60:63], v[28:31], a[20:23], v[60:63]
 v_mfma_f32_16x16x32_bf16 v[60:63], v[32:35], a[24:27], v[60:63]
 v_mfma_f32_16x16x32_bf16 v[60:63], v[36:39], a[28:31], v[60:63]
 v_mfma_f32_16x16x32_bf16 v[64:67], v[24:27], a[32:35], 0
 v_mfma_f32_16x16x32_bf16 v[64:67], v[28:31], a[36:39], v[64:67]
 v_mfma_f32_16x16x32_bf16 v[64:67], v[32:35], a[40:43], v[64:67]
 v_mfma_f32_16x16x32_bf16 v[64:67], v[36:39], a[44:47], v[64:67]
 v_mfma_f32_16x16x32_bf16 v[68:71], v[24:27], a[48:51], 0
 v_mfma_f32_16x16x32_bf16 v[68:71], v[28:31], a[52:55], v[68:71]
 v_mfma_f32_16x16x32_bf16 v[68:71], v[32:35], a[56:59], v[68:71]
 v_mfma_f32_16x16x32_bf16 v[68:71], v[36:39], a[60:63], v[68:71]
 v_mfma_f32_16x16x32_bf16 v[72:75], v[24:27], a[64:67], 0
 v_mfma_f32_16x16x32_bf16 v[72:75], v[28:31], a[68:71], v[72:75]
 v_mfma_f32_16x16x32_bf16 v[72:75], v[32:35], a[72:75], v[72:75]
 v_mfma_f32_16x16x32_bf16 v[72:75], v[36:39], a[76:79], v[72:75]
 v_mfma_f32_16x16x32_bf16 v[76:79], v[24:27], a[80:83], 0
 v_mfma_f32_16x16x32_bf16 v[76:79], v[28:31], a[84:87], v[76:79]
 v_mfma_f32_16x16x32_bf16 v[76:79], v[32:35], a[88:91], v[76:79]
 v_mfma_f32_16x16x32_bf16 v[76:79], v[36:39], a[92:95], v[76:79]
 s_nop 7
 v_max3_f32 v100, v100, v56, v57
 v_max3_f32 v100, v100, v58, v59
 v_max3_f32 v101, v101, v60, v61
 v_max3_f32 v101, v101, v62, v63
 v_max3_f32 v102, v102, v64, v65
 v_max3_f32 v102, v102, v66, v67
 v_max3_f32 v103, v103, v68, v69
 v_max3_f32 v103, v103, v70, v71
 v_max3_f32 v104, v104, v72, v73
 v_max3_f32 v104, v104, v74, v75
 v_max3_f32 v105, v105, v76, v77
 v_max3_f32 v105, v105, v78, v79
 s_add_u32 s30, s30, 4096
 s_cmp_lt_u32 s30, 0x80000
 s_cbranch_scc1 L_fa_6
 v_mov_b32 v11, v100
 s_nop 1
 v_permlane32_swap_b32 v100, v11
 s_nop 0
 v_max_f32 v100, v100, v11
 v_mov_b32 v11, v100
 s_nop 1
 v_permlane16_swap_b32 v100, v11
 s_nop 0
 v_max_f32 v100, v100, v11
 v_mov_b32 v4, 0
 v_mov_b32 v136, 0
 v_mov_b32 v137, 0
 v_mov_b32 v138, 0
 v_mov_b32 v139, 0
 v_mov_b32 v140, 0
 v_mov_b32 v141, 0
 v_mov_b32 v142, 0
 v_mov_b32 v143, 0
 v_mov_b32 v144, 0
 v_mov_b32 v145, 0
 v_mov_b32 v146, 0
 v_mov_b32 v147, 0
 v_mov_b32 v148, 0
 v_mov_b32 v149, 0
 v_mov_b32 v150, 0
 v_mov_b32 v151, 0
 v_mov_b32 v152, 0
 v_mov_b32 v153, 0
 v_mov_b32 v154, 0
 v_mov_b32 v155, 0
 v_mov_b32 v156, 0
 v_mov_b32 v157, 0
 v_mov_b32 v158, 0
 v_mov_b32 v159, 0
 v_mov_b32 v160, 0
 v_mov_b32 v161, 0
 v_mov_b32 v162, 0
 v_mov_b32 v163, 0
 v_mov_b32 v164, 0
 v_mov_b32 v165, 0
 v_mov_b32 v166, 0
 v_mov_b32 v167, 0
 v_mov_b32 v11, v101
 s_nop 1
 v_permlane32_swap_b32 v101, v11
 s_nop 0
 v_max_f32 v101, v101, v11
 v_mov_b32 v11, v101
 s_nop 1
 v_permlane16_swap_b32 v101, v11
 s_nop 0
 v_max_f32 v101, v101, v11
 v_mov_b32 v5, 0
 v_mov_b32 v168, 0
 v_mov_b32 v169, 0
 v_mov_b32 v170, 0
 v_mov_b32 v171, 0
 v_mov_b32 v172, 0
 v_mov_b32 v173, 0
 v_mov_b32 v174, 0
 v_mov_b32 v175, 0
 v_mov_b32 v176, 0
 v_mov_b32 v177, 0
 v_mov_b32 v178, 0
 v_mov_b32 v179, 0
 v_mov_b32 v180, 0
 v_mov_b32 v181, 0
 v_mov_b32 v182, 0
 v_mov_b32 v183, 0
 v_mov_b32 v184, 0
 v_mov_b32 v185, 0
 v_mov_b32 v186, 0
 v_mov_b32 v187, 0
 v_mov_b32 v188, 0
 v_mov_b32 v189, 0
 v_mov_b32 v190, 0
 v_mov_b32 v191, 0
 v_mov_b32 v192, 0
 v_mov_b32 v193, 0
 v_mov_b32 v194, 0
 v_mov_b32 v195, 0
 v_mov_b32 v196, 0
 v_mov_b32 v197, 0
 v_mov_b32 v198, 0
 v_mov_b32 v199, 0
 v_mov_b32 v11, v102
 s_nop 1
 v_permlane32_swap_b32 v102, v11
 s_nop 0
 v_max_f32 v102, v102, v11
 v_mov_b32 v11, v102
 s_nop 1
 v_permlane16_swap_b32 v102, v11
 s_nop 0
 v_max_f32 v102, v102, v11
 v_mov_b32 v6, 0
 v_mov_b32 v200, 0
 v_mov_b32 v201, 0
 v_mov_b32 v202, 0
 v_mov_b32 v203, 0
 v_mov_b32 v204, 0
 v_mov_b32 v205, 0
 v_mov_b32 v206, 0
 v_mov_b32 v207, 0
 v_mov_b32 v208, 0
 v_mov_b32 v209, 0
 v_mov_b32 v210, 0
 v_mov_b32 v211, 0
 v_mov_b32 v212, 0
 v_mov_b32 v213, 0
 v_mov_b32 v214, 0
 v_mov_b32 v215, 0
 v_mov_b32 v216, 0
 v_mov_b32 v217, 0
 v_mov_b32 v218, 0
 v_mov_b32 v219, 0
 v_mov_b32 v220, 0
 v_mov_b32 v221, 0
 v_mov_b32 v222, 0
 v_mov_b32 v223, 0
 v_mov_b32 v224, 0
 v_mov_b32 v225, 0
 v_mov_b32 v226, 0
 v_mov_b32 v227, 0
 v_mov_b32 v228, 0
 v_mov_b32 v229, 0
 v_mov_b32 v230, 0
 v_mov_b32 v231, 0
 v_mov_b32 v11, v103
 s_nop 1
 v_permlane32_swap_b32 v103, v11
 s_nop 0
 v_max_f32 v103, v103, v11
 v_mov_b32 v11, v103
 s_nop 1
 v_permlane16_swap_b32 v103, v11
 s_nop 0
 v_max_f32 v103, v103, v11
 v_mov_b32 v7, 0
 v_mov_b32 v232, 0
 v_mov_b32 v233, 0
 v_mov_b32 v234, 0
 v_mov_b32 v235, 0
 v_mov_b32 v236, 0
 v_mov_b32 v237, 0
 v_mov_b32 v238, 0
 v_mov_b32 v239, 0
 v_mov_b32 v240, 0
 v_mov_b32 v241, 0
 v_mov_b32 v242, 0
 v_mov_b32 v243, 0
 v_mov_b32 v244, 0
 v_mov_b32 v245, 0
 v_mov_b32 v246, 0
 v_mov_b32 v247, 0
 v_mov_b32 v248, 0
 v_mov_b32 v249, 0
 v_mov_b32 v250, 0
 v_mov_b32 v251, 0
 v_mov_b32 v252, 0
 v_mov_b32 v253, 0
 v_mov_b32 v254, 0
 v_mov_b32 v255, 0
 v_accvgpr_write_b32 a152, 0
 v_accvgpr_write_b32 a153, 0
 v_accvgpr_write_b32 a154, 0
 v_accvgpr_write_b32 a155, 0
 v_accvgpr_write_b32 a156, 0
 v_accvgpr_write_b32 a157, 0
 v_accvgpr_write_b32 a158, 0
 v_accvgpr_write_b32 a159, 0
 v_mov_b32 v11, v104
 s_nop 1
 v_permlane32_swap_b32 v104, v11
 s_nop 0
 v_max_f32 v104, v104, v11
 v_mov_b32 v11, v104
 s_nop 1
 v_permlane16_swap_b32 v104, v11
 s_nop 0
 v_max_f32 v104, v104, v11
 v_mov_b32 v8, 0
 v_accvgpr_write_b32 a160, 0
 v_accvgpr_write_b32 a161, 0
 v_accvgpr_write_b32 a162, 0
 v_accvgpr_write_b32 a163, 0
 v_accvgpr_write_b32 a164, 0
 v_accvgpr_write_b32 a165, 0
 v_accvgpr_write_b32 a166, 0
 v_accvgpr_write_b32 a167, 0
 v_accvgpr_write_b32 a168, 0
 v_accvgpr_write_b32 a169, 0
 v_accvgpr_write_b32 a170, 0
 v_accvgpr_write_b32 a171, 0
 v_accvgpr_write_b32 a172, 0
 v_accvgpr_write_b32 a173, 0
 v_accvgpr_write_b32 a174, 0
 v_accvgpr_write_b32 a175, 0
 v_accvgpr_write_b32 a176, 0
 v_accvgpr_write_b32 a177, 0
 v_accvgpr_write_b32 a178, 0
 v_accvgpr_write_b32 a179, 0
 v_accvgpr_write_b32 a180, 0
 v_accvgpr_write_b32 a181, 0
 v_accvgpr_write_b32 a182, 0
 v_accvgpr_write_b32 a183, 0
 v_accvgpr_write_b32 a184, 0
 v_accvgpr_write_b32 a185, 0
 v_accvgpr_write_b32 a186, 0
 v_accvgpr_write_b32 a187, 0
 v_accvgpr_write_b32 a188, 0
 v_accvgpr_write_b32 a189, 0
 v_accvgpr_write_b32 a190, 0
 v_accvgpr_write_b32 a191, 0
 v_mov_b32 v11, v105
 s_nop 1
 v_permlane32_swap_b32 v105, v11
 s_nop 0
 v_max_f32 v105, v105, v11
 v_mov_b32 v11, v105
 s_nop 1
 v_permlane16_swap_b32 v105, v11
 s_nop 0
 v_max_f32 v105, v105, v11
 v_mov_b32 v9, 0
 v_accvgpr_write_b32 a192, 0
 v_accvgpr_write_b32 a193, 0
 v_accvgpr_write_b32 a194, 0
 v_accvgpr_write_b32 a195, 0
 v_accvgpr_write_b32 a196, 0
 v_accvgpr_write_b32 a197, 0
 v_accvgpr_write_b32 a198, 0
 v_accvgpr_write_b32 a199, 0
 v_accvgpr_write_b32 a200, 0
 v_accvgpr_write_b32 a201, 0
 v_accvgpr_write_b32 a202, 0
 v_accvgpr_write_b32 a203, 0
 v_accvgpr_write_b32 a204, 0
 v_accvgpr_write_b32 a205, 0
 v_accvgpr_write_b32 a206, 0
 v_accvgpr_write_b32 a207, 0
 v_accvgpr_write_b32 a208, 0
 v_accvgpr_write_b32 a209, 0
 v_accvgpr_write_b32 a210, 0
 v_accvgpr_write_b32 a211, 0
 v_accvgpr_write_b32 a212, 0
 v_accvgpr_write_b32 a213, 0
 v_accvgpr_write_b32 a214, 0
 v_accvgpr_write_b32 a215, 0
 v_accvgpr_write_b32 a216, 0
 v_accvgpr_write_b32 a217, 0
 v_accvgpr_write_b32 a218, 0
 v_accvgpr_write_b32 a219, 0
 v_accvgpr_write_b32 a220, 0
 v_accvgpr_write_b32 a221, 0
 v_accvgpr_write_b32 a222, 0
 v_accvgpr_write_b32 a223, 0
 s_mov_b32 s36, s28
L_fb_6:
 s_barrier
 s_add_u32 m0, s28, 0
 s_nop 0
 buffer_load_dwordx4 v3, s[8:11], s36 offen offset:0 lds
 s_add_u32 m0, s28, 896
 s_nop 0
 buffer_load_dwordx4 v3, s[8:11], s36 offen offset:128 lds
 s_add_u32 m0, s28, 65536
 s_nop 0
 buffer_load_dwordx4 v3, s[12:15], s36 offen offset:0 lds
 s_add_u32 m0, s28, 66432
 s_nop 0
 buffer_load_dwordx4 v3, s[12:15], s36 offen offset:128 lds
 s_waitcnt vmcnt(0)
 s_barrier
 ds_read_b128 v[24:27], v0 offset:0
 ds_read_b128 v[28:31], v0 offset:512
 ds_read_b128 v[32:35], v0 offset:1024
 ds_read_b128 v[36:39], v0 offset:1536
 ds_read_b128 v[40:43], v0 offset:4096
 ds_read_b128 v[44:47], v0 offset:4608
 ds_read_b128 v[48:51], v0 offset:5120
 ds_read_b128 v[52:55], v0 offset:5632
 s_waitcnt lgkmcnt(0)
 ds_read_b64_tr_b16 v[56:57], v1 offset:0
 ds_read_b64_tr_b16 v[58:59], v1 offset:4096
 ds_read_b64_tr_b16 v[60:61], v2 offset:0
 ds_read_b64_tr_b16 v[62:63], v2 offset:4096
 ds_read_b64_tr_b16 v[64:65], v1 offset:512
 ds_read_b64_tr_b16 v[66:67], v1 offset:4608
 ds_read_b64_tr_b16 v[68:69], v2 offset:512
 ds_read_b64_tr_b16 v[70:71], v2 offset:4608
 s_waitcnt lgkmcnt(0)
 ds_read_b64_tr_b16 v[72:73], v1 offset:1024
 ds_read_b64_tr_b16 v[74:75], v1 offset:5120
 ds_read_b64_tr_b16 v[76:77], v2 offset:1024
 ds_read_b64_tr_b16 v[78:79], v2 offset:5120
 ds_read_b64_tr_b16 v[80:81], v1 offset:1536
 ds_read_b64_tr_b16 v[82:83], v1 offset:5632
 ds_read_b64_tr_b16 v[84:85], v2 offset:1536
 ds_read_b64_tr_b16 v[86:87], v2 offset:5632
 s_waitcnt lgkmcnt(0)
 v_mfma_f32_16x16x32_bf16 v[88:91], v[24:27], a[0:3], 0
 v_mfma_f32_16x16x32_bf16 v[88:91], v[28:31], a[4:7], v[88:91]
 v_mfma_f32_16x16x32_bf16 v[88:91], v[32:35], a[8:11], v[88:91]
 v_mfma_f32_16x16x32_bf16 v[88:91], v[36:39], a[12:15], v[88:91]
 v_mfma_f32_16x16x32_bf16 v[92:95], v[40:43], a[0:3], 0
 v_mfma_f32_16x16x32_bf16 v[92:95], v[44:47], a[4:7], v[92:95]
 v_mfma_f32_16x16x32_bf16 v[92:95], v[48:51], a[8:11], v[92:95]
 v_mfma_f32_16x16x32_bf16 v[92:95], v[52:55], a[12:15], v[92:95]
 s_nop 7
 v_sub_f32 v88, v88, v100
 v_sub_f32 v89, v89, v100
 v_sub_f32 v90, v90, v100
 v_sub_f32 v91, v91, v100
 v_sub_f32 v92, v92, v100
 v_sub_f32 v93, v93, v100
 v_sub_f32 v94, v94, v100
 v_sub_f32 v95, v95, v100
 v_exp_f32 v88, v88
 v_exp_f32 v89, v89
 v_exp_f32 v90, v90
 v_exp_f32 v91, v91
 v_exp_f32 v92, v92
 v_exp_f32 v93, v93
 v_exp_f32 v94, v94
 v_exp_f32 v95, v95
 s_nop 0
 v_add_f32 v4, v88, v4
 v_add_f32 v4, v89, v4
 v_add_f32 v4, v90, v4
 v_add_f32 v4, v91, v4
 v_add_f32 v4, v92, v4
 v_add_f32 v4, v93, v4
 v_add_f32 v4, v94, v4
 v_add_f32 v4, v95, v4
 v_cvt_pk_bf16_f32 v96, v88, v89
 v_cvt_pk_bf16_f32 v97, v90, v91
 v_cvt_pk_bf16_f32 v98, v92, v93
 v_cvt_pk_bf16_f32 v99, v94, v95
 s_nop 1
 v_mfma_f32_16x16x32_bf16 v[136:139], v[96:99], v[56:59], v[136:139]
 v_mfma_f32_16x16x32_bf16 v[140:143], v[96:99], v[60:63], v[140:143]
 v_mfma_f32_16x16x32_bf16 v[144:147], v[96:99], v[64:67], v[144:147]
 v_mfma_f32_16x16x32_bf16 v[148:151], v[96:99], v[68:71], v[148:151]
 v_mfma_f32_16x16x32_bf16 v[152:155], v[96:99], v[72:75], v[152:155]
 v_mfma_f32_16x16x32_bf16 v[156:159], v[96:99], v[76:79], v[156:159]
 v_mfma_f32_16x16x32_bf16 v[160:163], v[96:99], v[80:83], v[160:163]
 v_mfma_f32_16x16x32_bf16 v[164:167], v[96:99], v[84:87], v[164:167]
 v_mfma_f32_16x16x32_bf16 v[88:91], v[24:27], a[16:19], 0
 v_mfma_f32_16x16x32_bf16 v[88:91], v[28:31], a[20:23], v[88:91]
 v_mfma_f32_16x16x32_bf16 v[88:91], v[32:35], a[24:27], v[88:91]
 v_mfma_f32_16x16x32_bf16 v[88:91], v[36:39], a[28:31], v[88:91]
 v_mfma_f32_16x16x32_bf16 v[92:95], v[40:43], a[16:19], 0
 v_mfma_f32_16x16x32_bf16 v[92:95], v[44:47], a[20:23], v[92:95]
 v_mfma_f32_16x16x32_bf16 v[92:95], v[48:51], a[24:27], v[92:95]
 v_mfma_f32_16x16x32_bf16 v[92:95], v[52:55], a[28:31], v[92:95]
 s_nop 7
 v_sub_f32 v88, v88, v101
 v_sub_f32 v89, v89, v101
 v_sub_f32 v90, v90, v101
 v_sub_f32 v91, v91, v101
 v_sub_f32 v92, v92, v101
 v_sub_f32 v93, v93, v101
 v_sub_f32 v94, v94, v101
 v_sub_f32 v95, v95, v101
 v_exp_f32 v88, v88
 v_exp_f32 v89, v89
 v_exp_f32 v90, v90
 v_exp_f32 v91, v91
 v_exp_f32 v92, v92
 v_exp_f32 v93, v93
 v_exp_f32 v94, v94
 v_exp_f32 v95, v95
 s_nop 0
 v_add_f32 v5, v88, v5
 v_add_f32 v5, v89, v5
 v_add_f32 v5, v90, v5
 v_add_f32 v5, v91, v5
 v_add_f32 v5, v92, v5
 v_add_f32 v5, v93, v5
 v_add_f32 v5, v94, v5
 v_add_f32 v5, v95, v5
 v_cvt_pk_bf16_f32 v96, v88, v89
 v_cvt_pk_bf16_f32 v97, v90, v91
 v_cvt_pk_bf16_f32 v98, v92, v93
 v_cvt_pk_bf16_f32 v99, v94, v95
 s_nop 1
 v_mfma_f32_16x16x32_bf16 v[168:171], v[96:99], v[56:59], v[168:171]
 v_mfma_f32_16x16x32_bf16 v[172:175], v[96:99], v[60:63], v[172:175]
 v_mfma_f32_16x16x32_bf16 v[176:179], v[96:99], v[64:67], v[176:179]
 v_mfma_f32_16x16x32_bf16 v[180:183], v[96:99], v[68:71], v[180:183]
 v_mfma_f32_16x16x32_bf16 v[184:187], v[96:99], v[72:75], v[184:187]
 v_mfma_f32_16x16x32_bf16 v[188:191], v[96:99], v[76:79], v[188:191]
 v_mfma_f32_16x16x32_bf16 v[192:195], v[96:99], v[80:83], v[192:195]
 v_mfma_f32_16x16x32_bf16 v[196:199], v[96:99], v[84:87], v[196:199]
 v_mfma_f32_16x16x32_bf16 v[88:91], v[24:27], a[32:35], 0
 v_mfma_f32_16x16x32_bf16 v[88:91], v[28:31], a[36:39], v[88:91]
 v_mfma_f32_16x16x32_bf16 v[88:91], v[32:35], a[40:43], v[88:91]
 v_mfma_f32_16x16x32_bf16 v[88:91], v[36:39], a[44:47], v[88:91]
 v_mfma_f32_16x16x32_bf16 v[92:95], v[40:43], a[32:35], 0
 v_mfma_f32_16x16x32_bf16 v[92:95], v[44:47], a[36:39], v[92:95]
 v_mfma_f32_16x16x32_bf16 v[92:95], v[48:51], a[40:43], v[92:95]
 v_mfma_f32_16x16x32_bf16 v[92:95], v[52:55], a[44:47], v[92:95]
 s_nop 7
 v_sub_f32 v88, v88, v102
 v_sub_f32 v89, v89, v102
 v_sub_f32 v90, v90, v102
 v_sub_f32 v91, v91, v102
 v_sub_f32 v92, v92, v102
 v_sub_f32 v93, v93, v102
 v_sub_f32 v94, v94, v102
 v_sub_f32 v95, v95, v102
 v_exp_f32 v88, v88
 v_exp_f32 v89, v89
 v_exp_f32 v90, v90
 v_exp_f32 v91, v91
 v_exp_f32 v92, v92
 v_exp_f32 v93, v93
 v_exp_f32 v94, v94
 v_exp_f32 v95, v95
 s_nop 0
 v_add_f32 v6, v88, v6
 v_add_f32 v6, v89, v6
 v_add_f32 v6, v90, v6
 v_add_f32 v6, v91, v6
 v_add_f32 v6, v92, v6
 v_add_f32 v6, v93, v6
 v_add_f32 v6, v94, v6
 v_add_f32 v6, v95, v6
 v_cvt_pk_bf16_f32 v96, v88, v89
 v_cvt_pk_bf16_f32 v97, v90, v91
 v_cvt_pk_bf16_f32 v98, v92, v93
 v_cvt_pk_bf16_f32 v99, v94, v95
 s_nop 1
 v_mfma_f32_16x16x32_bf16 v[200:203], v[96:99], v[56:59], v[200:203]
 v_mfma_f32_16x16x32_bf16 v[204:207], v[96:99], v[60:63], v[204:207]
 v_mfma_f32_16x16x32_bf16 v[208:211], v[96:99], v[64:67], v[208:211]
 v_mfma_f32_16x16x32_bf16 v[212:215], v[96:99], v[68:71], v[212:215]
 v_mfma_f32_16x16x32_bf16 v[216:219], v[96:99], v[72:75], v[216:219]
 v_mfma_f32_16x16x32_bf16 v[220:223], v[96:99], v[76:79], v[220:223]
 v_mfma_f32_16x16x32_bf16 v[224:227], v[96:99], v[80:83], v[224:227]
 v_mfma_f32_16x16x32_bf16 v[228:231], v[96:99], v[84:87], v[228:231]
 v_mfma_f32_16x16x32_bf16 v[88:91], v[24:27], a[48:51], 0
 v_mfma_f32_16x16x32_bf16 v[88:91], v[28:31], a[52:55], v[88:91]
 v_mfma_f32_16x16x32_bf16 v[88:91], v[32:35], a[56:59], v[88:91]
 v_mfma_f32_16x16x32_bf16 v[88:91], v[36:39], a[60:63], v[88:91]
 v_mfma_f32_16x16x32_bf16 v[92:95], v[40:43], a[48:51], 0
 v_mfma_f32_16x16x32_bf16 v[92:95], v[44:47], a[52:55], v[92:95]
 v_mfma_f32_16x16x32_bf16 v[92:95], v[48:51], a[56:59], v[92:95]
 v_mfma_f32_16x16x32_bf16 v[92:95], v[52:55], a[60:63], v[92:95]
 s_nop 7
 v_sub_f32 v88, v88, v103
 v_sub_f32 v89, v89, v103
 v_sub_f32 v90, v90, v103
 v_sub_f32 v91, v91, v103
 v_sub_f32 v92, v92, v103
 v_sub_f32 v93, v93, v103
 v_sub_f32 v94, v94, v103
 v_sub_f32 v95, v95, v103
 v_exp_f32 v88, v88
 v_exp_f32 v89, v89
 v_exp_f32 v90, v90
 v_exp_f32 v91, v91
 v_exp_f32 v92, v92
 v_exp_f32 v93, v93
 v_exp_f32 v94, v94
 v_exp_f32 v95, v95
 s_nop 0
 v_add_f32 v7, v88, v7
 v_add_f32 v7, v89, v7
 v_add_f32 v7, v90, v7
 v_add_f32 v7, v91, v7
 v_add_f32 v7, v92, v7
 v_add_f32 v7, v93, v7
 v_add_f32 v7, v94, v7
 v_add_f32 v7, v95, v7
 v_cvt_pk_bf16_f32 v96, v88, v89
 v_cvt_pk_bf16_f32 v97, v90, v91
 v_cvt_pk_bf16_f32 v98, v92, v93
 v_cvt_pk_bf16_f32 v99, v94, v95
 s_nop 1
 v_mfma_f32_16x16x32_bf16 v[232:235], v[96:99], v[56:59], v[232:235]
 v_mfma_f32_16x16x32_bf16 v[236:239], v[96:99], v[60:63], v[236:239]
 v_mfma_f32_16x16x32_bf16 v[240:243], v[96:99], v[64:67], v[240:243]
 v_mfma_f32_16x16x32_bf16 v[244:247], v[96:99], v[68:71], v[244:247]
 v_mfma_f32_16x16x32_bf16 v[248:251], v[96:99], v[72:75], v[248:251]
 v_mfma_f32_16x16x32_bf16 v[252:255], v[96:99], v[76:79], v[252:255]
 v_mfma_f32_16x16x32_bf16 a[152:155], v[96:99], v[80:83], a[152:155]
 v_mfma_f32_16x16x32_bf16 a[156:159], v[96:99], v[84:87], a[156:159]
 v_mfma_f32_16x16x32_bf16 v[88:91], v[24:27], a[64:67], 0
 v_mfma_f32_16x16x32_bf16 v[88:91], v[28:31], a[68:71], v[88:91]
 v_mfma_f32_16x16x32_bf16 v[88:91], v[32:35], a[72:75], v[88:91]
 v_mfma_f32_16x16x32_bf16 v[88:91], v[36:39], a[76:79], v[88:91]
 v_mfma_f32_16x16x32_bf16 v[92:95], v[40:43], a[64:67], 0
 v_mfma_f32_16x16x32_bf16 v[92:95], v[44:47], a[68:71], v[92:95]
 v_mfma_f32_16x16x32_bf16 v[92:95], v[48:51], a[72:75], v[92:95]
 v_mfma_f32_16x16x32_bf16 v[92:95], v[52:55], a[76:79], v[92:95]
 s_nop 7
 v_sub_f32 v88, v88, v104
 v_sub_f32 v89, v89, v104
 v_sub_f32 v90, v90, v104
 v_sub_f32 v91, v91, v104
 v_sub_f32 v92, v92, v104
 v_sub_f32 v93, v93, v104
 v_sub_f32 v94, v94, v104
 v_sub_f32 v95, v95, v104
 v_exp_f32 v88, v88
 v_exp_f32 v89, v89
 v_exp_f32 v90, v90
 v_exp_f32 v91, v91
 v_exp_f32 v92, v92
 v_exp_f32 v93, v93
 v_exp_f32 v94, v94
 v_exp_f32 v95, v95
 s_nop 0
 v_add_f32 v8, v88, v8
 v_add_f32 v8, v89, v8
 v_add_f32 v8, v90, v8
 v_add_f32 v8, v91, v8
 v_add_f32 v8, v92, v8
 v_add_f32 v8, v93, v8
 v_add_f32 v8, v94, v8
 v_add_f32 v8, v95, v8
 v_cvt_pk_bf16_f32 v96, v88, v89
 v_cvt_pk_bf16_f32 v97, v90, v91
 v_cvt_pk_bf16_f32 v98, v92, v93
 v_cvt_pk_bf16_f32 v99, v94, v95
 s_nop 1
 v_mfma_f32_16x16x32_bf16 a[160:163], v[96:99], v[56:59], a[160:163]
 v_mfma_f32_16x16x32_bf16 a[164:167], v[96:99], v[60:63], a[164:167]
 v_mfma_f32_16x16x32_bf16 a[168:171], v[96:99], v[64:67], a[168:171]
 v_mfma_f32_16x16x32_bf16 a[172:175], v[96:99], v[68:71], a[172:175]
 v_mfma_f32_16x16x32_bf16 a[176:179], v[96:99], v[72:75], a[176:179]
 v_mfma_f32_16x16x32_bf16 a[180:183], v[96:99], v[76:79], a[180:183]
 v_mfma_f32_16x16x32_bf16 a[184:187], v[96:99], v[80:83], a[184:187]
 v_mfma_f32_16x16x32_bf16 a[188:191], v[96:99], v[84:87], a[188:191]
 v_mfma_f32_16x16x32_bf16 v[88:91], v[24:27], a[80:83], 0
 v_mfma_f32_16x16x32_bf16 v[88:91], v[28:31], a[84:87], v[88:91]
 v_mfma_f32_16x16x32_bf16 v[88:91], v[32:35], a[88:91], v[88:91]
 v_mfma_f32_16x16x32_bf16 v[88:91], v[36:39], a[92:95], v[88:91]
 v_mfma_f32_16x16x32_bf16 v[92:95], v[40:43], a[80:83], 0
 v_mfma_f32_16x16x32_bf16 v[92:95], v[44:47], a[84:87], v[92:95]
 v_mfma_f32_16x16x32_bf16 v[92:95], v[48:51], a[88:91], v[92:95]
 v_mfma_f32_16x16x32_bf16 v[92:95], v[52:55], a[92:95], v[92:95]
 s_nop 7
 v_sub_f32 v88, v88, v105
 v_sub_f32 v89, v89, v105
 v_sub_f32 v90, v90, v105
 v_sub_f32 v91, v91, v105
 v_sub_f32 v92, v92, v105
 v_sub_f32 v93, v93, v105
 v_sub_f32 v94, v94, v105
 v_sub_f32 v95, v95, v105
 v_exp_f32 v88, v88
 v_exp_f32 v89, v89
 v_exp_f32 v90, v90
 v_exp_f32 v91, v91
 v_exp_f32 v92, v92
 v_exp_f32 v93, v93
 v_exp_f32 v94, v94
 v_exp_f32 v95, v95
 s_nop 0
 v_add_f32 v9, v88, v9
 v_add_f32 v9, v89, v9
 v_add_f32 v9, v90, v9
 v_add_f32 v9, v91, v9
 v_add_f32 v9, v92, v9
 v_add_f32 v9, v93, v9
 v_add_f32 v9, v94, v9
 v_add_f32 v9, v95, v9
 v_cvt_pk_bf16_f32 v96, v88, v89
 v_cvt_pk_bf16_f32 v97, v90, v91
 v_cvt_pk_bf16_f32 v98, v92, v93
 v_cvt_pk_bf16_f32 v99, v94, v95
 s_nop 1
 v_mfma_f32_16x16x32_bf16 a[192:195], v[96:99], v[56:59], a[192:195]
 v_mfma_f32_16x16x32_bf16 a[196:199], v[96:99], v[60:63], a[196:199]
 v_mfma_f32_16x16x32_bf16 a[200:203], v[96:99], v[64:67], a[200:203]
 v_mfma_f32_16x16x32_bf16 a[204:207], v[96:99], v[68:71], a[204:207]
 v_mfma_f32_16x16x32_bf16 a[208:211], v[96:99], v[72:75], a[208:211]
 v_mfma_f32_16x16x32_bf16 a[212:215], v[96:99], v[76:79], a[212:215]
 v_mfma_f32_16x16x32_bf16 a[216:219], v[96:99], v[80:83], a[216:219]
 v_mfma_f32_16x16x32_bf16 a[220:223], v[96:99], v[84:87], a[220:223]
 s_add_u32 s36, s36, 8192
 s_cmp_lt_u32 s36, 0x80000
 s_cbranch_scc1 L_fb_6
 s_nop 7
 v_mfma_f32_16x16x4_f32 v[48:51], v4, v20, 0
 s_nop 9
 v_rcp_f32 v48, v48
 v_rcp_f32 v49, v49
 v_rcp_f32 v50, v50
 v_rcp_f32 v51, v51
 s_mov_b32 s30, 0
 v_pk_mul_f32 v[136:137], v[136:137], v[48:49]
 v_pk_mul_f32 v[140:141], v[140:141], v[48:49]
 v_pk_mul_f32 v[144:145], v[144:145], v[48:49]
 v_pk_mul_f32 v[148:149], v[148:149], v[48:49]
 v_pk_mul_f32 v[152:153], v[152:153], v[48:49]
 v_pk_mul_f32 v[156:157], v[156:157], v[48:49]
 v_pk_mul_f32 v[160:161], v[160:161], v[48:49]
 v_pk_mul_f32 v[164:165], v[164:165], v[48:49]
 v_pk_mul_f32 v[138:139], v[138:139], v[50:51]
 v_pk_mul_f32 v[142:143], v[142:143], v[50:51]
 v_pk_mul_f32 v[146:147], v[146:147], v[50:51]
 v_pk_mul_f32 v[150:151], v[150:151], v[50:51]
 v_pk_mul_f32 v[154:155], v[154:155], v[50:51]
 v_pk_mul_f32 v[158:159], v[158:159], v[50:51]
 v_pk_mul_f32 v[162:163], v[162:163], v[50:51]
 v_pk_mul_f32 v[166:167], v[166:167], v[50:51]
 v_cvt_pk_bf16_f32 v40, v136, v140
 v_cvt_pk_bf16_f32 v41, v144, v148
 v_cvt_pk_bf16_f32 v42, v152, v156
 v_cvt_pk_bf16_f32 v43, v160, v164
 ds_write_b128 v16, v[40:43] offset:0
 ds_read_b64_tr_b16 v[24:25], v17 offset:0
 ds_read_b64_tr_b16 v[26:27], v17 offset:64
 v_cvt_pk_bf16_f32 v44, v137, v141
 v_cvt_pk_bf16_f32 v45, v145, v149
 v_cvt_pk_bf16_f32 v46, v153, v157
 v_cvt_pk_bf16_f32 v47, v161, v165
 ds_write_b128 v16, v[44:47] offset:272
 ds_read_b64_tr_b16 v[28:29], v17 offset:272
 ds_read_b64_tr_b16 v[30:31], v17 offset:336
 v_cvt_pk_bf16_f32 v40, v138, v142
 v_cvt_pk_bf16_f32 v41, v146, v150
 v_cvt_pk_bf16_f32 v42, v154, v158
 v_cvt_pk_bf16_f32 v43, v162, v166
 ds_write_b128 v16, v[40:43] offset:544
 ds_read_b64_tr_b16 v[32:33], v17 offset:544
 ds_read_b64_tr_b16 v[34:35], v17 offset:608
 v_cvt_pk_bf16_f32 v44, v139, v143
 v_cvt_pk_bf16_f32 v45, v147, v151
 v_cvt_pk_bf16_f32 v46, v155, v159
 v_cvt_pk_bf16_f32 v47, v163, v167
 ds_write_b128 v16, v[44:47] offset:816
 ds_read_b64_tr_b16 v[36:37], v17 offset:816
 ds_read_b64_tr_b16 v[38:39], v17 offset:880
 s_waitcnt lgkmcnt(9)
 buffer_store_dwordx4 v[24:27], v18, s[16:19], s30 offen offset:0 sc0 sc1
 s_waitcnt lgkmcnt(6)
 buffer_store_dwordx4 v[28:31], v18, s[16:19], s30 offen offset:256 sc0 sc1
 s_waitcnt lgkmcnt(3)
 buffer_store_dwordx4 v[32:35], v18, s[16:19], s30 offen offset:512 sc0 sc1
 s_waitcnt lgkmcnt(0)
 buffer_store_dwordx4 v[36:39], v18, s[16:19], s30 offen offset:768 sc0 sc1
 v_mfma_f32_16x16x4_f32 v[48:51], v5, v20, 0
 s_nop 9
 v_rcp_f32 v48, v48
 v_rcp_f32 v49, v49
 v_rcp_f32 v50, v50
 v_rcp_f32 v51, v51
 s_mov_b32 s30, 4096
 v_pk_mul_f32 v[168:169], v[168:169], v[48:49]
 v_pk_mul_f32 v[172:173], v[172:173], v[48:49]
 v_pk_mul_f32 v[176:177], v[176:177], v[48:49]
 v_pk_mul_f32 v[180:181], v[180:181], v[48:49]
 v_pk_mul_f32 v[184:185], v[184:185], v[48:49]
 v_pk_mul_f32 v[188:189], v[188:189], v[48:49]
 v_pk_mul_f32 v[192:193], v[192:193], v[48:49]
 v_pk_mul_f32 v[196:197], v[196:197], v[48:49]
 v_pk_mul_f32 v[170:171], v[170:171], v[50:51]
 v_pk_mul_f32 v[174:175], v[174:175], v[50:51]
 v_pk_mul_f32 v[178:179], v[178:179], v[50:51]
 v_pk_mul_f32 v[182:183], v[182:183], v[50:51]
 v_pk_mul_f32 v[186:187], v[186:187], v[50:51]
 v_pk_mul_f32 v[190:191], v[190:191], v[50:51]
 v_pk_mul_f32 v[194:195], v[194:195], v[50:51]
 v_pk_mul_f32 v[198:199], v[198:199], v[50:51]
 v_cvt_pk_bf16_f32 v40, v168, v172
 v_cvt_pk_bf16_f32 v41, v176, v180
 v_cvt_pk_bf16_f32 v42, v184, v188
 v_cvt_pk_bf16_f32 v43, v192, v196
 ds_write_b128 v16, v[40:43] offset:0
 ds_read_b64_tr_b16 v[24:25], v17 offset:0
 ds_read_b64_tr_b16 v[26:27], v17 offset:64
 v_cvt_pk_bf16_f32 v44, v169, v173
 v_cvt_pk_bf16_f32 v45, v177, v181
 v_cvt_pk_bf16_f32 v46, v185, v189
 v_cvt_pk_bf16_f32 v47, v193, v197
 ds_write_b128 v16, v[44:47] offset:272
 ds_read_b64_tr_b16 v[28:29], v17 offset:272
 ds_read_b64_tr_b16 v[30:31], v17 offset:336
 v_cvt_pk_bf16_f32 v40, v170, v174
 v_cvt_pk_bf16_f32 v41, v178, v182
 v_cvt_pk_bf16_f32 v42, v186, v190
 v_cvt_pk_bf16_f32 v43, v194, v198
 ds_write_b128 v16, v[40:43] offset:544
 ds_read_b64_tr_b16 v[32:33], v17 offset:544
 ds_read_b64_tr_b16 v[34:35], v17 offset:608
 v_cvt_pk_bf16_f32 v44, v171, v175
 v_cvt_pk_bf16_f32 v45, v179, v183
 v_cvt_pk_bf16_f32 v46, v187, v191
 v_cvt_pk_bf16_f32 v47, v195, v199
 ds_write_b128 v16, v[44:47] offset:816
 ds_read_b64_tr_b16 v[36:37], v17 offset:816
 ds_read_b64_tr_b16 v[38:39], v17 offset:880
 s_waitcnt lgkmcnt(9)
 buffer_store_dwordx4 v[24:27], v18, s[16:19], s30 offen offset:0 sc0 sc1
 s_waitcnt lgkmcnt(6)
 buffer_store_dwordx4 v[28:31], v18, s[16:19], s30 offen offset:256 sc0 sc1
 s_waitcnt lgkmcnt(3)
 buffer_store_dwordx4 v[32:35], v18, s[16:19], s30 offen offset:512 sc0 sc1
 s_waitcnt lgkmcnt(0)
 buffer_store_dwordx4 v[36:39], v18, s[16:19], s30 offen offset:768 sc0 sc1
 v_mfma_f32_16x16x4_f32 v[48:51], v6, v20, 0
 s_nop 9
 v_rcp_f32 v48, v48
 v_rcp_f32 v49, v49
 v_rcp_f32 v50, v50
 v_rcp_f32 v51, v51
 s_mov_b32 s30, 8192
 v_pk_mul_f32 v[200:201], v[200:201], v[48:49]
 v_pk_mul_f32 v[204:205], v[204:205], v[48:49]
 v_pk_mul_f32 v[208:209], v[208:209], v[48:49]
 v_pk_mul_f32 v[212:213], v[212:213], v[48:49]
 v_pk_mul_f32 v[216:217], v[216:217], v[48:49]
 v_pk_mul_f32 v[220:221], v[220:221], v[48:49]
 v_pk_mul_f32 v[224:225], v[224:225], v[48:49]
 v_pk_mul_f32 v[228:229], v[228:229], v[48:49]
 v_pk_mul_f32 v[202:203], v[202:203], v[50:51]
 v_pk_mul_f32 v[206:207], v[206:207], v[50:51]
 v_pk_mul_f32 v[210:211], v[210:211], v[50:51]
 v_pk_mul_f32 v[214:215], v[214:215], v[50:51]
 v_pk_mul_f32 v[218:219], v[218:219], v[50:51]
 v_pk_mul_f32 v[222:223], v[222:223], v[50:51]
 v_pk_mul_f32 v[226:227], v[226:227], v[50:51]
 v_pk_mul_f32 v[230:231], v[230:231], v[50:51]
 v_cvt_pk_bf16_f32 v40, v200, v204
 v_cvt_pk_bf16_f32 v41, v208, v212
 v_cvt_pk_bf16_f32 v42, v216, v220
 v_cvt_pk_bf16_f32 v43, v224, v228
 ds_write_b128 v16, v[40:43] offset:0
 ds_read_b64_tr_b16 v[24:25], v17 offset:0
 ds_read_b64_tr_b16 v[26:27], v17 offset:64
 v_cvt_pk_bf16_f32 v44, v201, v205
 v_cvt_pk_bf16_f32 v45, v209, v213
 v_cvt_pk_bf16_f32 v46, v217, v221
 v_cvt_pk_bf16_f32 v47, v225, v229
 ds_write_b128 v16, v[44:47] offset:272
 ds_read_b64_tr_b16 v[28:29], v17 offset:272
 ds_read_b64_tr_b16 v[30:31], v17 offset:336
 v_cvt_pk_bf16_f32 v40, v202, v206
 v_cvt_pk_bf16_f32 v41, v210, v214
 v_cvt_pk_bf16_f32 v42, v218, v222
 v_cvt_pk_bf16_f32 v43, v226, v230
 ds_write_b128 v16, v[40:43] offset:544
 ds_read_b64_tr_b16 v[32:33], v17 offset:544
 ds_read_b64_tr_b16 v[34:35], v17 offset:608
 v_cvt_pk_bf16_f32 v44, v203, v207
 v_cvt_pk_bf16_f32 v45, v211, v215
 v_cvt_pk_bf16_f32 v46, v219, v223
 v_cvt_pk_bf16_f32 v47, v227, v231
 ds_write_b128 v16, v[44:47] offset:816
 ds_read_b64_tr_b16 v[36:37], v17 offset:816
 ds_read_b64_tr_b16 v[38:39], v17 offset:880
 s_waitcnt lgkmcnt(9)
 buffer_store_dwordx4 v[24:27], v18, s[16:19], s30 offen offset:0 sc0 sc1
 s_waitcnt lgkmcnt(6)
 buffer_store_dwordx4 v[28:31], v18, s[16:19], s30 offen offset:256 sc0 sc1
 s_waitcnt lgkmcnt(3)
 buffer_store_dwordx4 v[32:35], v18, s[16:19], s30 offen offset:512 sc0 sc1
 s_waitcnt lgkmcnt(0)
 buffer_store_dwordx4 v[36:39], v18, s[16:19], s30 offen offset:768 sc0 sc1
 v_mfma_f32_16x16x4_f32 v[48:51], v7, v20, 0
 s_nop 9
 v_rcp_f32 v48, v48
 v_rcp_f32 v49, v49
 v_rcp_f32 v50, v50
 v_rcp_f32 v51, v51
 v_accvgpr_read_b32 v224, a152
 v_accvgpr_read_b32 v225, a153
 v_accvgpr_read_b32 v226, a154
 v_accvgpr_read_b32 v227, a155
 v_accvgpr_read_b32 v228, a156
 v_accvgpr_read_b32 v229, a157
 v_accvgpr_read_b32 v230, a158
 v_accvgpr_read_b32 v231, a159
 s_mov_b32 s30, 12288
 v_pk_mul_f32 v[232:233], v[232:233], v[48:49]
 v_pk_mul_f32 v[236:237], v[236:237], v[48:49]
 v_pk_mul_f32 v[240:241], v[240:241], v[48:49]
 v_pk_mul_f32 v[244:245], v[244:245], v[48:49]
 v_pk_mul_f32 v[248:249], v[248:249], v[48:49]
 v_pk_mul_f32 v[252:253], v[252:253], v[48:49]
 v_pk_mul_f32 v[224:225], v[224:225], v[48:49]
 v_pk_mul_f32 v[228:229], v[228:229], v[48:49]
 v_pk_mul_f32 v[234:235], v[234:235], v[50:51]
 v_pk_mul_f32 v[238:239], v[238:239], v[50:51]
 v_pk_mul_f32 v[242:243], v[242:243], v[50:51]
 v_pk_mul_f32 v[246:247], v[246:247], v[50:51]
 v_pk_mul_f32 v[250:251], v[250:251], v[50:51]
 v_pk_mul_f32 v[254:255], v[254:255], v[50:51]
 v_pk_mul_f32 v[226:227], v[226:227], v[50:51]
 v_pk_mul_f32 v[230:231], v[230:231], v[50:51]
 v_cvt_pk_bf16_f32 v40, v232, v236
 v_cvt_pk_bf16_f32 v41, v240, v244
 v_cvt_pk_bf16_f32 v42, v248, v252
 v_cvt_pk_bf16_f32 v43, v224, v228
 ds_write_b128 v16, v[40:43] offset:0
 ds_read_b64_tr_b16 v[24:25], v17 offset:0
 ds_read_b64_tr_b16 v[26:27], v17 offset:64
 v_cvt_pk_bf16_f32 v44, v233, v237
 v_cvt_pk_bf16_f32 v45, v241, v245
 v_cvt_pk_bf16_f32 v46, v249, v253
 v_cvt_pk_bf16_f32 v47, v225, v229
 ds_write_b128 v16, v[44:47] offset:272
 ds_read_b64_tr_b16 v[28:29], v17 offset:272
 ds_read_b64_tr_b16 v[30:31], v17 offset:336
 v_cvt_pk_bf16_f32 v40, v234, v238
 v_cvt_pk_bf16_f32 v41, v242, v246
 v_cvt_pk_bf16_f32 v42, v250, v254
 v_cvt_pk_bf16_f32 v43, v226, v230
 ds_write_b128 v16, v[40:43] offset:544
 ds_read_b64_tr_b16 v[32:33], v17 offset:544
 ds_read_b64_tr_b16 v[34:35], v17 offset:608
 v_cvt_pk_bf16_f32 v44, v235, v239
 v_cvt_pk_bf16_f32 v45, v243, v247
 v_cvt_pk_bf16_f32 v46, v251, v255
 v_cvt_pk_bf16_f32 v47, v227, v231
 ds_write_b128 v16, v[44:47] offset:816
 ds_read_b64_tr_b16 v[36:37], v17 offset:816
 ds_read_b64_tr_b16 v[38:39], v17 offset:880
 s_waitcnt lgkmcnt(9)
 buffer_store_dwordx4 v[24:27], v18, s[16:19], s30 offen offset:0 sc0 sc1
 s_waitcnt lgkmcnt(6)
 buffer_store_dwordx4 v[28:31], v18, s[16:19], s30 offen offset:256 sc0 sc1
 s_waitcnt lgkmcnt(3)
 buffer_store_dwordx4 v[32:35], v18, s[16:19], s30 offen offset:512 sc0 sc1
 s_waitcnt lgkmcnt(0)
 buffer_store_dwordx4 v[36:39], v18, s[16:19], s30 offen offset:768 sc0 sc1
 v_mfma_f32_16x16x4_f32 v[48:51], v8, v20, 0
 s_nop 9
 v_rcp_f32 v48, v48
 v_rcp_f32 v49, v49
 v_rcp_f32 v50, v50
 v_rcp_f32 v51, v51
 v_accvgpr_read_b32 v200, a160
 v_accvgpr_read_b32 v201, a161
 v_accvgpr_read_b32 v202, a162
 v_accvgpr_read_b32 v203, a163
 v_accvgpr_read_b32 v204, a164
 v_accvgpr_read_b32 v205, a165
 v_accvgpr_read_b32 v206, a166
 v_accvgpr_read_b32 v207, a167
 v_accvgpr_read_b32 v208, a168
 v_accvgpr_read_b32 v209, a169
 v_accvgpr_read_b32 v210, a170
 v_accvgpr_read_b32 v211, a171
 v_accvgpr_read_b32 v212, a172
 v_accvgpr_read_b32 v213, a173
 v_accvgpr_read_b32 v214, a174
 v_accvgpr_read_b32 v215, a175
 v_accvgpr_read_b32 v216, a176
 v_accvgpr_read_b32 v217, a177
 v_accvgpr_read_b32 v218, a178
 v_accvgpr_read_b32 v219, a179
 v_accvgpr_read_b32 v220, a180
 v_accvgpr_read_b32 v221, a181
 v_accvgpr_read_b32 v222, a182
 v_accvgpr_read_b32 v223, a183
 v_accvgpr_read_b32 v224, a184
 v_accvgpr_read_b32 v225, a185
 v_accvgpr_read_b32 v226, a186
 v_accvgpr_read_b32 v227, a187
 v_accvgpr_read_b32 v228, a188
 v_accvgpr_read_b32 v229, a189
 v_accvgpr_read_b32 v230, a190
 v_accvgpr_read_b32 v231, a191
 s_mov_b32 s30, 16384
 v_pk_mul_f32 v[200:201], v[200:201], v[48:49]
 v_pk_mul_f32 v[204:205], v[204:205], v[48:49]
 v_pk_mul_f32 v[208:209], v[208:209], v[48:49]
 v_pk_mul_f32 v[212:213], v[212:213], v[48:49]
 v_pk_mul_f32 v[216:217], v[216:217], v[48:49]
 v_pk_mul_f32 v[220:221], v[220:221], v[48:49]
 v_pk_mul_f32 v[224:225], v[224:225], v[48:49]
 v_pk_mul_f32 v[228:229], v[228:229], v[48:49]
 v_pk_mul_f32 v[202:203], v[202:203], v[50:51]
 v_pk_mul_f32 v[206:207], v[206:207], v[50:51]
 v_pk_mul_f32 v[210:211], v[210:211], v[50:51]
 v_pk_mul_f32 v[214:215], v[214:215], v[50:51]
 v_pk_mul_f32 v[218:219], v[218:219], v[50:51]
 v_pk_mul_f32 v[222:223], v[222:223], v[50:51]
 v_pk_mul_f32 v[226:227], v[226:227], v[50:51]
 v_pk_mul_f32 v[230:231], v[230:231], v[50:51]
 v_cvt_pk_bf16_f32 v40, v200, v204
 v_cvt_pk_bf16_f32 v41, v208, v212
 v_cvt_pk_bf16_f32 v42, v216, v220
 v_cvt_pk_bf16_f32 v43, v224, v228
 ds_write_b128 v16, v[40:43] offset:0
 ds_read_b64_tr_b16 v[24:25], v17 offset:0
 ds_read_b64_tr_b16 v[26:27], v17 offset:64
 v_cvt_pk_bf16_f32 v44, v201, v205
 v_cvt_pk_bf16_f32 v45, v209, v213
 v_cvt_pk_bf16_f32 v46, v217, v221
 v_cvt_pk_bf16_f32 v47, v225, v229
 ds_write_b128 v16, v[44:47] offset:272
 ds_read_b64_tr_b16 v[28:29], v17 offset:272
 ds_read_b64_tr_b16 v[30:31], v17 offset:336
 v_cvt_pk_bf16_f32 v40, v202, v206
 v_cvt_pk_bf16_f32 v41, v210, v214
 v_cvt_pk_bf16_f32 v42, v218, v222
 v_cvt_pk_bf16_f32 v43, v226, v230
 ds_write_b128 v16, v[40:43] offset:544
 ds_read_b64_tr_b16 v[32:33], v17 offset:544
 ds_read_b64_tr_b16 v[34:35], v17 offset:608
 v_cvt_pk_bf16_f32 v44, v203, v207
 v_cvt_pk_bf16_f32 v45, v211, v215
 v_cvt_pk_bf16_f32 v46, v219, v223
 v_cvt_pk_bf16_f32 v47, v227, v231
 ds_write_b128 v16, v[44:47] offset:816
 ds_read_b64_tr_b16 v[36:37], v17 offset:816
 ds_read_b64_tr_b16 v[38:39], v17 offset:880
 s_waitcnt lgkmcnt(9)
 buffer_store_dwordx4 v[24:27], v18, s[16:19], s30 offen offset:0 sc0 sc1
 s_waitcnt lgkmcnt(6)
 buffer_store_dwordx4 v[28:31], v18, s[16:19], s30 offen offset:256 sc0 sc1
 s_waitcnt lgkmcnt(3)
 buffer_store_dwordx4 v[32:35], v18, s[16:19], s30 offen offset:512 sc0 sc1
 s_waitcnt lgkmcnt(0)
 buffer_store_dwordx4 v[36:39], v18, s[16:19], s30 offen offset:768 sc0 sc1
 v_mfma_f32_16x16x4_f32 v[48:51], v9, v20, 0
 s_nop 9
 v_rcp_f32 v48, v48
 v_rcp_f32 v49, v49
 v_rcp_f32 v50, v50
 v_rcp_f32 v51, v51
 v_accvgpr_read_b32 v200, a192
 v_accvgpr_read_b32 v201, a193
 v_accvgpr_read_b32 v202, a194
 v_accvgpr_read_b32 v203, a195
 v_accvgpr_read_b32 v204, a196
 v_accvgpr_read_b32 v205, a197
 v_accvgpr_read_b32 v206, a198
 v_accvgpr_read_b32 v207, a199
 v_accvgpr_read_b32 v208, a200
 v_accvgpr_read_b32 v209, a201
 v_accvgpr_read_b32 v210, a202
 v_accvgpr_read_b32 v211, a203
 v_accvgpr_read_b32 v212, a204
 v_accvgpr_read_b32 v213, a205
 v_accvgpr_read_b32 v214, a206
 v_accvgpr_read_b32 v215, a207
 v_accvgpr_read_b32 v216, a208
 v_accvgpr_read_b32 v217, a209
 v_accvgpr_read_b32 v218, a210
 v_accvgpr_read_b32 v219, a211
 v_accvgpr_read_b32 v220, a212
 v_accvgpr_read_b32 v221, a213
 v_accvgpr_read_b32 v222, a214
 v_accvgpr_read_b32 v223, a215
 v_accvgpr_read_b32 v224, a216
 v_accvgpr_read_b32 v225, a217
 v_accvgpr_read_b32 v226, a218
 v_accvgpr_read_b32 v227, a219
 v_accvgpr_read_b32 v228, a220
 v_accvgpr_read_b32 v229, a221
 v_accvgpr_read_b32 v230, a222
 v_accvgpr_read_b32 v231, a223
 s_mov_b32 s30, 20480
 v_pk_mul_f32 v[200:201], v[200:201], v[48:49]
 v_pk_mul_f32 v[204:205], v[204:205], v[48:49]
 v_pk_mul_f32 v[208:209], v[208:209], v[48:49]
 v_pk_mul_f32 v[212:213], v[212:213], v[48:49]
 v_pk_mul_f32 v[216:217], v[216:217], v[48:49]
 v_pk_mul_f32 v[220:221], v[220:221], v[48:49]
 v_pk_mul_f32 v[224:225], v[224:225], v[48:49]
 v_pk_mul_f32 v[228:229], v[228:229], v[48:49]
 v_pk_mul_f32 v[202:203], v[202:203], v[50:51]
 v_pk_mul_f32 v[206:207], v[206:207], v[50:51]
 v_pk_mul_f32 v[210:211], v[210:211], v[50:51]
 v_pk_mul_f32 v[214:215], v[214:215], v[50:51]
 v_pk_mul_f32 v[218:219], v[218:219], v[50:51]
 v_pk_mul_f32 v[222:223], v[222:223], v[50:51]
 v_pk_mul_f32 v[226:227], v[226:227], v[50:51]
 v_pk_mul_f32 v[230:231], v[230:231], v[50:51]
 v_cvt_pk_bf16_f32 v40, v200, v204
 v_cvt_pk_bf16_f32 v41, v208, v212
 v_cvt_pk_bf16_f32 v42, v216, v220
 v_cvt_pk_bf16_f32 v43, v224, v228
 ds_write_b128 v16, v[40:43] offset:0
 ds_read_b64_tr_b16 v[24:25], v17 offset:0
 ds_read_b64_tr_b16 v[26:27], v17 offset:64
 v_cvt_pk_bf16_f32 v44, v201, v205
 v_cvt_pk_bf16_f32 v45, v209, v213
 v_cvt_pk_bf16_f32 v46, v217, v221
 v_cvt_pk_bf16_f32 v47, v225, v229
 ds_write_b128 v16, v[44:47] offset:272
 ds_read_b64_tr_b16 v[28:29], v17 offset:272
 ds_read_b64_tr_b16 v[30:31], v17 offset:336
 v_cvt_pk_bf16_f32 v40, v202, v206
 v_cvt_pk_bf16_f32 v41, v210, v214
 v_cvt_pk_bf16_f32 v42, v218, v222
 v_cvt_pk_bf16_f32 v43, v226, v230
 ds_write_b128 v16, v[40:43] offset:544
 ds_read_b64_tr_b16 v[32:33], v17 offset:544
 ds_read_b64_tr_b16 v[34:35], v17 offset:608
 v_cvt_pk_bf16_f32 v44, v203, v207
 v_cvt_pk_bf16_f32 v45, v211, v215
 v_cvt_pk_bf16_f32 v46, v219, v223
 v_cvt_pk_bf16_f32 v47, v227, v231
 ds_write_b128 v16, v[44:47] offset:816
 ds_read_b64_tr_b16 v[36:37], v17 offset:816
 ds_read_b64_tr_b16 v[38:39], v17 offset:880
 s_waitcnt lgkmcnt(9)
 buffer_store_dwordx4 v[24:27], v18, s[16:19], s30 offen offset:0 sc0 sc1
 s_waitcnt lgkmcnt(6)
 buffer_store_dwordx4 v[28:31], v18, s[16:19], s30 offen offset:256 sc0 sc1
 s_waitcnt lgkmcnt(3)
 buffer_store_dwordx4 v[32:35], v18, s[16:19], s30 offen offset:512 sc0 sc1
 s_waitcnt lgkmcnt(0)
 buffer_store_dwordx4 v[36:39], v18, s[16:19], s30 offen offset:768 sc0 sc1
 s_endpgm
.section .rodata,"a"
.p2align 6
.amdhsa_kernel standalone__mha_softmax__near_ridge_kernel
  .amdhsa_next_free_vgpr 512
  .amdhsa_next_free_sgpr 96
  .amdhsa_accum_offset 256
  .amdhsa_group_segment_fixed_size 0
  .amdhsa_kernarg_size 48
  .amdhsa_user_sgpr_count 2
  .amdhsa_user_sgpr_kernarg_segment_ptr 1
  .amdhsa_system_sgpr_workgroup_id_x 1
  .amdhsa_float_denorm_mode_32 3
.end_amdhsa_kernel
```
